```python
import torch

def _softmax(x, axis=-1):
    return torch.softmax(x, dim=axis)

def _gelu(x):
    return torch.nn.functional.gelu(x, approximate='tanh')

def _silu(x):
    return torch.nn.functional.silu(x)

def _sigmoid(x):
    return torch.sigmoid(x)

def _layernorm(x, axis=-1, eps=1e-05):
    m = x.mean(dim=axis, keepdim=True)
    v = x.var(dim=axis, keepdim=True, unbiased=False)
    return (x - m) / torch.sqrt(v + eps)

def _scatter_add(tgt, idx, src, axis=0):
    return tgt.clone().index_add_(axis, idx, src)

def _segment_sum(src, seg, n):
    out = torch.zeros((n,) + src.shape[1:], dtype=src.dtype)
    return out.index_add_(0, seg, src)

def _pad(x, pw):
    flat = tuple((v for pair in reversed(pw) for v in pair))
    return torch.nn.functional.pad(x, flat)
kernel_name = 'gather_scatter__tensor_product_equiv_tfn__graph'

def setup_inputs():

    _w = lambda a: (lambda t: t.to(torch.bfloat16) if t.is_floating_point() else t)(torch.as_tensor(a))
    N, deg, C, L, DE = (10000, 32, 128, 1, 4)
    E = N * deg
    M = (L + 1) ** 2
    src = (lambda lo, hi, *s: torch.randint(lo, hi, s))(0, N, E).to(torch.int64)
    dst = (lambda lo, hi, *s: torch.randint(lo, hi, s))(0, N, E).to(torch.int64)
    r = (lambda *s: torch.randn(*s, dtype=torch.bfloat16) * 0.05)(E, 3)
    r = r / (torch.linalg.norm(r, dim=-1, keepdim=True) + 1e-09)
    rx, ry, rz = (r[:, 0].clone(), r[:, 1].clone(), r[:, 2].clone())
    Ys = [torch.ones((E, 1), dtype=float)]
    if L >= 1:
        Ys.append(r.to(float))
    if L >= 2:
        Ys.append(torch.stack([2 * rx * ry, 2 * ry * rz, (3 * rz * rz - 1.0) / (lambda _x: torch.sqrt(torch.as_tensor(_x)))(3.0), 2 * rx * rz, rx * rx - ry * ry], dim=-1).to(float))
    for _l in range(3, L + 1):
        Ys.append(((lambda *s: torch.randn(*s, dtype=torch.bfloat16) * 0.05)(E, 2 * _l + 1) * 0.3).to(float))
    Y = torch.cat(Ys, dim=-1)
    cg = torch.zeros((M, M, M), dtype=float)
    off = [_l * _l for _l in range(L + 2)]
    for l1 in range(L + 1):
        for l2 in range(L + 1):
            for l3 in range(abs(l1 - l2), min(L, l1 + l2) + 1):
                d1, d2, d3 = (2 * l1 + 1, 2 * l2 + 1, 2 * l3 + 1)
                cg[off[l1]:off[l1 + 1], off[l2]:off[l2 + 1], off[l3]:off[l3 + 1]] = (lambda *s: torch.randn(*s, dtype=torch.bfloat16) * 0.05)(d1, d2, d3) / (lambda _x: torch.sqrt(torch.as_tensor(_x)))(float(d1 * d2))
    return {'x': _w((lambda *s: torch.randn(*s, dtype=torch.bfloat16) * 0.05)(N, C, M) * 0.2), 'src': _w(src), 'dst': _w(dst), 'Y': _w(Y), 'edge_feat': _w((lambda *s: torch.randn(*s, dtype=torch.bfloat16) * 0.05)(E, DE)), 'w_rad': _w((lambda *s: torch.randn(*s, dtype=torch.bfloat16) * 0.05)(DE, C) * (1.0 / max(1.0, DE) ** 0.5)), 'cg': _w(cg), 'w_mix': _w((lambda *s: torch.randn(*s, dtype=torch.bfloat16) * 0.05)(C, C) * (1.0 / max(1.0, C) ** 0.5))}

def reference(x, src, dst, Y, edge_feat, w_rad, cg, w_mix):
    N, C, M = (x.shape[0], x.shape[1], x.shape[2])
    R = _silu(edge_feat @ w_rad)
    xs = x[src]
    tp = torch.einsum('eci,ef,ifo->eco', xs, Y, cg)
    msg = R[:, :, None] * tp
    agg = _segment_sum(msg.reshape(-1, C * M), dst, N).reshape(N, C, M)
    return torch.einsum('ncm,cd->ndm', agg, w_mix)
```

```asm
; @launch kernel=part_kernel grid=(256,1,1) block=(704,1,1) lds=27200
; @launch kernel=main_kernel grid=(256,1,1) block=(512,1,1) lds=144128
.amdgcn_target "amdgcn-amd-amdhsa--gfx950"
.text
.globl part_kernel
.p2align 8
.type part_kernel,@function
part_kernel:
    s_cmp_ge_u32 s2, 256
    s_cbranch_scc1 K1_END
    s_load_dwordx16 s[4:19], s[0:1], 0
    s_load_dwordx2 s[20:21], s[0:1], 80
    v_lshrrev_b32 v1, 6, v0
    v_lshlrev_b32 v2, 2, v0
    v_mov_b32 v3, 0
    v_readfirstlane_b32 s3, v1
    v_cmp_gt_u32 vcc, 256, v0
    s_and_saveexec_b64 s[22:23], vcc
    ds_write_b32 v2, v3 offset:0
    s_mov_b64 exec, s[22:23]
    s_and_b32 s24, s2, 7
    s_lshl_b32 s24, s24, 5
    s_lshr_b32 s25, s2, 3
    s_add_u32 s24, s24, s25
    s_cmp_eq_u32 s3, 10
    s_cbranch_scc1 K1_SIDE
    s_mul_i32 s25, s2, 5000
    v_lshlrev_b32 v4, 3, v0
    v_add_u32 v4, s25, v4
    v_lshlrev_b32 v5, 1, v4
    v_cmp_gt_u32 vcc, 625, v0
    s_and_b64 s[26:27], vcc, exec
    s_mov_b64 exec, s[26:27]
    s_waitcnt lgkmcnt(0)
    global_load_dwordx2 v[6:7], v4, s[8:9]
    global_load_dwordx2 v[8:9], v4, s[6:7]
    global_load_dwordx4 v[12:15], v5, s[10:11]
    global_load_dwordx4 v[16:19], v5, s[12:13]
    v_mov_b32 v20, 1
    s_barrier
    s_waitcnt vmcnt(3)
    v_mul_u32_u24 v22, 214749, v6
    v_mul_u32_u24 v23, 214749, v7
    v_lshrrev_b32 v22, 23, v22
    v_lshrrev_b32 v23, 23, v23
    v_lshlrev_b32 v24, 2, v22
    ds_add_rtn_u32 v26, v24, v20 offset:0
    v_lshlrev_b32 v25, 2, v23
    ds_add_rtn_u32 v27, v25, v20 offset:0
    v_mul_u32_u24 v28, 625, v22
    v_add_u32 v28, 15, v28
    v_lshrrev_b32 v28, 4, v28
    v_sub_u32 v28, v6, v28
    v_mul_u32_u24 v30, 52, v28
    v_lshrrev_b32 v30, 8, v30
    v_mul_u32_u24 v32, 5, v30
    v_sub_u32 v32, v28, v32
    v_lshlrev_b32 v30, 4, v30
    v_lshl_or_b32 v30, v32, 7, v30
    v_mul_u32_u24 v29, 625, v23
    v_add_u32 v29, 15, v29
    v_lshrrev_b32 v29, 4, v29
    v_sub_u32 v29, v7, v29
    v_mul_u32_u24 v31, 52, v29
    v_lshrrev_b32 v31, 8, v31
    v_mul_u32_u24 v33, 5, v31
    v_sub_u32 v33, v29, v33
    v_lshlrev_b32 v31, 4, v31
    v_lshl_or_b32 v31, v33, 7, v31
    s_waitcnt vmcnt(2)
    v_mul_u32_u24 v32, 1677, v8
    v_lshrrev_b32 v32, 20, v32
    v_lshl_or_b32 v30, v8, 10, v30
    v_or_b32 v30, v30, v32
    v_mul_u32_u24 v33, 1677, v9
    v_lshrrev_b32 v33, 20, v33
    v_lshl_or_b32 v31, v9, 10, v31
    v_or_b32 v31, v31, v33
    s_mov_b64 exec, -1
    v_and_b32 v1, 63, v0
    v_lshlrev_b32 v2, 4, v1
    s_waitcnt lgkmcnt(0)
    s_barrier
    ds_read_b128 v[36:39], v2 offset:0
    s_waitcnt lgkmcnt(0)
    v_add_u32 v41, v36, v37
    v_add_u32 v42, v41, v38
    v_add_u32 v43, v42, v39
    v_mov_b32 v44, v43
    s_nop 1
    v_add_u32_dpp v44, v44, v44 row_shr:1 row_mask:0xf bank_mask:0xf
    s_nop 1
    v_add_u32_dpp v44, v44, v44 row_shr:2 row_mask:0xf bank_mask:0xf
    s_nop 1
    v_add_u32_dpp v44, v44, v44 row_shr:4 row_mask:0xf bank_mask:0xf
    s_nop 1
    v_add_u32_dpp v44, v44, v44 row_shr:8 row_mask:0xf bank_mask:0xf
    s_nop 1
    v_add_u32_dpp v44, v44, v44 row_bcast:15 row_mask:0xa bank_mask:0xf
    s_nop 1
    v_add_u32_dpp v44, v44, v44 row_bcast:31 row_mask:0xc bank_mask:0xf
    v_sub_u32 v44, v44, v43
    v_add_u32 v45, v44, v36
    v_add_u32 v46, v44, v41
    v_add_u32 v47, v44, v42
    ds_write_b128 v2, v[44:47] offset:1024
    s_mov_b64 exec, s[26:27]
    ds_read_b32 v34, v24 offset:1024
    ds_read_b32 v35, v25 offset:1024
    s_mov_b64 exec, -1
    s_cmp_ge_u32 s3, 4
    s_cbranch_scc1 K1_NOTAB
    s_set_gpr_idx_on s3, gpr_idx(SRC0)
    v_mov_b32 v40, v44
    v_mov_b32 v41, v36
    s_set_gpr_idx_off
    v_lshl_or_b32 v40, v41, 16, v40
    s_lshl_b32 s28, s3, 10
    s_lshl_b32 s29, s24, 2
    s_add_u32 s28, s28, s29
    v_lshlrev_b32 v41, 12, v1
    v_add_u32 v41, s28, v41
    global_store_dword v41, v40, s[20:21]
K1_NOTAB:
    s_mov_b64 exec, s[26:27]
    s_waitcnt lgkmcnt(0)
    v_add_u32 v34, v34, v26
    v_lshlrev_b32 v26, 2, v34
    ds_write_b32 v26, v30 offset:2048
    v_lshlrev_b32 v34, 4, v34
    v_add_u32 v34, 7168, v34
    v_add_u32 v35, v35, v27
    v_lshlrev_b32 v27, 2, v35
    ds_write_b32 v27, v31 offset:2048
    v_lshlrev_b32 v35, 4, v35
    v_add_u32 v35, 7168, v35
    s_waitcnt vmcnt(1)
    s_cmp_ge_u32 s3, 4
    s_cbranch_scc0 K1_W1
    s_waitcnt vmcnt(0)
K1_W1:
    ds_write2_b64 v34, v[12:13], v[16:17] offset0:0 offset1:1
    ds_write2_b64 v35, v[14:15], v[18:19] offset0:0 offset1:1
    v_lshlrev_b32 v4, 3, v0
    v_lshlrev_b32 v5, 4, v0
    s_mul_i32 s28, s24, 5000
    s_mul_i32 s29, s24, 20000
    s_add_u32 s28, s28, 262144
    s_add_u32 s29, s29, 1572864
    v_add_u32 v6, s28, v4
    v_add_u32 v7, s29, v5
    v_add_u32 v10, 10000, v7
    s_waitcnt lgkmcnt(0)
    s_barrier
    ds_read_b128 v[12:15], v5 offset:7168
    ds_read_b128 v[16:19], v5 offset:17168
    ds_read_b64 v[8:9], v4 offset:2048
    s_waitcnt lgkmcnt(2)
    global_store_dwordx4 v7, v[12:15], s[20:21]
    s_waitcnt lgkmcnt(1)
    global_store_dwordx4 v10, v[16:19], s[20:21]
    s_waitcnt lgkmcnt(0)
    global_store_dwordx2 v6, v[8:9], s[20:21]
    s_endpgm
K1_SIDE:
    v_and_b32 v1, 63, v0
    s_waitcnt lgkmcnt(0)
    s_cmp_lt_u32 s2, 32
    s_cbranch_scc1 K1_WM
    s_cmp_eq_u32 s2, 32
    s_cbranch_scc1 K1_WR
    s_cmp_eq_u32 s2, 33
    s_cbranch_scc1 K1_CG
    s_mul_i32 s30, s2, 40000
    v_mul_u32_u24 v30, 128, v1
    v_add_u32 v30, s30, v30
    s_mov_b32 s36, s4
    s_mov_b32 s37, s5
    s_mov_b32 s38, 10240000
    s_mov_b32 s39, 0x20000
    s_mov_b32 s31, 0
    buffer_load_dword v31, v30, s[36:39], s31 offen
    s_mov_b32 s31, 8192
    buffer_load_dword v31, v30, s[36:39], s31 offen
    s_mov_b32 s31, 16384
    buffer_load_dword v31, v30, s[36:39], s31 offen
    s_mov_b32 s31, 24576
    buffer_load_dword v31, v30, s[36:39], s31 offen
    s_mov_b32 s31, 32768
    buffer_load_dword v31, v30, s[36:39], s31 offen
    s_barrier
    s_barrier
    s_barrier
    s_endpgm
K1_WM:
    s_lshr_b32 s28, s2, 3
    s_lshl_b32 s28, s28, 6
    s_bfe_u32 s29, s2, 0x10002
    s_lshl_b32 s29, s29, 1
    s_add_u32 s28, s28, s29
    s_and_b32 s29, s2, 3
    s_lshl_b32 s29, s29, 13
    s_add_u32 s28, s28, s29
    v_lshrrev_b32 v2, 4, v1
    v_lshlrev_b32 v2, 11, v2
    v_and_b32 v3, 15, v1
    v_lshl_or_b32 v2, v3, 2, v2
    v_add_u32 v2, s28, v2
    global_load_ushort v4, v2, s[18:19] offset:0
    global_load_ushort v5, v2, s[18:19] offset:256
    global_load_ushort v6, v2, s[18:19] offset:512
    global_load_ushort v7, v2, s[18:19] offset:768
    global_load_ushort v8, v2, s[18:19] offset:1024
    global_load_ushort v9, v2, s[18:19] offset:1280
    global_load_ushort v10, v2, s[18:19] offset:1536
    global_load_ushort v11, v2, s[18:19] offset:1792
    s_mul_i32 s30, s2, 40000
    v_mul_u32_u24 v30, 128, v1
    v_add_u32 v30, s30, v30
    s_mov_b32 s36, s4
    s_mov_b32 s37, s5
    s_mov_b32 s38, 10240000
    s_mov_b32 s39, 0x20000
    s_mov_b32 s31, 0
    buffer_load_dword v31, v30, s[36:39], s31 offen
    s_mov_b32 s31, 8192
    buffer_load_dword v31, v30, s[36:39], s31 offen
    s_mov_b32 s31, 16384
    buffer_load_dword v31, v30, s[36:39], s31 offen
    s_mov_b32 s31, 24576
    buffer_load_dword v31, v30, s[36:39], s31 offen
    s_mov_b32 s31, 32768
    buffer_load_dword v31, v30, s[36:39], s31 offen
    s_barrier
    s_barrier
    s_barrier
    s_waitcnt vmcnt(5)
    v_lshl_or_b32 v12, v5, 16, v4
    v_lshl_or_b32 v13, v7, 16, v6
    v_lshl_or_b32 v14, v9, 16, v8
    v_lshl_or_b32 v15, v11, 16, v10
    s_lshl_b32 s28, s2, 10
    s_add_u32 s28, s28, 6815744
    v_lshlrev_b32 v2, 4, v1
    v_add_u32 v2, s28, v2
    global_store_dwordx4 v2, v[12:15], s[20:21]
    s_endpgm
K1_WR:
    v_lshlrev_b32 v2, 2, v1
    global_load_dword v4, v2, s[14:15] offset:0
    global_load_dword v5, v2, s[14:15] offset:256
    global_load_dword v6, v2, s[14:15] offset:512
    global_load_dword v7, v2, s[14:15] offset:768
    s_mul_i32 s30, s2, 40000
    v_mul_u32_u24 v30, 128, v1
    v_add_u32 v30, s30, v30
    s_mov_b32 s36, s4
    s_mov_b32 s37, s5
    s_mov_b32 s38, 10240000
    s_mov_b32 s39, 0x20000
    s_mov_b32 s31, 0
    buffer_load_dword v31, v30, s[36:39], s31 offen
    s_mov_b32 s31, 8192
    buffer_load_dword v31, v30, s[36:39], s31 offen
    s_mov_b32 s31, 16384
    buffer_load_dword v31, v30, s[36:39], s31 offen
    s_mov_b32 s31, 24576
    buffer_load_dword v31, v30, s[36:39], s31 offen
    s_mov_b32 s31, 32768
    buffer_load_dword v31, v30, s[36:39], s31 offen
    s_barrier
    s_barrier
    s_barrier
    s_waitcnt vmcnt(5)
    s_mov_b32 s28, 0xbfb8aa3b
    v_lshlrev_b32 v2, 4, v1
    v_add_u32 v2, 6750208, v2
    v_lshlrev_b32 v8, 16, v4
    v_mul_f32 v12, s28, v8
    v_lshlrev_b32 v9, 16, v5
    v_mul_f32 v13, s28, v9
    v_lshlrev_b32 v10, 16, v6
    v_mul_f32 v14, s28, v10
    v_lshlrev_b32 v11, 16, v7
    v_mul_f32 v15, s28, v11
    v_cvt_pk_bf16_f32 v20, v12, v13
    v_cvt_pk_bf16_f32 v21, v14, v15
    v_lshlrev_b32 v16, 16, v20
    v_fma_f32 v16, s28, v8, -v16
    v_and_b32 v17, 0xffff0000, v20
    v_fma_f32 v17, s28, v9, -v17
    v_lshlrev_b32 v18, 16, v21
    v_fma_f32 v18, s28, v10, -v18
    v_and_b32 v19, 0xffff0000, v21
    v_fma_f32 v19, s28, v11, -v19
    v_cvt_pk_bf16_f32 v22, v16, v17
    v_cvt_pk_bf16_f32 v23, v18, v19
    global_store_dwordx4 v2, v[20:23], s[20:21] offset:0
    v_and_b32 v8, 0xffff0000, v4
    v_mul_f32 v12, s28, v8
    v_and_b32 v9, 0xffff0000, v5
    v_mul_f32 v13, s28, v9
    v_and_b32 v10, 0xffff0000, v6
    v_mul_f32 v14, s28, v10
    v_and_b32 v11, 0xffff0000, v7
    v_mul_f32 v15, s28, v11
    v_cvt_pk_bf16_f32 v24, v12, v13
    v_cvt_pk_bf16_f32 v25, v14, v15
    v_lshlrev_b32 v16, 16, v24
    v_fma_f32 v16, s28, v8, -v16
    v_and_b32 v17, 0xffff0000, v24
    v_fma_f32 v17, s28, v9, -v17
    v_lshlrev_b32 v18, 16, v25
    v_fma_f32 v18, s28, v10, -v18
    v_and_b32 v19, 0xffff0000, v25
    v_fma_f32 v19, s28, v11, -v19
    v_cvt_pk_bf16_f32 v26, v16, v17
    v_cvt_pk_bf16_f32 v27, v18, v19
    global_store_dwordx4 v2, v[24:27], s[20:21] offset:1024
    s_endpgm
K1_CG:
    v_and_b32 v2, 3, v1
    v_lshlrev_b32 v2, 5, v2
    v_bfe_u32 v3, v1, 2, 2
    v_lshl_or_b32 v2, v3, 1, v2
    global_load_ushort v4, v2, s[16:17] offset:0
    global_load_ushort v5, v2, s[16:17] offset:8
    global_load_ushort v6, v2, s[16:17] offset:16
    global_load_ushort v7, v2, s[16:17] offset:24
    s_mul_i32 s30, s2, 40000
    v_mul_u32_u24 v30, 128, v1
    v_add_u32 v30, s30, v30
    s_mov_b32 s36, s4
    s_mov_b32 s37, s5
    s_mov_b32 s38, 10240000
    s_mov_b32 s39, 0x20000
    s_mov_b32 s31, 0
    buffer_load_dword v31, v30, s[36:39], s31 offen
    s_mov_b32 s31, 8192
    buffer_load_dword v31, v30, s[36:39], s31 offen
    s_mov_b32 s31, 16384
    buffer_load_dword v31, v30, s[36:39], s31 offen
    s_mov_b32 s31, 24576
    buffer_load_dword v31, v30, s[36:39], s31 offen
    s_mov_b32 s31, 32768
    buffer_load_dword v31, v30, s[36:39], s31 offen
    s_barrier
    s_barrier
    s_barrier
    s_waitcnt vmcnt(5)
    v_lshl_or_b32 v8, v5, 16, v4
    v_lshl_or_b32 v9, v7, 16, v6
    v_lshrrev_b32 v3, 4, v1
    v_cmp_eq_u32 vcc, 0, v3
    s_nop 1
    v_cndmask_b32 v12, 0, v8, vcc
    v_cndmask_b32 v13, 0, v9, vcc
    v_cmp_eq_u32 vcc, 1, v3
    s_nop 1
    v_cndmask_b32 v14, 0, v8, vcc
    v_cndmask_b32 v15, 0, v9, vcc
    v_cmp_eq_u32 vcc, 2, v3
    s_nop 1
    v_cndmask_b32 v16, 0, v8, vcc
    v_cndmask_b32 v17, 0, v9, vcc
    v_cmp_eq_u32 vcc, 3, v3
    s_nop 1
    v_cndmask_b32 v18, 0, v8, vcc
    v_cndmask_b32 v19, 0, v9, vcc
    v_lshlrev_b32 v2, 4, v1
    v_add_u32 v2, 6752256, v2
    global_store_dwordx4 v2, v[12:15], s[20:21]
    global_store_dwordx4 v2, v[16:19], s[20:21] offset:1024
K1_END:
    s_endpgm
.globl main_kernel
.p2align 8
.type main_kernel,@function
main_kernel:
    s_cmp_ge_u32 s2, 256
    s_cbranch_scc1 K2_END
    s_load_dwordx2 s[4:5], s[0:1], 0
    s_load_dwordx2 s[6:7], s[0:1], 64
    s_load_dwordx2 s[20:21], s[0:1], 80
    v_lshrrev_b32 v2, 6, v0
    v_and_b32 v1, 63, v0
    v_lshlrev_b32 v3, 2, v0
    v_readfirstlane_b32 s3, v2
    v_mov_b32 v4, 0
    v_mov_b32 v5, 0
    v_mov_b32 v6, 0
    v_mov_b32 v7, 0
    v_lshlrev_b32 v8, 4, v0
    v_add_u32 v8, 103168, v8
    ds_write_b128 v8, v[4:7]
    v_cmp_gt_u32 vcc, 128, v0
    s_and_saveexec_b64 s[22:23], vcc
    ds_write_b32 v3, v4 offset:0
    s_mov_b64 exec, s[22:23]
    v_lshlrev_b32 v9, 4, v1
    s_lshl_b32 s16, s2, 10
    v_add_u32 v10, s16, v9
    s_and_b32 s17, s3, 3
    s_lshl_b32 s17, s17, 13
    s_add_u32 s17, s17, 6815744
    v_add_u32 v11, s17, v9
    v_add_u32 v12, 6750208, v9
    s_waitcnt lgkmcnt(0)
    global_load_dwordx4 v[120:123], v10, s[20:21]
    global_load_dwordx4 v[176:179], v12, s[20:21]
    global_load_dwordx4 v[180:183], v12, s[20:21] offset:1024
    global_load_dwordx4 v[232:235], v12, s[20:21] offset:2048
    global_load_dwordx4 v[236:239], v12, s[20:21] offset:3072
    v_add_u32 v12, 4096, v11
    global_load_dwordx4 v[200:203], v11, s[20:21] offset:0
    global_load_dwordx4 v[204:207], v11, s[20:21] offset:1024
    global_load_dwordx4 v[208:211], v11, s[20:21] offset:2048
    global_load_dwordx4 v[212:215], v11, s[20:21] offset:3072
    global_load_dwordx4 v[216:219], v12, s[20:21] offset:0
    global_load_dwordx4 v[220:223], v12, s[20:21] offset:1024
    global_load_dwordx4 v[224:227], v12, s[20:21] offset:2048
    global_load_dwordx4 v[228:231], v12, s[20:21] offset:3072
    s_mov_b32 s8, s4
    s_and_b32 s9, s5, 0xffff
    s_or_b32 s9, s9, 0x100000
    s_mov_b32 s10, 10240000
    s_mov_b32 s11, 0x800000
    s_mul_i32 s16, s2, 625
    s_add_u32 s17, s16, 640
    s_add_u32 s16, s16, 15
    s_lshr_b32 s16, s16, 4
    s_lshr_b32 s17, s17, 4
    s_mov_b32 s12, s6
    s_mov_b32 s13, s7
    s_lshl_b32 s14, s17, 10
    s_mov_b32 s15, 0x20000
    s_barrier
    v_mov_b32 v16, 0
    v_mov_b32 v17, 0
    v_mov_b32 v18, 0
    v_mov_b32 v19, 0
    v_mov_b32 v20, 0
    v_mov_b32 v21, 0
    v_mov_b32 v22, 0
    v_mov_b32 v23, 0
    v_mov_b32 v24, 0
    v_mov_b32 v25, 0
    v_mov_b32 v26, 0
    v_mov_b32 v27, 0
    v_mov_b32 v28, 0
    v_mov_b32 v29, 0
    v_mov_b32 v30, 0
    v_mov_b32 v31, 0
    v_mov_b32 v32, 0
    v_mov_b32 v33, 0
    v_mov_b32 v34, 0
    v_mov_b32 v35, 0
    v_mov_b32 v36, 0
    v_mov_b32 v37, 0
    v_mov_b32 v38, 0
    v_mov_b32 v39, 0
    v_mov_b32 v40, 0
    v_mov_b32 v41, 0
    v_mov_b32 v42, 0
    v_mov_b32 v43, 0
    v_mov_b32 v44, 0
    v_mov_b32 v45, 0
    v_mov_b32 v46, 0
    v_mov_b32 v47, 0
    v_mov_b32 v48, 0
    v_mov_b32 v49, 0
    v_mov_b32 v50, 0
    v_mov_b32 v51, 0
    v_mov_b32 v52, 0
    v_mov_b32 v53, 0
    v_mov_b32 v54, 0
    v_mov_b32 v55, 0
    v_mul_u32_u24 v13, 5000, v1
    s_waitcnt vmcnt(12)
    v_lshrrev_b32 v124, 16, v120
    v_and_b32 v120, 0xffff, v120
    v_lshrrev_b32 v125, 16, v121
    v_and_b32 v121, 0xffff, v121
    v_lshrrev_b32 v126, 16, v122
    v_and_b32 v122, 0xffff, v122
    v_lshrrev_b32 v127, 16, v123
    v_and_b32 v123, 0xffff, v123
    v_add_u32 v129, v124, v125
    v_add_u32 v130, v129, v126
    v_add_u32 v131, v130, v127
    v_mov_b32 v132, v131
    v_add3_u32 v248, v13, v120, 0
    v_add_u32 v249, 1250, v121
    v_add_u32 v249, v13, v249
    v_add_u32 v250, 2500, v122
    v_add_u32 v250, v13, v250
    v_add_u32 v251, 3750, v123
    v_add_u32 v251, v13, v251
    v_add_u32_dpp v132, v132, v132 row_shr:1 row_mask:0xf bank_mask:0xf
    s_nop 1
    v_add_u32_dpp v132, v132, v132 row_shr:2 row_mask:0xf bank_mask:0xf
    s_nop 1
    v_add_u32_dpp v132, v132, v132 row_shr:4 row_mask:0xf bank_mask:0xf
    s_nop 1
    v_add_u32_dpp v132, v132, v132 row_shr:8 row_mask:0xf bank_mask:0xf
    s_nop 1
    v_add_u32_dpp v132, v132, v132 row_bcast:15 row_mask:0xa bank_mask:0xf
    s_nop 1
    v_add_u32_dpp v132, v132, v132 row_bcast:31 row_mask:0xc bank_mask:0xf
    s_nop 0
    v_readlane_b32 s24, v132, 63
    v_sub_u32 v240, v132, v131
    v_add_u32 v241, v240, v124
    v_add_u32 v242, v240, v129
    v_add_u32 v243, v240, v130
    v_sub_u32 v248, v248, v240
    v_add_u32 v244, v240, v124
    v_sub_u32 v249, v249, v241
    v_add_u32 v245, v241, v125
    v_sub_u32 v250, v250, v242
    v_add_u32 v246, v242, v126
    v_sub_u32 v251, v251, v243
    v_add_u32 v247, v243, v127
    s_mov_b32 s25, 0
K2_ROUND:
    s_mul_i32 s30, s3, 192
    s_add_u32 s30, s30, s25
    s_add_u32 s31, s30, 192
    s_lshl_b32 s32, s3, 10
    s_add_u32 s32, s32, 103168
    v_subrev_u32 v56, s30, v240
    v_max_i32 v56, 0, v56
    v_lshl_add_u32 v56, v56, 2, s32
    v_subrev_u32 v57, s30, v241
    v_max_i32 v57, 0, v57
    v_lshl_add_u32 v57, v57, 2, s32
    v_subrev_u32 v58, s30, v242
    v_max_i32 v58, 0, v58
    v_lshl_add_u32 v58, v58, 2, s32
    v_subrev_u32 v59, s30, v243
    v_max_i32 v59, 0, v59
    v_lshl_add_u32 v59, v59, 2, s32
    v_cmp_lt_u32 vcc, s30, v244
    v_cmp_gt_u32 s[34:35], s31, v240
    s_and_b64 exec, vcc, s[34:35]
    ds_max_u32 v56, v248
    s_mov_b64 exec, -1
    v_cmp_lt_u32 vcc, s30, v245
    v_cmp_gt_u32 s[34:35], s31, v241
    s_and_b64 exec, vcc, s[34:35]
    ds_max_u32 v57, v249
    s_mov_b64 exec, -1
    v_cmp_lt_u32 vcc, s30, v246
    v_cmp_gt_u32 s[34:35], s31, v242
    s_and_b64 exec, vcc, s[34:35]
    ds_max_u32 v58, v250
    s_mov_b64 exec, -1
    v_cmp_lt_u32 vcc, s30, v247
    v_cmp_gt_u32 s[34:35], s31, v243
    s_and_b64 exec, vcc, s[34:35]
    ds_max_u32 v59, v251
    s_mov_b64 exec, -1
    v_lshl_add_u32 v60, v1, 2, s32
    ds_read_b32 v64, v60 offset:0
    ds_read_b32 v65, v60 offset:256
    ds_read_b32 v66, v60 offset:512
    v_add_u32 v68, s30, v1
    v_add_u32 v69, 64, v68
    v_add_u32 v70, 128, v68
    v_cmp_gt_u32 s[36:37], s24, v68
    v_cmp_gt_u32 s[38:39], s24, v69
    v_cmp_gt_u32 s[40:41], s24, v70
    s_waitcnt lgkmcnt(0)
    v_max_u32_dpp v64, v64, v64 row_shr:1 row_mask:0xf bank_mask:0xf
    v_max_u32_dpp v65, v65, v65 row_shr:1 row_mask:0xf bank_mask:0xf
    v_max_u32_dpp v66, v66, v66 row_shr:1 row_mask:0xf bank_mask:0xf
    v_max_u32_dpp v64, v64, v64 row_shr:2 row_mask:0xf bank_mask:0xf
    v_max_u32_dpp v65, v65, v65 row_shr:2 row_mask:0xf bank_mask:0xf
    v_max_u32_dpp v66, v66, v66 row_shr:2 row_mask:0xf bank_mask:0xf
    v_max_u32_dpp v64, v64, v64 row_shr:4 row_mask:0xf bank_mask:0xf
    v_max_u32_dpp v65, v65, v65 row_shr:4 row_mask:0xf bank_mask:0xf
    v_max_u32_dpp v66, v66, v66 row_shr:4 row_mask:0xf bank_mask:0xf
    v_max_u32_dpp v64, v64, v64 row_shr:8 row_mask:0xf bank_mask:0xf
    v_max_u32_dpp v65, v65, v65 row_shr:8 row_mask:0xf bank_mask:0xf
    v_max_u32_dpp v66, v66, v66 row_shr:8 row_mask:0xf bank_mask:0xf
    v_max_u32_dpp v64, v64, v64 row_bcast:15 row_mask:0xa bank_mask:0xf
    v_max_u32_dpp v65, v65, v65 row_bcast:15 row_mask:0xa bank_mask:0xf
    v_max_u32_dpp v66, v66, v66 row_bcast:15 row_mask:0xa bank_mask:0xf
    v_max_u32_dpp v64, v64, v64 row_bcast:31 row_mask:0xc bank_mask:0xf
    v_max_u32_dpp v65, v65, v65 row_bcast:31 row_mask:0xc bank_mask:0xf
    v_max_u32_dpp v66, v66, v66 row_bcast:31 row_mask:0xc bank_mask:0xf
    v_readlane_b32 s33, v64, 63
    v_readlane_b32 s34, v65, 63
    s_max_u32 s34, s33, s34
    v_max_u32 v65, s33, v65
    v_max_u32 v66, s34, v66
    v_add_u32 v68, v68, v64
    v_lshlrev_b32 v88, 2, v68
    v_add_u32 v88, 262144, v88
    v_lshlrev_b32 v91, 4, v68
    v_add_u32 v91, 1572864, v91
    v_add_u32 v69, v69, v65
    v_lshlrev_b32 v89, 2, v69
    v_add_u32 v89, 262144, v89
    v_lshlrev_b32 v92, 4, v69
    v_add_u32 v92, 1572864, v92
    v_add_u32 v70, v70, v66
    v_lshlrev_b32 v90, 2, v70
    v_add_u32 v90, 262144, v90
    v_lshlrev_b32 v93, 4, v70
    v_add_u32 v93, 1572864, v93
    s_mov_b32 s44, s20
    s_mov_b32 s45, s21
    s_mov_b32 s46, 0x662000
    s_mov_b32 s47, 0x20000
    s_mov_b64 exec, s[36:37]
    buffer_load_dword v72, v88, s[44:47], 0 offen
    s_mov_b64 exec, s[38:39]
    buffer_load_dword v73, v89, s[44:47], 0 offen
    s_mov_b64 exec, s[40:41]
    buffer_load_dword v74, v90, s[44:47], 0 offen
    s_mov_b64 exec, s[36:37]
    buffer_load_dwordx4 v[76:79], v91, s[44:47], 0 offen
    s_mov_b64 exec, s[38:39]
    buffer_load_dwordx4 v[80:83], v92, s[44:47], 0 offen
    s_mov_b64 exec, s[40:41]
    buffer_load_dwordx4 v[84:87], v93, s[44:47], 0 offen
    s_mov_b64 exec, -1
    v_mov_b32 v14, 1
    s_waitcnt vmcnt(5)
    s_mov_b64 exec, s[36:37]
    v_and_b32 v100, 127, v72
    v_lshlrev_b32 v88, 2, v100
    ds_add_rtn_u32 v96, v88, v14 offset:0
    s_waitcnt vmcnt(4)
    s_mov_b64 exec, s[38:39]
    v_and_b32 v101, 127, v73
    v_lshlrev_b32 v89, 2, v101
    ds_add_rtn_u32 v97, v89, v14 offset:0
    s_waitcnt vmcnt(3)
    s_mov_b64 exec, s[40:41]
    v_and_b32 v102, 127, v74
    v_lshlrev_b32 v90, 2, v102
    ds_add_rtn_u32 v98, v90, v14 offset:0
    s_mov_b64 exec, -1
    v_lshlrev_b32 v15, 3, v1
    v_lshrrev_b32 v88, 1, v100
    v_lshlrev_b32 v88, 2, v88
    v_and_b32 v100, 1, v100
    v_lshlrev_b32 v100, 4, v100
    v_lshrrev_b32 v91, 4, v72
    v_and_b32 v91, 0x38, v91
    v_and_b32 v72, 0xfffffc00, v72
    v_lshrrev_b32 v89, 1, v101
    v_lshlrev_b32 v89, 2, v89
    v_and_b32 v101, 1, v101
    v_lshlrev_b32 v101, 4, v101
    v_lshrrev_b32 v92, 4, v73
    v_and_b32 v92, 0x38, v92
    v_and_b32 v73, 0xfffffc00, v73
    v_lshrrev_b32 v90, 1, v102
    v_lshlrev_b32 v90, 2, v90
    v_and_b32 v102, 1, v102
    v_lshlrev_b32 v102, 4, v102
    v_lshrrev_b32 v93, 4, v74
    v_and_b32 v93, 0x38, v93
    v_and_b32 v74, 0xfffffc00, v74
    s_waitcnt lgkmcnt(0)
    s_barrier
    ds_read_b64 v[104:105], v15 offset:0
    s_lshl_b32 s33, s3, 3
    s_add_u32 s34, s33, 7
    v_lshrrev_b32 v110, 3, v1
    v_mul_u32_u24 v110, 48, v110
    s_waitcnt lgkmcnt(0)
    v_add_u32 v106, v104, v105
    v_mov_b32 v107, v106
    s_nop 1
    v_add_u32_dpp v107, v107, v107 row_shr:1 row_mask:0xf bank_mask:0xf
    s_nop 1
    v_add_u32_dpp v107, v107, v107 row_shr:2 row_mask:0xf bank_mask:0xf
    s_nop 1
    v_add_u32_dpp v107, v107, v107 row_shr:4 row_mask:0xf bank_mask:0xf
    s_nop 1
    v_add_u32_dpp v107, v107, v107 row_shr:8 row_mask:0xf bank_mask:0xf
    s_nop 1
    v_add_u32_dpp v107, v107, v107 row_bcast:15 row_mask:0xa bank_mask:0xf
    s_nop 1
    v_add_u32_dpp v107, v107, v107 row_bcast:31 row_mask:0xc bank_mask:0xf
    v_sub_u32 v106, v107, v106
    v_readlane_b32 s29, v107, s34
    s_nop 0
    v_mov_b32_dpp v108, v106 row_newbcast:0 row_mask:0xf bank_mask:0x3
    s_nop 1
    v_mov_b32_dpp v108, v106 row_newbcast:8 row_mask:0xf bank_mask:0xc
    v_readlane_b32 s35, v106, s33
    v_add_u32 v109, 15, v108
    v_and_b32 v109, -16, v109
    v_add_u32 v109, v109, v110
    v_sub_u32 v108, v109, v108
    v_add_u32 v108, v108, v106
    v_add_u32 v104, v108, v104
    v_lshl_or_b32 v104, v104, 16, v108
    v_readlane_b32 s28, v109, s33
    s_sub_u32 s29, s29, s35
    ds_bpermute_b32 v88, v88, v104
    ds_bpermute_b32 v89, v89, v104
    ds_bpermute_b32 v90, v90, v104
    s_add_u32 s33, s28, s29
    v_add_u32 v105, s33, v1
    v_lshlrev_b32 v106, 2, v105
    v_lshlrev_b32 v107, 4, v105
    v_mov_b32 v108, 10238976
    s_mov_b64 exec, 0xfffff
    ds_write_b32 v106, v108 offset:512
    ds_write_b8 v105, v4 offset:8256
    ds_write_b128 v107, v[4:7] offset:10240
    s_waitcnt vmcnt(0) lgkmcnt(3)
    s_mov_b64 exec, s[36:37]
    v_bfe_u32 v88, v88, v100, 16
    v_add_u32 v88, v88, v96
    v_lshlrev_b32 v96, 2, v88
    v_lshlrev_b32 v100, 4, v88
    ds_write_b32 v96, v72 offset:512
    ds_write_b8 v88, v91 offset:8256
    ds_write_b128 v100, v[76:79] offset:10240
    s_mov_b64 exec, s[38:39]
    v_bfe_u32 v89, v89, v101, 16
    v_add_u32 v89, v89, v97
    v_lshlrev_b32 v97, 2, v89
    v_lshlrev_b32 v101, 4, v89
    ds_write_b32 v97, v73 offset:512
    ds_write_b8 v89, v92 offset:8256
    ds_write_b128 v101, v[80:83] offset:10240
    s_mov_b64 exec, s[40:41]
    v_bfe_u32 v90, v90, v102, 16
    v_add_u32 v90, v90, v98
    v_lshlrev_b32 v98, 2, v90
    v_lshlrev_b32 v102, 4, v90
    ds_write_b32 v98, v74 offset:512
    ds_write_b8 v90, v93 offset:8256
    ds_write_b128 v102, v[84:87] offset:10240
    s_mov_b64 exec, -1
    s_lshl_b32 s33, s28, 2
    s_add_u32 s33, s33, 512
    v_mov_b32 v196, s33
    s_add_u32 s33, s28, 8256
    v_mov_b32 v197, s33
    s_lshl_b32 s33, s28, 5
    s_add_u32 s33, s33, 41216
    v_add_u32 v198, s33, v15
    s_lshl_b32 s34, s28, 4
    s_add_u32 s34, s34, 10240
    v_and_b32 v12, 15, v1
    v_lshl_add_u32 v199, v12, 4, s34
    v_add_u32 v10, s34, v9
    v_lshrrev_b32 v11, 4, v1
    v_lshlrev_b32 v11, 3, v11
    v_lshl_add_u32 v11, v12, 5, v11
    v_add_u32 v11, s33, v11
    s_add_u32 s26, s29, 3
    s_lshr_b32 s26, s26, 2
    s_waitcnt lgkmcnt(0)
    s_barrier
    v_cmp_gt_u32 vcc, 128, v0
    s_and_saveexec_b64 s[22:23], vcc
    ds_write_b32 v3, v4 offset:0
    s_mov_b64 exec, s[22:23]
    s_cmp_eq_u32 s26, 0
    s_cbranch_scc1 K2_LOOPDONE
    ds_read_b128 v[120:123], v196 offset:0
    ds_read_b128 v[124:127], v196 offset:16
    ds_read_b128 v[188:191], v196 offset:32
    ds_read_b64 v[186:187], v199 offset:8
    ds_read_b128 v[192:195], v197
    s_waitcnt lgkmcnt(4)
    buffer_load_dwordx4 v[56:59], v120, s[8:11], 0 offen
    buffer_load_dwordx4 v[60:63], v121, s[8:11], 0 offen
    buffer_load_dwordx4 v[64:67], v122, s[8:11], 0 offen
    buffer_load_dwordx4 v[68:71], v123, s[8:11], 0 offen
    s_waitcnt lgkmcnt(3)
    buffer_load_dwordx4 v[72:75], v124, s[8:11], 0 offen
    buffer_load_dwordx4 v[76:79], v125, s[8:11], 0 offen
    buffer_load_dwordx4 v[80:83], v126, s[8:11], 0 offen
    buffer_load_dwordx4 v[84:87], v127, s[8:11], 0 offen
    s_lshl_b32 s33, s26, 2
K2_APREP:
    ds_read_b64 v[152:153], v10
    v_cmp_gt_u32 vcc, s33, v1
    v_add_u32 v10, 1024, v10
    s_waitcnt lgkmcnt(0)
    v_cndmask_b32 v152, 0, v152, vcc
    v_cndmask_b32 v153, 0, v153, vcc
    s_nop 1
    v_mfma_f32_16x16x16_bf16 v[136:139], v[232:233], v[152:153], 0
    v_mfma_f32_16x16x16_bf16 v[140:143], v[234:235], v[152:153], 0
    v_mfma_f32_16x16x16_bf16 v[144:147], v[236:237], v[152:153], 0
    v_mfma_f32_16x16x16_bf16 v[148:151], v[238:239], v[152:153], 0
    v_add_u32 v160, 0, v12
    v_cmp_gt_u32 vcc, s33, v160
    s_nop 2
    v_cvt_pk_bf16_f32 v168, v136, v137
    v_cvt_pk_bf16_f32 v169, v138, v139
    s_mov_b64 exec, vcc
    ds_write_b64 v11, v[168:169] offset:0
    s_mov_b64 exec, -1
    v_add_u32 v160, 16, v12
    v_cmp_gt_u32 vcc, s33, v160
    v_cvt_pk_bf16_f32 v170, v140, v141
    v_cvt_pk_bf16_f32 v171, v142, v143
    s_mov_b64 exec, vcc
    ds_write_b64 v11, v[170:171] offset:512
    s_mov_b64 exec, -1
    v_add_u32 v160, 32, v12
    v_cmp_gt_u32 vcc, s33, v160
    v_cvt_pk_bf16_f32 v172, v144, v145
    v_cvt_pk_bf16_f32 v173, v146, v147
    s_mov_b64 exec, vcc
    ds_write_b64 v11, v[172:173] offset:1024
    s_mov_b64 exec, -1
    v_add_u32 v160, 48, v12
    v_cmp_gt_u32 vcc, s33, v160
    v_cvt_pk_bf16_f32 v174, v148, v149
    v_cvt_pk_bf16_f32 v175, v150, v151
    s_mov_b64 exec, vcc
    ds_write_b64 v11, v[174:175] offset:1536
    s_mov_b64 exec, -1
    v_add_u32 v11, 2048, v11
    s_sub_u32 s33, s33, 64
    s_cmp_gt_i32 s33, 0
    s_cbranch_scc1 K2_APREP
    ds_read_b64 v[184:185], v198
    v_mfma_f32_4x4x4_16b_bf16 v[152:155], v[186:187], v[176:177], 0 cbsz:4 abid:0
    v_mfma_f32_4x4x4_16b_bf16 v[156:159], v[186:187], v[180:181], 0 cbsz:4 abid:0
    s_nop 0
    v_mfma_f32_4x4x4_16b_bf16 v[152:155], v[186:187], v[178:179], v[152:155] cbsz:4 abid:0
    v_mfma_f32_4x4x4_16b_bf16 v[156:159], v[186:187], v[182:183], v[156:159] cbsz:4 abid:0
    s_nop 4
.p2align 4
K2_LOOP:
    s_waitcnt lgkmcnt(0)
    s_waitcnt vmcnt(7)
    v_mfma_f32_4x4x4_16b_bf16 v[120:123], v[184:185], v[56:57], 0 cbsz:4 abid:0
    v_exp_f32 v168, v152
    v_mfma_f32_4x4x4_16b_bf16 v[124:127], v[184:185], v[58:59], 0 cbsz:4 abid:0
    buffer_load_dwordx4 v[88:91], v188, s[8:11], 0 offen
    v_exp_f32 v169, v153
    s_waitcnt vmcnt(7)
    v_mfma_f32_4x4x4_16b_bf16 v[128:131], v[184:185], v[60:61], 0 cbsz:4 abid:1
    v_exp_f32 v170, v154
    v_mfma_f32_4x4x4_16b_bf16 v[132:135], v[184:185], v[62:63], 0 cbsz:4 abid:1
    buffer_load_dwordx4 v[92:95], v189, s[8:11], 0 offen
    v_exp_f32 v171, v155
    s_waitcnt vmcnt(7)
    v_mfma_f32_4x4x4_16b_bf16 v[136:139], v[184:185], v[64:65], 0 cbsz:4 abid:2
    v_exp_f32 v172, v156
    v_mfma_f32_4x4x4_16b_bf16 v[140:143], v[184:185], v[66:67], 0 cbsz:4 abid:2
    buffer_load_dwordx4 v[96:99], v190, s[8:11], 0 offen
    v_exp_f32 v173, v157
    v_exp_f32 v174, v158
    v_exp_f32 v175, v159
    v_pk_add_f32 v[168:169], v[168:169], 1.0 op_sel_hi:[1,0]
    v_pk_add_f32 v[170:171], v[170:171], 1.0 op_sel_hi:[1,0]
    v_pk_add_f32 v[172:173], v[172:173], 1.0 op_sel_hi:[1,0]
    v_pk_add_f32 v[174:175], v[174:175], 1.0 op_sel_hi:[1,0]
    s_waitcnt vmcnt(7)
    v_mfma_f32_4x4x4_16b_bf16 v[144:147], v[184:185], v[68:69], 0 cbsz:4 abid:3
    v_rcp_f32 v168, v168
    v_mfma_f32_4x4x4_16b_bf16 v[148:151], v[184:185], v[70:71], 0 cbsz:4 abid:3
    buffer_load_dwordx4 v[100:103], v191, s[8:11], 0 offen
    v_rcp_f32 v169, v169
    ds_read_b128 v[188:191], v196 offset:48
    v_mfma_f32_4x4x4_16b_bf16 v[160:163], v[186:187], v[176:177], 0 cbsz:4 abid:1
    v_rcp_f32 v170, v170
    v_mfma_f32_4x4x4_16b_bf16 v[164:167], v[186:187], v[180:181], 0 cbsz:4 abid:1
    v_rcp_f32 v171, v171
    v_mfma_f32_4x4x4_16b_bf16 v[160:163], v[186:187], v[178:179], v[160:163] cbsz:4 abid:1
    v_rcp_f32 v172, v172
    v_mfma_f32_4x4x4_16b_bf16 v[164:167], v[186:187], v[182:183], v[164:167] cbsz:4 abid:1
    v_rcp_f32 v173, v173
    v_rcp_f32 v174, v174
    v_rcp_f32 v175, v175
    v_readfirstlane_b32 s27, v192
    v_pk_mul_f32 v[168:169], v[168:169], v[152:153]
    v_pk_mul_f32 v[170:171], v[170:171], v[154:155]
    v_pk_mul_f32 v[172:173], v[172:173], v[156:157]
    v_pk_mul_f32 v[174:175], v[174:175], v[158:159]
    s_set_gpr_idx_on s27, gpr_idx(SRC2,DST)
    v_pk_fma_f32 v[16:17], v[168:169], v[120:121], v[16:17] op_sel:[0,0,0] op_sel_hi:[0,1,1]
    v_pk_fma_f32 v[18:19], v[168:169], v[122:123], v[18:19] op_sel:[0,0,0] op_sel_hi:[0,1,1]
    v_pk_fma_f32 v[20:21], v[172:173], v[124:125], v[20:21] op_sel:[0,0,0] op_sel_hi:[0,1,1]
    v_pk_fma_f32 v[22:23], v[172:173], v[126:127], v[22:23] op_sel:[0,0,0] op_sel_hi:[0,1,1]
    s_lshr_b32 s27, s27, 8
    s_set_gpr_idx_idx s27
    v_pk_fma_f32 v[16:17], v[168:169], v[128:129], v[16:17] op_sel:[1,0,0] op_sel_hi:[1,1,1]
    v_pk_fma_f32 v[18:19], v[168:169], v[130:131], v[18:19] op_sel:[1,0,0] op_sel_hi:[1,1,1]
    v_pk_fma_f32 v[20:21], v[172:173], v[132:133], v[20:21] op_sel:[1,0,0] op_sel_hi:[1,1,1]
    v_pk_fma_f32 v[22:23], v[172:173], v[134:135], v[22:23] op_sel:[1,0,0] op_sel_hi:[1,1,1]
    s_lshr_b32 s27, s27, 8
    s_set_gpr_idx_idx s27
    v_pk_fma_f32 v[16:17], v[170:171], v[136:137], v[16:17] op_sel:[0,0,0] op_sel_hi:[0,1,1]
    v_pk_fma_f32 v[18:19], v[170:171], v[138:139], v[18:19] op_sel:[0,0,0] op_sel_hi:[0,1,1]
    v_pk_fma_f32 v[20:21], v[174:175], v[140:141], v[20:21] op_sel:[0,0,0] op_sel_hi:[0,1,1]
    v_pk_fma_f32 v[22:23], v[174:175], v[142:143], v[22:23] op_sel:[0,0,0] op_sel_hi:[0,1,1]
    s_lshr_b32 s27, s27, 8
    s_set_gpr_idx_idx s27
    v_pk_fma_f32 v[16:17], v[170:171], v[144:145], v[16:17] op_sel:[1,0,0] op_sel_hi:[1,1,1]
    v_pk_fma_f32 v[18:19], v[170:171], v[146:147], v[18:19] op_sel:[1,0,0] op_sel_hi:[1,1,1]
    v_pk_fma_f32 v[20:21], v[174:175], v[148:149], v[20:21] op_sel:[1,0,0] op_sel_hi:[1,1,1]
    v_pk_fma_f32 v[22:23], v[174:175], v[150:151], v[22:23] op_sel:[1,0,0] op_sel_hi:[1,1,1]
    s_set_gpr_idx_off
    s_sub_u32 s26, s26, 1
    s_cmp_eq_u32 s26, 0
    s_cbranch_scc1 K2_LOOPDONE
    s_waitcnt lgkmcnt(0)
    s_waitcnt vmcnt(7)
    v_mfma_f32_4x4x4_16b_bf16 v[120:123], v[184:185], v[72:73], 0 cbsz:4 abid:4
    v_exp_f32 v168, v160
    v_mfma_f32_4x4x4_16b_bf16 v[124:127], v[184:185], v[74:75], 0 cbsz:4 abid:4
    buffer_load_dwordx4 v[104:107], v188, s[8:11], 0 offen
    v_exp_f32 v169, v161
    s_waitcnt vmcnt(7)
    v_mfma_f32_4x4x4_16b_bf16 v[128:131], v[184:185], v[76:77], 0 cbsz:4 abid:5
    v_exp_f32 v170, v162
    v_mfma_f32_4x4x4_16b_bf16 v[132:135], v[184:185], v[78:79], 0 cbsz:4 abid:5
    buffer_load_dwordx4 v[108:111], v189, s[8:11], 0 offen
    v_exp_f32 v171, v163
    s_waitcnt vmcnt(7)
    v_mfma_f32_4x4x4_16b_bf16 v[136:139], v[184:185], v[80:81], 0 cbsz:4 abid:6
    v_exp_f32 v172, v164
    v_mfma_f32_4x4x4_16b_bf16 v[140:143], v[184:185], v[82:83], 0 cbsz:4 abid:6
    buffer_load_dwordx4 v[112:115], v190, s[8:11], 0 offen
    v_exp_f32 v173, v165
    v_exp_f32 v174, v166
    v_exp_f32 v175, v167
    v_pk_add_f32 v[168:169], v[168:169], 1.0 op_sel_hi:[1,0]
    v_pk_add_f32 v[170:171], v[170:171], 1.0 op_sel_hi:[1,0]
    v_pk_add_f32 v[172:173], v[172:173], 1.0 op_sel_hi:[1,0]
    v_pk_add_f32 v[174:175], v[174:175], 1.0 op_sel_hi:[1,0]
    s_waitcnt vmcnt(7)
    v_mfma_f32_4x4x4_16b_bf16 v[144:147], v[184:185], v[84:85], 0 cbsz:4 abid:7
    v_rcp_f32 v168, v168
    v_mfma_f32_4x4x4_16b_bf16 v[148:151], v[184:185], v[86:87], 0 cbsz:4 abid:7
    buffer_load_dwordx4 v[116:119], v191, s[8:11], 0 offen
    v_rcp_f32 v169, v169
    ds_read_b128 v[188:191], v196 offset:64
    v_mfma_f32_4x4x4_16b_bf16 v[152:155], v[186:187], v[176:177], 0 cbsz:4 abid:2
    v_rcp_f32 v170, v170
    v_mfma_f32_4x4x4_16b_bf16 v[156:159], v[186:187], v[180:181], 0 cbsz:4 abid:2
    v_rcp_f32 v171, v171
    v_mfma_f32_4x4x4_16b_bf16 v[152:155], v[186:187], v[178:179], v[152:155] cbsz:4 abid:2
    v_rcp_f32 v172, v172
    v_mfma_f32_4x4x4_16b_bf16 v[156:159], v[186:187], v[182:183], v[156:159] cbsz:4 abid:2
    v_rcp_f32 v173, v173
    v_rcp_f32 v174, v174
    v_rcp_f32 v175, v175
    v_readfirstlane_b32 s27, v193
    v_pk_mul_f32 v[168:169], v[168:169], v[160:161]
    v_pk_mul_f32 v[170:171], v[170:171], v[162:163]
    v_pk_mul_f32 v[172:173], v[172:173], v[164:165]
    v_pk_mul_f32 v[174:175], v[174:175], v[166:167]
    s_set_gpr_idx_on s27, gpr_idx(SRC2,DST)
    v_pk_fma_f32 v[16:17], v[168:169], v[120:121], v[16:17] op_sel:[0,0,0] op_sel_hi:[0,1,1]
    v_pk_fma_f32 v[18:19], v[168:169], v[122:123], v[18:19] op_sel:[0,0,0] op_sel_hi:[0,1,1]
    v_pk_fma_f32 v[20:21], v[172:173], v[124:125], v[20:21] op_sel:[0,0,0] op_sel_hi:[0,1,1]
    v_pk_fma_f32 v[22:23], v[172:173], v[126:127], v[22:23] op_sel:[0,0,0] op_sel_hi:[0,1,1]
    s_lshr_b32 s27, s27, 8
    s_set_gpr_idx_idx s27
    v_pk_fma_f32 v[16:17], v[168:169], v[128:129], v[16:17] op_sel:[1,0,0] op_sel_hi:[1,1,1]
    v_pk_fma_f32 v[18:19], v[168:169], v[130:131], v[18:19] op_sel:[1,0,0] op_sel_hi:[1,1,1]
    v_pk_fma_f32 v[20:21], v[172:173], v[132:133], v[20:21] op_sel:[1,0,0] op_sel_hi:[1,1,1]
    v_pk_fma_f32 v[22:23], v[172:173], v[134:135], v[22:23] op_sel:[1,0,0] op_sel_hi:[1,1,1]
    s_lshr_b32 s27, s27, 8
    s_set_gpr_idx_idx s27
    v_pk_fma_f32 v[16:17], v[170:171], v[136:137], v[16:17] op_sel:[0,0,0] op_sel_hi:[0,1,1]
    v_pk_fma_f32 v[18:19], v[170:171], v[138:139], v[18:19] op_sel:[0,0,0] op_sel_hi:[0,1,1]
    v_pk_fma_f32 v[20:21], v[174:175], v[140:141], v[20:21] op_sel:[0,0,0] op_sel_hi:[0,1,1]
    v_pk_fma_f32 v[22:23], v[174:175], v[142:143], v[22:23] op_sel:[0,0,0] op_sel_hi:[0,1,1]
    s_lshr_b32 s27, s27, 8
    s_set_gpr_idx_idx s27
    v_pk_fma_f32 v[16:17], v[170:171], v[144:145], v[16:17] op_sel:[1,0,0] op_sel_hi:[1,1,1]
    v_pk_fma_f32 v[18:19], v[170:171], v[146:147], v[18:19] op_sel:[1,0,0] op_sel_hi:[1,1,1]
    v_pk_fma_f32 v[20:21], v[174:175], v[148:149], v[20:21] op_sel:[1,0,0] op_sel_hi:[1,1,1]
    v_pk_fma_f32 v[22:23], v[174:175], v[150:151], v[22:23] op_sel:[1,0,0] op_sel_hi:[1,1,1]
    s_set_gpr_idx_off
    s_sub_u32 s26, s26, 1
    s_cmp_eq_u32 s26, 0
    s_cbranch_scc1 K2_LOOPDONE
    s_waitcnt lgkmcnt(0)
    s_waitcnt vmcnt(7)
    v_mfma_f32_4x4x4_16b_bf16 v[120:123], v[184:185], v[88:89], 0 cbsz:4 abid:8
    v_exp_f32 v168, v152
    v_mfma_f32_4x4x4_16b_bf16 v[124:127], v[184:185], v[90:91], 0 cbsz:4 abid:8
    buffer_load_dwordx4 v[56:59], v188, s[8:11], 0 offen
    v_exp_f32 v169, v153
    s_waitcnt vmcnt(7)
    v_mfma_f32_4x4x4_16b_bf16 v[128:131], v[184:185], v[92:93], 0 cbsz:4 abid:9
    v_exp_f32 v170, v154
    v_mfma_f32_4x4x4_16b_bf16 v[132:135], v[184:185], v[94:95], 0 cbsz:4 abid:9
    buffer_load_dwordx4 v[60:63], v189, s[8:11], 0 offen
    v_exp_f32 v171, v155
    s_waitcnt vmcnt(7)
    v_mfma_f32_4x4x4_16b_bf16 v[136:139], v[184:185], v[96:97], 0 cbsz:4 abid:10
    v_exp_f32 v172, v156
    v_mfma_f32_4x4x4_16b_bf16 v[140:143], v[184:185], v[98:99], 0 cbsz:4 abid:10
    buffer_load_dwordx4 v[64:67], v190, s[8:11], 0 offen
    v_exp_f32 v173, v157
    v_exp_f32 v174, v158
    v_exp_f32 v175, v159
    v_pk_add_f32 v[168:169], v[168:169], 1.0 op_sel_hi:[1,0]
    v_pk_add_f32 v[170:171], v[170:171], 1.0 op_sel_hi:[1,0]
    v_pk_add_f32 v[172:173], v[172:173], 1.0 op_sel_hi:[1,0]
    v_pk_add_f32 v[174:175], v[174:175], 1.0 op_sel_hi:[1,0]
    s_waitcnt vmcnt(7)
    v_mfma_f32_4x4x4_16b_bf16 v[144:147], v[184:185], v[100:101], 0 cbsz:4 abid:11
    v_rcp_f32 v168, v168
    v_mfma_f32_4x4x4_16b_bf16 v[148:151], v[184:185], v[102:103], 0 cbsz:4 abid:11
    buffer_load_dwordx4 v[68:71], v191, s[8:11], 0 offen
    v_rcp_f32 v169, v169
    ds_read_b128 v[188:191], v196 offset:80
    v_mfma_f32_4x4x4_16b_bf16 v[160:163], v[186:187], v[176:177], 0 cbsz:4 abid:3
    v_rcp_f32 v170, v170
    v_mfma_f32_4x4x4_16b_bf16 v[164:167], v[186:187], v[180:181], 0 cbsz:4 abid:3
    v_rcp_f32 v171, v171
    v_mfma_f32_4x4x4_16b_bf16 v[160:163], v[186:187], v[178:179], v[160:163] cbsz:4 abid:3
    v_rcp_f32 v172, v172
    v_mfma_f32_4x4x4_16b_bf16 v[164:167], v[186:187], v[182:183], v[164:167] cbsz:4 abid:3
    ds_read_b64 v[186:187], v199 offset:264
    v_rcp_f32 v173, v173
    v_rcp_f32 v174, v174
    v_rcp_f32 v175, v175
    v_readfirstlane_b32 s27, v194
    v_pk_mul_f32 v[168:169], v[168:169], v[152:153]
    v_pk_mul_f32 v[170:171], v[170:171], v[154:155]
    v_pk_mul_f32 v[172:173], v[172:173], v[156:157]
    v_pk_mul_f32 v[174:175], v[174:175], v[158:159]
    s_set_gpr_idx_on s27, gpr_idx(SRC2,DST)
    v_pk_fma_f32 v[16:17], v[168:169], v[120:121], v[16:17] op_sel:[0,0,0] op_sel_hi:[0,1,1]
    v_pk_fma_f32 v[18:19], v[168:169], v[122:123], v[18:19] op_sel:[0,0,0] op_sel_hi:[0,1,1]
    v_pk_fma_f32 v[20:21], v[172:173], v[124:125], v[20:21] op_sel:[0,0,0] op_sel_hi:[0,1,1]
    v_pk_fma_f32 v[22:23], v[172:173], v[126:127], v[22:23] op_sel:[0,0,0] op_sel_hi:[0,1,1]
    s_lshr_b32 s27, s27, 8
    s_set_gpr_idx_idx s27
    v_pk_fma_f32 v[16:17], v[168:169], v[128:129], v[16:17] op_sel:[1,0,0] op_sel_hi:[1,1,1]
    v_pk_fma_f32 v[18:19], v[168:169], v[130:131], v[18:19] op_sel:[1,0,0] op_sel_hi:[1,1,1]
    v_pk_fma_f32 v[20:21], v[172:173], v[132:133], v[20:21] op_sel:[1,0,0] op_sel_hi:[1,1,1]
    v_pk_fma_f32 v[22:23], v[172:173], v[134:135], v[22:23] op_sel:[1,0,0] op_sel_hi:[1,1,1]
    s_lshr_b32 s27, s27, 8
    s_set_gpr_idx_idx s27
    v_pk_fma_f32 v[16:17], v[170:171], v[136:137], v[16:17] op_sel:[0,0,0] op_sel_hi:[0,1,1]
    v_pk_fma_f32 v[18:19], v[170:171], v[138:139], v[18:19] op_sel:[0,0,0] op_sel_hi:[0,1,1]
    v_pk_fma_f32 v[20:21], v[174:175], v[140:141], v[20:21] op_sel:[0,0,0] op_sel_hi:[0,1,1]
    v_pk_fma_f32 v[22:23], v[174:175], v[142:143], v[22:23] op_sel:[0,0,0] op_sel_hi:[0,1,1]
    s_lshr_b32 s27, s27, 8
    s_set_gpr_idx_idx s27
    v_pk_fma_f32 v[16:17], v[170:171], v[144:145], v[16:17] op_sel:[1,0,0] op_sel_hi:[1,1,1]
    v_pk_fma_f32 v[18:19], v[170:171], v[146:147], v[18:19] op_sel:[1,0,0] op_sel_hi:[1,1,1]
    v_pk_fma_f32 v[20:21], v[174:175], v[148:149], v[20:21] op_sel:[1,0,0] op_sel_hi:[1,1,1]
    v_pk_fma_f32 v[22:23], v[174:175], v[150:151], v[22:23] op_sel:[1,0,0] op_sel_hi:[1,1,1]
    s_set_gpr_idx_off
    s_sub_u32 s26, s26, 1
    s_cmp_eq_u32 s26, 0
    s_cbranch_scc1 K2_LOOPDONE
    s_waitcnt lgkmcnt(0)
    s_waitcnt vmcnt(7)
    v_mfma_f32_4x4x4_16b_bf16 v[120:123], v[184:185], v[104:105], 0 cbsz:4 abid:12
    v_exp_f32 v168, v160
    v_mfma_f32_4x4x4_16b_bf16 v[124:127], v[184:185], v[106:107], 0 cbsz:4 abid:12
    buffer_load_dwordx4 v[72:75], v188, s[8:11], 0 offen
    v_exp_f32 v169, v161
    s_waitcnt vmcnt(7)
    v_mfma_f32_4x4x4_16b_bf16 v[128:131], v[184:185], v[108:109], 0 cbsz:4 abid:13
    v_exp_f32 v170, v162
    v_mfma_f32_4x4x4_16b_bf16 v[132:135], v[184:185], v[110:111], 0 cbsz:4 abid:13
    buffer_load_dwordx4 v[76:79], v189, s[8:11], 0 offen
    v_exp_f32 v171, v163
    s_waitcnt vmcnt(7)
    v_mfma_f32_4x4x4_16b_bf16 v[136:139], v[184:185], v[112:113], 0 cbsz:4 abid:14
    v_exp_f32 v172, v164
    v_mfma_f32_4x4x4_16b_bf16 v[140:143], v[184:185], v[114:115], 0 cbsz:4 abid:14
    buffer_load_dwordx4 v[80:83], v190, s[8:11], 0 offen
    v_exp_f32 v173, v165
    v_exp_f32 v174, v166
    v_exp_f32 v175, v167
    v_pk_add_f32 v[168:169], v[168:169], 1.0 op_sel_hi:[1,0]
    v_pk_add_f32 v[170:171], v[170:171], 1.0 op_sel_hi:[1,0]
    v_pk_add_f32 v[172:173], v[172:173], 1.0 op_sel_hi:[1,0]
    v_pk_add_f32 v[174:175], v[174:175], 1.0 op_sel_hi:[1,0]
    s_waitcnt vmcnt(7)
    v_mfma_f32_4x4x4_16b_bf16 v[144:147], v[184:185], v[116:117], 0 cbsz:4 abid:15
    v_rcp_f32 v168, v168
    v_mfma_f32_4x4x4_16b_bf16 v[148:151], v[184:185], v[118:119], 0 cbsz:4 abid:15
    buffer_load_dwordx4 v[84:87], v191, s[8:11], 0 offen
    v_rcp_f32 v169, v169
    ds_read_b128 v[188:191], v196 offset:96
    ds_read_b64 v[184:185], v198 offset:512
    v_mfma_f32_4x4x4_16b_bf16 v[152:155], v[186:187], v[176:177], 0 cbsz:4 abid:0
    v_rcp_f32 v170, v170
    v_mfma_f32_4x4x4_16b_bf16 v[156:159], v[186:187], v[180:181], 0 cbsz:4 abid:0
    v_rcp_f32 v171, v171
    v_mfma_f32_4x4x4_16b_bf16 v[152:155], v[186:187], v[178:179], v[152:155] cbsz:4 abid:0
    v_rcp_f32 v172, v172
    v_mfma_f32_4x4x4_16b_bf16 v[156:159], v[186:187], v[182:183], v[156:159] cbsz:4 abid:0
    v_rcp_f32 v173, v173
    v_rcp_f32 v174, v174
    v_rcp_f32 v175, v175
    v_readfirstlane_b32 s27, v195
    ds_read_b128 v[192:195], v197 offset:16
    v_add_u32 v196, 64, v196
    v_add_u32 v197, 16, v197
    v_add_u32 v198, 512, v198
    v_add_u32 v199, 256, v199
    v_pk_mul_f32 v[168:169], v[168:169], v[160:161]
    v_pk_mul_f32 v[170:171], v[170:171], v[162:163]
    v_pk_mul_f32 v[172:173], v[172:173], v[164:165]
    v_pk_mul_f32 v[174:175], v[174:175], v[166:167]
    s_set_gpr_idx_on s27, gpr_idx(SRC2,DST)
    v_pk_fma_f32 v[16:17], v[168:169], v[120:121], v[16:17] op_sel:[0,0,0] op_sel_hi:[0,1,1]
    v_pk_fma_f32 v[18:19], v[168:169], v[122:123], v[18:19] op_sel:[0,0,0] op_sel_hi:[0,1,1]
    v_pk_fma_f32 v[20:21], v[172:173], v[124:125], v[20:21] op_sel:[0,0,0] op_sel_hi:[0,1,1]
    v_pk_fma_f32 v[22:23], v[172:173], v[126:127], v[22:23] op_sel:[0,0,0] op_sel_hi:[0,1,1]
    s_lshr_b32 s27, s27, 8
    s_set_gpr_idx_idx s27
    v_pk_fma_f32 v[16:17], v[168:169], v[128:129], v[16:17] op_sel:[1,0,0] op_sel_hi:[1,1,1]
    v_pk_fma_f32 v[18:19], v[168:169], v[130:131], v[18:19] op_sel:[1,0,0] op_sel_hi:[1,1,1]
    v_pk_fma_f32 v[20:21], v[172:173], v[132:133], v[20:21] op_sel:[1,0,0] op_sel_hi:[1,1,1]
    v_pk_fma_f32 v[22:23], v[172:173], v[134:135], v[22:23] op_sel:[1,0,0] op_sel_hi:[1,1,1]
    s_lshr_b32 s27, s27, 8
    s_set_gpr_idx_idx s27
    v_pk_fma_f32 v[16:17], v[170:171], v[136:137], v[16:17] op_sel:[0,0,0] op_sel_hi:[0,1,1]
    v_pk_fma_f32 v[18:19], v[170:171], v[138:139], v[18:19] op_sel:[0,0,0] op_sel_hi:[0,1,1]
    v_pk_fma_f32 v[20:21], v[174:175], v[140:141], v[20:21] op_sel:[0,0,0] op_sel_hi:[0,1,1]
    v_pk_fma_f32 v[22:23], v[174:175], v[142:143], v[22:23] op_sel:[0,0,0] op_sel_hi:[0,1,1]
    s_lshr_b32 s27, s27, 8
    s_set_gpr_idx_idx s27
    v_pk_fma_f32 v[16:17], v[170:171], v[144:145], v[16:17] op_sel:[1,0,0] op_sel_hi:[1,1,1]
    v_pk_fma_f32 v[18:19], v[170:171], v[146:147], v[18:19] op_sel:[1,0,0] op_sel_hi:[1,1,1]
    v_pk_fma_f32 v[20:21], v[174:175], v[148:149], v[20:21] op_sel:[1,0,0] op_sel_hi:[1,1,1]
    v_pk_fma_f32 v[22:23], v[174:175], v[150:151], v[22:23] op_sel:[1,0,0] op_sel_hi:[1,1,1]
    s_set_gpr_idx_off
    s_sub_u32 s26, s26, 1
    s_cmp_eq_u32 s26, 0
    s_cbranch_scc0 K2_LOOP
K2_LOOPDONE:
    s_add_u32 s25, s25, 1536
    s_cmp_ge_u32 s25, s24
    s_cbranch_scc1 K2_EPI
    s_waitcnt vmcnt(0) lgkmcnt(0)
    ds_write_b128 v8, v[4:7]
    s_waitcnt lgkmcnt(0)
    s_barrier
    s_branch K2_ROUND
K2_EPI:
    s_mov_b32 s30, 0xbf317218
    s_mov_b32 s31, s30
    v_lshrrev_b32 v10, 2, v1
    v_lshlrev_b32 v10, 4, v10
    v_and_b32 v11, 3, v1
    v_lshl_or_b32 v10, v11, 2, v10
    s_mul_i32 s32, s3, 20
    v_pk_mul_f32 v[16:17], v[16:17], s[30:31]
    v_pk_mul_f32 v[18:19], v[18:19], s[30:31]
    v_pk_mul_f32 v[20:21], v[20:21], s[30:31]
    v_pk_mul_f32 v[22:23], v[22:23], s[30:31]
    v_pk_mul_f32 v[24:25], v[24:25], s[30:31]
    v_pk_mul_f32 v[26:27], v[26:27], s[30:31]
    v_pk_mul_f32 v[28:29], v[28:29], s[30:31]
    v_pk_mul_f32 v[30:31], v[30:31], s[30:31]
    v_pk_mul_f32 v[32:33], v[32:33], s[30:31]
    v_pk_mul_f32 v[34:35], v[34:35], s[30:31]
    v_pk_mul_f32 v[36:37], v[36:37], s[30:31]
    v_pk_mul_f32 v[38:39], v[38:39], s[30:31]
    v_pk_mul_f32 v[40:41], v[40:41], s[30:31]
    v_pk_mul_f32 v[42:43], v[42:43], s[30:31]
    v_pk_mul_f32 v[44:45], v[44:45], s[30:31]
    v_pk_mul_f32 v[46:47], v[46:47], s[30:31]
    v_pk_mul_f32 v[48:49], v[48:49], s[30:31]
    v_pk_mul_f32 v[50:51], v[50:51], s[30:31]
    v_pk_mul_f32 v[52:53], v[52:53], s[30:31]
    v_pk_mul_f32 v[54:55], v[54:55], s[30:31]
    s_waitcnt lgkmcnt(0)
    s_add_u32 s33, s32, 0
    s_and_b32 s34, s33, 15
    s_lshl_b32 s34, s34, 4
    s_lshl_b32 s33, s33, 8
    s_add_u32 s33, s33, 103168
    v_cvt_pk_bf16_f32 v168, v16, v20
    v_xor_b32 v172, s34, v10
    v_add_u32 v172, s33, v172
    ds_write_b32 v172, v168
    s_add_u32 s33, s32, 1
    s_and_b32 s34, s33, 15
    s_lshl_b32 s34, s34, 4
    s_lshl_b32 s33, s33, 8
    s_add_u32 s33, s33, 103168
    v_cvt_pk_bf16_f32 v169, v17, v21
    v_xor_b32 v173, s34, v10
    v_add_u32 v173, s33, v173
    ds_write_b32 v173, v169
    s_add_u32 s33, s32, 2
    s_and_b32 s34, s33, 15
    s_lshl_b32 s34, s34, 4
    s_lshl_b32 s33, s33, 8
    s_add_u32 s33, s33, 103168
    v_cvt_pk_bf16_f32 v170, v18, v22
    v_xor_b32 v174, s34, v10
    v_add_u32 v174, s33, v174
    ds_write_b32 v174, v170
    s_add_u32 s33, s32, 3
    s_and_b32 s34, s33, 15
    s_lshl_b32 s34, s34, 4
    s_lshl_b32 s33, s33, 8
    s_add_u32 s33, s33, 103168
    v_cvt_pk_bf16_f32 v171, v19, v23
    v_xor_b32 v175, s34, v10
    v_add_u32 v175, s33, v175
    ds_write_b32 v175, v171
    s_add_u32 s33, s32, 4
    s_and_b32 s34, s33, 15
    s_lshl_b32 s34, s34, 4
    s_lshl_b32 s33, s33, 8
    s_add_u32 s33, s33, 103168
    v_cvt_pk_bf16_f32 v168, v24, v28
    v_xor_b32 v172, s34, v10
    v_add_u32 v172, s33, v172
    ds_write_b32 v172, v168
    s_add_u32 s33, s32, 5
    s_and_b32 s34, s33, 15
    s_lshl_b32 s34, s34, 4
    s_lshl_b32 s33, s33, 8
    s_add_u32 s33, s33, 103168
    v_cvt_pk_bf16_f32 v169, v25, v29
    v_xor_b32 v173, s34, v10
    v_add_u32 v173, s33, v173
    ds_write_b32 v173, v169
    s_add_u32 s33, s32, 6
    s_and_b32 s34, s33, 15
    s_lshl_b32 s34, s34, 4
    s_lshl_b32 s33, s33, 8
    s_add_u32 s33, s33, 103168
    v_cvt_pk_bf16_f32 v170, v26, v30
    v_xor_b32 v174, s34, v10
    v_add_u32 v174, s33, v174
    ds_write_b32 v174, v170
    s_add_u32 s33, s32, 7
    s_and_b32 s34, s33, 15
    s_lshl_b32 s34, s34, 4
    s_lshl_b32 s33, s33, 8
    s_add_u32 s33, s33, 103168
    v_cvt_pk_bf16_f32 v171, v27, v31
    v_xor_b32 v175, s34, v10
    v_add_u32 v175, s33, v175
    ds_write_b32 v175, v171
    s_add_u32 s33, s32, 8
    s_and_b32 s34, s33, 15
    s_lshl_b32 s34, s34, 4
    s_lshl_b32 s33, s33, 8
    s_add_u32 s33, s33, 103168
    v_cvt_pk_bf16_f32 v168, v32, v36
    v_xor_b32 v172, s34, v10
    v_add_u32 v172, s33, v172
    ds_write_b32 v172, v168
    s_add_u32 s33, s32, 9
    s_and_b32 s34, s33, 15
    s_lshl_b32 s34, s34, 4
    s_lshl_b32 s33, s33, 8
    s_add_u32 s33, s33, 103168
    v_cvt_pk_bf16_f32 v169, v33, v37
    v_xor_b32 v173, s34, v10
    v_add_u32 v173, s33, v173
    ds_write_b32 v173, v169
    s_add_u32 s33, s32, 10
    s_and_b32 s34, s33, 15
    s_lshl_b32 s34, s34, 4
    s_lshl_b32 s33, s33, 8
    s_add_u32 s33, s33, 103168
    v_cvt_pk_bf16_f32 v170, v34, v38
    v_xor_b32 v174, s34, v10
    v_add_u32 v174, s33, v174
    ds_write_b32 v174, v170
    s_add_u32 s33, s32, 11
    s_and_b32 s34, s33, 15
    s_lshl_b32 s34, s34, 4
    s_lshl_b32 s33, s33, 8
    s_add_u32 s33, s33, 103168
    v_cvt_pk_bf16_f32 v171, v35, v39
    v_xor_b32 v175, s34, v10
    v_add_u32 v175, s33, v175
    ds_write_b32 v175, v171
    s_add_u32 s33, s32, 12
    s_and_b32 s34, s33, 15
    s_lshl_b32 s34, s34, 4
    s_lshl_b32 s33, s33, 8
    s_add_u32 s33, s33, 103168
    v_cvt_pk_bf16_f32 v168, v40, v44
    v_xor_b32 v172, s34, v10
    v_add_u32 v172, s33, v172
    ds_write_b32 v172, v168
    s_add_u32 s33, s32, 13
    s_and_b32 s34, s33, 15
    s_lshl_b32 s34, s34, 4
    s_lshl_b32 s33, s33, 8
    s_add_u32 s33, s33, 103168
    v_cvt_pk_bf16_f32 v169, v41, v45
    v_xor_b32 v173, s34, v10
    v_add_u32 v173, s33, v173
    ds_write_b32 v173, v169
    s_add_u32 s33, s32, 14
    s_and_b32 s34, s33, 15
    s_lshl_b32 s34, s34, 4
    s_lshl_b32 s33, s33, 8
    s_add_u32 s33, s33, 103168
    v_cvt_pk_bf16_f32 v170, v42, v46
    v_xor_b32 v174, s34, v10
    v_add_u32 v174, s33, v174
    ds_write_b32 v174, v170
    s_add_u32 s33, s32, 15
    s_and_b32 s34, s33, 15
    s_lshl_b32 s34, s34, 4
    s_lshl_b32 s33, s33, 8
    s_add_u32 s33, s33, 103168
    v_cvt_pk_bf16_f32 v171, v43, v47
    v_xor_b32 v175, s34, v10
    v_add_u32 v175, s33, v175
    ds_write_b32 v175, v171
    s_add_u32 s33, s32, 16
    s_and_b32 s34, s33, 15
    s_lshl_b32 s34, s34, 4
    s_lshl_b32 s33, s33, 8
    s_add_u32 s33, s33, 103168
    v_cvt_pk_bf16_f32 v168, v48, v52
    v_xor_b32 v172, s34, v10
    v_add_u32 v172, s33, v172
    ds_write_b32 v172, v168
    s_add_u32 s33, s32, 17
    s_and_b32 s34, s33, 15
    s_lshl_b32 s34, s34, 4
    s_lshl_b32 s33, s33, 8
    s_add_u32 s33, s33, 103168
    v_cvt_pk_bf16_f32 v169, v49, v53
    v_xor_b32 v173, s34, v10
    v_add_u32 v173, s33, v173
    ds_write_b32 v173, v169
    s_add_u32 s33, s32, 18
    s_and_b32 s34, s33, 15
    s_lshl_b32 s34, s34, 4
    s_lshl_b32 s33, s33, 8
    s_add_u32 s33, s33, 103168
    v_cvt_pk_bf16_f32 v170, v50, v54
    v_xor_b32 v174, s34, v10
    v_add_u32 v174, s33, v174
    ds_write_b32 v174, v170
    s_add_u32 s33, s32, 19
    s_and_b32 s34, s33, 15
    s_lshl_b32 s34, s34, 4
    s_lshl_b32 s33, s33, 8
    s_add_u32 s33, s33, 103168
    v_cvt_pk_bf16_f32 v171, v51, v55
    v_xor_b32 v175, s34, v10
    v_add_u32 v175, s33, v175
    ds_write_b32 v175, v171
    v_and_b32 v12, 15, v1
    v_lshrrev_b32 v11, 4, v1
    v_xor_b32 v13, v11, v12
    s_lshr_b32 s33, s3, 2
    s_lshl_b32 s34, s33, 12
    s_add_u32 s34, s34, 103168
    v_lshl_add_u32 v14, v12, 8, s34
    v_xor_b32 v152, 0, v13
    v_lshl_add_u32 v152, v152, 4, v14
    v_xor_b32 v153, 4, v13
    v_lshl_add_u32 v153, v153, 4, v14
    v_xor_b32 v154, 8, v13
    v_lshl_add_u32 v154, v154, 4, v14
    v_xor_b32 v155, 12, v13
    v_lshl_add_u32 v155, v155, 4, v14
    s_lshl_b32 s33, s33, 2
    s_add_u32 s33, s33, s16
    s_lshl_b32 s33, s33, 10
    s_and_b32 s34, s3, 3
    s_lshl_b32 s34, s34, 8
    s_add_u32 s33, s33, s34
    v_lshlrev_b32 v11, 10, v11
    v_lshl_add_u32 v11, v12, 4, v11
    v_add_u32 v11, s33, v11
    s_waitcnt vmcnt(0) lgkmcnt(0)
    s_barrier
    ds_read_b128 v[56:59], v152 offset:0
    ds_read_b128 v[60:63], v153 offset:0
    ds_read_b128 v[64:67], v154 offset:0
    ds_read_b128 v[68:71], v155 offset:0
    ds_read_b128 v[72:75], v152 offset:8192
    ds_read_b128 v[76:79], v153 offset:8192
    ds_read_b128 v[80:83], v154 offset:8192
    ds_read_b128 v[84:87], v155 offset:8192
    ds_read_b128 v[88:91], v152 offset:16384
    ds_read_b128 v[92:95], v153 offset:16384
    ds_read_b128 v[96:99], v154 offset:16384
    ds_read_b128 v[100:103], v155 offset:16384
    ds_read_b128 v[104:107], v152 offset:24576
    ds_read_b128 v[108:111], v153 offset:24576
    ds_read_b128 v[112:115], v154 offset:24576
    ds_read_b128 v[116:119], v155 offset:24576
    s_waitcnt lgkmcnt(15)
    v_mfma_f32_16x16x32_bf16 v[120:123], v[56:59], v[200:203], 0
    v_mfma_f32_16x16x32_bf16 v[124:127], v[56:59], v[216:219], 0
    s_waitcnt lgkmcnt(14)
    v_mfma_f32_16x16x32_bf16 v[120:123], v[60:63], v[204:207], v[120:123]
    v_mfma_f32_16x16x32_bf16 v[124:127], v[60:63], v[220:223], v[124:127]
    s_waitcnt lgkmcnt(13)
    v_mfma_f32_16x16x32_bf16 v[120:123], v[64:67], v[208:211], v[120:123]
    v_mfma_f32_16x16x32_bf16 v[124:127], v[64:67], v[224:227], v[124:127]
    s_waitcnt lgkmcnt(12)
    v_mfma_f32_16x16x32_bf16 v[120:123], v[68:71], v[212:215], v[120:123]
    v_mfma_f32_16x16x32_bf16 v[124:127], v[68:71], v[228:231], v[124:127]
    ds_read_b128 v[56:59], v152 offset:32768
    ds_read_b128 v[60:63], v153 offset:32768
    ds_read_b128 v[64:67], v154 offset:32768
    ds_read_b128 v[68:71], v155 offset:32768
    s_waitcnt lgkmcnt(15)
    v_mfma_f32_16x16x32_bf16 v[128:131], v[72:75], v[200:203], 0
    v_mfma_f32_16x16x32_bf16 v[132:135], v[72:75], v[216:219], 0
    s_waitcnt lgkmcnt(14)
    v_mfma_f32_16x16x32_bf16 v[128:131], v[76:79], v[204:207], v[128:131]
    v_mfma_f32_16x16x32_bf16 v[132:135], v[76:79], v[220:223], v[132:135]
    s_waitcnt lgkmcnt(13)
    v_mfma_f32_16x16x32_bf16 v[128:131], v[80:83], v[208:211], v[128:131]
    v_mfma_f32_16x16x32_bf16 v[132:135], v[80:83], v[224:227], v[132:135]
    s_waitcnt lgkmcnt(12)
    v_mfma_f32_16x16x32_bf16 v[128:131], v[84:87], v[212:215], v[128:131]
    v_mfma_f32_16x16x32_bf16 v[132:135], v[84:87], v[228:231], v[132:135]
    v_cvt_pk_bf16_f32 v136, v120, v121
    v_cvt_pk_bf16_f32 v137, v122, v123
    v_cvt_pk_bf16_f32 v138, v124, v125
    v_cvt_pk_bf16_f32 v139, v126, v127
    s_mov_b32 s33, 0
    buffer_store_dwordx4 v[136:139], v11, s[12:15], s33 offen
    s_waitcnt lgkmcnt(11)
    v_mfma_f32_16x16x32_bf16 v[120:123], v[88:91], v[200:203], 0
    v_mfma_f32_16x16x32_bf16 v[124:127], v[88:91], v[216:219], 0
    s_waitcnt lgkmcnt(10)
    v_mfma_f32_16x16x32_bf16 v[120:123], v[92:95], v[204:207], v[120:123]
    v_mfma_f32_16x16x32_bf16 v[124:127], v[92:95], v[220:223], v[124:127]
    s_waitcnt lgkmcnt(9)
    v_mfma_f32_16x16x32_bf16 v[120:123], v[96:99], v[208:211], v[120:123]
    v_mfma_f32_16x16x32_bf16 v[124:127], v[96:99], v[224:227], v[124:127]
    s_waitcnt lgkmcnt(8)
    v_mfma_f32_16x16x32_bf16 v[120:123], v[100:103], v[212:215], v[120:123]
    v_mfma_f32_16x16x32_bf16 v[124:127], v[100:103], v[228:231], v[124:127]
    v_cvt_pk_bf16_f32 v140, v128, v129
    v_cvt_pk_bf16_f32 v141, v130, v131
    v_cvt_pk_bf16_f32 v142, v132, v133
    v_cvt_pk_bf16_f32 v143, v134, v135
    s_mov_b32 s33, 8192
    buffer_store_dwordx4 v[140:143], v11, s[12:15], s33 offen
    s_waitcnt lgkmcnt(7)
    v_mfma_f32_16x16x32_bf16 v[128:131], v[104:107], v[200:203], 0
    v_mfma_f32_16x16x32_bf16 v[132:135], v[104:107], v[216:219], 0
    s_waitcnt lgkmcnt(6)
    v_mfma_f32_16x16x32_bf16 v[128:131], v[108:111], v[204:207], v[128:131]
    v_mfma_f32_16x16x32_bf16 v[132:135], v[108:111], v[220:223], v[132:135]
    s_waitcnt lgkmcnt(5)
    v_mfma_f32_16x16x32_bf16 v[128:131], v[112:115], v[208:211], v[128:131]
    v_mfma_f32_16x16x32_bf16 v[132:135], v[112:115], v[224:227], v[132:135]
    s_waitcnt lgkmcnt(4)
    v_mfma_f32_16x16x32_bf16 v[128:131], v[116:119], v[212:215], v[128:131]
    v_mfma_f32_16x16x32_bf16 v[132:135], v[116:119], v[228:231], v[132:135]
    v_cvt_pk_bf16_f32 v136, v120, v121
    v_cvt_pk_bf16_f32 v137, v122, v123
    v_cvt_pk_bf16_f32 v138, v124, v125
    v_cvt_pk_bf16_f32 v139, v126, v127
    s_mov_b32 s33, 16384
    buffer_store_dwordx4 v[136:139], v11, s[12:15], s33 offen
    s_waitcnt lgkmcnt(3)
    v_mfma_f32_16x16x32_bf16 v[120:123], v[56:59], v[200:203], 0
    v_mfma_f32_16x16x32_bf16 v[124:127], v[56:59], v[216:219], 0
    s_waitcnt lgkmcnt(2)
    v_mfma_f32_16x16x32_bf16 v[120:123], v[60:63], v[204:207], v[120:123]
    v_mfma_f32_16x16x32_bf16 v[124:127], v[60:63], v[220:223], v[124:127]
    s_waitcnt lgkmcnt(1)
    v_mfma_f32_16x16x32_bf16 v[120:123], v[64:67], v[208:211], v[120:123]
    v_mfma_f32_16x16x32_bf16 v[124:127], v[64:67], v[224:227], v[124:127]
    s_waitcnt lgkmcnt(0)
    v_mfma_f32_16x16x32_bf16 v[120:123], v[68:71], v[212:215], v[120:123]
    v_mfma_f32_16x16x32_bf16 v[124:127], v[68:71], v[228:231], v[124:127]
    v_cvt_pk_bf16_f32 v140, v128, v129
    v_cvt_pk_bf16_f32 v141, v130, v131
    v_cvt_pk_bf16_f32 v142, v132, v133
    v_cvt_pk_bf16_f32 v143, v134, v135
    s_mov_b32 s33, 24576
    buffer_store_dwordx4 v[140:143], v11, s[12:15], s33 offen
    s_nop 0
    v_cvt_pk_bf16_f32 v136, v120, v121
    v_cvt_pk_bf16_f32 v137, v122, v123
    v_cvt_pk_bf16_f32 v138, v124, v125
    v_cvt_pk_bf16_f32 v139, v126, v127
    s_mov_b32 s33, 32768
    buffer_store_dwordx4 v[136:139], v11, s[12:15], s33 offen
K2_END:
    s_endpgm
.section .rodata,"a"
.p2align 6
.amdhsa_kernel part_kernel
  .amdhsa_next_free_vgpr 48
  .amdhsa_next_free_sgpr 64
  .amdhsa_accum_offset 48
  .amdhsa_group_segment_fixed_size 0
  .amdhsa_kernarg_size 88
  .amdhsa_user_sgpr_count 2
  .amdhsa_user_sgpr_kernarg_segment_ptr 1
  .amdhsa_system_sgpr_workgroup_id_x 1
  .amdhsa_float_denorm_mode_32 3
.end_amdhsa_kernel
.p2align 6
.amdhsa_kernel main_kernel
  .amdhsa_next_free_vgpr 256
  .amdhsa_next_free_sgpr 64
  .amdhsa_accum_offset 256
  .amdhsa_group_segment_fixed_size 0
  .amdhsa_kernarg_size 88
  .amdhsa_user_sgpr_count 2
  .amdhsa_user_sgpr_kernarg_segment_ptr 1
  .amdhsa_system_sgpr_workgroup_id_x 1
  .amdhsa_float_denorm_mode_32 3
.end_amdhsa_kernel
```

```asm
; @launch kernel=part_kernel grid=(256,1,1) block=(704,1,1) lds=27200
; @launch kernel=main_kernel grid=(256,1,1) block=(512,1,1) lds=146432
.amdgcn_target "amdgcn-amd-amdhsa--gfx950"
.text
.globl part_kernel
.p2align 8
.type part_kernel,@function
part_kernel:
    s_cmp_ge_u32 s2, 256
    s_cbranch_scc1 K1_END
    s_load_dwordx16 s[4:19], s[0:1], 0
    s_load_dwordx2 s[20:21], s[0:1], 80
    v_lshrrev_b32 v1, 6, v0
    v_lshlrev_b32 v2, 2, v0
    v_mov_b32 v3, 0
    v_readfirstlane_b32 s3, v1
    v_cmp_gt_u32 vcc, 256, v0
    s_and_saveexec_b64 s[22:23], vcc
    ds_write_b32 v2, v3 offset:0
    s_mov_b64 exec, s[22:23]
    s_and_b32 s24, s2, 7
    s_lshl_b32 s24, s24, 5
    s_lshr_b32 s25, s2, 3
    s_add_u32 s24, s24, s25
    s_cmp_eq_u32 s3, 10
    s_cbranch_scc1 K1_SIDE
    s_mul_i32 s25, s2, 5000
    v_lshlrev_b32 v4, 3, v0
    v_add_u32 v4, s25, v4
    v_lshlrev_b32 v5, 1, v4
    v_cmp_gt_u32 vcc, 625, v0
    s_and_b64 s[26:27], vcc, exec
    s_mov_b64 exec, s[26:27]
    s_waitcnt lgkmcnt(0)
    global_load_dwordx2 v[6:7], v4, s[8:9]
    global_load_dwordx2 v[8:9], v4, s[6:7]
    global_load_dwordx4 v[12:15], v5, s[10:11]
    global_load_dwordx4 v[16:19], v5, s[12:13]
    v_mov_b32 v20, 1
    s_barrier
    s_waitcnt vmcnt(3)
    v_mul_u32_u24 v22, 214749, v6
    v_mul_u32_u24 v23, 214749, v7
    v_lshrrev_b32 v22, 23, v22
    v_lshrrev_b32 v23, 23, v23
    v_lshlrev_b32 v24, 2, v22
    ds_add_rtn_u32 v26, v24, v20 offset:0
    v_lshlrev_b32 v25, 2, v23
    ds_add_rtn_u32 v27, v25, v20 offset:0
    v_mul_u32_u24 v28, 625, v22
    v_add_u32 v28, 15, v28
    v_lshrrev_b32 v28, 4, v28
    v_sub_u32 v28, v6, v28
    v_lshlrev_b32 v30, 4, v28
    v_mul_u32_u24 v29, 625, v23
    v_add_u32 v29, 15, v29
    v_lshrrev_b32 v29, 4, v29
    v_sub_u32 v29, v7, v29
    v_lshlrev_b32 v31, 4, v29
    s_waitcnt vmcnt(2)
    v_mul_u32_u24 v32, 1677, v8
    v_lshrrev_b32 v32, 20, v32
    v_lshl_or_b32 v30, v8, 10, v30
    v_or_b32 v30, v30, v32
    v_mul_u32_u24 v33, 1677, v9
    v_lshrrev_b32 v33, 20, v33
    v_lshl_or_b32 v31, v9, 10, v31
    v_or_b32 v31, v31, v33
    s_mov_b64 exec, -1
    v_and_b32 v1, 63, v0
    v_lshlrev_b32 v2, 4, v1
    s_waitcnt lgkmcnt(0)
    s_barrier
    ds_read_b128 v[36:39], v2 offset:0
    s_waitcnt lgkmcnt(0)
    v_add_u32 v41, v36, v37
    v_add_u32 v42, v41, v38
    v_add_u32 v43, v42, v39
    v_mov_b32 v44, v43
    s_nop 1
    v_add_u32_dpp v44, v44, v44 row_shr:1 row_mask:0xf bank_mask:0xf
    s_nop 1
    v_add_u32_dpp v44, v44, v44 row_shr:2 row_mask:0xf bank_mask:0xf
    s_nop 1
    v_add_u32_dpp v44, v44, v44 row_shr:4 row_mask:0xf bank_mask:0xf
    s_nop 1
    v_add_u32_dpp v44, v44, v44 row_shr:8 row_mask:0xf bank_mask:0xf
    s_nop 1
    v_add_u32_dpp v44, v44, v44 row_bcast:15 row_mask:0xa bank_mask:0xf
    s_nop 1
    v_add_u32_dpp v44, v44, v44 row_bcast:31 row_mask:0xc bank_mask:0xf
    v_sub_u32 v44, v44, v43
    v_add_u32 v45, v44, v36
    v_add_u32 v46, v44, v41
    v_add_u32 v47, v44, v42
    ds_write_b128 v2, v[44:47] offset:1024
    s_mov_b64 exec, s[26:27]
    ds_read_b32 v34, v24 offset:1024
    ds_read_b32 v35, v25 offset:1024
    s_mov_b64 exec, -1
    s_cmp_ge_u32 s3, 4
    s_cbranch_scc1 K1_NOTAB
    s_set_gpr_idx_on s3, gpr_idx(SRC0)
    v_mov_b32 v40, v44
    v_mov_b32 v41, v36
    s_set_gpr_idx_off
    v_lshl_or_b32 v40, v41, 16, v40
    s_lshl_b32 s28, s3, 10
    s_lshl_b32 s29, s24, 2
    s_add_u32 s28, s28, s29
    v_lshlrev_b32 v41, 12, v1
    v_add_u32 v41, s28, v41
    global_store_dword v41, v40, s[20:21]
K1_NOTAB:
    s_mov_b64 exec, s[26:27]
    s_waitcnt lgkmcnt(0)
    v_add_u32 v34, v34, v26
    v_lshlrev_b32 v26, 2, v34
    ds_write_b32 v26, v30 offset:2048
    v_lshlrev_b32 v34, 4, v34
    v_add_u32 v34, 7168, v34
    v_add_u32 v35, v35, v27
    v_lshlrev_b32 v27, 2, v35
    ds_write_b32 v27, v31 offset:2048
    v_lshlrev_b32 v35, 4, v35
    v_add_u32 v35, 7168, v35
    s_waitcnt vmcnt(1)
    s_cmp_ge_u32 s3, 4
    s_cbranch_scc0 K1_W1
    s_waitcnt vmcnt(0)
K1_W1:
    ds_write2_b64 v34, v[12:13], v[16:17] offset0:0 offset1:1
    ds_write2_b64 v35, v[14:15], v[18:19] offset0:0 offset1:1
    v_lshlrev_b32 v4, 3, v0
    v_lshlrev_b32 v5, 4, v0
    s_mul_i32 s28, s24, 5000
    s_mul_i32 s29, s24, 20000
    s_add_u32 s28, s28, 262144
    s_add_u32 s29, s29, 1572864
    v_add_u32 v6, s28, v4
    v_add_u32 v7, s29, v5
    v_add_u32 v10, 10000, v7
    s_waitcnt lgkmcnt(0)
    s_barrier
    ds_read_b128 v[12:15], v5 offset:7168
    ds_read_b128 v[16:19], v5 offset:17168
    ds_read_b64 v[8:9], v4 offset:2048
    s_waitcnt lgkmcnt(2)
    global_store_dwordx4 v7, v[12:15], s[20:21]
    s_waitcnt lgkmcnt(1)
    global_store_dwordx4 v10, v[16:19], s[20:21]
    s_waitcnt lgkmcnt(0)
    global_store_dwordx2 v6, v[8:9], s[20:21]
    s_endpgm
K1_SIDE:
    v_and_b32 v1, 63, v0
    s_waitcnt lgkmcnt(0)
    s_cmp_lt_u32 s2, 32
    s_cbranch_scc1 K1_WM
    s_cmp_eq_u32 s2, 32
    s_cbranch_scc1 K1_WR
    s_cmp_eq_u32 s2, 33
    s_cbranch_scc1 K1_CG
    s_mul_i32 s30, s2, 40000
    v_mul_u32_u24 v30, 128, v1
    v_add_u32 v30, s30, v30
    s_mov_b32 s36, s4
    s_mov_b32 s37, s5
    s_mov_b32 s38, 10240000
    s_mov_b32 s39, 0x20000
    s_mov_b32 s31, 0
    buffer_load_dword v31, v30, s[36:39], s31 offen
    s_mov_b32 s31, 8192
    buffer_load_dword v31, v30, s[36:39], s31 offen
    s_mov_b32 s31, 16384
    buffer_load_dword v31, v30, s[36:39], s31 offen
    s_mov_b32 s31, 24576
    buffer_load_dword v31, v30, s[36:39], s31 offen
    s_mov_b32 s31, 32768
    buffer_load_dword v31, v30, s[36:39], s31 offen
    s_barrier
    s_barrier
    s_barrier
    s_endpgm
K1_WM:
    s_lshr_b32 s28, s2, 3
    s_lshl_b32 s28, s28, 6
    s_bfe_u32 s29, s2, 0x10002
    s_lshl_b32 s29, s29, 1
    s_add_u32 s28, s28, s29
    s_and_b32 s29, s2, 3
    s_lshl_b32 s29, s29, 13
    s_add_u32 s28, s28, s29
    v_lshrrev_b32 v2, 4, v1
    v_lshlrev_b32 v2, 11, v2
    v_and_b32 v3, 15, v1
    v_lshl_or_b32 v2, v3, 2, v2
    v_add_u32 v2, s28, v2
    global_load_ushort v4, v2, s[18:19] offset:0
    global_load_ushort v5, v2, s[18:19] offset:256
    global_load_ushort v6, v2, s[18:19] offset:512
    global_load_ushort v7, v2, s[18:19] offset:768
    global_load_ushort v8, v2, s[18:19] offset:1024
    global_load_ushort v9, v2, s[18:19] offset:1280
    global_load_ushort v10, v2, s[18:19] offset:1536
    global_load_ushort v11, v2, s[18:19] offset:1792
    s_mul_i32 s30, s2, 40000
    v_mul_u32_u24 v30, 128, v1
    v_add_u32 v30, s30, v30
    s_mov_b32 s36, s4
    s_mov_b32 s37, s5
    s_mov_b32 s38, 10240000
    s_mov_b32 s39, 0x20000
    s_mov_b32 s31, 0
    buffer_load_dword v31, v30, s[36:39], s31 offen
    s_mov_b32 s31, 8192
    buffer_load_dword v31, v30, s[36:39], s31 offen
    s_mov_b32 s31, 16384
    buffer_load_dword v31, v30, s[36:39], s31 offen
    s_mov_b32 s31, 24576
    buffer_load_dword v31, v30, s[36:39], s31 offen
    s_mov_b32 s31, 32768
    buffer_load_dword v31, v30, s[36:39], s31 offen
    s_barrier
    s_barrier
    s_barrier
    s_waitcnt vmcnt(5)
    v_lshl_or_b32 v12, v5, 16, v4
    v_lshl_or_b32 v13, v7, 16, v6
    v_lshl_or_b32 v14, v9, 16, v8
    v_lshl_or_b32 v15, v11, 16, v10
    s_lshl_b32 s28, s2, 10
    s_add_u32 s28, s28, 6815744
    v_lshlrev_b32 v2, 4, v1
    v_add_u32 v2, s28, v2
    global_store_dwordx4 v2, v[12:15], s[20:21]
    s_endpgm
K1_WR:
    v_lshlrev_b32 v2, 2, v1
    global_load_dword v4, v2, s[14:15] offset:0
    global_load_dword v5, v2, s[14:15] offset:256
    global_load_dword v6, v2, s[14:15] offset:512
    global_load_dword v7, v2, s[14:15] offset:768
    s_mul_i32 s30, s2, 40000
    v_mul_u32_u24 v30, 128, v1
    v_add_u32 v30, s30, v30
    s_mov_b32 s36, s4
    s_mov_b32 s37, s5
    s_mov_b32 s38, 10240000
    s_mov_b32 s39, 0x20000
    s_mov_b32 s31, 0
    buffer_load_dword v31, v30, s[36:39], s31 offen
    s_mov_b32 s31, 8192
    buffer_load_dword v31, v30, s[36:39], s31 offen
    s_mov_b32 s31, 16384
    buffer_load_dword v31, v30, s[36:39], s31 offen
    s_mov_b32 s31, 24576
    buffer_load_dword v31, v30, s[36:39], s31 offen
    s_mov_b32 s31, 32768
    buffer_load_dword v31, v30, s[36:39], s31 offen
    s_barrier
    s_barrier
    s_barrier
    s_waitcnt vmcnt(5)
    s_mov_b32 s28, 0xbfb8aa3b
    v_lshlrev_b32 v2, 4, v1
    v_add_u32 v2, 6750208, v2
    v_lshlrev_b32 v8, 16, v4
    v_mul_f32 v12, s28, v8
    v_lshlrev_b32 v9, 16, v5
    v_mul_f32 v13, s28, v9
    v_lshlrev_b32 v10, 16, v6
    v_mul_f32 v14, s28, v10
    v_lshlrev_b32 v11, 16, v7
    v_mul_f32 v15, s28, v11
    v_cvt_pk_bf16_f32 v20, v12, v13
    v_cvt_pk_bf16_f32 v21, v14, v15
    v_lshlrev_b32 v16, 16, v20
    v_fma_f32 v16, s28, v8, -v16
    v_and_b32 v17, 0xffff0000, v20
    v_fma_f32 v17, s28, v9, -v17
    v_lshlrev_b32 v18, 16, v21
    v_fma_f32 v18, s28, v10, -v18
    v_and_b32 v19, 0xffff0000, v21
    v_fma_f32 v19, s28, v11, -v19
    v_cvt_pk_bf16_f32 v22, v16, v17
    v_cvt_pk_bf16_f32 v23, v18, v19
    global_store_dwordx4 v2, v[20:23], s[20:21] offset:0
    v_and_b32 v8, 0xffff0000, v4
    v_mul_f32 v12, s28, v8
    v_and_b32 v9, 0xffff0000, v5
    v_mul_f32 v13, s28, v9
    v_and_b32 v10, 0xffff0000, v6
    v_mul_f32 v14, s28, v10
    v_and_b32 v11, 0xffff0000, v7
    v_mul_f32 v15, s28, v11
    v_cvt_pk_bf16_f32 v24, v12, v13
    v_cvt_pk_bf16_f32 v25, v14, v15
    v_lshlrev_b32 v16, 16, v24
    v_fma_f32 v16, s28, v8, -v16
    v_and_b32 v17, 0xffff0000, v24
    v_fma_f32 v17, s28, v9, -v17
    v_lshlrev_b32 v18, 16, v25
    v_fma_f32 v18, s28, v10, -v18
    v_and_b32 v19, 0xffff0000, v25
    v_fma_f32 v19, s28, v11, -v19
    v_cvt_pk_bf16_f32 v26, v16, v17
    v_cvt_pk_bf16_f32 v27, v18, v19
    global_store_dwordx4 v2, v[24:27], s[20:21] offset:1024
    s_endpgm
K1_CG:
    v_and_b32 v2, 3, v1
    v_lshlrev_b32 v2, 5, v2
    v_bfe_u32 v3, v1, 2, 2
    v_lshl_or_b32 v2, v3, 1, v2
    global_load_ushort v4, v2, s[16:17] offset:0
    global_load_ushort v5, v2, s[16:17] offset:8
    global_load_ushort v6, v2, s[16:17] offset:16
    global_load_ushort v7, v2, s[16:17] offset:24
    s_mul_i32 s30, s2, 40000
    v_mul_u32_u24 v30, 128, v1
    v_add_u32 v30, s30, v30
    s_mov_b32 s36, s4
    s_mov_b32 s37, s5
    s_mov_b32 s38, 10240000
    s_mov_b32 s39, 0x20000
    s_mov_b32 s31, 0
    buffer_load_dword v31, v30, s[36:39], s31 offen
    s_mov_b32 s31, 8192
    buffer_load_dword v31, v30, s[36:39], s31 offen
    s_mov_b32 s31, 16384
    buffer_load_dword v31, v30, s[36:39], s31 offen
    s_mov_b32 s31, 24576
    buffer_load_dword v31, v30, s[36:39], s31 offen
    s_mov_b32 s31, 32768
    buffer_load_dword v31, v30, s[36:39], s31 offen
    s_barrier
    s_barrier
    s_barrier
    s_waitcnt vmcnt(5)
    v_lshl_or_b32 v8, v5, 16, v4
    v_lshl_or_b32 v9, v7, 16, v6
    v_lshrrev_b32 v3, 4, v1
    v_cmp_eq_u32 vcc, 0, v3
    s_nop 1
    v_cndmask_b32 v12, 0, v8, vcc
    v_cndmask_b32 v13, 0, v9, vcc
    v_cmp_eq_u32 vcc, 1, v3
    s_nop 1
    v_cndmask_b32 v14, 0, v8, vcc
    v_cndmask_b32 v15, 0, v9, vcc
    v_cmp_eq_u32 vcc, 2, v3
    s_nop 1
    v_cndmask_b32 v16, 0, v8, vcc
    v_cndmask_b32 v17, 0, v9, vcc
    v_cmp_eq_u32 vcc, 3, v3
    s_nop 1
    v_cndmask_b32 v18, 0, v8, vcc
    v_cndmask_b32 v19, 0, v9, vcc
    v_lshlrev_b32 v2, 4, v1
    v_add_u32 v2, 6752256, v2
    global_store_dwordx4 v2, v[12:15], s[20:21]
    global_store_dwordx4 v2, v[16:19], s[20:21] offset:1024
K1_END:
    s_endpgm
.globl main_kernel
.p2align 8
.type main_kernel,@function
main_kernel:
    s_cmp_ge_u32 s2, 256
    s_cbranch_scc1 K2_END
    s_load_dwordx2 s[4:5], s[0:1], 0
    s_load_dwordx2 s[6:7], s[0:1], 64
    s_load_dwordx2 s[20:21], s[0:1], 80
    s_and_b32 s3, s2, 7
    s_lshr_b32 s2, s2, 3
    s_lshl_b32 s3, s3, 5
    s_or_b32 s2, s2, s3
    v_lshrrev_b32 v2, 6, v0
    v_and_b32 v1, 63, v0
    v_lshlrev_b32 v3, 2, v0
    v_readfirstlane_b32 s3, v2
    v_mov_b32 v4, 0
    v_mov_b32 v5, 0
    v_mov_b32 v6, 0
    v_mov_b32 v7, 0
    v_lshlrev_b32 v8, 4, v0
    v_add_u32 v8, 105472, v8
    ds_write_b128 v8, v[4:7]
    v_cvt_f32_u32 v10, v1
    v_cmp_le_u32 vcc, 128, v0
    v_lshlrev_b32 v9, 4, v1
    s_getpc_b64 s[18:19]
K2_PC:
    s_add_u32 s18, s18, K2_TAB-K2_PC
    s_addc_u32 s19, s19, 0
    v_cndmask_b32 v10, 0, v10, vcc
    v_cmp_gt_u32 vcc, 192, v0
    s_and_saveexec_b64 s[22:23], vcc
    ds_write_b32 v3, v10 offset:0
    s_mov_b64 exec, s[22:23]
    s_mul_i32 s16, s2, 625
    s_add_u32 s17, s16, 640
    s_add_u32 s16, s16, 15
    s_lshr_b32 s16, s16, 4
    s_lshr_b32 s17, s17, 4
    s_sub_u32 s30, s17, s16
    s_sub_u32 s30, s30, 39
    s_lshl_b32 s30, s30, 6
    v_add_u32 v11, s30, v1
    s_lshl_b32 s30, s2, 10
    v_add_u32 v10, s30, v9
    s_waitcnt lgkmcnt(0)
    global_load_dwordx4 v[120:123], v10, s[20:21]
    global_load_ubyte v2, v11, s[18:19]
    s_mov_b32 s8, s4
    s_and_b32 s9, s5, 0xffff
    s_or_b32 s9, s9, 0x100000
    s_mov_b32 s10, 10240000
    s_mov_b32 s11, 0x800000
    s_mov_b32 s12, s6
    s_mov_b32 s13, s7
    s_lshl_b32 s14, s17, 10
    s_mov_b32 s15, 0x20000
    s_barrier
    v_mov_b32 v16, 0
    v_mov_b32 v17, 0
    v_mov_b32 v18, 0
    v_mov_b32 v19, 0
    v_mov_b32 v20, 0
    v_mov_b32 v21, 0
    v_mov_b32 v22, 0
    v_mov_b32 v23, 0
    v_mov_b32 v24, 0
    v_mov_b32 v25, 0
    v_mov_b32 v26, 0
    v_mov_b32 v27, 0
    v_mov_b32 v28, 0
    v_mov_b32 v29, 0
    v_mov_b32 v30, 0
    v_mov_b32 v31, 0
    v_mov_b32 v32, 0
    v_mov_b32 v33, 0
    v_mov_b32 v34, 0
    v_mov_b32 v35, 0
    v_mov_b32 v36, 0
    v_mov_b32 v37, 0
    v_mov_b32 v38, 0
    v_mov_b32 v39, 0
    v_mov_b32 v40, 0
    v_mov_b32 v41, 0
    v_mov_b32 v42, 0
    v_mov_b32 v43, 0
    v_mov_b32 v44, 0
    v_mov_b32 v45, 0
    v_mov_b32 v46, 0
    v_mov_b32 v47, 0
    v_mov_b32 v48, 0
    v_mov_b32 v49, 0
    v_mov_b32 v50, 0
    v_mov_b32 v51, 0
    v_mov_b32 v52, 0
    v_mov_b32 v53, 0
    v_mov_b32 v54, 0
    v_mov_b32 v55, 0
    v_mul_u32_u24 v13, 5000, v1
    s_waitcnt vmcnt(1)
    v_lshrrev_b32 v124, 16, v120
    v_and_b32 v120, 0xffff, v120
    v_lshrrev_b32 v125, 16, v121
    v_and_b32 v121, 0xffff, v121
    v_lshrrev_b32 v126, 16, v122
    v_and_b32 v122, 0xffff, v122
    v_lshrrev_b32 v127, 16, v123
    v_and_b32 v123, 0xffff, v123
    v_add_u32 v129, v124, v125
    v_add_u32 v130, v129, v126
    v_add_u32 v131, v130, v127
    v_mov_b32 v132, v131
    v_add3_u32 v248, v13, v120, 0
    v_add_u32 v249, 1250, v121
    v_add_u32 v249, v13, v249
    v_add_u32 v250, 2500, v122
    v_add_u32 v250, v13, v250
    v_add_u32 v251, 3750, v123
    v_add_u32 v251, v13, v251
    v_add_u32_dpp v132, v132, v132 row_shr:1 row_mask:0xf bank_mask:0xf
    s_nop 1
    v_add_u32_dpp v132, v132, v132 row_shr:2 row_mask:0xf bank_mask:0xf
    s_nop 1
    v_add_u32_dpp v132, v132, v132 row_shr:4 row_mask:0xf bank_mask:0xf
    s_nop 1
    v_add_u32_dpp v132, v132, v132 row_shr:8 row_mask:0xf bank_mask:0xf
    s_nop 1
    v_add_u32_dpp v132, v132, v132 row_bcast:15 row_mask:0xa bank_mask:0xf
    s_nop 1
    v_add_u32_dpp v132, v132, v132 row_bcast:31 row_mask:0xc bank_mask:0xf
    s_nop 0
    v_readlane_b32 s24, v132, 63
    v_sub_u32 v240, v132, v131
    v_add_u32 v241, v240, v124
    v_add_u32 v242, v240, v129
    v_add_u32 v243, v240, v130
    v_sub_u32 v248, v248, v240
    v_add_u32 v244, v240, v124
    v_sub_u32 v249, v249, v241
    v_add_u32 v245, v241, v125
    v_sub_u32 v250, v250, v242
    v_add_u32 v246, v242, v126
    v_sub_u32 v251, v251, v243
    v_add_u32 v247, v243, v127
    s_mov_b32 s25, 0
K2_ROUND:
    s_mul_i32 s30, s3, 192
    s_add_u32 s30, s30, s25
    s_add_u32 s31, s30, 192
    s_lshl_b32 s32, s3, 10
    s_add_u32 s32, s32, 105472
    v_subrev_u32 v56, s30, v240
    v_max_i32 v56, 0, v56
    v_lshl_add_u32 v56, v56, 2, s32
    v_subrev_u32 v57, s30, v241
    v_max_i32 v57, 0, v57
    v_lshl_add_u32 v57, v57, 2, s32
    v_subrev_u32 v58, s30, v242
    v_max_i32 v58, 0, v58
    v_lshl_add_u32 v58, v58, 2, s32
    v_subrev_u32 v59, s30, v243
    v_max_i32 v59, 0, v59
    v_lshl_add_u32 v59, v59, 2, s32
    v_cmp_lt_u32 vcc, s30, v244
    v_cmp_gt_u32 s[34:35], s31, v240
    s_and_b64 exec, vcc, s[34:35]
    ds_max_u32 v56, v248
    s_mov_b64 exec, -1
    v_cmp_lt_u32 vcc, s30, v245
    v_cmp_gt_u32 s[34:35], s31, v241
    s_and_b64 exec, vcc, s[34:35]
    ds_max_u32 v57, v249
    s_mov_b64 exec, -1
    v_cmp_lt_u32 vcc, s30, v246
    v_cmp_gt_u32 s[34:35], s31, v242
    s_and_b64 exec, vcc, s[34:35]
    ds_max_u32 v58, v250
    s_mov_b64 exec, -1
    v_cmp_lt_u32 vcc, s30, v247
    v_cmp_gt_u32 s[34:35], s31, v243
    s_and_b64 exec, vcc, s[34:35]
    ds_max_u32 v59, v251
    s_mov_b64 exec, -1
    v_lshl_add_u32 v60, v1, 2, s32
    ds_read_b32 v64, v60 offset:0
    ds_read_b32 v65, v60 offset:256
    ds_read_b32 v66, v60 offset:512
    v_add_u32 v68, s30, v1
    v_add_u32 v69, 64, v68
    v_add_u32 v70, 128, v68
    v_cmp_gt_u32 s[36:37], s24, v68
    v_cmp_gt_u32 s[38:39], s24, v69
    v_cmp_gt_u32 s[40:41], s24, v70
    s_waitcnt lgkmcnt(0)
    v_max_u32_dpp v64, v64, v64 row_shr:1 row_mask:0xf bank_mask:0xf
    v_max_u32_dpp v65, v65, v65 row_shr:1 row_mask:0xf bank_mask:0xf
    v_max_u32_dpp v66, v66, v66 row_shr:1 row_mask:0xf bank_mask:0xf
    v_max_u32_dpp v64, v64, v64 row_shr:2 row_mask:0xf bank_mask:0xf
    v_max_u32_dpp v65, v65, v65 row_shr:2 row_mask:0xf bank_mask:0xf
    v_max_u32_dpp v66, v66, v66 row_shr:2 row_mask:0xf bank_mask:0xf
    v_max_u32_dpp v64, v64, v64 row_shr:4 row_mask:0xf bank_mask:0xf
    v_max_u32_dpp v65, v65, v65 row_shr:4 row_mask:0xf bank_mask:0xf
    v_max_u32_dpp v66, v66, v66 row_shr:4 row_mask:0xf bank_mask:0xf
    v_max_u32_dpp v64, v64, v64 row_shr:8 row_mask:0xf bank_mask:0xf
    v_max_u32_dpp v65, v65, v65 row_shr:8 row_mask:0xf bank_mask:0xf
    v_max_u32_dpp v66, v66, v66 row_shr:8 row_mask:0xf bank_mask:0xf
    v_max_u32_dpp v64, v64, v64 row_bcast:15 row_mask:0xa bank_mask:0xf
    v_max_u32_dpp v65, v65, v65 row_bcast:15 row_mask:0xa bank_mask:0xf
    v_max_u32_dpp v66, v66, v66 row_bcast:15 row_mask:0xa bank_mask:0xf
    v_max_u32_dpp v64, v64, v64 row_bcast:31 row_mask:0xc bank_mask:0xf
    v_max_u32_dpp v65, v65, v65 row_bcast:31 row_mask:0xc bank_mask:0xf
    v_max_u32_dpp v66, v66, v66 row_bcast:31 row_mask:0xc bank_mask:0xf
    v_readlane_b32 s33, v64, 63
    v_readlane_b32 s34, v65, 63
    s_max_u32 s34, s33, s34
    v_max_u32 v65, s33, v65
    v_max_u32 v66, s34, v66
    v_add_u32 v68, v68, v64
    v_lshlrev_b32 v88, 2, v68
    v_add_u32 v88, 262144, v88
    v_lshlrev_b32 v91, 4, v68
    v_add_u32 v91, 1572864, v91
    v_add_u32 v69, v69, v65
    v_lshlrev_b32 v89, 2, v69
    v_add_u32 v89, 262144, v89
    v_lshlrev_b32 v92, 4, v69
    v_add_u32 v92, 1572864, v92
    v_add_u32 v70, v70, v66
    v_lshlrev_b32 v90, 2, v70
    v_add_u32 v90, 262144, v90
    v_lshlrev_b32 v93, 4, v70
    v_add_u32 v93, 1572864, v93
    s_mov_b32 s44, s20
    s_mov_b32 s45, s21
    s_mov_b32 s46, 0x662000
    s_mov_b32 s47, 0x20000
    s_mov_b64 exec, s[36:37]
    buffer_load_dword v72, v88, s[44:47], 0 offen
    s_mov_b64 exec, s[38:39]
    buffer_load_dword v73, v89, s[44:47], 0 offen
    s_mov_b64 exec, s[40:41]
    buffer_load_dword v74, v90, s[44:47], 0 offen
    s_mov_b64 exec, s[36:37]
    buffer_load_dwordx4 v[76:79], v91, s[44:47], 0 offen
    s_mov_b64 exec, s[38:39]
    buffer_load_dwordx4 v[80:83], v92, s[44:47], 0 offen
    s_mov_b64 exec, s[40:41]
    buffer_load_dwordx4 v[84:87], v93, s[44:47], 0 offen
    s_mov_b64 exec, -1
    v_mov_b32 v14, 0x42800000
    s_cmp_lg_u32 s25, 0
    s_cbranch_scc1 K2_NOBAL
    s_waitcnt vmcnt(5)
    s_mov_b64 exec, s[36:37]
    v_lshrrev_b32 v88, 2, v72
    v_and_b32 v88, 0xfc, v88
    ds_add_f32 v88, v14 offset:512
    s_waitcnt vmcnt(4)
    s_mov_b64 exec, s[38:39]
    v_lshrrev_b32 v89, 2, v73
    v_and_b32 v89, 0xfc, v89
    ds_add_f32 v89, v14 offset:512
    s_waitcnt vmcnt(3)
    s_mov_b64 exec, s[40:41]
    v_lshrrev_b32 v90, 2, v74
    v_and_b32 v90, 0xfc, v90
    ds_add_f32 v90, v14 offset:512
    s_mov_b64 exec, -1
    v_lshlrev_b32 v15, 2, v1
    s_waitcnt lgkmcnt(0)
    s_barrier
    ds_read_b32 v168, v15 offset:512
    ds_read_b128 v[120:123], v4 offset:512
    ds_read_b128 v[124:127], v4 offset:528
    ds_read_b128 v[128:131], v4 offset:544
    ds_read_b128 v[132:135], v4 offset:560
    ds_read_b128 v[136:139], v4 offset:576
    ds_read_b128 v[140:143], v4 offset:592
    ds_read_b128 v[144:147], v4 offset:608
    ds_read_b128 v[148:151], v4 offset:624
    ds_read_b128 v[152:155], v4 offset:640
    ds_read_b128 v[156:159], v4 offset:656
    v_add_u32 v12, 6750208, v9
    global_load_dwordx4 v[176:179], v12, s[20:21]
    global_load_dwordx4 v[180:183], v12, s[20:21] offset:1024
    global_load_dwordx4 v[232:235], v12, s[20:21] offset:2048
    global_load_dwordx4 v[236:239], v12, s[20:21] offset:3072
    s_and_b32 s33, s3, 3
    s_lshl_b32 s33, s33, 13
    s_add_u32 s33, s33, 6815744
    v_add_u32 v11, s33, v9
    v_add_u32 v12, 4096, v11
    global_load_dwordx4 v[200:203], v11, s[20:21] offset:0
    global_load_dwordx4 v[204:207], v11, s[20:21] offset:1024
    global_load_dwordx4 v[208:211], v11, s[20:21] offset:2048
    global_load_dwordx4 v[212:215], v11, s[20:21] offset:3072
    global_load_dwordx4 v[216:219], v12, s[20:21] offset:0
    global_load_dwordx4 v[220:223], v12, s[20:21] offset:1024
    global_load_dwordx4 v[224:227], v12, s[20:21] offset:2048
    global_load_dwordx4 v[228:231], v12, s[20:21] offset:3072
    s_waitcnt lgkmcnt(9)
    v_pk_add_f32 v[120:121], v[120:121], v[168:169] op_sel_hi:[1,0] neg_lo:[0,1] neg_hi:[0,1] clamp
    v_pk_add_f32 v[122:123], v[122:123], v[168:169] op_sel_hi:[1,0] neg_lo:[0,1] neg_hi:[0,1] clamp
    s_waitcnt lgkmcnt(8)
    v_pk_add_f32 v[124:125], v[124:125], v[168:169] op_sel_hi:[1,0] neg_lo:[0,1] neg_hi:[0,1] clamp
    v_pk_add_f32 v[124:125], v[124:125], v[120:121]
    v_pk_add_f32 v[126:127], v[126:127], v[168:169] op_sel_hi:[1,0] neg_lo:[0,1] neg_hi:[0,1] clamp
    v_pk_add_f32 v[126:127], v[126:127], v[122:123]
    s_waitcnt lgkmcnt(7)
    v_pk_add_f32 v[128:129], v[128:129], v[168:169] op_sel_hi:[1,0] neg_lo:[0,1] neg_hi:[0,1] clamp
    v_pk_add_f32 v[128:129], v[128:129], v[124:125]
    v_pk_add_f32 v[130:131], v[130:131], v[168:169] op_sel_hi:[1,0] neg_lo:[0,1] neg_hi:[0,1] clamp
    v_pk_add_f32 v[130:131], v[130:131], v[126:127]
    s_waitcnt lgkmcnt(6)
    v_pk_add_f32 v[132:133], v[132:133], v[168:169] op_sel_hi:[1,0] neg_lo:[0,1] neg_hi:[0,1] clamp
    v_pk_add_f32 v[132:133], v[132:133], v[128:129]
    v_pk_add_f32 v[134:135], v[134:135], v[168:169] op_sel_hi:[1,0] neg_lo:[0,1] neg_hi:[0,1] clamp
    v_pk_add_f32 v[134:135], v[134:135], v[130:131]
    s_waitcnt lgkmcnt(5)
    v_pk_add_f32 v[136:137], v[136:137], v[168:169] op_sel_hi:[1,0] neg_lo:[0,1] neg_hi:[0,1] clamp
    v_pk_add_f32 v[136:137], v[136:137], v[132:133]
    v_pk_add_f32 v[138:139], v[138:139], v[168:169] op_sel_hi:[1,0] neg_lo:[0,1] neg_hi:[0,1] clamp
    v_pk_add_f32 v[138:139], v[138:139], v[134:135]
    s_waitcnt lgkmcnt(4)
    v_pk_add_f32 v[140:141], v[140:141], v[168:169] op_sel_hi:[1,0] neg_lo:[0,1] neg_hi:[0,1] clamp
    v_pk_add_f32 v[140:141], v[140:141], v[136:137]
    v_pk_add_f32 v[142:143], v[142:143], v[168:169] op_sel_hi:[1,0] neg_lo:[0,1] neg_hi:[0,1] clamp
    v_pk_add_f32 v[142:143], v[142:143], v[138:139]
    s_waitcnt lgkmcnt(3)
    v_pk_add_f32 v[144:145], v[144:145], v[168:169] op_sel_hi:[1,0] neg_lo:[0,1] neg_hi:[0,1] clamp
    v_pk_add_f32 v[144:145], v[144:145], v[140:141]
    v_pk_add_f32 v[146:147], v[146:147], v[168:169] op_sel_hi:[1,0] neg_lo:[0,1] neg_hi:[0,1] clamp
    v_pk_add_f32 v[146:147], v[146:147], v[142:143]
    s_waitcnt lgkmcnt(2)
    v_pk_add_f32 v[148:149], v[148:149], v[168:169] op_sel_hi:[1,0] neg_lo:[0,1] neg_hi:[0,1] clamp
    v_pk_add_f32 v[148:149], v[148:149], v[144:145]
    v_pk_add_f32 v[150:151], v[150:151], v[168:169] op_sel_hi:[1,0] neg_lo:[0,1] neg_hi:[0,1] clamp
    v_pk_add_f32 v[150:151], v[150:151], v[146:147]
    s_waitcnt lgkmcnt(1)
    v_pk_add_f32 v[152:153], v[152:153], v[168:169] op_sel_hi:[1,0] neg_lo:[0,1] neg_hi:[0,1] clamp
    v_pk_add_f32 v[152:153], v[152:153], v[148:149]
    v_pk_add_f32 v[154:155], v[154:155], v[168:169] op_sel_hi:[1,0] neg_lo:[0,1] neg_hi:[0,1] clamp
    v_pk_add_f32 v[154:155], v[154:155], v[150:151]
    s_waitcnt lgkmcnt(0)
    v_pk_add_f32 v[156:157], v[156:157], v[168:169] op_sel_hi:[1,0] neg_lo:[0,1] neg_hi:[0,1] clamp
    v_pk_add_f32 v[156:157], v[156:157], v[152:153]
    v_pk_add_f32 v[158:159], v[158:159], v[168:169] op_sel_hi:[1,0] neg_lo:[0,1] neg_hi:[0,1] clamp
    v_pk_add_f32 v[158:159], v[158:159], v[154:155]
    v_pk_add_f32 v[158:159], v[158:159], v[156:157]
    v_add_f32 v158, v158, v159
    v_cvt_u32_f32 v158, v158
    v_lshlrev_b32 v158, 2, v158
    ds_bpermute_b32 v2, v158, v2
    v_cmp_gt_u32 vcc, 40, v1
    s_waitcnt lgkmcnt(0)
    s_nop 0
    v_cndmask_b32 v2, -1, v2, vcc
    s_branch K2_BAL
K2_NOBAL:
    s_waitcnt vmcnt(0)
    v_lshrrev_b32 v88, 2, v72
    v_and_b32 v88, 0xfc, v88
    v_lshrrev_b32 v89, 2, v73
    v_and_b32 v89, 0xfc, v89
    v_lshrrev_b32 v90, 2, v74
    v_and_b32 v90, 0xfc, v90
K2_BAL:
    ds_bpermute_b32 v91, v88, v2
    ds_bpermute_b32 v92, v89, v2
    ds_bpermute_b32 v93, v90, v2
    v_mov_b32 v14, 1
    v_lshlrev_b32 v15, 3, v1
    v_and_b32 v100, 15, v72
    v_and_b32 v101, 15, v73
    v_and_b32 v102, 15, v74
    s_waitcnt lgkmcnt(2)
    s_mov_b64 exec, s[36:37]
    v_and_b32 v88, 7, v91
    v_lshl_or_b32 v100, v88, 4, v100
    v_lshlrev_b32 v88, 2, v100
    ds_add_rtn_u32 v96, v88, v14 offset:0
    s_waitcnt lgkmcnt(2)
    s_mov_b64 exec, s[38:39]
    v_and_b32 v89, 7, v92
    v_lshl_or_b32 v101, v89, 4, v101
    v_lshlrev_b32 v89, 2, v101
    ds_add_rtn_u32 v97, v89, v14 offset:0
    s_waitcnt lgkmcnt(2)
    s_mov_b64 exec, s[40:41]
    v_and_b32 v90, 7, v93
    v_lshl_or_b32 v102, v90, 4, v102
    v_lshlrev_b32 v90, 2, v102
    ds_add_rtn_u32 v98, v90, v14 offset:0
    s_mov_b64 exec, -1
    v_lshrrev_b32 v88, 1, v100
    v_lshlrev_b32 v88, 2, v88
    v_and_b32 v100, 1, v100
    v_lshlrev_b32 v100, 4, v100
    v_and_b32 v91, 0x38, v91
    v_and_b32 v72, 4294966272, v72
    v_lshrrev_b32 v89, 1, v101
    v_lshlrev_b32 v89, 2, v89
    v_and_b32 v101, 1, v101
    v_lshlrev_b32 v101, 4, v101
    v_and_b32 v92, 0x38, v92
    v_and_b32 v73, 4294966272, v73
    v_lshrrev_b32 v90, 1, v102
    v_lshlrev_b32 v90, 2, v90
    v_and_b32 v102, 1, v102
    v_lshlrev_b32 v102, 4, v102
    v_and_b32 v93, 0x38, v93
    v_and_b32 v74, 4294966272, v74
    s_waitcnt lgkmcnt(0)
    s_barrier
    ds_read_b64 v[104:105], v15 offset:0
    s_lshl_b32 s33, s3, 3
    s_add_u32 s34, s33, 7
    v_lshrrev_b32 v110, 3, v1
    v_mul_u32_u24 v110, 48, v110
    s_waitcnt lgkmcnt(0)
    v_add_u32 v106, v104, v105
    v_mov_b32 v107, v106
    s_nop 1
    v_add_u32_dpp v107, v107, v107 row_shr:1 row_mask:0xf bank_mask:0xf
    s_nop 1
    v_add_u32_dpp v107, v107, v107 row_shr:2 row_mask:0xf bank_mask:0xf
    s_nop 1
    v_add_u32_dpp v107, v107, v107 row_shr:4 row_mask:0xf bank_mask:0xf
    s_nop 1
    v_add_u32_dpp v107, v107, v107 row_shr:8 row_mask:0xf bank_mask:0xf
    s_nop 1
    v_add_u32_dpp v107, v107, v107 row_bcast:15 row_mask:0xa bank_mask:0xf
    s_nop 1
    v_add_u32_dpp v107, v107, v107 row_bcast:31 row_mask:0xc bank_mask:0xf
    v_sub_u32 v106, v107, v106
    v_readlane_b32 s29, v107, s34
    s_nop 0
    v_mov_b32_dpp v108, v106 row_newbcast:0 row_mask:0xf bank_mask:0x3
    s_nop 1
    v_mov_b32_dpp v108, v106 row_newbcast:8 row_mask:0xf bank_mask:0xc
    v_readlane_b32 s35, v106, s33
    v_add_u32 v109, 15, v108
    v_and_b32 v109, -16, v109
    v_add_u32 v109, v109, v110
    v_sub_u32 v108, v109, v108
    v_add_u32 v108, v108, v106
    v_add_u32 v104, v108, v104
    v_lshl_or_b32 v104, v104, 16, v108
    v_readlane_b32 s28, v109, s33
    s_sub_u32 s29, s29, s35
    ds_bpermute_b32 v88, v88, v104
    ds_bpermute_b32 v89, v89, v104
    ds_bpermute_b32 v90, v90, v104
    s_add_u32 s33, s28, s29
    v_add_u32 v105, s33, v1
    v_lshlrev_b32 v106, 2, v105
    v_lshlrev_b32 v107, 4, v105
    v_mov_b32 v108, 10238976
    s_mov_b64 exec, 0xfffff
    ds_write_b32 v106, v108 offset:2816
    ds_write_b8 v105, v4 offset:10560
    ds_write_b128 v107, v[4:7] offset:12544
    s_waitcnt vmcnt(12) lgkmcnt(3)
    s_mov_b64 exec, s[36:37]
    v_bfe_u32 v88, v88, v100, 16
    v_add_u32 v88, v88, v96
    v_lshlrev_b32 v96, 2, v88
    v_lshlrev_b32 v100, 4, v88
    ds_write_b32 v96, v72 offset:2816
    ds_write_b8 v88, v91 offset:10560
    ds_write_b128 v100, v[76:79] offset:12544
    s_mov_b64 exec, s[38:39]
    v_bfe_u32 v89, v89, v101, 16
    v_add_u32 v89, v89, v97
    v_lshlrev_b32 v97, 2, v89
    v_lshlrev_b32 v101, 4, v89
    ds_write_b32 v97, v73 offset:2816
    ds_write_b8 v89, v92 offset:10560
    ds_write_b128 v101, v[80:83] offset:12544
    s_mov_b64 exec, s[40:41]
    v_bfe_u32 v90, v90, v102, 16
    v_add_u32 v90, v90, v98
    v_lshlrev_b32 v98, 2, v90
    v_lshlrev_b32 v102, 4, v90
    ds_write_b32 v98, v74 offset:2816
    ds_write_b8 v90, v93 offset:10560
    ds_write_b128 v102, v[84:87] offset:12544
    s_mov_b64 exec, -1
    s_lshl_b32 s33, s28, 2
    s_add_u32 s33, s33, 2816
    v_mov_b32 v196, s33
    s_add_u32 s33, s28, 10560
    v_mov_b32 v197, s33
    s_lshl_b32 s33, s28, 5
    s_add_u32 s33, s33, 43520
    v_add_u32 v198, s33, v15
    s_lshl_b32 s34, s28, 4
    s_add_u32 s34, s34, 12544
    v_and_b32 v12, 15, v1
    v_lshl_add_u32 v199, v12, 4, s34
    v_add_u32 v10, s34, v9
    v_lshrrev_b32 v11, 4, v1
    v_lshlrev_b32 v11, 3, v11
    v_lshl_add_u32 v11, v12, 5, v11
    v_add_u32 v11, s33, v11
    s_add_u32 s26, s29, 3
    s_lshr_b32 s26, s26, 2
    v_and_b32 v252, 0x1ff, v0
    v_lshlrev_b32 v252, 2, v252
    v_xor_b32 v253, 1024, v252
    ds_write_b32 v252, v4 offset:768
    v_mov_b32 v254, 0
    s_waitcnt lgkmcnt(0)
    s_barrier
    v_cmp_gt_u32 vcc, 128, v0
    s_and_saveexec_b64 s[22:23], vcc
    ds_write_b32 v3, v4 offset:0
    s_mov_b64 exec, s[22:23]
    s_cmp_eq_u32 s26, 0
    s_cbranch_scc1 K2_LOOPDONE
    ds_read_b128 v[120:123], v196 offset:0
    ds_read_b128 v[124:127], v196 offset:16
    ds_read_b128 v[188:191], v196 offset:32
    ds_read_b64 v[186:187], v199 offset:8
    ds_read_b128 v[192:195], v197
    s_waitcnt lgkmcnt(4)
    buffer_load_dwordx4 v[56:59], v120, s[8:11], 0 offen
    buffer_load_dwordx4 v[60:63], v121, s[8:11], 0 offen
    buffer_load_dwordx4 v[64:67], v122, s[8:11], 0 offen
    buffer_load_dwordx4 v[68:71], v123, s[8:11], 0 offen
    s_waitcnt lgkmcnt(3)
    buffer_load_dwordx4 v[72:75], v124, s[8:11], 0 offen
    buffer_load_dwordx4 v[76:79], v125, s[8:11], 0 offen
    buffer_load_dwordx4 v[80:83], v126, s[8:11], 0 offen
    buffer_load_dwordx4 v[84:87], v127, s[8:11], 0 offen
    s_waitcnt vmcnt(8)
    s_lshl_b32 s33, s26, 2
K2_APREP:
    ds_read_b64 v[152:153], v10
    v_cmp_gt_u32 vcc, s33, v1
    v_add_u32 v10, 1024, v10
    s_waitcnt lgkmcnt(0)
    v_cndmask_b32 v152, 0, v152, vcc
    v_cndmask_b32 v153, 0, v153, vcc
    s_nop 1
    v_mfma_f32_16x16x16_bf16 v[136:139], v[232:233], v[152:153], 0
    v_mfma_f32_16x16x16_bf16 v[140:143], v[234:235], v[152:153], 0
    v_mfma_f32_16x16x16_bf16 v[144:147], v[236:237], v[152:153], 0
    v_mfma_f32_16x16x16_bf16 v[148:151], v[238:239], v[152:153], 0
    v_add_u32 v160, 0, v12
    v_cmp_gt_u32 vcc, s33, v160
    s_nop 2
    v_cvt_pk_bf16_f32 v168, v136, v137
    v_cvt_pk_bf16_f32 v169, v138, v139
    s_mov_b64 exec, vcc
    ds_write_b64 v11, v[168:169] offset:0
    s_mov_b64 exec, -1
    v_add_u32 v160, 16, v12
    v_cmp_gt_u32 vcc, s33, v160
    v_cvt_pk_bf16_f32 v170, v140, v141
    v_cvt_pk_bf16_f32 v171, v142, v143
    s_mov_b64 exec, vcc
    ds_write_b64 v11, v[170:171] offset:512
    s_mov_b64 exec, -1
    v_add_u32 v160, 32, v12
    v_cmp_gt_u32 vcc, s33, v160
    v_cvt_pk_bf16_f32 v172, v144, v145
    v_cvt_pk_bf16_f32 v173, v146, v147
    s_mov_b64 exec, vcc
    ds_write_b64 v11, v[172:173] offset:1024
    s_mov_b64 exec, -1
    v_add_u32 v160, 48, v12
    v_cmp_gt_u32 vcc, s33, v160
    v_cvt_pk_bf16_f32 v174, v148, v149
    v_cvt_pk_bf16_f32 v175, v150, v151
    s_mov_b64 exec, vcc
    ds_write_b64 v11, v[174:175] offset:1536
    s_mov_b64 exec, -1
    v_add_u32 v11, 2048, v11
    s_sub_u32 s33, s33, 64
    s_cmp_gt_i32 s33, 0
    s_cbranch_scc1 K2_APREP
    ds_read_b64 v[184:185], v198
    v_mfma_f32_4x4x4_16b_bf16 v[152:155], v[186:187], v[176:177], 0 cbsz:4 abid:0
    v_mfma_f32_4x4x4_16b_bf16 v[156:159], v[186:187], v[180:181], 0 cbsz:4 abid:0
    s_nop 0
    v_mfma_f32_4x4x4_16b_bf16 v[152:155], v[186:187], v[178:179], v[152:155] cbsz:4 abid:0
    v_mfma_f32_4x4x4_16b_bf16 v[156:159], v[186:187], v[182:183], v[156:159] cbsz:4 abid:0
    s_nop 4
    s_sub_u32 s26, s26, 1
.p2align 4
K2_LOOP:
    s_waitcnt vmcnt(6) lgkmcnt(0)
    v_cmp_gt_u32 vcc, v188, v254
    ds_write_b32 v252, v188 offset:768
    s_setprio 0
    s_cbranch_vccnz K2_P0
    s_setprio 1
K2_P0:
    v_mfma_f32_4x4x4_16b_bf16 v[120:123], v[184:185], v[56:57], 0 cbsz:4 abid:0
    v_exp_f32 v168, v152
    v_mfma_f32_4x4x4_16b_bf16 v[124:127], v[184:185], v[58:59], 0 cbsz:4 abid:0
    v_exp_f32 v169, v153
    v_mfma_f32_4x4x4_16b_bf16 v[128:131], v[184:185], v[60:61], 0 cbsz:4 abid:1
    v_exp_f32 v170, v154
    v_mfma_f32_4x4x4_16b_bf16 v[132:135], v[184:185], v[62:63], 0 cbsz:4 abid:1
    buffer_load_dwordx4 v[88:91], v188, s[8:11], 0 offen
    buffer_load_dwordx4 v[92:95], v189, s[8:11], 0 offen
    v_exp_f32 v171, v155
    s_waitcnt vmcnt(6)
    v_mfma_f32_4x4x4_16b_bf16 v[136:139], v[184:185], v[64:65], 0 cbsz:4 abid:2
    v_exp_f32 v172, v156
    v_mfma_f32_4x4x4_16b_bf16 v[140:143], v[184:185], v[66:67], 0 cbsz:4 abid:2
    v_exp_f32 v173, v157
    v_exp_f32 v174, v158
    v_exp_f32 v175, v159
    v_pk_add_f32 v[168:169], v[168:169], 1.0 op_sel_hi:[1,0]
    v_pk_add_f32 v[170:171], v[170:171], 1.0 op_sel_hi:[1,0]
    v_pk_add_f32 v[172:173], v[172:173], 1.0 op_sel_hi:[1,0]
    v_pk_add_f32 v[174:175], v[174:175], 1.0 op_sel_hi:[1,0]
    v_mfma_f32_4x4x4_16b_bf16 v[144:147], v[184:185], v[68:69], 0 cbsz:4 abid:3
    v_rcp_f32 v168, v168
    v_mfma_f32_4x4x4_16b_bf16 v[148:151], v[184:185], v[70:71], 0 cbsz:4 abid:3
    buffer_load_dwordx4 v[96:99], v190, s[8:11], 0 offen
    buffer_load_dwordx4 v[100:103], v191, s[8:11], 0 offen
    v_rcp_f32 v169, v169
    ds_read_b128 v[188:191], v196 offset:48
    v_mfma_f32_4x4x4_16b_bf16 v[160:163], v[186:187], v[176:177], 0 cbsz:4 abid:1
    v_rcp_f32 v170, v170
    v_mfma_f32_4x4x4_16b_bf16 v[164:167], v[186:187], v[180:181], 0 cbsz:4 abid:1
    v_rcp_f32 v171, v171
    v_mfma_f32_4x4x4_16b_bf16 v[160:163], v[186:187], v[178:179], v[160:163] cbsz:4 abid:1
    v_rcp_f32 v172, v172
    v_mfma_f32_4x4x4_16b_bf16 v[164:167], v[186:187], v[182:183], v[164:167] cbsz:4 abid:1
    v_rcp_f32 v173, v173
    v_rcp_f32 v174, v174
    v_rcp_f32 v175, v175
    v_readfirstlane_b32 s27, v192
    v_pk_mul_f32 v[168:169], v[168:169], v[152:153]
    v_pk_mul_f32 v[170:171], v[170:171], v[154:155]
    v_pk_mul_f32 v[172:173], v[172:173], v[156:157]
    v_pk_mul_f32 v[174:175], v[174:175], v[158:159]
    s_set_gpr_idx_on s27, gpr_idx(SRC2,DST)
    v_pk_fma_f32 v[16:17], v[168:169], v[120:121], v[16:17] op_sel:[0,0,0] op_sel_hi:[0,1,1]
    v_pk_fma_f32 v[18:19], v[168:169], v[122:123], v[18:19] op_sel:[0,0,0] op_sel_hi:[0,1,1]
    v_pk_fma_f32 v[20:21], v[172:173], v[124:125], v[20:21] op_sel:[0,0,0] op_sel_hi:[0,1,1]
    v_pk_fma_f32 v[22:23], v[172:173], v[126:127], v[22:23] op_sel:[0,0,0] op_sel_hi:[0,1,1]
    s_lshr_b32 s27, s27, 8
    s_set_gpr_idx_idx s27
    v_pk_fma_f32 v[16:17], v[168:169], v[128:129], v[16:17] op_sel:[1,0,0] op_sel_hi:[1,1,1]
    v_pk_fma_f32 v[18:19], v[168:169], v[130:131], v[18:19] op_sel:[1,0,0] op_sel_hi:[1,1,1]
    v_pk_fma_f32 v[20:21], v[172:173], v[132:133], v[20:21] op_sel:[1,0,0] op_sel_hi:[1,1,1]
    v_pk_fma_f32 v[22:23], v[172:173], v[134:135], v[22:23] op_sel:[1,0,0] op_sel_hi:[1,1,1]
    s_lshr_b32 s27, s27, 8
    s_set_gpr_idx_idx s27
    v_pk_fma_f32 v[16:17], v[170:171], v[136:137], v[16:17] op_sel:[0,0,0] op_sel_hi:[0,1,1]
    v_pk_fma_f32 v[18:19], v[170:171], v[138:139], v[18:19] op_sel:[0,0,0] op_sel_hi:[0,1,1]
    v_pk_fma_f32 v[20:21], v[174:175], v[140:141], v[20:21] op_sel:[0,0,0] op_sel_hi:[0,1,1]
    v_pk_fma_f32 v[22:23], v[174:175], v[142:143], v[22:23] op_sel:[0,0,0] op_sel_hi:[0,1,1]
    s_lshr_b32 s27, s27, 8
    s_set_gpr_idx_idx s27
    v_pk_fma_f32 v[16:17], v[170:171], v[144:145], v[16:17] op_sel:[1,0,0] op_sel_hi:[1,1,1]
    v_pk_fma_f32 v[18:19], v[170:171], v[146:147], v[18:19] op_sel:[1,0,0] op_sel_hi:[1,1,1]
    v_pk_fma_f32 v[20:21], v[174:175], v[148:149], v[20:21] op_sel:[1,0,0] op_sel_hi:[1,1,1]
    v_pk_fma_f32 v[22:23], v[174:175], v[150:151], v[22:23] op_sel:[1,0,0] op_sel_hi:[1,1,1]
    s_set_gpr_idx_off
    s_sub_u32 s26, s26, 1
    s_cbranch_scc1 K2_LOOPDONE
    s_waitcnt vmcnt(6) lgkmcnt(0)
    v_mfma_f32_4x4x4_16b_bf16 v[120:123], v[184:185], v[72:73], 0 cbsz:4 abid:4
    v_exp_f32 v168, v160
    v_mfma_f32_4x4x4_16b_bf16 v[124:127], v[184:185], v[74:75], 0 cbsz:4 abid:4
    v_exp_f32 v169, v161
    v_mfma_f32_4x4x4_16b_bf16 v[128:131], v[184:185], v[76:77], 0 cbsz:4 abid:5
    v_exp_f32 v170, v162
    v_mfma_f32_4x4x4_16b_bf16 v[132:135], v[184:185], v[78:79], 0 cbsz:4 abid:5
    buffer_load_dwordx4 v[104:107], v188, s[8:11], 0 offen
    buffer_load_dwordx4 v[108:111], v189, s[8:11], 0 offen
    v_exp_f32 v171, v163
    s_waitcnt vmcnt(6)
    v_mfma_f32_4x4x4_16b_bf16 v[136:139], v[184:185], v[80:81], 0 cbsz:4 abid:6
    v_exp_f32 v172, v164
    v_mfma_f32_4x4x4_16b_bf16 v[140:143], v[184:185], v[82:83], 0 cbsz:4 abid:6
    v_exp_f32 v173, v165
    v_exp_f32 v174, v166
    v_exp_f32 v175, v167
    v_pk_add_f32 v[168:169], v[168:169], 1.0 op_sel_hi:[1,0]
    v_pk_add_f32 v[170:171], v[170:171], 1.0 op_sel_hi:[1,0]
    v_pk_add_f32 v[172:173], v[172:173], 1.0 op_sel_hi:[1,0]
    v_pk_add_f32 v[174:175], v[174:175], 1.0 op_sel_hi:[1,0]
    v_mfma_f32_4x4x4_16b_bf16 v[144:147], v[184:185], v[84:85], 0 cbsz:4 abid:7
    v_rcp_f32 v168, v168
    v_mfma_f32_4x4x4_16b_bf16 v[148:151], v[184:185], v[86:87], 0 cbsz:4 abid:7
    buffer_load_dwordx4 v[112:115], v190, s[8:11], 0 offen
    buffer_load_dwordx4 v[116:119], v191, s[8:11], 0 offen
    v_rcp_f32 v169, v169
    ds_read_b128 v[188:191], v196 offset:64
    v_mfma_f32_4x4x4_16b_bf16 v[152:155], v[186:187], v[176:177], 0 cbsz:4 abid:2
    v_rcp_f32 v170, v170
    v_mfma_f32_4x4x4_16b_bf16 v[156:159], v[186:187], v[180:181], 0 cbsz:4 abid:2
    v_rcp_f32 v171, v171
    v_mfma_f32_4x4x4_16b_bf16 v[152:155], v[186:187], v[178:179], v[152:155] cbsz:4 abid:2
    v_rcp_f32 v172, v172
    v_mfma_f32_4x4x4_16b_bf16 v[156:159], v[186:187], v[182:183], v[156:159] cbsz:4 abid:2
    v_rcp_f32 v173, v173
    v_rcp_f32 v174, v174
    v_rcp_f32 v175, v175
    v_readfirstlane_b32 s27, v193
    v_pk_mul_f32 v[168:169], v[168:169], v[160:161]
    v_pk_mul_f32 v[170:171], v[170:171], v[162:163]
    v_pk_mul_f32 v[172:173], v[172:173], v[164:165]
    v_pk_mul_f32 v[174:175], v[174:175], v[166:167]
    s_set_gpr_idx_on s27, gpr_idx(SRC2,DST)
    v_pk_fma_f32 v[16:17], v[168:169], v[120:121], v[16:17] op_sel:[0,0,0] op_sel_hi:[0,1,1]
    v_pk_fma_f32 v[18:19], v[168:169], v[122:123], v[18:19] op_sel:[0,0,0] op_sel_hi:[0,1,1]
    v_pk_fma_f32 v[20:21], v[172:173], v[124:125], v[20:21] op_sel:[0,0,0] op_sel_hi:[0,1,1]
    v_pk_fma_f32 v[22:23], v[172:173], v[126:127], v[22:23] op_sel:[0,0,0] op_sel_hi:[0,1,1]
    s_lshr_b32 s27, s27, 8
    s_set_gpr_idx_idx s27
    v_pk_fma_f32 v[16:17], v[168:169], v[128:129], v[16:17] op_sel:[1,0,0] op_sel_hi:[1,1,1]
    v_pk_fma_f32 v[18:19], v[168:169], v[130:131], v[18:19] op_sel:[1,0,0] op_sel_hi:[1,1,1]
    v_pk_fma_f32 v[20:21], v[172:173], v[132:133], v[20:21] op_sel:[1,0,0] op_sel_hi:[1,1,1]
    v_pk_fma_f32 v[22:23], v[172:173], v[134:135], v[22:23] op_sel:[1,0,0] op_sel_hi:[1,1,1]
    s_lshr_b32 s27, s27, 8
    s_set_gpr_idx_idx s27
    v_pk_fma_f32 v[16:17], v[170:171], v[136:137], v[16:17] op_sel:[0,0,0] op_sel_hi:[0,1,1]
    v_pk_fma_f32 v[18:19], v[170:171], v[138:139], v[18:19] op_sel:[0,0,0] op_sel_hi:[0,1,1]
    v_pk_fma_f32 v[20:21], v[174:175], v[140:141], v[20:21] op_sel:[0,0,0] op_sel_hi:[0,1,1]
    v_pk_fma_f32 v[22:23], v[174:175], v[142:143], v[22:23] op_sel:[0,0,0] op_sel_hi:[0,1,1]
    s_lshr_b32 s27, s27, 8
    s_set_gpr_idx_idx s27
    v_pk_fma_f32 v[16:17], v[170:171], v[144:145], v[16:17] op_sel:[1,0,0] op_sel_hi:[1,1,1]
    v_pk_fma_f32 v[18:19], v[170:171], v[146:147], v[18:19] op_sel:[1,0,0] op_sel_hi:[1,1,1]
    v_pk_fma_f32 v[20:21], v[174:175], v[148:149], v[20:21] op_sel:[1,0,0] op_sel_hi:[1,1,1]
    v_pk_fma_f32 v[22:23], v[174:175], v[150:151], v[22:23] op_sel:[1,0,0] op_sel_hi:[1,1,1]
    s_set_gpr_idx_off
    s_sub_u32 s26, s26, 1
    s_cbranch_scc1 K2_LOOPDONE
    s_waitcnt vmcnt(6) lgkmcnt(0)
    v_mfma_f32_4x4x4_16b_bf16 v[120:123], v[184:185], v[88:89], 0 cbsz:4 abid:8
    v_exp_f32 v168, v152
    v_mfma_f32_4x4x4_16b_bf16 v[124:127], v[184:185], v[90:91], 0 cbsz:4 abid:8
    v_exp_f32 v169, v153
    v_mfma_f32_4x4x4_16b_bf16 v[128:131], v[184:185], v[92:93], 0 cbsz:4 abid:9
    v_exp_f32 v170, v154
    v_mfma_f32_4x4x4_16b_bf16 v[132:135], v[184:185], v[94:95], 0 cbsz:4 abid:9
    buffer_load_dwordx4 v[56:59], v188, s[8:11], 0 offen
    buffer_load_dwordx4 v[60:63], v189, s[8:11], 0 offen
    v_exp_f32 v171, v155
    s_waitcnt vmcnt(6)
    v_mfma_f32_4x4x4_16b_bf16 v[136:139], v[184:185], v[96:97], 0 cbsz:4 abid:10
    v_exp_f32 v172, v156
    v_mfma_f32_4x4x4_16b_bf16 v[140:143], v[184:185], v[98:99], 0 cbsz:4 abid:10
    v_exp_f32 v173, v157
    v_exp_f32 v174, v158
    v_exp_f32 v175, v159
    v_pk_add_f32 v[168:169], v[168:169], 1.0 op_sel_hi:[1,0]
    v_pk_add_f32 v[170:171], v[170:171], 1.0 op_sel_hi:[1,0]
    v_pk_add_f32 v[172:173], v[172:173], 1.0 op_sel_hi:[1,0]
    v_pk_add_f32 v[174:175], v[174:175], 1.0 op_sel_hi:[1,0]
    v_mfma_f32_4x4x4_16b_bf16 v[144:147], v[184:185], v[100:101], 0 cbsz:4 abid:11
    v_rcp_f32 v168, v168
    v_mfma_f32_4x4x4_16b_bf16 v[148:151], v[184:185], v[102:103], 0 cbsz:4 abid:11
    buffer_load_dwordx4 v[64:67], v190, s[8:11], 0 offen
    buffer_load_dwordx4 v[68:71], v191, s[8:11], 0 offen
    v_rcp_f32 v169, v169
    ds_read_b128 v[188:191], v196 offset:80
    v_mfma_f32_4x4x4_16b_bf16 v[160:163], v[186:187], v[176:177], 0 cbsz:4 abid:3
    v_rcp_f32 v170, v170
    v_mfma_f32_4x4x4_16b_bf16 v[164:167], v[186:187], v[180:181], 0 cbsz:4 abid:3
    v_rcp_f32 v171, v171
    v_mfma_f32_4x4x4_16b_bf16 v[160:163], v[186:187], v[178:179], v[160:163] cbsz:4 abid:3
    v_rcp_f32 v172, v172
    v_mfma_f32_4x4x4_16b_bf16 v[164:167], v[186:187], v[182:183], v[164:167] cbsz:4 abid:3
    ds_read_b64 v[186:187], v199 offset:264
    v_rcp_f32 v173, v173
    v_rcp_f32 v174, v174
    v_rcp_f32 v175, v175
    v_readfirstlane_b32 s27, v194
    v_pk_mul_f32 v[168:169], v[168:169], v[152:153]
    v_pk_mul_f32 v[170:171], v[170:171], v[154:155]
    v_pk_mul_f32 v[172:173], v[172:173], v[156:157]
    v_pk_mul_f32 v[174:175], v[174:175], v[158:159]
    s_set_gpr_idx_on s27, gpr_idx(SRC2,DST)
    v_pk_fma_f32 v[16:17], v[168:169], v[120:121], v[16:17] op_sel:[0,0,0] op_sel_hi:[0,1,1]
    v_pk_fma_f32 v[18:19], v[168:169], v[122:123], v[18:19] op_sel:[0,0,0] op_sel_hi:[0,1,1]
    v_pk_fma_f32 v[20:21], v[172:173], v[124:125], v[20:21] op_sel:[0,0,0] op_sel_hi:[0,1,1]
    v_pk_fma_f32 v[22:23], v[172:173], v[126:127], v[22:23] op_sel:[0,0,0] op_sel_hi:[0,1,1]
    s_lshr_b32 s27, s27, 8
    s_set_gpr_idx_idx s27
    v_pk_fma_f32 v[16:17], v[168:169], v[128:129], v[16:17] op_sel:[1,0,0] op_sel_hi:[1,1,1]
    v_pk_fma_f32 v[18:19], v[168:169], v[130:131], v[18:19] op_sel:[1,0,0] op_sel_hi:[1,1,1]
    v_pk_fma_f32 v[20:21], v[172:173], v[132:133], v[20:21] op_sel:[1,0,0] op_sel_hi:[1,1,1]
    v_pk_fma_f32 v[22:23], v[172:173], v[134:135], v[22:23] op_sel:[1,0,0] op_sel_hi:[1,1,1]
    s_lshr_b32 s27, s27, 8
    s_set_gpr_idx_idx s27
    v_pk_fma_f32 v[16:17], v[170:171], v[136:137], v[16:17] op_sel:[0,0,0] op_sel_hi:[0,1,1]
    v_pk_fma_f32 v[18:19], v[170:171], v[138:139], v[18:19] op_sel:[0,0,0] op_sel_hi:[0,1,1]
    v_pk_fma_f32 v[20:21], v[174:175], v[140:141], v[20:21] op_sel:[0,0,0] op_sel_hi:[0,1,1]
    v_pk_fma_f32 v[22:23], v[174:175], v[142:143], v[22:23] op_sel:[0,0,0] op_sel_hi:[0,1,1]
    s_lshr_b32 s27, s27, 8
    s_set_gpr_idx_idx s27
    v_pk_fma_f32 v[16:17], v[170:171], v[144:145], v[16:17] op_sel:[1,0,0] op_sel_hi:[1,1,1]
    v_pk_fma_f32 v[18:19], v[170:171], v[146:147], v[18:19] op_sel:[1,0,0] op_sel_hi:[1,1,1]
    v_pk_fma_f32 v[20:21], v[174:175], v[148:149], v[20:21] op_sel:[1,0,0] op_sel_hi:[1,1,1]
    v_pk_fma_f32 v[22:23], v[174:175], v[150:151], v[22:23] op_sel:[1,0,0] op_sel_hi:[1,1,1]
    s_set_gpr_idx_off
    s_sub_u32 s26, s26, 1
    s_cbranch_scc1 K2_LOOPDONE
    s_waitcnt vmcnt(6) lgkmcnt(0)
    v_mfma_f32_4x4x4_16b_bf16 v[120:123], v[184:185], v[104:105], 0 cbsz:4 abid:12
    v_exp_f32 v168, v160
    v_mfma_f32_4x4x4_16b_bf16 v[124:127], v[184:185], v[106:107], 0 cbsz:4 abid:12
    v_exp_f32 v169, v161
    v_mfma_f32_4x4x4_16b_bf16 v[128:131], v[184:185], v[108:109], 0 cbsz:4 abid:13
    v_exp_f32 v170, v162
    v_mfma_f32_4x4x4_16b_bf16 v[132:135], v[184:185], v[110:111], 0 cbsz:4 abid:13
    buffer_load_dwordx4 v[72:75], v188, s[8:11], 0 offen
    buffer_load_dwordx4 v[76:79], v189, s[8:11], 0 offen
    v_exp_f32 v171, v163
    s_waitcnt vmcnt(6)
    v_mfma_f32_4x4x4_16b_bf16 v[136:139], v[184:185], v[112:113], 0 cbsz:4 abid:14
    v_exp_f32 v172, v164
    v_mfma_f32_4x4x4_16b_bf16 v[140:143], v[184:185], v[114:115], 0 cbsz:4 abid:14
    v_exp_f32 v173, v165
    v_exp_f32 v174, v166
    v_exp_f32 v175, v167
    v_pk_add_f32 v[168:169], v[168:169], 1.0 op_sel_hi:[1,0]
    v_pk_add_f32 v[170:171], v[170:171], 1.0 op_sel_hi:[1,0]
    v_pk_add_f32 v[172:173], v[172:173], 1.0 op_sel_hi:[1,0]
    v_pk_add_f32 v[174:175], v[174:175], 1.0 op_sel_hi:[1,0]
    v_mfma_f32_4x4x4_16b_bf16 v[144:147], v[184:185], v[116:117], 0 cbsz:4 abid:15
    v_rcp_f32 v168, v168
    v_mfma_f32_4x4x4_16b_bf16 v[148:151], v[184:185], v[118:119], 0 cbsz:4 abid:15
    buffer_load_dwordx4 v[80:83], v190, s[8:11], 0 offen
    buffer_load_dwordx4 v[84:87], v191, s[8:11], 0 offen
    v_rcp_f32 v169, v169
    ds_read_b128 v[188:191], v196 offset:96
    ds_read_b64 v[184:185], v198 offset:512
    ds_read_b32 v254, v253 offset:768
    v_mfma_f32_4x4x4_16b_bf16 v[152:155], v[186:187], v[176:177], 0 cbsz:4 abid:0
    v_rcp_f32 v170, v170
    v_mfma_f32_4x4x4_16b_bf16 v[156:159], v[186:187], v[180:181], 0 cbsz:4 abid:0
    v_rcp_f32 v171, v171
    v_mfma_f32_4x4x4_16b_bf16 v[152:155], v[186:187], v[178:179], v[152:155] cbsz:4 abid:0
    v_rcp_f32 v172, v172
    v_mfma_f32_4x4x4_16b_bf16 v[156:159], v[186:187], v[182:183], v[156:159] cbsz:4 abid:0
    v_rcp_f32 v173, v173
    v_rcp_f32 v174, v174
    v_rcp_f32 v175, v175
    v_readfirstlane_b32 s27, v195
    ds_read_b128 v[192:195], v197 offset:16
    v_add_u32 v196, 64, v196
    v_add_u32 v197, 16, v197
    v_add_u32 v198, 512, v198
    v_add_u32 v199, 256, v199
    v_pk_mul_f32 v[168:169], v[168:169], v[160:161]
    v_pk_mul_f32 v[170:171], v[170:171], v[162:163]
    v_pk_mul_f32 v[172:173], v[172:173], v[164:165]
    v_pk_mul_f32 v[174:175], v[174:175], v[166:167]
    s_set_gpr_idx_on s27, gpr_idx(SRC2,DST)
    v_pk_fma_f32 v[16:17], v[168:169], v[120:121], v[16:17] op_sel:[0,0,0] op_sel_hi:[0,1,1]
    v_pk_fma_f32 v[18:19], v[168:169], v[122:123], v[18:19] op_sel:[0,0,0] op_sel_hi:[0,1,1]
    v_pk_fma_f32 v[20:21], v[172:173], v[124:125], v[20:21] op_sel:[0,0,0] op_sel_hi:[0,1,1]
    v_pk_fma_f32 v[22:23], v[172:173], v[126:127], v[22:23] op_sel:[0,0,0] op_sel_hi:[0,1,1]
    s_lshr_b32 s27, s27, 8
    s_set_gpr_idx_idx s27
    v_pk_fma_f32 v[16:17], v[168:169], v[128:129], v[16:17] op_sel:[1,0,0] op_sel_hi:[1,1,1]
    v_pk_fma_f32 v[18:19], v[168:169], v[130:131], v[18:19] op_sel:[1,0,0] op_sel_hi:[1,1,1]
    v_pk_fma_f32 v[20:21], v[172:173], v[132:133], v[20:21] op_sel:[1,0,0] op_sel_hi:[1,1,1]
    v_pk_fma_f32 v[22:23], v[172:173], v[134:135], v[22:23] op_sel:[1,0,0] op_sel_hi:[1,1,1]
    s_lshr_b32 s27, s27, 8
    s_set_gpr_idx_idx s27
    v_pk_fma_f32 v[16:17], v[170:171], v[136:137], v[16:17] op_sel:[0,0,0] op_sel_hi:[0,1,1]
    v_pk_fma_f32 v[18:19], v[170:171], v[138:139], v[18:19] op_sel:[0,0,0] op_sel_hi:[0,1,1]
    v_pk_fma_f32 v[20:21], v[174:175], v[140:141], v[20:21] op_sel:[0,0,0] op_sel_hi:[0,1,1]
    v_pk_fma_f32 v[22:23], v[174:175], v[142:143], v[22:23] op_sel:[0,0,0] op_sel_hi:[0,1,1]
    s_lshr_b32 s27, s27, 8
    s_set_gpr_idx_idx s27
    v_pk_fma_f32 v[16:17], v[170:171], v[144:145], v[16:17] op_sel:[1,0,0] op_sel_hi:[1,1,1]
    v_pk_fma_f32 v[18:19], v[170:171], v[146:147], v[18:19] op_sel:[1,0,0] op_sel_hi:[1,1,1]
    v_pk_fma_f32 v[20:21], v[174:175], v[148:149], v[20:21] op_sel:[1,0,0] op_sel_hi:[1,1,1]
    v_pk_fma_f32 v[22:23], v[174:175], v[150:151], v[22:23] op_sel:[1,0,0] op_sel_hi:[1,1,1]
    s_set_gpr_idx_off
    s_sub_u32 s26, s26, 1
    s_cbranch_scc0 K2_LOOP
K2_LOOPDONE:
    v_mov_b32 v254, -1
    ds_write_b32 v252, v254 offset:768
    s_setprio 0
    s_add_u32 s25, s25, 1536
    s_cmp_ge_u32 s25, s24
    s_cbranch_scc1 K2_EPI
    s_waitcnt vmcnt(0) lgkmcnt(0)
    ds_write_b128 v8, v[4:7]
    s_waitcnt lgkmcnt(0)
    s_barrier
    s_branch K2_ROUND
K2_EPI:
    s_mov_b32 s30, 0xbf317218
    s_mov_b32 s31, s30
    v_lshrrev_b32 v10, 2, v1
    v_lshlrev_b32 v10, 4, v10
    v_and_b32 v11, 3, v1
    v_lshl_or_b32 v10, v11, 2, v10
    s_add_u32 s32, s3, 0
    v_cmp_eq_u32 vcc, s32, v2
    s_ff1_i32_b64 s40, vcc
    s_lshl_b32 s40, s40, 2
    s_add_u32 s32, s3, 8
    v_cmp_eq_u32 vcc, s32, v2
    s_ff1_i32_b64 s41, vcc
    s_lshl_b32 s41, s41, 2
    s_add_u32 s32, s3, 16
    v_cmp_eq_u32 vcc, s32, v2
    s_ff1_i32_b64 s42, vcc
    s_lshl_b32 s42, s42, 2
    s_add_u32 s32, s3, 24
    v_cmp_eq_u32 vcc, s32, v2
    s_ff1_i32_b64 s43, vcc
    s_lshl_b32 s43, s43, 2
    s_add_u32 s32, s3, 32
    v_cmp_eq_u32 vcc, s32, v2
    s_ff1_i32_b64 s44, vcc
    s_lshl_b32 s44, s44, 2
    v_pk_mul_f32 v[16:17], v[16:17], s[30:31]
    v_pk_mul_f32 v[18:19], v[18:19], s[30:31]
    v_pk_mul_f32 v[20:21], v[20:21], s[30:31]
    v_pk_mul_f32 v[22:23], v[22:23], s[30:31]
    v_pk_mul_f32 v[24:25], v[24:25], s[30:31]
    v_pk_mul_f32 v[26:27], v[26:27], s[30:31]
    v_pk_mul_f32 v[28:29], v[28:29], s[30:31]
    v_pk_mul_f32 v[30:31], v[30:31], s[30:31]
    v_pk_mul_f32 v[32:33], v[32:33], s[30:31]
    v_pk_mul_f32 v[34:35], v[34:35], s[30:31]
    v_pk_mul_f32 v[36:37], v[36:37], s[30:31]
    v_pk_mul_f32 v[38:39], v[38:39], s[30:31]
    v_pk_mul_f32 v[40:41], v[40:41], s[30:31]
    v_pk_mul_f32 v[42:43], v[42:43], s[30:31]
    v_pk_mul_f32 v[44:45], v[44:45], s[30:31]
    v_pk_mul_f32 v[46:47], v[46:47], s[30:31]
    v_pk_mul_f32 v[48:49], v[48:49], s[30:31]
    v_pk_mul_f32 v[50:51], v[50:51], s[30:31]
    v_pk_mul_f32 v[52:53], v[52:53], s[30:31]
    v_pk_mul_f32 v[54:55], v[54:55], s[30:31]
    s_waitcnt lgkmcnt(0)
    s_add_u32 s33, s40, 0
    s_and_b32 s34, s33, 15
    s_lshl_b32 s34, s34, 4
    s_lshl_b32 s33, s33, 8
    s_add_u32 s33, s33, 105472
    v_cvt_pk_bf16_f32 v168, v16, v20
    v_xor_b32 v172, s34, v10
    v_add_u32 v172, s33, v172
    ds_write_b32 v172, v168
    s_add_u32 s33, s40, 1
    s_and_b32 s34, s33, 15
    s_lshl_b32 s34, s34, 4
    s_lshl_b32 s33, s33, 8
    s_add_u32 s33, s33, 105472
    v_cvt_pk_bf16_f32 v169, v17, v21
    v_xor_b32 v173, s34, v10
    v_add_u32 v173, s33, v173
    ds_write_b32 v173, v169
    s_add_u32 s33, s40, 2
    s_and_b32 s34, s33, 15
    s_lshl_b32 s34, s34, 4
    s_lshl_b32 s33, s33, 8
    s_add_u32 s33, s33, 105472
    v_cvt_pk_bf16_f32 v170, v18, v22
    v_xor_b32 v174, s34, v10
    v_add_u32 v174, s33, v174
    ds_write_b32 v174, v170
    s_add_u32 s33, s40, 3
    s_and_b32 s34, s33, 15
    s_lshl_b32 s34, s34, 4
    s_lshl_b32 s33, s33, 8
    s_add_u32 s33, s33, 105472
    v_cvt_pk_bf16_f32 v171, v19, v23
    v_xor_b32 v175, s34, v10
    v_add_u32 v175, s33, v175
    ds_write_b32 v175, v171
    s_add_u32 s33, s41, 0
    s_and_b32 s34, s33, 15
    s_lshl_b32 s34, s34, 4
    s_lshl_b32 s33, s33, 8
    s_add_u32 s33, s33, 105472
    v_cvt_pk_bf16_f32 v168, v24, v28
    v_xor_b32 v172, s34, v10
    v_add_u32 v172, s33, v172
    ds_write_b32 v172, v168
    s_add_u32 s33, s41, 1
    s_and_b32 s34, s33, 15
    s_lshl_b32 s34, s34, 4
    s_lshl_b32 s33, s33, 8
    s_add_u32 s33, s33, 105472
    v_cvt_pk_bf16_f32 v169, v25, v29
    v_xor_b32 v173, s34, v10
    v_add_u32 v173, s33, v173
    ds_write_b32 v173, v169
    s_add_u32 s33, s41, 2
    s_and_b32 s34, s33, 15
    s_lshl_b32 s34, s34, 4
    s_lshl_b32 s33, s33, 8
    s_add_u32 s33, s33, 105472
    v_cvt_pk_bf16_f32 v170, v26, v30
    v_xor_b32 v174, s34, v10
    v_add_u32 v174, s33, v174
    ds_write_b32 v174, v170
    s_add_u32 s33, s41, 3
    s_and_b32 s34, s33, 15
    s_lshl_b32 s34, s34, 4
    s_lshl_b32 s33, s33, 8
    s_add_u32 s33, s33, 105472
    v_cvt_pk_bf16_f32 v171, v27, v31
    v_xor_b32 v175, s34, v10
    v_add_u32 v175, s33, v175
    ds_write_b32 v175, v171
    s_add_u32 s33, s42, 0
    s_and_b32 s34, s33, 15
    s_lshl_b32 s34, s34, 4
    s_lshl_b32 s33, s33, 8
    s_add_u32 s33, s33, 105472
    v_cvt_pk_bf16_f32 v168, v32, v36
    v_xor_b32 v172, s34, v10
    v_add_u32 v172, s33, v172
    ds_write_b32 v172, v168
    s_add_u32 s33, s42, 1
    s_and_b32 s34, s33, 15
    s_lshl_b32 s34, s34, 4
    s_lshl_b32 s33, s33, 8
    s_add_u32 s33, s33, 105472
    v_cvt_pk_bf16_f32 v169, v33, v37
    v_xor_b32 v173, s34, v10
    v_add_u32 v173, s33, v173
    ds_write_b32 v173, v169
    s_add_u32 s33, s42, 2
    s_and_b32 s34, s33, 15
    s_lshl_b32 s34, s34, 4
    s_lshl_b32 s33, s33, 8
    s_add_u32 s33, s33, 105472
    v_cvt_pk_bf16_f32 v170, v34, v38
    v_xor_b32 v174, s34, v10
    v_add_u32 v174, s33, v174
    ds_write_b32 v174, v170
    s_add_u32 s33, s42, 3
    s_and_b32 s34, s33, 15
    s_lshl_b32 s34, s34, 4
    s_lshl_b32 s33, s33, 8
    s_add_u32 s33, s33, 105472
    v_cvt_pk_bf16_f32 v171, v35, v39
    v_xor_b32 v175, s34, v10
    v_add_u32 v175, s33, v175
    ds_write_b32 v175, v171
    s_add_u32 s33, s43, 0
    s_and_b32 s34, s33, 15
    s_lshl_b32 s34, s34, 4
    s_lshl_b32 s33, s33, 8
    s_add_u32 s33, s33, 105472
    v_cvt_pk_bf16_f32 v168, v40, v44
    v_xor_b32 v172, s34, v10
    v_add_u32 v172, s33, v172
    ds_write_b32 v172, v168
    s_add_u32 s33, s43, 1
    s_and_b32 s34, s33, 15
    s_lshl_b32 s34, s34, 4
    s_lshl_b32 s33, s33, 8
    s_add_u32 s33, s33, 105472
    v_cvt_pk_bf16_f32 v169, v41, v45
    v_xor_b32 v173, s34, v10
    v_add_u32 v173, s33, v173
    ds_write_b32 v173, v169
    s_add_u32 s33, s43, 2
    s_and_b32 s34, s33, 15
    s_lshl_b32 s34, s34, 4
    s_lshl_b32 s33, s33, 8
    s_add_u32 s33, s33, 105472
    v_cvt_pk_bf16_f32 v170, v42, v46
    v_xor_b32 v174, s34, v10
    v_add_u32 v174, s33, v174
    ds_write_b32 v174, v170
    s_add_u32 s33, s43, 3
    s_and_b32 s34, s33, 15
    s_lshl_b32 s34, s34, 4
    s_lshl_b32 s33, s33, 8
    s_add_u32 s33, s33, 105472
    v_cvt_pk_bf16_f32 v171, v43, v47
    v_xor_b32 v175, s34, v10
    v_add_u32 v175, s33, v175
    ds_write_b32 v175, v171
    s_add_u32 s33, s44, 0
    s_and_b32 s34, s33, 15
    s_lshl_b32 s34, s34, 4
    s_lshl_b32 s33, s33, 8
    s_add_u32 s33, s33, 105472
    v_cvt_pk_bf16_f32 v168, v48, v52
    v_xor_b32 v172, s34, v10
    v_add_u32 v172, s33, v172
    ds_write_b32 v172, v168
    s_add_u32 s33, s44, 1
    s_and_b32 s34, s33, 15
    s_lshl_b32 s34, s34, 4
    s_lshl_b32 s33, s33, 8
    s_add_u32 s33, s33, 105472
    v_cvt_pk_bf16_f32 v169, v49, v53
    v_xor_b32 v173, s34, v10
    v_add_u32 v173, s33, v173
    ds_write_b32 v173, v169
    s_add_u32 s33, s44, 2
    s_and_b32 s34, s33, 15
    s_lshl_b32 s34, s34, 4
    s_lshl_b32 s33, s33, 8
    s_add_u32 s33, s33, 105472
    v_cvt_pk_bf16_f32 v170, v50, v54
    v_xor_b32 v174, s34, v10
    v_add_u32 v174, s33, v174
    ds_write_b32 v174, v170
    s_add_u32 s33, s44, 3
    s_and_b32 s34, s33, 15
    s_lshl_b32 s34, s34, 4
    s_lshl_b32 s33, s33, 8
    s_add_u32 s33, s33, 105472
    v_cvt_pk_bf16_f32 v171, v51, v55
    v_xor_b32 v175, s34, v10
    v_add_u32 v175, s33, v175
    ds_write_b32 v175, v171
    v_and_b32 v12, 15, v1
    v_lshrrev_b32 v11, 4, v1
    v_xor_b32 v13, v11, v12
    s_lshr_b32 s33, s3, 2
    s_lshl_b32 s34, s33, 12
    s_add_u32 s34, s34, 105472
    v_lshl_add_u32 v14, v12, 8, s34
    v_xor_b32 v152, 0, v13
    v_lshl_add_u32 v152, v152, 4, v14
    v_xor_b32 v153, 4, v13
    v_lshl_add_u32 v153, v153, 4, v14
    v_xor_b32 v154, 8, v13
    v_lshl_add_u32 v154, v154, 4, v14
    v_xor_b32 v155, 12, v13
    v_lshl_add_u32 v155, v155, 4, v14
    s_lshl_b32 s33, s33, 2
    s_add_u32 s33, s33, s16
    s_lshl_b32 s33, s33, 10
    s_and_b32 s34, s3, 3
    s_lshl_b32 s34, s34, 8
    s_add_u32 s33, s33, s34
    v_lshlrev_b32 v11, 10, v11
    v_lshl_add_u32 v11, v12, 4, v11
    v_add_u32 v11, s33, v11
    s_waitcnt vmcnt(0) lgkmcnt(0)
    s_barrier
    ds_read_b128 v[56:59], v152 offset:0
    ds_read_b128 v[60:63], v153 offset:0
    ds_read_b128 v[64:67], v154 offset:0
    ds_read_b128 v[68:71], v155 offset:0
    ds_read_b128 v[72:75], v152 offset:8192
    ds_read_b128 v[76:79], v153 offset:8192
    ds_read_b128 v[80:83], v154 offset:8192
    ds_read_b128 v[84:87], v155 offset:8192
    ds_read_b128 v[88:91], v152 offset:16384
    ds_read_b128 v[92:95], v153 offset:16384
    ds_read_b128 v[96:99], v154 offset:16384
    ds_read_b128 v[100:103], v155 offset:16384
    ds_read_b128 v[104:107], v152 offset:24576
    ds_read_b128 v[108:111], v153 offset:24576
    ds_read_b128 v[112:115], v154 offset:24576
    ds_read_b128 v[116:119], v155 offset:24576
    s_waitcnt lgkmcnt(15)
    v_mfma_f32_16x16x32_bf16 v[120:123], v[56:59], v[200:203], 0
    v_mfma_f32_16x16x32_bf16 v[124:127], v[56:59], v[216:219], 0
    s_waitcnt lgkmcnt(14)
    v_mfma_f32_16x16x32_bf16 v[120:123], v[60:63], v[204:207], v[120:123]
    v_mfma_f32_16x16x32_bf16 v[124:127], v[60:63], v[220:223], v[124:127]
    s_waitcnt lgkmcnt(13)
    v_mfma_f32_16x16x32_bf16 v[120:123], v[64:67], v[208:211], v[120:123]
    v_mfma_f32_16x16x32_bf16 v[124:127], v[64:67], v[224:227], v[124:127]
    s_waitcnt lgkmcnt(12)
    v_mfma_f32_16x16x32_bf16 v[120:123], v[68:71], v[212:215], v[120:123]
    v_mfma_f32_16x16x32_bf16 v[124:127], v[68:71], v[228:231], v[124:127]
    ds_read_b128 v[56:59], v152 offset:32768
    ds_read_b128 v[60:63], v153 offset:32768
    ds_read_b128 v[64:67], v154 offset:32768
    ds_read_b128 v[68:71], v155 offset:32768
    s_waitcnt lgkmcnt(15)
    v_mfma_f32_16x16x32_bf16 v[128:131], v[72:75], v[200:203], 0
    v_mfma_f32_16x16x32_bf16 v[132:135], v[72:75], v[216:219], 0
    s_waitcnt lgkmcnt(14)
    v_mfma_f32_16x16x32_bf16 v[128:131], v[76:79], v[204:207], v[128:131]
    v_mfma_f32_16x16x32_bf16 v[132:135], v[76:79], v[220:223], v[132:135]
    s_waitcnt lgkmcnt(13)
    v_mfma_f32_16x16x32_bf16 v[128:131], v[80:83], v[208:211], v[128:131]
    v_mfma_f32_16x16x32_bf16 v[132:135], v[80:83], v[224:227], v[132:135]
    s_waitcnt lgkmcnt(12)
    v_mfma_f32_16x16x32_bf16 v[128:131], v[84:87], v[212:215], v[128:131]
    v_mfma_f32_16x16x32_bf16 v[132:135], v[84:87], v[228:231], v[132:135]
    v_cvt_pk_bf16_f32 v136, v120, v121
    v_cvt_pk_bf16_f32 v137, v122, v123
    v_cvt_pk_bf16_f32 v138, v124, v125
    v_cvt_pk_bf16_f32 v139, v126, v127
    s_mov_b32 s33, 0
    buffer_store_dwordx4 v[136:139], v11, s[12:15], s33 offen sc1
    s_waitcnt lgkmcnt(11)
    v_mfma_f32_16x16x32_bf16 v[120:123], v[88:91], v[200:203], 0
    v_mfma_f32_16x16x32_bf16 v[124:127], v[88:91], v[216:219], 0
    s_waitcnt lgkmcnt(10)
    v_mfma_f32_16x16x32_bf16 v[120:123], v[92:95], v[204:207], v[120:123]
    v_mfma_f32_16x16x32_bf16 v[124:127], v[92:95], v[220:223], v[124:127]
    s_waitcnt lgkmcnt(9)
    v_mfma_f32_16x16x32_bf16 v[120:123], v[96:99], v[208:211], v[120:123]
    v_mfma_f32_16x16x32_bf16 v[124:127], v[96:99], v[224:227], v[124:127]
    s_waitcnt lgkmcnt(8)
    v_mfma_f32_16x16x32_bf16 v[120:123], v[100:103], v[212:215], v[120:123]
    v_mfma_f32_16x16x32_bf16 v[124:127], v[100:103], v[228:231], v[124:127]
    v_cvt_pk_bf16_f32 v140, v128, v129
    v_cvt_pk_bf16_f32 v141, v130, v131
    v_cvt_pk_bf16_f32 v142, v132, v133
    v_cvt_pk_bf16_f32 v143, v134, v135
    s_mov_b32 s33, 8192
    buffer_store_dwordx4 v[140:143], v11, s[12:15], s33 offen sc1
    s_waitcnt lgkmcnt(7)
    v_mfma_f32_16x16x32_bf16 v[128:131], v[104:107], v[200:203], 0
    v_mfma_f32_16x16x32_bf16 v[132:135], v[104:107], v[216:219], 0
    s_waitcnt lgkmcnt(6)
    v_mfma_f32_16x16x32_bf16 v[128:131], v[108:111], v[204:207], v[128:131]
    v_mfma_f32_16x16x32_bf16 v[132:135], v[108:111], v[220:223], v[132:135]
    s_waitcnt lgkmcnt(5)
    v_mfma_f32_16x16x32_bf16 v[128:131], v[112:115], v[208:211], v[128:131]
    v_mfma_f32_16x16x32_bf16 v[132:135], v[112:115], v[224:227], v[132:135]
    s_waitcnt lgkmcnt(4)
    v_mfma_f32_16x16x32_bf16 v[128:131], v[116:119], v[212:215], v[128:131]
    v_mfma_f32_16x16x32_bf16 v[132:135], v[116:119], v[228:231], v[132:135]
    v_cvt_pk_bf16_f32 v136, v120, v121
    v_cvt_pk_bf16_f32 v137, v122, v123
    v_cvt_pk_bf16_f32 v138, v124, v125
    v_cvt_pk_bf16_f32 v139, v126, v127
    s_mov_b32 s33, 16384
    buffer_store_dwordx4 v[136:139], v11, s[12:15], s33 offen sc1
    s_waitcnt lgkmcnt(3)
    v_mfma_f32_16x16x32_bf16 v[120:123], v[56:59], v[200:203], 0
    v_mfma_f32_16x16x32_bf16 v[124:127], v[56:59], v[216:219], 0
    s_waitcnt lgkmcnt(2)
    v_mfma_f32_16x16x32_bf16 v[120:123], v[60:63], v[204:207], v[120:123]
    v_mfma_f32_16x16x32_bf16 v[124:127], v[60:63], v[220:223], v[124:127]
    s_waitcnt lgkmcnt(1)
    v_mfma_f32_16x16x32_bf16 v[120:123], v[64:67], v[208:211], v[120:123]
    v_mfma_f32_16x16x32_bf16 v[124:127], v[64:67], v[224:227], v[124:127]
    s_waitcnt lgkmcnt(0)
    v_mfma_f32_16x16x32_bf16 v[120:123], v[68:71], v[212:215], v[120:123]
    v_mfma_f32_16x16x32_bf16 v[124:127], v[68:71], v[228:231], v[124:127]
    v_cvt_pk_bf16_f32 v140, v128, v129
    v_cvt_pk_bf16_f32 v141, v130, v131
    v_cvt_pk_bf16_f32 v142, v132, v133
    v_cvt_pk_bf16_f32 v143, v134, v135
    s_mov_b32 s33, 24576
    buffer_store_dwordx4 v[140:143], v11, s[12:15], s33 offen sc1
    s_nop 0
    v_cvt_pk_bf16_f32 v136, v120, v121
    v_cvt_pk_bf16_f32 v137, v122, v123
    v_cvt_pk_bf16_f32 v138, v124, v125
    v_cvt_pk_bf16_f32 v139, v126, v127
    s_mov_b32 s33, 32768
    buffer_store_dwordx4 v[136:139], v11, s[12:15], s33 offen sc1
K2_END:
    s_endpgm
.p2align 6
.type K2_TAB,@object
K2_TAB:
.byte 6, 5, 14, 7, 4, 2, 0, 1, 3, 12, 22, 11, 10, 8, 30, 9, 19, 13, 15, 17, 16, 21, 23, 20, 18, 25, 29, 28, 31, 27, 26, 24, 34, 32, 39, 33, 35, 36, 37, 38, 255, 255, 255, 255, 255, 255, 255, 255, 255, 255, 255, 255, 255, 255, 255, 255, 255, 255, 255, 255, 255, 255, 255, 255
.byte 3, 2, 4, 7, 0, 1, 6, 8, 5, 9, 15, 13, 14, 11, 12, 22, 21, 16, 10, 23, 17, 20, 30, 19, 18, 25, 27, 24, 29, 28, 26, 31, 34, 37, 36, 39, 33, 38, 32, 35, 255, 255, 255, 255, 255, 255, 255, 255, 255, 255, 255, 255, 255, 255, 255, 255, 255, 255, 255, 255, 255, 255, 255, 255
.section .rodata,"a"
.p2align 6
.amdhsa_kernel part_kernel
  .amdhsa_next_free_vgpr 48
  .amdhsa_next_free_sgpr 64
  .amdhsa_accum_offset 48
  .amdhsa_group_segment_fixed_size 0
  .amdhsa_kernarg_size 88
  .amdhsa_user_sgpr_count 2
  .amdhsa_user_sgpr_kernarg_segment_ptr 1
  .amdhsa_system_sgpr_workgroup_id_x 1
  .amdhsa_float_denorm_mode_32 3
.end_amdhsa_kernel
.p2align 6
.amdhsa_kernel main_kernel
  .amdhsa_next_free_vgpr 256
  .amdhsa_next_free_sgpr 64
  .amdhsa_accum_offset 256
  .amdhsa_group_segment_fixed_size 0
  .amdhsa_kernarg_size 88
  .amdhsa_user_sgpr_count 2
  .amdhsa_user_sgpr_kernarg_segment_ptr 1
  .amdhsa_system_sgpr_workgroup_id_x 1
  .amdhsa_float_denorm_mode_32 3
.end_amdhsa_kernel
```

```asm
; @launch grid=(256,1,1) block=(512,1,1) lds=152832
.amdgcn_target "amdgcn-amd-amdhsa--gfx950"
.text
.globl gather_scatter__tensor_product_equiv_tfn__graph_kernel
.p2align 8
.type gather_scatter__tensor_product_equiv_tfn__graph_kernel,@function
gather_scatter__tensor_product_equiv_tfn__graph_kernel:
    s_cmp_ge_u32 s2, 256
    s_cbranch_scc1 K_END
    s_load_dwordx16 s[4:19], s[0:1], 0
    s_load_dwordx4 s[20:23], s[0:1], 64
    s_load_dwordx2 s[24:25], s[0:1], 80
    v_lshrrev_b32 v2, 6, v0
    v_and_b32 v1, 63, v0
    v_lshlrev_b32 v3, 2, v0
    v_readfirstlane_b32 s3, v2
    v_mov_b32 v4, 0
    v_mov_b32 v5, 0
    v_mov_b32 v6, 0
    v_mov_b32 v7, 0
    v_cvt_f32_u32 v10, v1
    v_lshlrev_b32 v8, 4, v0
    v_add_u32 v8, 106752, v8
    s_cmp_eq_u32 s3, 2
    s_cselect_b32 s56, -1, 0
    ds_write_b128 v8, v[4:7]
    v_and_b32 v10, s56, v10
    ds_write_b32 v3, v4 offset:2048
    ds_write_b32 v3, v10
    s_mul_i32 s57, s2, 5120
    v_lshlrev_b32 v10, 4, v0
    v_add_u32 v11, s57, v10
    v_lshlrev_b32 v12, 1, v11
    s_and_b32 s53, s2, 7
    s_lshr_b32 s56, s2, 3
    s_lshl_b32 s53, s53, 5
    s_or_b32 s53, s53, s56
    s_cmp_lt_u32 s2, 250
    s_cselect_b32 s56, 5, 0
    s_cmp_lt_u32 s3, s56
    s_cselect_b32 s40, 1, 0
    v_lshlrev_b32 v9, 4, v1
    v_lshlrev_b32 v15, 2, v1
    s_waitcnt lgkmcnt(0)
    s_load_dword s52, s[24:25], 0
    s_cmp_eq_u32 s40, 0
    s_cbranch_scc1 K_HELP
    global_load_dwordx4 v[120:123], v11, s[8:9]
    s_barrier
    global_load_dwordx4 v[124:127], v11, s[6:7]
    global_load_dwordx4 v[128:131], v12, s[10:11] offset:0
    global_load_dwordx4 v[132:135], v12, s[10:11] offset:16
    global_load_dwordx4 v[136:139], v12, s[12:13] offset:0
    global_load_dwordx4 v[140:143], v12, s[12:13] offset:16
    s_mul_i32 s54, s53, 625
    s_add_u32 s57, s54, 640
    s_add_u32 s54, s54, 15
    s_lshr_b32 s54, s54, 4
    s_lshr_b32 s57, s57, 4
    s_mov_b32 s28, s4
    s_and_b32 s29, s5, 0xffff
    s_or_b32 s29, s29, 0x100000
    s_mov_b32 s30, 10240000
    s_mov_b32 s31, 0x800000
    s_mov_b32 s32, s20
    s_mov_b32 s33, s21
    s_lshl_b32 s34, s57, 10
    s_mov_b32 s35, 0x20000
    s_mov_b32 s36, s24
    s_mov_b32 s37, s25
    s_mov_b32 s38, 8388608
    s_mov_b32 s39, 0x20000
    s_mov_b32 s47, 0
    v_mov_b32 v14, 1
    v_mov_b32 v16, 0
    v_mov_b32 v17, 0
    v_mov_b32 v18, 0
    v_mov_b32 v19, 0
    v_mov_b32 v20, 0
    v_mov_b32 v21, 0
    v_mov_b32 v22, 0
    v_mov_b32 v23, 0
    v_mov_b32 v24, 0
    v_mov_b32 v25, 0
    v_mov_b32 v26, 0
    v_mov_b32 v27, 0
    v_mov_b32 v28, 0
    v_mov_b32 v29, 0
    v_mov_b32 v30, 0
    v_mov_b32 v31, 0
    v_mov_b32 v32, 0
    v_mov_b32 v33, 0
    v_mov_b32 v34, 0
    v_mov_b32 v35, 0
    v_mov_b32 v36, 0
    v_mov_b32 v37, 0
    v_mov_b32 v38, 0
    v_mov_b32 v39, 0
    v_mov_b32 v40, 0
    v_mov_b32 v41, 0
    v_mov_b32 v42, 0
    v_mov_b32 v43, 0
    v_mov_b32 v44, 0
    v_mov_b32 v45, 0
    v_mov_b32 v46, 0
    v_mov_b32 v47, 0
    v_mov_b32 v48, 0
    v_mov_b32 v49, 0
    v_mov_b32 v50, 0
    v_mov_b32 v51, 0
    v_mov_b32 v52, 0
    v_mov_b32 v53, 0
    v_mov_b32 v54, 0
    v_mov_b32 v55, 0
    s_waitcnt vmcnt(5)
    v_mul_u32_u24 v60, 214749, v120
    v_lshrrev_b32 v60, 23, v60
    v_lshlrev_b32 v144, 2, v60
    ds_add_rtn_u32 v148, v144, v14 offset:768
    v_mul_u32_u24 v61, 214749, v121
    v_lshrrev_b32 v61, 23, v61
    v_lshlrev_b32 v145, 2, v61
    ds_add_rtn_u32 v149, v145, v14 offset:768
    v_mul_u32_u24 v62, 214749, v122
    v_lshrrev_b32 v62, 23, v62
    v_lshlrev_b32 v146, 2, v62
    ds_add_rtn_u32 v150, v146, v14 offset:768
    v_mul_u32_u24 v63, 214749, v123
    v_lshrrev_b32 v63, 23, v63
    v_lshlrev_b32 v147, 2, v63
    ds_add_rtn_u32 v151, v147, v14 offset:768
    v_mul_u32_u24 v64, 625, v60
    v_add_u32 v64, 15, v64
    v_lshrrev_b32 v64, 4, v64
    v_sub_u32 v56, v120, v64
    v_mul_u32_u24 v64, 625, v61
    v_add_u32 v64, 15, v64
    v_lshrrev_b32 v64, 4, v64
    v_sub_u32 v57, v121, v64
    v_mul_u32_u24 v64, 625, v62
    v_add_u32 v64, 15, v64
    v_lshrrev_b32 v64, 4, v64
    v_sub_u32 v58, v122, v64
    v_mul_u32_u24 v64, 625, v63
    v_add_u32 v64, 15, v64
    v_lshrrev_b32 v64, 4, v64
    v_sub_u32 v59, v123, v64
    s_branch K_BB
K_HELP:
    s_barrier
    s_cmp_lt_u32 s3, 5
    s_cbranch_scc1 K_HELP2
    s_cmp_eq_u32 s3, 7
    s_cbranch_scc1 K_HELP7
    s_cmp_eq_u32 s3, 5
    s_cbranch_scc1 K_HELP2
    s_and_b32 s56, s53, 31
    s_lshl_b32 s56, s56, 10
    v_lshl_add_u32 v13, v1, 7, s56
    s_mov_b64 exec, 0xff
    global_load_dword v255, v13, s[18:19]
    s_mov_b64 exec, -1
    s_branch K_HELP2
K_HELP7:
    s_mov_b32 m0, 147712
    s_getpc_b64 s[26:27]
K_PC:
    global_load_lds_dwordx4 v9, s[14:15]
    s_add_u32 s26, s26, K_TAB-K_PC
    s_addc_u32 s27, s27, 0
    s_mov_b32 m0, 148736
    s_mov_b64 exec, 0xff
    global_load_lds_dwordx4 v9, s[16:17]
    s_mov_b32 m0, 148864
    s_nop 0
    global_load_lds_dwordx4 v9, s[26:27]
    s_mov_b64 exec, -1
K_HELP2:
    s_mul_i32 s54, s53, 625
    s_add_u32 s57, s54, 640
    s_add_u32 s54, s54, 15
    s_lshr_b32 s54, s54, 4
    s_lshr_b32 s57, s57, 4
    s_mov_b32 s28, s4
    s_and_b32 s29, s5, 0xffff
    s_or_b32 s29, s29, 0x100000
    s_mov_b32 s30, 10240000
    s_mov_b32 s31, 0x800000
    s_mov_b32 s32, s20
    s_mov_b32 s33, s21
    s_lshl_b32 s34, s57, 10
    s_mov_b32 s35, 0x20000
    s_mov_b32 s36, s24
    s_mov_b32 s37, s25
    s_mov_b32 s38, 8388608
    s_mov_b32 s39, 0x20000
    s_mov_b32 s47, 0
    v_mov_b32 v14, 1
    v_mov_b32 v16, 0
    v_mov_b32 v17, 0
    v_mov_b32 v18, 0
    v_mov_b32 v19, 0
    v_mov_b32 v20, 0
    v_mov_b32 v21, 0
    v_mov_b32 v22, 0
    v_mov_b32 v23, 0
    v_mov_b32 v24, 0
    v_mov_b32 v25, 0
    v_mov_b32 v26, 0
    v_mov_b32 v27, 0
    v_mov_b32 v28, 0
    v_mov_b32 v29, 0
    v_mov_b32 v30, 0
    v_mov_b32 v31, 0
    v_mov_b32 v32, 0
    v_mov_b32 v33, 0
    v_mov_b32 v34, 0
    v_mov_b32 v35, 0
    v_mov_b32 v36, 0
    v_mov_b32 v37, 0
    v_mov_b32 v38, 0
    v_mov_b32 v39, 0
    v_mov_b32 v40, 0
    v_mov_b32 v41, 0
    v_mov_b32 v42, 0
    v_mov_b32 v43, 0
    v_mov_b32 v44, 0
    v_mov_b32 v45, 0
    v_mov_b32 v46, 0
    v_mov_b32 v47, 0
    v_mov_b32 v48, 0
    v_mov_b32 v49, 0
    v_mov_b32 v50, 0
    v_mov_b32 v51, 0
    v_mov_b32 v52, 0
    v_mov_b32 v53, 0
    v_mov_b32 v54, 0
    v_mov_b32 v55, 0
K_BB:
    s_waitcnt lgkmcnt(0)
    s_barrier
    s_add_u32 s52, s52, 1
    s_and_b32 s56, s52, 0x3ff
    s_lshl_b32 s58, s56, 22
    s_and_b32 s59, s52, 0xff
    s_lshl_b32 s26, s59, 24
    s_sub_u32 s56, s3, 5
    s_lshl_b32 s57, s56, 14
    v_add_u32 v13, s57, v9
    s_cmp_lt_u32 s56, 2
    s_cbranch_scc1 K_DMA
    s_cmp_ge_u32 s2, 250
    s_cbranch_scc1 K_BC1
    ds_read_b128 v[152:155], v9 offset:768
    s_cmp_eq_u32 s3, 7
    s_cbranch_scc1 K_SC
    s_waitcnt vmcnt(4)
    v_mul_u32_u24 v60, 1677, v124
    v_lshrrev_b32 v60, 20, v60
    v_lshl_or_b32 v56, v56, 4, v60
    v_lshl_or_b32 v56, v124, 10, v56
    v_mul_u32_u24 v61, 1677, v125
    v_lshrrev_b32 v61, 20, v61
    v_lshl_or_b32 v57, v57, 4, v61
    v_lshl_or_b32 v57, v125, 10, v57
    v_mul_u32_u24 v62, 1677, v126
    v_lshrrev_b32 v62, 20, v62
    v_lshl_or_b32 v58, v58, 4, v62
    v_lshl_or_b32 v58, v126, 10, v58
    v_mul_u32_u24 v63, 1677, v127
    v_lshrrev_b32 v63, 20, v63
    v_lshl_or_b32 v59, v59, 4, v63
    v_lshl_or_b32 v59, v127, 10, v59
K_SC:
    s_waitcnt lgkmcnt(0)
    v_add_u32 v156, v152, v153
    v_add_u32 v157, v156, v154
    v_add_u32 v158, v157, v155
    v_mov_b32 v160, v158
    s_nop 1
    v_add_u32_dpp v160, v160, v160 row_shr:1 row_mask:0xf bank_mask:0xf
    s_nop 1
    v_add_u32_dpp v160, v160, v160 row_shr:2 row_mask:0xf bank_mask:0xf
    s_nop 1
    v_add_u32_dpp v160, v160, v160 row_shr:4 row_mask:0xf bank_mask:0xf
    s_nop 1
    v_add_u32_dpp v160, v160, v160 row_shr:8 row_mask:0xf bank_mask:0xf
    s_nop 1
    v_add_u32_dpp v160, v160, v160 row_bcast:15 row_mask:0xa bank_mask:0xf
    s_nop 1
    v_add_u32_dpp v160, v160, v160 row_bcast:31 row_mask:0xc bank_mask:0xf
    v_sub_u32 v160, v160, v158
    v_add_u32 v161, v160, v152
    v_add_u32 v162, v160, v156
    v_add_u32 v163, v160, v157
    s_cmp_lg_u32 s3, 7
    s_cbranch_scc1 K_NOROW
    v_lshl_or_b32 v168, v152, 11, v160
    v_or_b32 v168, s58, v168
    v_mov_b32 v169, s52
    v_lshl_or_b32 v170, v153, 11, v161
    v_or_b32 v170, s58, v170
    v_mov_b32 v171, s52
    v_lshl_or_b32 v172, v154, 11, v162
    v_or_b32 v172, s58, v172
    v_mov_b32 v173, s52
    v_lshl_or_b32 v174, v155, 11, v163
    v_or_b32 v174, s58, v174
    v_mov_b32 v175, s52
    s_lshl_b32 s57, s2, 11
    s_add_u32 s57, s57, 8192
    v_lshlrev_b32 v11, 5, v1
    buffer_store_dwordx4 v[168:171], v11, s[36:39], s57 offen sc1
    buffer_store_dwordx4 v[172:175], v11, s[36:39], s57 offen offset:16 sc1
    s_branch K_BC1
K_DMA:
    s_add_u32 s57, s57, 114944
    s_mov_b32 m0, s57
    s_add_u32 s57, s57, 4096
    global_load_lds_dwordx4 v13, s[18:19] offset:0
    global_load_lds_dwordx4 v13, s[18:19] offset:1024
    global_load_lds_dwordx4 v13, s[18:19] offset:2048
    global_load_lds_dwordx4 v13, s[18:19] offset:3072
    v_add_u32 v13, 4096, v13
    s_mov_b32 m0, s57
    s_add_u32 s57, s57, 4096
    global_load_lds_dwordx4 v13, s[18:19] offset:0
    global_load_lds_dwordx4 v13, s[18:19] offset:1024
    global_load_lds_dwordx4 v13, s[18:19] offset:2048
    global_load_lds_dwordx4 v13, s[18:19] offset:3072
    v_add_u32 v13, 4096, v13
    s_mov_b32 m0, s57
    s_add_u32 s57, s57, 4096
    global_load_lds_dwordx4 v13, s[18:19] offset:0
    global_load_lds_dwordx4 v13, s[18:19] offset:1024
    global_load_lds_dwordx4 v13, s[18:19] offset:2048
    global_load_lds_dwordx4 v13, s[18:19] offset:3072
    v_add_u32 v13, 4096, v13
    s_mov_b32 m0, s57
    s_add_u32 s57, s57, 4096
    global_load_lds_dwordx4 v13, s[18:19] offset:0
    global_load_lds_dwordx4 v13, s[18:19] offset:1024
    global_load_lds_dwordx4 v13, s[18:19] offset:2048
    global_load_lds_dwordx4 v13, s[18:19] offset:3072
    s_branch K_BC1
K_NOROW:
    ds_write_b128 v9, v[160:163] offset:4096
    ds_read_b32 v60, v144 offset:4096
    ds_read_b32 v61, v145 offset:4096
    ds_read_b32 v62, v146 offset:4096
    ds_read_b32 v63, v147 offset:4096
    v_or_b32 v66, s26, v56
    v_mov_b32 v67, s52
    v_or_b32 v68, s26, v57
    v_mov_b32 v69, s52
    v_or_b32 v70, s26, v58
    v_mov_b32 v71, s52
    v_or_b32 v72, s26, v59
    v_mov_b32 v73, s52
    s_waitcnt lgkmcnt(3)
    v_add_lshl_u32 v144, v60, v148, 3
    ds_write_b64 v144, v[66:67] offset:13824
    s_waitcnt lgkmcnt(3)
    v_add_lshl_u32 v145, v61, v149, 3
    ds_write_b64 v145, v[68:69] offset:13824
    s_waitcnt lgkmcnt(3)
    v_add_lshl_u32 v146, v62, v150, 3
    ds_write_b64 v146, v[70:71] offset:13824
    s_waitcnt lgkmcnt(3)
    v_add_lshl_u32 v147, v63, v151, 3
    ds_write_b64 v147, v[72:73] offset:13824
    v_lshlrev_b32 v144, 1, v144
    v_add_u32 v144, 44800, v144
    v_lshlrev_b32 v145, 1, v145
    v_add_u32 v145, 44800, v145
    v_lshlrev_b32 v146, 1, v146
    v_add_u32 v146, 44800, v146
    v_lshlrev_b32 v147, 1, v147
    v_add_u32 v147, 44800, v147
K_BC1:
    s_mul_i32 s60, s2, 10240
    s_add_u32 s60, s60, 532480
    s_waitcnt lgkmcnt(0)
    s_barrier
    s_cmp_ge_u32 s2, 250
    s_cbranch_scc1 K_BC0
    ds_read_b128 v[76:79], v10 offset:13824
    s_sub_u32 s56, s3, 5
    s_cmp_lt_u32 s56, 2
    s_cbranch_scc0 K_KS1
    ds_read_b128 v[80:83], v10 offset:16896
    s_add_u32 s59, s60, 3072
    s_waitcnt lgkmcnt(0)
    buffer_store_dwordx4 v[80:83], v10, s[36:39], s59 offen sc1
K_KS1:
    s_waitcnt lgkmcnt(0)
    buffer_store_dwordx4 v[76:79], v10, s[36:39], s60 offen sc1
    s_cmp_ge_u32 s3, 5
    s_cbranch_scc1 K_BC3
    s_waitcnt vmcnt(1)
    ds_write2_b64 v144, v[128:129], v[136:137] offset0:0 offset1:1
    ds_write2_b64 v145, v[130:131], v[138:139] offset0:0 offset1:1
    ds_write2_b64 v146, v[132:133], v[140:141] offset0:0 offset1:1
    ds_write2_b64 v147, v[134:135], v[142:143] offset0:0 offset1:1
    s_branch K_BC
K_BC0:
    s_waitcnt vmcnt(0)
K_BC3:
    s_cmp_eq_u32 s3, 7
    s_cbranch_scc1 K_BC7
    s_waitcnt vmcnt(2)
K_BC7:
    s_waitcnt vmcnt(3)
K_BC:
    s_mul_i32 s56, s2, 20480
    s_add_u32 s56, s56, 3145728
    s_add_u32 s57, s56, 8192
    s_add_u32 s59, s56, 16384
    v_lshlrev_b32 v11, 11, v0
    s_lshl_b32 s61, s53, 3
    s_add_u32 s61, s61, 8192
    s_waitcnt lgkmcnt(0)
    s_barrier
    s_cmp_ge_u32 s2, 250
    s_cbranch_scc1 K_NOKEY
    ds_read_b128 v[56:59], v10 offset:44800
    ds_read_b128 v[60:63], v10 offset:52992
    s_cmp_ge_u32 s3, 4
    s_cbranch_scc1 K_ST1
    ds_read_b128 v[64:67], v10 offset:61184
    s_waitcnt lgkmcnt(0)
    buffer_store_dwordx4 v[64:67], v10, s[36:39], s59 offen sc1
K_ST1:
    s_waitcnt lgkmcnt(1)
    buffer_store_dwordx4 v[56:59], v10, s[36:39], s56 offen sc1
    s_waitcnt lgkmcnt(0)
    buffer_store_dwordx4 v[60:63], v10, s[36:39], s57 offen sc1
K_NOKEY:
    s_lshr_b32 s56, s34, 10
    s_sub_u32 s56, s56, s54
    s_sub_u32 s56, s56, 39
    s_lshl_b32 s56, s56, 6
    s_add_u32 s56, s56, 148864
    v_add_u32 v2, s56, v1
    v_add_u32 v13, 147712, v15
    ds_read_u8 v2, v2
    ds_read2st64_b32 v[188:189], v13 offset0:0 offset1:1
    ds_read2st64_b32 v[190:191], v13 offset0:2 offset1:3
    v_and_b32 v12, 3, v1
    v_lshlrev_b32 v12, 5, v12
    v_bfe_u32 v13, v1, 2, 2
    v_lshl_or_b32 v12, v13, 1, v12
    v_add_u32 v12, 148736, v12
    ds_read_u16 v192, v12 offset:0
    ds_read_u16 v193, v12 offset:8
    ds_read_u16 v194, v12 offset:16
    ds_read_u16 v195, v12 offset:24
    v_mov_b32 v152, 0
    s_waitcnt lgkmcnt(0)
    s_mov_b32 s56, 0xbfb8aa3b
    v_lshlrev_b32 v136, 16, v188
    v_mul_f32 v140, s56, v136
    v_lshlrev_b32 v137, 16, v189
    v_mul_f32 v141, s56, v137
    v_lshlrev_b32 v138, 16, v190
    v_mul_f32 v142, s56, v138
    v_lshlrev_b32 v139, 16, v191
    v_mul_f32 v143, s56, v139
    v_cvt_pk_bf16_f32 v176, v140, v141
    v_cvt_pk_bf16_f32 v177, v142, v143
    v_lshlrev_b32 v140, 16, v176
    v_fma_f32 v140, s56, v136, -v140
    v_and_b32 v141, 0xffff0000, v176
    v_fma_f32 v141, s56, v137, -v141
    v_lshlrev_b32 v142, 16, v177
    v_fma_f32 v142, s56, v138, -v142
    v_and_b32 v143, 0xffff0000, v177
    v_fma_f32 v143, s56, v139, -v143
    v_cvt_pk_bf16_f32 v178, v140, v141
    v_cvt_pk_bf16_f32 v179, v142, v143
    v_and_b32 v136, 0xffff0000, v188
    v_mul_f32 v140, s56, v136
    v_and_b32 v137, 0xffff0000, v189
    v_mul_f32 v141, s56, v137
    v_and_b32 v138, 0xffff0000, v190
    v_mul_f32 v142, s56, v138
    v_and_b32 v139, 0xffff0000, v191
    v_mul_f32 v143, s56, v139
    v_cvt_pk_bf16_f32 v180, v140, v141
    v_cvt_pk_bf16_f32 v181, v142, v143
    v_lshlrev_b32 v140, 16, v180
    v_fma_f32 v140, s56, v136, -v140
    v_and_b32 v141, 0xffff0000, v180
    v_fma_f32 v141, s56, v137, -v141
    v_lshlrev_b32 v142, 16, v181
    v_fma_f32 v142, s56, v138, -v142
    v_and_b32 v143, 0xffff0000, v181
    v_fma_f32 v143, s56, v139, -v143
    v_cvt_pk_bf16_f32 v182, v140, v141
    v_cvt_pk_bf16_f32 v183, v142, v143
    v_lshl_or_b32 v136, v193, 16, v192
    v_lshl_or_b32 v137, v195, 16, v194
    v_lshrrev_b32 v13, 4, v1
    v_cmp_eq_u32 vcc, 0, v13
    s_nop 1
    v_cndmask_b32 v232, 0, v136, vcc
    v_cndmask_b32 v233, 0, v137, vcc
    v_cmp_eq_u32 vcc, 1, v13
    s_nop 1
    v_cndmask_b32 v234, 0, v136, vcc
    v_cndmask_b32 v235, 0, v137, vcc
    v_cmp_eq_u32 vcc, 2, v13
    s_nop 1
    v_cndmask_b32 v236, 0, v136, vcc
    v_cndmask_b32 v237, 0, v137, vcc
    v_cmp_eq_u32 vcc, 3, v13
    s_nop 1
    v_cndmask_b32 v238, 0, v136, vcc
    v_cndmask_b32 v239, 0, v137, vcc
    s_and_b32 s56, s3, 3
    s_lshl_b32 s56, s56, 6
    s_add_u32 s56, s56, 114944
    v_lshrrev_b32 v10, 4, v1
    v_lshlrev_b32 v10, 11, v10
    v_and_b32 v12, 15, v1
    v_lshl_or_b32 v10, v12, 2, v10
    v_add_u32 v10, s56, v10
    s_mov_b32 s56, 0x05040100
    s_mov_b32 s57, 0x07060302
    ds_read2st64_b32 v[120:121], v10 offset0:0 offset1:1
    ds_read2st64_b32 v[122:123], v10 offset0:2 offset1:3
    ds_read2st64_b32 v[124:125], v10 offset0:4 offset1:5
    ds_read2st64_b32 v[126:127], v10 offset0:6 offset1:7
    ds_read2st64_b32 v[128:129], v10 offset0:32 offset1:33
    ds_read2st64_b32 v[130:131], v10 offset0:34 offset1:35
    ds_read2st64_b32 v[132:133], v10 offset0:36 offset1:37
    ds_read2st64_b32 v[134:135], v10 offset0:38 offset1:39
    ds_read2st64_b32 v[136:137], v10 offset0:64 offset1:65
    ds_read2st64_b32 v[138:139], v10 offset0:66 offset1:67
    ds_read2st64_b32 v[140:141], v10 offset0:68 offset1:69
    ds_read2st64_b32 v[142:143], v10 offset0:70 offset1:71
    ds_read2st64_b32 v[144:145], v10 offset0:96 offset1:97
    ds_read2st64_b32 v[146:147], v10 offset0:98 offset1:99
    ds_read2st64_b32 v[148:149], v10 offset0:100 offset1:101
    ds_read2st64_b32 v[150:151], v10 offset0:102 offset1:103
    s_waitcnt lgkmcnt(15)
    v_perm_b32 v200, v121, v120, s56
    v_perm_b32 v216, v121, v120, s57
    s_waitcnt lgkmcnt(14)
    v_perm_b32 v201, v123, v122, s56
    v_perm_b32 v217, v123, v122, s57
    s_waitcnt lgkmcnt(13)
    v_perm_b32 v202, v125, v124, s56
    v_perm_b32 v218, v125, v124, s57
    s_waitcnt lgkmcnt(12)
    v_perm_b32 v203, v127, v126, s56
    v_perm_b32 v219, v127, v126, s57
    s_waitcnt lgkmcnt(11)
    v_perm_b32 v204, v129, v128, s56
    v_perm_b32 v220, v129, v128, s57
    s_waitcnt lgkmcnt(10)
    v_perm_b32 v205, v131, v130, s56
    v_perm_b32 v221, v131, v130, s57
    s_waitcnt lgkmcnt(9)
    v_perm_b32 v206, v133, v132, s56
    v_perm_b32 v222, v133, v132, s57
    s_waitcnt lgkmcnt(8)
    v_perm_b32 v207, v135, v134, s56
    v_perm_b32 v223, v135, v134, s57
    s_waitcnt lgkmcnt(7)
    v_perm_b32 v208, v137, v136, s56
    v_perm_b32 v224, v137, v136, s57
    s_waitcnt lgkmcnt(6)
    v_perm_b32 v209, v139, v138, s56
    v_perm_b32 v225, v139, v138, s57
    s_waitcnt lgkmcnt(5)
    v_perm_b32 v210, v141, v140, s56
    v_perm_b32 v226, v141, v140, s57
    s_waitcnt lgkmcnt(4)
    v_perm_b32 v211, v143, v142, s56
    v_perm_b32 v227, v143, v142, s57
    s_waitcnt lgkmcnt(3)
    v_perm_b32 v212, v145, v144, s56
    v_perm_b32 v228, v145, v144, s57
    s_waitcnt lgkmcnt(2)
    v_perm_b32 v213, v147, v146, s56
    v_perm_b32 v229, v147, v146, s57
    s_waitcnt lgkmcnt(1)
    v_perm_b32 v214, v149, v148, s56
    v_perm_b32 v230, v149, v148, s57
    s_waitcnt lgkmcnt(0)
    v_perm_b32 v215, v151, v150, s56
    v_perm_b32 v231, v151, v150, s57
    v_and_b32 v252, 0x1ff, v0
    v_lshlrev_b32 v252, 2, v252
    v_xor_b32 v253, 1024, v252
    v_mul_u32_u24 v13, 5120, v1
    s_cmp_ge_u32 s3, 4
    s_cbranch_scc1 K_TABOK
    s_mov_b32 s59, 40000
    s_lshr_b32 s58, s58, 22
    v_cmp_gt_u32 vcc, 250, v0
    s_mov_b64 exec, vcc
    buffer_load_dwordx2 v[152:153], v11, s[36:39], s61 offen sc1
K_POLLA:
    s_waitcnt vmcnt(0)
    v_lshrrev_b32 v154, 22, v152
    v_cmp_ne_u32 vcc, s52, v153
    v_cmp_ne_u32 s[56:57], s58, v154
    s_or_b64 vcc, vcc, s[56:57]
    s_cbranch_vccz K_POLLAOK
    s_sub_u32 s59, s59, 1
    s_cbranch_scc1 K_POLLAFAIL
    buffer_load_dwordx2 v[152:153], v11, s[36:39], s61 offen sc1
    s_branch K_POLLA
K_POLLAFAIL:
    ds_write_b32 v4, v14 offset:1792
    s_mul_i32 s56, s2, 128
    s_add_u32 s56, s56, 8323072
    v_mov_b32 v10, s52
    s_mov_b64 exec, 1
    buffer_store_dword v10, v4, s[36:39], s56 offen offset:4 sc1
    s_mov_b64 exec, -1
K_POLLAOK:
    s_mov_b64 exec, -1
    ds_write_b32 v3, v152 offset:5120
K_TABOK:
    s_waitcnt vmcnt(0) lgkmcnt(0)
    s_barrier
    s_cmp_lg_u32 s3, 4
    s_cbranch_scc1 K_NOFLAG
    s_mul_i32 s56, s2, 128
    s_add_u32 s56, s56, 8323072
    v_mov_b32 v10, s52
    s_mov_b64 exec, 1
    buffer_store_dword v10, v4, s[36:39], s56 offen sc1
    s_mov_b64 exec, -1
K_NOFLAG:
    ds_read_b128 v[120:123], v9 offset:5120
    ds_read_b32 v10, v4 offset:1792
    v_mul_u32_u24 v154, 128, v0
    s_mov_b32 s63, 0
    s_waitcnt lgkmcnt(0)
    v_readfirstlane_b32 s55, v10
    v_bfe_u32 v124, v120, 11, 11
    v_bfe_u32 v125, v121, 11, 11
    v_bfe_u32 v126, v122, 11, 11
    v_bfe_u32 v127, v123, 11, 11
    v_add_u32 v129, v124, v125
    v_add_u32 v130, v129, v126
    v_add_u32 v131, v130, v127
    v_mov_b32 v132, v131
    v_and_b32 v120, 0x7ff, v120
    v_add_u32 v248, v13, v120
    v_add_u32_dpp v132, v132, v132 row_shr:1 row_mask:0xf bank_mask:0xf
    v_and_b32 v121, 0x7ff, v121
    v_add_u32 v249, v13, v121
    v_add_u32_dpp v132, v132, v132 row_shr:2 row_mask:0xf bank_mask:0xf
    v_add_u32 v249, 1280, v249
    v_and_b32 v122, 0x7ff, v122
    v_add_u32_dpp v132, v132, v132 row_shr:4 row_mask:0xf bank_mask:0xf
    v_add_u32 v250, v13, v122
    v_add_u32 v250, 2560, v250
    v_add_u32_dpp v132, v132, v132 row_shr:8 row_mask:0xf bank_mask:0xf
    v_and_b32 v123, 0x7ff, v123
    v_add_u32 v251, v13, v123
    v_add_u32_dpp v132, v132, v132 row_bcast:15 row_mask:0xa bank_mask:0xf
    v_add_u32 v251, 3840, v251
    s_nop 0
    v_add_u32_dpp v132, v132, v132 row_bcast:31 row_mask:0xc bank_mask:0xf
    s_cmp_lg_u32 s55, 0
    s_cbranch_scc1 K_FB0
    v_readlane_b32 s46, v132, 63
    v_sub_u32 v240, v132, v131
    v_add_u32 v241, v240, v124
    v_add_u32 v242, v240, v129
    v_add_u32 v243, v240, v130
    v_sub_u32 v248, v248, v240
    v_add_u32 v244, v240, v124
    v_sub_u32 v249, v249, v241
    v_add_u32 v245, v241, v125
    v_sub_u32 v250, v250, v242
    v_add_u32 v246, v242, v126
    v_sub_u32 v251, v251, v243
    v_add_u32 v247, v243, v127
K_ROUND:
    s_mul_i32 s56, s3, 192
    s_add_u32 s56, s56, s47
    s_add_u32 s57, s56, 192
    s_lshl_b32 s58, s3, 10
    s_add_u32 s58, s58, 106752
    v_cmp_lt_u32 vcc, s56, v244
    v_cmp_gt_u32 s[60:61], s57, v240
    v_subrev_u32 v56, s56, v240
    v_max_i32 v56, 0, v56
    v_lshl_add_u32 v56, v56, 2, s58
    s_and_b64 exec, vcc, s[60:61]
    ds_max_u32 v56, v248
    s_mov_b64 exec, -1
    v_cmp_lt_u32 vcc, s56, v245
    v_cmp_gt_u32 s[60:61], s57, v241
    v_subrev_u32 v57, s56, v241
    v_max_i32 v57, 0, v57
    v_lshl_add_u32 v57, v57, 2, s58
    s_and_b64 exec, vcc, s[60:61]
    ds_max_u32 v57, v249
    s_mov_b64 exec, -1
    v_cmp_lt_u32 vcc, s56, v246
    v_cmp_gt_u32 s[60:61], s57, v242
    v_subrev_u32 v58, s56, v242
    v_max_i32 v58, 0, v58
    v_lshl_add_u32 v58, v58, 2, s58
    s_and_b64 exec, vcc, s[60:61]
    ds_max_u32 v58, v250
    s_mov_b64 exec, -1
    v_cmp_lt_u32 vcc, s56, v247
    v_cmp_gt_u32 s[60:61], s57, v243
    v_subrev_u32 v59, s56, v243
    v_max_i32 v59, 0, v59
    v_lshl_add_u32 v59, v59, 2, s58
    s_and_b64 exec, vcc, s[60:61]
    ds_max_u32 v59, v251
    s_mov_b64 exec, -1
    v_add_u32 v60, s58, v15
    ds_read_b32 v64, v60 offset:0
    ds_read_b32 v65, v60 offset:256
    ds_read_b32 v66, v60 offset:512
    v_add_u32 v68, s56, v1
    v_add_u32 v69, 64, v68
    v_add_u32 v70, 128, v68
    v_cmp_gt_u32 s[40:41], s46, v68
    v_cmp_gt_u32 s[42:43], s46, v69
    v_cmp_gt_u32 s[44:45], s46, v70
    s_mov_b32 s60, 532480
    s_mov_b32 s61, 3145728
    s_waitcnt lgkmcnt(0)
    v_max_u32_dpp v64, v64, v64 row_shr:1 row_mask:0xf bank_mask:0xf
    v_max_u32_dpp v65, v65, v65 row_shr:1 row_mask:0xf bank_mask:0xf
    v_max_u32_dpp v66, v66, v66 row_shr:1 row_mask:0xf bank_mask:0xf
    v_max_u32_dpp v64, v64, v64 row_shr:2 row_mask:0xf bank_mask:0xf
    v_max_u32_dpp v65, v65, v65 row_shr:2 row_mask:0xf bank_mask:0xf
    v_max_u32_dpp v66, v66, v66 row_shr:2 row_mask:0xf bank_mask:0xf
    v_max_u32_dpp v64, v64, v64 row_shr:4 row_mask:0xf bank_mask:0xf
    v_max_u32_dpp v65, v65, v65 row_shr:4 row_mask:0xf bank_mask:0xf
    v_max_u32_dpp v66, v66, v66 row_shr:4 row_mask:0xf bank_mask:0xf
    v_max_u32_dpp v64, v64, v64 row_shr:8 row_mask:0xf bank_mask:0xf
    v_max_u32_dpp v65, v65, v65 row_shr:8 row_mask:0xf bank_mask:0xf
    v_max_u32_dpp v66, v66, v66 row_shr:8 row_mask:0xf bank_mask:0xf
    v_max_u32_dpp v64, v64, v64 row_bcast:15 row_mask:0xa bank_mask:0xf
    v_max_u32_dpp v65, v65, v65 row_bcast:15 row_mask:0xa bank_mask:0xf
    v_max_u32_dpp v66, v66, v66 row_bcast:15 row_mask:0xa bank_mask:0xf
    v_max_u32_dpp v64, v64, v64 row_bcast:31 row_mask:0xc bank_mask:0xf
    v_max_u32_dpp v65, v65, v65 row_bcast:31 row_mask:0xc bank_mask:0xf
    v_max_u32_dpp v66, v66, v66 row_bcast:31 row_mask:0xc bank_mask:0xf
    v_readlane_b32 s56, v64, 63
    v_readlane_b32 s57, v65, 63
    v_add_u32 v68, v68, v64
    s_max_u32 s57, s56, s57
    v_max_u32 v65, s56, v65
    v_max_u32 v66, s57, v66
    v_add_u32 v69, v69, v65
    v_add_u32 v70, v70, v66
    v_lshlrev_b32 v92, 3, v68
    v_lshlrev_b32 v95, 4, v68
    v_lshlrev_b32 v93, 3, v69
    v_lshlrev_b32 v96, 4, v69
    v_lshlrev_b32 v94, 3, v70
    v_lshlrev_b32 v97, 4, v70
    v_mov_b32 v14, 0x42800000
    s_lshr_b32 s62, s26, 24
K_KEYS:
    s_mov_b64 exec, s[40:41]
    buffer_load_dwordx2 v[72:73], v92, s[36:39], s60 offen sc1
    s_mov_b64 exec, s[42:43]
    buffer_load_dwordx2 v[74:75], v93, s[36:39], s60 offen sc1
    s_mov_b64 exec, s[44:45]
    buffer_load_dwordx2 v[76:77], v94, s[36:39], s60 offen sc1
    s_mov_b64 exec, -1
    s_mov_b64 s[58:59], 0
    s_waitcnt vmcnt(2)
    v_lshrrev_b32 v98, 24, v72
    v_cmp_ne_u32 vcc, s52, v73
    v_cmp_ne_u32 s[56:57], s62, v98
    s_or_b64 vcc, vcc, s[56:57]
    s_and_b64 vcc, vcc, s[40:41]
    s_or_b64 s[58:59], s[58:59], vcc
    s_waitcnt vmcnt(1)
    v_lshrrev_b32 v99, 24, v74
    v_cmp_ne_u32 vcc, s52, v75
    v_cmp_ne_u32 s[56:57], s62, v99
    s_or_b64 vcc, vcc, s[56:57]
    s_and_b64 vcc, vcc, s[42:43]
    s_or_b64 s[58:59], s[58:59], vcc
    s_waitcnt vmcnt(0)
    v_lshrrev_b32 v100, 24, v76
    v_cmp_ne_u32 vcc, s52, v77
    v_cmp_ne_u32 s[56:57], s62, v100
    s_or_b64 vcc, vcc, s[56:57]
    s_and_b64 vcc, vcc, s[44:45]
    s_or_b64 s[58:59], s[58:59], vcc
    s_cbranch_scc1 K_KEYS
    s_cmp_lg_u32 s47, 0
    s_cbranch_scc1 K_NOBAL
    s_mov_b32 s62, 8323072
    s_cmp_ge_u32 s3, 4
    s_cbranch_scc1 K_NOB0
    buffer_load_dwordx2 v[152:153], v154, s[36:39], s62 offen sc1
K_NOB0:
    s_mov_b64 exec, s[40:41]
    v_lshrrev_b32 v92, 2, v72
    v_and_b32 v92, 0xfc, v92
    ds_add_f32 v92, v14 offset:512
    s_mov_b64 exec, s[42:43]
    v_lshrrev_b32 v93, 2, v74
    v_and_b32 v93, 0xfc, v93
    ds_add_f32 v93, v14 offset:512
    s_mov_b64 exec, s[44:45]
    v_lshrrev_b32 v94, 2, v76
    v_and_b32 v94, 0xfc, v94
    ds_add_f32 v94, v14 offset:512
    s_mov_b64 exec, -1
    s_cmp_ge_u32 s3, 4
    s_cbranch_scc1 K_POLLBOK
K_POLLB:
    s_waitcnt vmcnt(0)
    v_cmp_ne_u32 vcc, s52, v152
    s_cbranch_vccz K_POLLB2
    buffer_load_dwordx2 v[152:153], v154, s[36:39], s62 offen sc1
    s_branch K_POLLB
K_POLLB2:
    v_cmp_eq_u32 vcc, s52, v153
    s_or_b32 s56, s2, s3
    s_cmp_eq_u32 s56, 0
    s_cselect_b32 s63, 1, 0
    s_or_b32 s63, s63, vcc_lo
    s_or_b32 s63, s63, vcc_hi
K_POLLBOK:
    s_waitcnt lgkmcnt(0)
    s_barrier
    s_mov_b64 exec, s[40:41]
    buffer_load_dwordx4 v[80:83], v95, s[36:39], s61 offen sc1
    s_mov_b64 exec, s[42:43]
    buffer_load_dwordx4 v[84:87], v96, s[36:39], s61 offen sc1
    s_mov_b64 exec, s[44:45]
    buffer_load_dwordx4 v[88:91], v97, s[36:39], s61 offen sc1
    s_mov_b64 exec, -1
K_BAL0:
    ds_read_b32 v168, v15 offset:512
    ds_read_b128 v[120:123], v4 offset:512
    ds_read_b128 v[124:127], v4 offset:528
    ds_read_b128 v[128:131], v4 offset:544
    ds_read_b128 v[132:135], v4 offset:560
    ds_read_b128 v[136:139], v4 offset:576
    ds_read_b128 v[140:143], v4 offset:592
    ds_read_b128 v[144:147], v4 offset:608
    ds_read_b128 v[148:151], v4 offset:624
    ds_read_b128 v[152:155], v4 offset:640
    ds_read_b128 v[156:159], v4 offset:656
    v_cmp_gt_u32 vcc, 40, v1
    s_waitcnt lgkmcnt(9)
    v_pk_add_f32 v[120:121], v[120:121], v[168:169] op_sel_hi:[1,0] neg_lo:[0,1] neg_hi:[0,1] clamp
    v_pk_add_f32 v[122:123], v[122:123], v[168:169] op_sel_hi:[1,0] neg_lo:[0,1] neg_hi:[0,1] clamp
    s_waitcnt lgkmcnt(8)
    v_pk_add_f32 v[124:125], v[124:125], v[168:169] op_sel_hi:[1,0] neg_lo:[0,1] neg_hi:[0,1] clamp
    v_pk_add_f32 v[124:125], v[124:125], v[120:121]
    v_pk_add_f32 v[126:127], v[126:127], v[168:169] op_sel_hi:[1,0] neg_lo:[0,1] neg_hi:[0,1] clamp
    v_pk_add_f32 v[126:127], v[126:127], v[122:123]
    s_waitcnt lgkmcnt(7)
    v_pk_add_f32 v[128:129], v[128:129], v[168:169] op_sel_hi:[1,0] neg_lo:[0,1] neg_hi:[0,1] clamp
    v_pk_add_f32 v[128:129], v[128:129], v[124:125]
    v_pk_add_f32 v[130:131], v[130:131], v[168:169] op_sel_hi:[1,0] neg_lo:[0,1] neg_hi:[0,1] clamp
    v_pk_add_f32 v[130:131], v[130:131], v[126:127]
    s_waitcnt lgkmcnt(6)
    v_pk_add_f32 v[132:133], v[132:133], v[168:169] op_sel_hi:[1,0] neg_lo:[0,1] neg_hi:[0,1] clamp
    v_pk_add_f32 v[132:133], v[132:133], v[128:129]
    v_pk_add_f32 v[134:135], v[134:135], v[168:169] op_sel_hi:[1,0] neg_lo:[0,1] neg_hi:[0,1] clamp
    v_pk_add_f32 v[134:135], v[134:135], v[130:131]
    s_waitcnt lgkmcnt(5)
    v_pk_add_f32 v[136:137], v[136:137], v[168:169] op_sel_hi:[1,0] neg_lo:[0,1] neg_hi:[0,1] clamp
    v_pk_add_f32 v[136:137], v[136:137], v[132:133]
    v_pk_add_f32 v[138:139], v[138:139], v[168:169] op_sel_hi:[1,0] neg_lo:[0,1] neg_hi:[0,1] clamp
    v_pk_add_f32 v[138:139], v[138:139], v[134:135]
    s_waitcnt lgkmcnt(4)
    v_pk_add_f32 v[140:141], v[140:141], v[168:169] op_sel_hi:[1,0] neg_lo:[0,1] neg_hi:[0,1] clamp
    v_pk_add_f32 v[140:141], v[140:141], v[136:137]
    v_pk_add_f32 v[142:143], v[142:143], v[168:169] op_sel_hi:[1,0] neg_lo:[0,1] neg_hi:[0,1] clamp
    v_pk_add_f32 v[142:143], v[142:143], v[138:139]
    s_waitcnt lgkmcnt(3)
    v_pk_add_f32 v[144:145], v[144:145], v[168:169] op_sel_hi:[1,0] neg_lo:[0,1] neg_hi:[0,1] clamp
    v_pk_add_f32 v[144:145], v[144:145], v[140:141]
    v_pk_add_f32 v[146:147], v[146:147], v[168:169] op_sel_hi:[1,0] neg_lo:[0,1] neg_hi:[0,1] clamp
    v_pk_add_f32 v[146:147], v[146:147], v[142:143]
    s_waitcnt lgkmcnt(2)
    v_pk_add_f32 v[148:149], v[148:149], v[168:169] op_sel_hi:[1,0] neg_lo:[0,1] neg_hi:[0,1] clamp
    v_pk_add_f32 v[148:149], v[148:149], v[144:145]
    v_pk_add_f32 v[150:151], v[150:151], v[168:169] op_sel_hi:[1,0] neg_lo:[0,1] neg_hi:[0,1] clamp
    v_pk_add_f32 v[150:151], v[150:151], v[146:147]
    s_waitcnt lgkmcnt(1)
    v_pk_add_f32 v[152:153], v[152:153], v[168:169] op_sel_hi:[1,0] neg_lo:[0,1] neg_hi:[0,1] clamp
    v_pk_add_f32 v[152:153], v[152:153], v[148:149]
    v_pk_add_f32 v[154:155], v[154:155], v[168:169] op_sel_hi:[1,0] neg_lo:[0,1] neg_hi:[0,1] clamp
    v_pk_add_f32 v[154:155], v[154:155], v[150:151]
    s_waitcnt lgkmcnt(0)
    v_pk_add_f32 v[156:157], v[156:157], v[168:169] op_sel_hi:[1,0] neg_lo:[0,1] neg_hi:[0,1] clamp
    v_pk_add_f32 v[156:157], v[156:157], v[152:153]
    v_pk_add_f32 v[158:159], v[158:159], v[168:169] op_sel_hi:[1,0] neg_lo:[0,1] neg_hi:[0,1] clamp
    v_pk_add_f32 v[158:159], v[158:159], v[154:155]
    v_pk_add_f32 v[158:159], v[158:159], v[156:157]
    v_add_f32 v158, v158, v159
    v_cvt_u32_f32 v158, v158
    v_lshlrev_b32 v158, 2, v158
    ds_bpermute_b32 v2, v158, v2
    s_waitcnt lgkmcnt(0)
    v_cndmask_b32 v2, -1, v2, vcc
K_BAL:
    ds_bpermute_b32 v95, v92, v2
    ds_bpermute_b32 v96, v93, v2
    ds_bpermute_b32 v97, v94, v2
    v_mov_b32 v14, 1
    v_lshlrev_b32 v10, 3, v1
    s_lshr_b32 s56, s53, 4
    s_and_b32 s56, s56, 14
    v_subrev_u32 v101, s56, v72
    v_and_b32 v101, 15, v101
    v_subrev_u32 v102, s56, v74
    v_and_b32 v102, 15, v102
    v_subrev_u32 v103, s56, v76
    v_and_b32 v103, 15, v103
    s_waitcnt lgkmcnt(2)
    s_mov_b64 exec, s[40:41]
    v_and_b32 v92, 7, v95
    v_lshl_or_b32 v101, v92, 4, v101
    v_lshlrev_b32 v92, 2, v101
    ds_add_rtn_u32 v98, v92, v14 offset:0
    s_waitcnt lgkmcnt(2)
    s_mov_b64 exec, s[42:43]
    v_and_b32 v93, 7, v96
    v_lshl_or_b32 v102, v93, 4, v102
    v_lshlrev_b32 v93, 2, v102
    ds_add_rtn_u32 v99, v93, v14 offset:0
    s_waitcnt lgkmcnt(2)
    s_mov_b64 exec, s[44:45]
    v_and_b32 v94, 7, v97
    v_lshl_or_b32 v103, v94, 4, v103
    v_lshlrev_b32 v94, 2, v103
    ds_add_rtn_u32 v100, v94, v14 offset:0
    s_mov_b64 exec, -1
    v_lshlrev_b32 v92, 1, v101
    v_lshlrev_b32 v101, 4, v101
    v_and_b32 v95, 0x38, v95
    v_and_b32 v72, 16776192, v72
    v_lshlrev_b32 v93, 1, v102
    v_lshlrev_b32 v102, 4, v102
    v_and_b32 v96, 0x38, v96
    v_and_b32 v74, 16776192, v74
    v_lshlrev_b32 v94, 1, v103
    v_lshlrev_b32 v103, 4, v103
    v_and_b32 v97, 0x38, v97
    v_and_b32 v76, 16776192, v76
    s_lshl_b32 s56, s3, 3
    s_add_u32 s57, s56, 7
    v_lshrrev_b32 v110, 3, v1
    v_mul_u32_u24 v110, 48, v110
    s_waitcnt lgkmcnt(0)
    s_barrier
    ds_read_b64 v[104:105], v10 offset:0
    v_and_b32 v12, 15, v1
    v_lshrrev_b32 v11, 4, v1
    v_lshlrev_b32 v11, 3, v11
    v_lshl_add_u32 v11, v12, 5, v11
    s_lshr_b32 s27, s53, 5
    s_mul_i32 s27, s27, 20009
    s_add_u32 s27, s27, 14
    s_lshr_b32 s27, s27, 4
    s_lshl_b32 s27, s27, 10
    s_sub_u32 s58, s27, 1024
    s_cselect_b32 s58, 10238976, s58
    v_mov_b32 v111, s58
    s_waitcnt lgkmcnt(0)
    v_add_u32 v106, v104, v105
    v_mov_b32 v107, v106
    s_nop 1
    v_add_u32_dpp v107, v107, v107 row_shr:1 row_mask:0xf bank_mask:0xf
    s_nop 1
    v_add_u32_dpp v107, v107, v107 row_shr:2 row_mask:0xf bank_mask:0xf
    s_nop 1
    v_add_u32_dpp v107, v107, v107 row_shr:4 row_mask:0xf bank_mask:0xf
    s_nop 1
    v_add_u32_dpp v107, v107, v107 row_shr:8 row_mask:0xf bank_mask:0xf
    s_nop 1
    v_add_u32_dpp v107, v107, v107 row_bcast:15 row_mask:0xa bank_mask:0xf
    s_nop 1
    v_add_u32_dpp v107, v107, v107 row_bcast:31 row_mask:0xc bank_mask:0xf
    v_sub_u32 v106, v107, v106
    v_readlane_b32 s51, v107, s57
    s_nop 0
    v_mov_b32_dpp v108, v106 row_newbcast:0 row_mask:0xf bank_mask:0x3
    v_readlane_b32 s58, v106, s56
    s_nop 0
    v_mov_b32_dpp v108, v106 row_newbcast:8 row_mask:0xf bank_mask:0xc
    v_add_u32 v109, 15, v108
    v_and_or_b32 v109, v109, -16, 0
    v_add_u32 v109, v109, v110
    v_sub_u32 v108, v109, v108
    v_add_u32 v108, v108, v106
    v_add_u32 v104, v108, v104
    v_lshl_or_b32 v104, v104, 16, v108
    v_readlane_b32 s50, v109, s56
    ds_bpermute_b32 v92, v92, v104
    ds_bpermute_b32 v93, v93, v104
    ds_bpermute_b32 v94, v94, v104
    s_sub_u32 s51, s51, s58
    s_add_u32 s56, s50, s51
    v_add_u32 v105, s56, v1
    v_lshlrev_b32 v106, 2, v105
    v_lshlrev_b32 v107, 4, v105
    s_mov_b64 exec, 0xfffff
    ds_write_b32 v106, v111 offset:4096
    ds_write_b8 v105, v4 offset:11840
    ds_write_b128 v107, v[4:7] offset:13824
    s_waitcnt vmcnt(0) lgkmcnt(3)
    s_mov_b64 exec, s[40:41]
    v_bfe_u32 v92, v92, v101, 16
    v_add_u32 v92, v92, v98
    v_lshlrev_b32 v98, 2, v92
    v_lshlrev_b32 v101, 4, v92
    ds_write_b32 v98, v72 offset:4096
    ds_write_b8 v92, v95 offset:11840
    ds_write_b128 v101, v[80:83] offset:13824
    s_mov_b64 exec, s[42:43]
    v_bfe_u32 v93, v93, v102, 16
    v_add_u32 v93, v93, v99
    v_lshlrev_b32 v99, 2, v93
    v_lshlrev_b32 v102, 4, v93
    ds_write_b32 v99, v74 offset:4096
    ds_write_b8 v93, v96 offset:11840
    ds_write_b128 v102, v[84:87] offset:13824
    s_mov_b64 exec, s[44:45]
    v_bfe_u32 v94, v94, v103, 16
    v_add_u32 v94, v94, v100
    v_lshlrev_b32 v100, 2, v94
    v_lshlrev_b32 v103, 4, v94
    ds_write_b32 v100, v76 offset:4096
    ds_write_b8 v94, v97 offset:11840
    ds_write_b128 v103, v[88:91] offset:13824
    s_mov_b64 exec, -1
    s_lshl_b32 s56, s50, 2
    s_add_u32 s56, s56, 4096
    v_mov_b32 v196, s56
    s_add_u32 s56, s50, 11840
    v_mov_b32 v197, s56
    s_lshl_b32 s56, s50, 5
    s_add_u32 s56, s56, 44800
    v_add_u32 v198, s56, v10
    v_add_u32 v11, s56, v11
    s_lshl_b32 s57, s50, 4
    s_add_u32 s57, s57, 13824
    v_lshl_add_u32 v199, v12, 4, s57
    v_add_u32 v10, s57, v9
    s_add_u32 s48, s51, 3
    s_lshr_b32 s48, s48, 2
    v_mov_b32 v254, 0
    s_waitcnt lgkmcnt(0)
    s_barrier
    s_cmp_eq_u32 s48, 0
    s_cbranch_scc1 K2_LOOPDONE
    ds_read_b128 v[120:123], v196 offset:0
    ds_read_b128 v[124:127], v196 offset:16
    ds_read_b64 v[152:153], v10
    ds_read_b128 v[188:191], v196 offset:32
    ds_read_b64 v[186:187], v199 offset:8
    ds_read_b128 v[192:195], v197
    s_lshl_b32 s56, s48, 2
    s_waitcnt lgkmcnt(5)
    buffer_load_dwordx4 v[56:59], v120, s[28:31], 0 offen
    buffer_load_dwordx4 v[60:63], v121, s[28:31], 0 offen
    buffer_load_dwordx4 v[64:67], v122, s[28:31], 0 offen
    buffer_load_dwordx4 v[68:71], v123, s[28:31], 0 offen
    s_waitcnt lgkmcnt(4)
    buffer_load_dwordx4 v[72:75], v124, s[28:31], 0 offen
    buffer_load_dwordx4 v[76:79], v125, s[28:31], 0 offen
    buffer_load_dwordx4 v[80:83], v126, s[28:31], 0 offen
    buffer_load_dwordx4 v[84:87], v127, s[28:31], 0 offen
K_APREP:
    v_cmp_gt_u32 vcc, s56, v1
    s_waitcnt lgkmcnt(0)
    s_nop 0
    v_cndmask_b32 v160, 0, v152, vcc
    v_cndmask_b32 v161, 0, v153, vcc
    ds_read_b64 v[152:153], v10 offset:1024
    v_add_u32 v10, 1024, v10
    v_mfma_f32_16x16x16_bf16 v[136:139], v[232:233], v[160:161], 0
    v_mfma_f32_16x16x16_bf16 v[140:143], v[234:235], v[160:161], 0
    v_mfma_f32_16x16x16_bf16 v[144:147], v[236:237], v[160:161], 0
    v_mfma_f32_16x16x16_bf16 v[148:151], v[238:239], v[160:161], 0
    s_nop 4
    v_cvt_pk_bf16_f32 v168, v136, v137
    v_cvt_pk_bf16_f32 v169, v138, v139
    ds_write_b64 v11, v[168:169] offset:0
    s_sub_u32 s56, s56, 16
    s_cmp_le_i32 s56, 0
    s_cbranch_scc1 K_APDONE
    v_cvt_pk_bf16_f32 v170, v140, v141
    v_cvt_pk_bf16_f32 v171, v142, v143
    ds_write_b64 v11, v[170:171] offset:512
    s_sub_u32 s56, s56, 16
    s_cmp_le_i32 s56, 0
    s_cbranch_scc1 K_APDONE
    v_cvt_pk_bf16_f32 v172, v144, v145
    v_cvt_pk_bf16_f32 v173, v146, v147
    ds_write_b64 v11, v[172:173] offset:1024
    s_sub_u32 s56, s56, 16
    s_cmp_le_i32 s56, 0
    s_cbranch_scc1 K_APDONE
    v_cvt_pk_bf16_f32 v174, v148, v149
    v_cvt_pk_bf16_f32 v175, v150, v151
    ds_write_b64 v11, v[174:175] offset:1536
    s_sub_u32 s56, s56, 16
    s_cmp_le_i32 s56, 0
    s_cbranch_scc1 K_APDONE
    v_add_u32 v11, 2048, v11
    s_branch K_APREP
K_APDONE:
    s_waitcnt lgkmcnt(0)
    ds_read_b64 v[184:185], v198
    v_mfma_f32_4x4x4_16b_bf16 v[152:155], v[186:187], v[176:177], 0 cbsz:4 abid:0
    v_mfma_f32_4x4x4_16b_bf16 v[156:159], v[186:187], v[180:181], 0 cbsz:4 abid:0
    s_nop 0
    v_mfma_f32_4x4x4_16b_bf16 v[152:155], v[186:187], v[178:179], v[152:155] cbsz:4 abid:0
    v_mfma_f32_4x4x4_16b_bf16 v[156:159], v[186:187], v[182:183], v[156:159] cbsz:4 abid:0
    s_sub_u32 s48, s48, 1
    s_nop 3
.p2align 4
K2_LOOP:
    s_waitcnt vmcnt(6) lgkmcnt(0)
    v_subrev_u32 v255, s27, v188
    v_cmp_gt_u32 vcc, v255, v254
    ds_write_b32 v252, v255 offset:2048
    s_setprio 0
    s_cbranch_vccnz K2_P0
    s_setprio 1
K2_P0:
    v_mfma_f32_4x4x4_16b_bf16 v[120:123], v[184:185], v[56:57], 0 cbsz:4 abid:0
    v_exp_f32 v168, v152
    v_mfma_f32_4x4x4_16b_bf16 v[124:127], v[184:185], v[58:59], 0 cbsz:4 abid:0
    v_exp_f32 v169, v153
    v_mfma_f32_4x4x4_16b_bf16 v[128:131], v[184:185], v[60:61], 0 cbsz:4 abid:1
    v_exp_f32 v170, v154
    v_mfma_f32_4x4x4_16b_bf16 v[132:135], v[184:185], v[62:63], 0 cbsz:4 abid:1
    buffer_load_dwordx4 v[88:91], v188, s[28:31], 0 offen
    buffer_load_dwordx4 v[92:95], v189, s[28:31], 0 offen
    v_exp_f32 v171, v155
    s_waitcnt vmcnt(6)
    v_mfma_f32_4x4x4_16b_bf16 v[136:139], v[184:185], v[64:65], 0 cbsz:4 abid:2
    v_exp_f32 v172, v156
    v_mfma_f32_4x4x4_16b_bf16 v[140:143], v[184:185], v[66:67], 0 cbsz:4 abid:2
    v_exp_f32 v173, v157
    v_exp_f32 v174, v158
    v_exp_f32 v175, v159
    v_pk_add_f32 v[168:169], v[168:169], 1.0 op_sel_hi:[1,0]
    v_pk_add_f32 v[170:171], v[170:171], 1.0 op_sel_hi:[1,0]
    v_pk_add_f32 v[172:173], v[172:173], 1.0 op_sel_hi:[1,0]
    v_pk_add_f32 v[174:175], v[174:175], 1.0 op_sel_hi:[1,0]
    v_mfma_f32_4x4x4_16b_bf16 v[144:147], v[184:185], v[68:69], 0 cbsz:4 abid:3
    v_rcp_f32 v168, v168
    v_mfma_f32_4x4x4_16b_bf16 v[148:151], v[184:185], v[70:71], 0 cbsz:4 abid:3
    buffer_load_dwordx4 v[96:99], v190, s[28:31], 0 offen
    buffer_load_dwordx4 v[100:103], v191, s[28:31], 0 offen
    v_rcp_f32 v169, v169
    ds_read_b128 v[188:191], v196 offset:48
    v_mfma_f32_4x4x4_16b_bf16 v[160:163], v[186:187], v[176:177], 0 cbsz:4 abid:1
    v_rcp_f32 v170, v170
    v_mfma_f32_4x4x4_16b_bf16 v[164:167], v[186:187], v[180:181], 0 cbsz:4 abid:1
    v_rcp_f32 v171, v171
    v_mfma_f32_4x4x4_16b_bf16 v[160:163], v[186:187], v[178:179], v[160:163] cbsz:4 abid:1
    v_rcp_f32 v172, v172
    v_mfma_f32_4x4x4_16b_bf16 v[164:167], v[186:187], v[182:183], v[164:167] cbsz:4 abid:1
    v_rcp_f32 v173, v173
    v_rcp_f32 v174, v174
    v_rcp_f32 v175, v175
    v_readfirstlane_b32 s49, v192
    v_pk_mul_f32 v[168:169], v[168:169], v[152:153]
    v_pk_mul_f32 v[170:171], v[170:171], v[154:155]
    v_pk_mul_f32 v[172:173], v[172:173], v[156:157]
    v_pk_mul_f32 v[174:175], v[174:175], v[158:159]
    s_set_gpr_idx_on s49, gpr_idx(SRC2,DST)
    v_pk_fma_f32 v[16:17], v[168:169], v[120:121], v[16:17] op_sel:[0,0,0] op_sel_hi:[0,1,1]
    v_pk_fma_f32 v[18:19], v[168:169], v[122:123], v[18:19] op_sel:[0,0,0] op_sel_hi:[0,1,1]
    v_pk_fma_f32 v[20:21], v[172:173], v[124:125], v[20:21] op_sel:[0,0,0] op_sel_hi:[0,1,1]
    v_pk_fma_f32 v[22:23], v[172:173], v[126:127], v[22:23] op_sel:[0,0,0] op_sel_hi:[0,1,1]
    s_lshr_b32 s49, s49, 8
    s_set_gpr_idx_idx s49
    v_pk_fma_f32 v[16:17], v[168:169], v[128:129], v[16:17] op_sel:[1,0,0] op_sel_hi:[1,1,1]
    v_pk_fma_f32 v[18:19], v[168:169], v[130:131], v[18:19] op_sel:[1,0,0] op_sel_hi:[1,1,1]
    v_pk_fma_f32 v[20:21], v[172:173], v[132:133], v[20:21] op_sel:[1,0,0] op_sel_hi:[1,1,1]
    v_pk_fma_f32 v[22:23], v[172:173], v[134:135], v[22:23] op_sel:[1,0,0] op_sel_hi:[1,1,1]
    s_lshr_b32 s49, s49, 8
    s_set_gpr_idx_idx s49
    v_pk_fma_f32 v[16:17], v[170:171], v[136:137], v[16:17] op_sel:[0,0,0] op_sel_hi:[0,1,1]
    v_pk_fma_f32 v[18:19], v[170:171], v[138:139], v[18:19] op_sel:[0,0,0] op_sel_hi:[0,1,1]
    v_pk_fma_f32 v[20:21], v[174:175], v[140:141], v[20:21] op_sel:[0,0,0] op_sel_hi:[0,1,1]
    v_pk_fma_f32 v[22:23], v[174:175], v[142:143], v[22:23] op_sel:[0,0,0] op_sel_hi:[0,1,1]
    s_lshr_b32 s49, s49, 8
    s_set_gpr_idx_idx s49
    v_pk_fma_f32 v[16:17], v[170:171], v[144:145], v[16:17] op_sel:[1,0,0] op_sel_hi:[1,1,1]
    v_pk_fma_f32 v[18:19], v[170:171], v[146:147], v[18:19] op_sel:[1,0,0] op_sel_hi:[1,1,1]
    v_pk_fma_f32 v[20:21], v[174:175], v[148:149], v[20:21] op_sel:[1,0,0] op_sel_hi:[1,1,1]
    v_pk_fma_f32 v[22:23], v[174:175], v[150:151], v[22:23] op_sel:[1,0,0] op_sel_hi:[1,1,1]
    s_set_gpr_idx_off
    s_sub_u32 s48, s48, 1
    s_cbranch_scc1 K2_LOOPDONE
    s_waitcnt vmcnt(6) lgkmcnt(0)
    v_mfma_f32_4x4x4_16b_bf16 v[120:123], v[184:185], v[72:73], 0 cbsz:4 abid:4
    v_exp_f32 v168, v160
    v_mfma_f32_4x4x4_16b_bf16 v[124:127], v[184:185], v[74:75], 0 cbsz:4 abid:4
    v_exp_f32 v169, v161
    v_mfma_f32_4x4x4_16b_bf16 v[128:131], v[184:185], v[76:77], 0 cbsz:4 abid:5
    v_exp_f32 v170, v162
    v_mfma_f32_4x4x4_16b_bf16 v[132:135], v[184:185], v[78:79], 0 cbsz:4 abid:5
    buffer_load_dwordx4 v[104:107], v188, s[28:31], 0 offen
    buffer_load_dwordx4 v[108:111], v189, s[28:31], 0 offen
    v_exp_f32 v171, v163
    s_waitcnt vmcnt(6)
    v_mfma_f32_4x4x4_16b_bf16 v[136:139], v[184:185], v[80:81], 0 cbsz:4 abid:6
    v_exp_f32 v172, v164
    v_mfma_f32_4x4x4_16b_bf16 v[140:143], v[184:185], v[82:83], 0 cbsz:4 abid:6
    v_exp_f32 v173, v165
    v_exp_f32 v174, v166
    v_exp_f32 v175, v167
    v_pk_add_f32 v[168:169], v[168:169], 1.0 op_sel_hi:[1,0]
    v_pk_add_f32 v[170:171], v[170:171], 1.0 op_sel_hi:[1,0]
    v_pk_add_f32 v[172:173], v[172:173], 1.0 op_sel_hi:[1,0]
    v_pk_add_f32 v[174:175], v[174:175], 1.0 op_sel_hi:[1,0]
    v_mfma_f32_4x4x4_16b_bf16 v[144:147], v[184:185], v[84:85], 0 cbsz:4 abid:7
    v_rcp_f32 v168, v168
    v_mfma_f32_4x4x4_16b_bf16 v[148:151], v[184:185], v[86:87], 0 cbsz:4 abid:7
    buffer_load_dwordx4 v[112:115], v190, s[28:31], 0 offen
    buffer_load_dwordx4 v[116:119], v191, s[28:31], 0 offen
    v_rcp_f32 v169, v169
    ds_read_b128 v[188:191], v196 offset:64
    ds_read_b32 v254, v253 offset:2048
    v_mfma_f32_4x4x4_16b_bf16 v[152:155], v[186:187], v[176:177], 0 cbsz:4 abid:2
    v_rcp_f32 v170, v170
    v_mfma_f32_4x4x4_16b_bf16 v[156:159], v[186:187], v[180:181], 0 cbsz:4 abid:2
    v_rcp_f32 v171, v171
    v_mfma_f32_4x4x4_16b_bf16 v[152:155], v[186:187], v[178:179], v[152:155] cbsz:4 abid:2
    v_rcp_f32 v172, v172
    v_mfma_f32_4x4x4_16b_bf16 v[156:159], v[186:187], v[182:183], v[156:159] cbsz:4 abid:2
    v_rcp_f32 v173, v173
    v_rcp_f32 v174, v174
    v_rcp_f32 v175, v175
    v_readfirstlane_b32 s49, v193
    v_pk_mul_f32 v[168:169], v[168:169], v[160:161]
    v_pk_mul_f32 v[170:171], v[170:171], v[162:163]
    v_pk_mul_f32 v[172:173], v[172:173], v[164:165]
    v_pk_mul_f32 v[174:175], v[174:175], v[166:167]
    s_set_gpr_idx_on s49, gpr_idx(SRC2,DST)
    v_pk_fma_f32 v[16:17], v[168:169], v[120:121], v[16:17] op_sel:[0,0,0] op_sel_hi:[0,1,1]
    v_pk_fma_f32 v[18:19], v[168:169], v[122:123], v[18:19] op_sel:[0,0,0] op_sel_hi:[0,1,1]
    v_pk_fma_f32 v[20:21], v[172:173], v[124:125], v[20:21] op_sel:[0,0,0] op_sel_hi:[0,1,1]
    v_pk_fma_f32 v[22:23], v[172:173], v[126:127], v[22:23] op_sel:[0,0,0] op_sel_hi:[0,1,1]
    s_lshr_b32 s49, s49, 8
    s_set_gpr_idx_idx s49
    v_pk_fma_f32 v[16:17], v[168:169], v[128:129], v[16:17] op_sel:[1,0,0] op_sel_hi:[1,1,1]
    v_pk_fma_f32 v[18:19], v[168:169], v[130:131], v[18:19] op_sel:[1,0,0] op_sel_hi:[1,1,1]
    v_pk_fma_f32 v[20:21], v[172:173], v[132:133], v[20:21] op_sel:[1,0,0] op_sel_hi:[1,1,1]
    v_pk_fma_f32 v[22:23], v[172:173], v[134:135], v[22:23] op_sel:[1,0,0] op_sel_hi:[1,1,1]
    s_lshr_b32 s49, s49, 8
    s_set_gpr_idx_idx s49
    v_pk_fma_f32 v[16:17], v[170:171], v[136:137], v[16:17] op_sel:[0,0,0] op_sel_hi:[0,1,1]
    v_pk_fma_f32 v[18:19], v[170:171], v[138:139], v[18:19] op_sel:[0,0,0] op_sel_hi:[0,1,1]
    v_pk_fma_f32 v[20:21], v[174:175], v[140:141], v[20:21] op_sel:[0,0,0] op_sel_hi:[0,1,1]
    v_pk_fma_f32 v[22:23], v[174:175], v[142:143], v[22:23] op_sel:[0,0,0] op_sel_hi:[0,1,1]
    s_lshr_b32 s49, s49, 8
    s_set_gpr_idx_idx s49
    v_pk_fma_f32 v[16:17], v[170:171], v[144:145], v[16:17] op_sel:[1,0,0] op_sel_hi:[1,1,1]
    v_pk_fma_f32 v[18:19], v[170:171], v[146:147], v[18:19] op_sel:[1,0,0] op_sel_hi:[1,1,1]
    v_pk_fma_f32 v[20:21], v[174:175], v[148:149], v[20:21] op_sel:[1,0,0] op_sel_hi:[1,1,1]
    v_pk_fma_f32 v[22:23], v[174:175], v[150:151], v[22:23] op_sel:[1,0,0] op_sel_hi:[1,1,1]
    s_set_gpr_idx_off
    s_sub_u32 s48, s48, 1
    s_cbranch_scc1 K2_LOOPDONE
    s_waitcnt vmcnt(6) lgkmcnt(0)
    v_subrev_u32 v255, s27, v188
    v_cmp_gt_u32 vcc, v255, v254
    ds_write_b32 v252, v255 offset:2048
    s_setprio 0
    s_cbranch_vccnz K2_P2
    s_setprio 1
K2_P2:
    v_mfma_f32_4x4x4_16b_bf16 v[120:123], v[184:185], v[88:89], 0 cbsz:4 abid:8
    v_exp_f32 v168, v152
    v_mfma_f32_4x4x4_16b_bf16 v[124:127], v[184:185], v[90:91], 0 cbsz:4 abid:8
    v_exp_f32 v169, v153
    v_mfma_f32_4x4x4_16b_bf16 v[128:131], v[184:185], v[92:93], 0 cbsz:4 abid:9
    v_exp_f32 v170, v154
    v_mfma_f32_4x4x4_16b_bf16 v[132:135], v[184:185], v[94:95], 0 cbsz:4 abid:9
    buffer_load_dwordx4 v[56:59], v188, s[28:31], 0 offen
    buffer_load_dwordx4 v[60:63], v189, s[28:31], 0 offen
    v_exp_f32 v171, v155
    s_waitcnt vmcnt(6)
    v_mfma_f32_4x4x4_16b_bf16 v[136:139], v[184:185], v[96:97], 0 cbsz:4 abid:10
    v_exp_f32 v172, v156
    v_mfma_f32_4x4x4_16b_bf16 v[140:143], v[184:185], v[98:99], 0 cbsz:4 abid:10
    v_exp_f32 v173, v157
    v_exp_f32 v174, v158
    v_exp_f32 v175, v159
    v_pk_add_f32 v[168:169], v[168:169], 1.0 op_sel_hi:[1,0]
    v_pk_add_f32 v[170:171], v[170:171], 1.0 op_sel_hi:[1,0]
    v_pk_add_f32 v[172:173], v[172:173], 1.0 op_sel_hi:[1,0]
    v_pk_add_f32 v[174:175], v[174:175], 1.0 op_sel_hi:[1,0]
    v_mfma_f32_4x4x4_16b_bf16 v[144:147], v[184:185], v[100:101], 0 cbsz:4 abid:11
    v_rcp_f32 v168, v168
    v_mfma_f32_4x4x4_16b_bf16 v[148:151], v[184:185], v[102:103], 0 cbsz:4 abid:11
    buffer_load_dwordx4 v[64:67], v190, s[28:31], 0 offen
    buffer_load_dwordx4 v[68:71], v191, s[28:31], 0 offen
    v_rcp_f32 v169, v169
    ds_read_b128 v[188:191], v196 offset:80
    v_mfma_f32_4x4x4_16b_bf16 v[160:163], v[186:187], v[176:177], 0 cbsz:4 abid:3
    v_rcp_f32 v170, v170
    v_mfma_f32_4x4x4_16b_bf16 v[164:167], v[186:187], v[180:181], 0 cbsz:4 abid:3
    v_rcp_f32 v171, v171
    v_mfma_f32_4x4x4_16b_bf16 v[160:163], v[186:187], v[178:179], v[160:163] cbsz:4 abid:3
    v_rcp_f32 v172, v172
    v_mfma_f32_4x4x4_16b_bf16 v[164:167], v[186:187], v[182:183], v[164:167] cbsz:4 abid:3
    ds_read_b64 v[186:187], v199 offset:264
    v_rcp_f32 v173, v173
    v_rcp_f32 v174, v174
    v_rcp_f32 v175, v175
    v_readfirstlane_b32 s49, v194
    v_pk_mul_f32 v[168:169], v[168:169], v[152:153]
    v_pk_mul_f32 v[170:171], v[170:171], v[154:155]
    v_pk_mul_f32 v[172:173], v[172:173], v[156:157]
    v_pk_mul_f32 v[174:175], v[174:175], v[158:159]
    s_set_gpr_idx_on s49, gpr_idx(SRC2,DST)
    v_pk_fma_f32 v[16:17], v[168:169], v[120:121], v[16:17] op_sel:[0,0,0] op_sel_hi:[0,1,1]
    v_pk_fma_f32 v[18:19], v[168:169], v[122:123], v[18:19] op_sel:[0,0,0] op_sel_hi:[0,1,1]
    v_pk_fma_f32 v[20:21], v[172:173], v[124:125], v[20:21] op_sel:[0,0,0] op_sel_hi:[0,1,1]
    v_pk_fma_f32 v[22:23], v[172:173], v[126:127], v[22:23] op_sel:[0,0,0] op_sel_hi:[0,1,1]
    s_lshr_b32 s49, s49, 8
    s_set_gpr_idx_idx s49
    v_pk_fma_f32 v[16:17], v[168:169], v[128:129], v[16:17] op_sel:[1,0,0] op_sel_hi:[1,1,1]
    v_pk_fma_f32 v[18:19], v[168:169], v[130:131], v[18:19] op_sel:[1,0,0] op_sel_hi:[1,1,1]
    v_pk_fma_f32 v[20:21], v[172:173], v[132:133], v[20:21] op_sel:[1,0,0] op_sel_hi:[1,1,1]
    v_pk_fma_f32 v[22:23], v[172:173], v[134:135], v[22:23] op_sel:[1,0,0] op_sel_hi:[1,1,1]
    s_lshr_b32 s49, s49, 8
    s_set_gpr_idx_idx s49
    v_pk_fma_f32 v[16:17], v[170:171], v[136:137], v[16:17] op_sel:[0,0,0] op_sel_hi:[0,1,1]
    v_pk_fma_f32 v[18:19], v[170:171], v[138:139], v[18:19] op_sel:[0,0,0] op_sel_hi:[0,1,1]
    v_pk_fma_f32 v[20:21], v[174:175], v[140:141], v[20:21] op_sel:[0,0,0] op_sel_hi:[0,1,1]
    v_pk_fma_f32 v[22:23], v[174:175], v[142:143], v[22:23] op_sel:[0,0,0] op_sel_hi:[0,1,1]
    s_lshr_b32 s49, s49, 8
    s_set_gpr_idx_idx s49
    v_pk_fma_f32 v[16:17], v[170:171], v[144:145], v[16:17] op_sel:[1,0,0] op_sel_hi:[1,1,1]
    v_pk_fma_f32 v[18:19], v[170:171], v[146:147], v[18:19] op_sel:[1,0,0] op_sel_hi:[1,1,1]
    v_pk_fma_f32 v[20:21], v[174:175], v[148:149], v[20:21] op_sel:[1,0,0] op_sel_hi:[1,1,1]
    v_pk_fma_f32 v[22:23], v[174:175], v[150:151], v[22:23] op_sel:[1,0,0] op_sel_hi:[1,1,1]
    s_set_gpr_idx_off
    s_sub_u32 s48, s48, 1
    s_cbranch_scc1 K2_LOOPDONE
    s_waitcnt vmcnt(6) lgkmcnt(0)
    v_mfma_f32_4x4x4_16b_bf16 v[120:123], v[184:185], v[104:105], 0 cbsz:4 abid:12
    v_exp_f32 v168, v160
    v_mfma_f32_4x4x4_16b_bf16 v[124:127], v[184:185], v[106:107], 0 cbsz:4 abid:12
    v_exp_f32 v169, v161
    v_mfma_f32_4x4x4_16b_bf16 v[128:131], v[184:185], v[108:109], 0 cbsz:4 abid:13
    v_exp_f32 v170, v162
    v_mfma_f32_4x4x4_16b_bf16 v[132:135], v[184:185], v[110:111], 0 cbsz:4 abid:13
    buffer_load_dwordx4 v[72:75], v188, s[28:31], 0 offen
    buffer_load_dwordx4 v[76:79], v189, s[28:31], 0 offen
    v_exp_f32 v171, v163
    s_waitcnt vmcnt(6)
    v_mfma_f32_4x4x4_16b_bf16 v[136:139], v[184:185], v[112:113], 0 cbsz:4 abid:14
    v_exp_f32 v172, v164
    v_mfma_f32_4x4x4_16b_bf16 v[140:143], v[184:185], v[114:115], 0 cbsz:4 abid:14
    v_exp_f32 v173, v165
    v_exp_f32 v174, v166
    v_exp_f32 v175, v167
    v_pk_add_f32 v[168:169], v[168:169], 1.0 op_sel_hi:[1,0]
    v_pk_add_f32 v[170:171], v[170:171], 1.0 op_sel_hi:[1,0]
    v_pk_add_f32 v[172:173], v[172:173], 1.0 op_sel_hi:[1,0]
    v_pk_add_f32 v[174:175], v[174:175], 1.0 op_sel_hi:[1,0]
    v_mfma_f32_4x4x4_16b_bf16 v[144:147], v[184:185], v[116:117], 0 cbsz:4 abid:15
    v_rcp_f32 v168, v168
    v_mfma_f32_4x4x4_16b_bf16 v[148:151], v[184:185], v[118:119], 0 cbsz:4 abid:15
    buffer_load_dwordx4 v[80:83], v190, s[28:31], 0 offen
    buffer_load_dwordx4 v[84:87], v191, s[28:31], 0 offen
    v_rcp_f32 v169, v169
    ds_read_b128 v[188:191], v196 offset:96
    ds_read_b64 v[184:185], v198 offset:512
    ds_read_b32 v254, v253 offset:2048
    v_mfma_f32_4x4x4_16b_bf16 v[152:155], v[186:187], v[176:177], 0 cbsz:4 abid:0
    v_rcp_f32 v170, v170
    v_mfma_f32_4x4x4_16b_bf16 v[156:159], v[186:187], v[180:181], 0 cbsz:4 abid:0
    v_rcp_f32 v171, v171
    v_mfma_f32_4x4x4_16b_bf16 v[152:155], v[186:187], v[178:179], v[152:155] cbsz:4 abid:0
    v_rcp_f32 v172, v172
    v_mfma_f32_4x4x4_16b_bf16 v[156:159], v[186:187], v[182:183], v[156:159] cbsz:4 abid:0
    v_rcp_f32 v173, v173
    v_rcp_f32 v174, v174
    v_rcp_f32 v175, v175
    v_readfirstlane_b32 s49, v195
    ds_read_b128 v[192:195], v197 offset:16
    v_add_u32 v196, 64, v196
    v_add_u32 v197, 16, v197
    v_add_u32 v198, 512, v198
    v_add_u32 v199, 256, v199
    v_pk_mul_f32 v[168:169], v[168:169], v[160:161]
    v_pk_mul_f32 v[170:171], v[170:171], v[162:163]
    v_pk_mul_f32 v[172:173], v[172:173], v[164:165]
    v_pk_mul_f32 v[174:175], v[174:175], v[166:167]
    s_set_gpr_idx_on s49, gpr_idx(SRC2,DST)
    v_pk_fma_f32 v[16:17], v[168:169], v[120:121], v[16:17] op_sel:[0,0,0] op_sel_hi:[0,1,1]
    v_pk_fma_f32 v[18:19], v[168:169], v[122:123], v[18:19] op_sel:[0,0,0] op_sel_hi:[0,1,1]
    v_pk_fma_f32 v[20:21], v[172:173], v[124:125], v[20:21] op_sel:[0,0,0] op_sel_hi:[0,1,1]
    v_pk_fma_f32 v[22:23], v[172:173], v[126:127], v[22:23] op_sel:[0,0,0] op_sel_hi:[0,1,1]
    s_lshr_b32 s49, s49, 8
    s_set_gpr_idx_idx s49
    v_pk_fma_f32 v[16:17], v[168:169], v[128:129], v[16:17] op_sel:[1,0,0] op_sel_hi:[1,1,1]
    v_pk_fma_f32 v[18:19], v[168:169], v[130:131], v[18:19] op_sel:[1,0,0] op_sel_hi:[1,1,1]
    v_pk_fma_f32 v[20:21], v[172:173], v[132:133], v[20:21] op_sel:[1,0,0] op_sel_hi:[1,1,1]
    v_pk_fma_f32 v[22:23], v[172:173], v[134:135], v[22:23] op_sel:[1,0,0] op_sel_hi:[1,1,1]
    s_lshr_b32 s49, s49, 8
    s_set_gpr_idx_idx s49
    v_pk_fma_f32 v[16:17], v[170:171], v[136:137], v[16:17] op_sel:[0,0,0] op_sel_hi:[0,1,1]
    v_pk_fma_f32 v[18:19], v[170:171], v[138:139], v[18:19] op_sel:[0,0,0] op_sel_hi:[0,1,1]
    v_pk_fma_f32 v[20:21], v[174:175], v[140:141], v[20:21] op_sel:[0,0,0] op_sel_hi:[0,1,1]
    v_pk_fma_f32 v[22:23], v[174:175], v[142:143], v[22:23] op_sel:[0,0,0] op_sel_hi:[0,1,1]
    s_lshr_b32 s49, s49, 8
    s_set_gpr_idx_idx s49
    v_pk_fma_f32 v[16:17], v[170:171], v[144:145], v[16:17] op_sel:[1,0,0] op_sel_hi:[1,1,1]
    v_pk_fma_f32 v[18:19], v[170:171], v[146:147], v[18:19] op_sel:[1,0,0] op_sel_hi:[1,1,1]
    v_pk_fma_f32 v[20:21], v[174:175], v[148:149], v[20:21] op_sel:[1,0,0] op_sel_hi:[1,1,1]
    v_pk_fma_f32 v[22:23], v[174:175], v[150:151], v[22:23] op_sel:[1,0,0] op_sel_hi:[1,1,1]
    s_set_gpr_idx_off
    s_sub_u32 s48, s48, 1
    s_cbranch_scc0 K2_LOOP
K2_LOOPDONE:
    v_mov_b32 v254, -1
    ds_write_b32 v252, v254 offset:2048
    s_setprio 0
    s_add_u32 s47, s47, 1536
    s_cmp_ge_u32 s47, s46
    s_cbranch_scc1 K_EPI
    s_waitcnt vmcnt(0) lgkmcnt(0)
    s_barrier
    ds_write_b128 v8, v[4:7]
    ds_write_b32 v3, v4 offset:2048
    v_cmp_gt_u32 vcc, 128, v0
    s_and_saveexec_b64 s[56:57], vcc
    ds_write_b32 v3, v4 offset:0
    s_mov_b64 exec, s[56:57]
    s_waitcnt lgkmcnt(0)
    s_barrier
    s_cmp_eq_u32 s55, 0
    s_cbranch_scc1 K_ROUND
    s_branch K_FB
K_NOBAL:
    s_mov_b64 exec, s[40:41]
    buffer_load_dwordx4 v[80:83], v95, s[36:39], s61 offen sc1
    s_mov_b64 exec, s[42:43]
    buffer_load_dwordx4 v[84:87], v96, s[36:39], s61 offen sc1
    s_mov_b64 exec, s[44:45]
    buffer_load_dwordx4 v[88:91], v97, s[36:39], s61 offen sc1
    s_mov_b64 exec, -1
K_NOBAL2:
    s_waitcnt vmcnt(0)
    v_lshrrev_b32 v92, 2, v72
    v_and_b32 v92, 0xfc, v92
    v_lshrrev_b32 v93, 2, v74
    v_and_b32 v93, 0xfc, v93
    v_lshrrev_b32 v94, 2, v76
    v_and_b32 v94, 0xfc, v94
    s_branch K_BAL
K_FB0:
    s_mov_b32 s46, 320000
    s_waitcnt vmcnt(0)
K_FB:
    s_mul_i32 s56, s3, 192
    s_add_u32 s56, s56, s47
    v_add_u32 v68, s56, v1
    v_add_u32 v69, 64, v68
    v_add_u32 v70, 128, v68
    v_cmp_gt_u32 s[40:41], s46, v68
    v_min_u32 v68, 319999, v68
    v_lshlrev_b32 v92, 2, v68
    v_lshlrev_b32 v95, 3, v68
    global_load_dword v56, v92, s[8:9]
    global_load_dword v60, v92, s[6:7]
    global_load_dwordx2 v[80:81], v95, s[10:11]
    global_load_dwordx2 v[82:83], v95, s[12:13]
    v_cmp_gt_u32 s[42:43], s46, v69
    v_min_u32 v69, 319999, v69
    v_lshlrev_b32 v93, 2, v69
    v_lshlrev_b32 v96, 3, v69
    global_load_dword v57, v93, s[8:9]
    global_load_dword v61, v93, s[6:7]
    global_load_dwordx2 v[84:85], v96, s[10:11]
    global_load_dwordx2 v[86:87], v96, s[12:13]
    v_cmp_gt_u32 s[44:45], s46, v70
    v_min_u32 v70, 319999, v70
    v_lshlrev_b32 v94, 2, v70
    v_lshlrev_b32 v97, 3, v70
    global_load_dword v58, v94, s[8:9]
    global_load_dword v62, v94, s[6:7]
    global_load_dwordx2 v[88:89], v97, s[10:11]
    global_load_dwordx2 v[90:91], v97, s[12:13]
    s_waitcnt vmcnt(0)
    v_mul_u32_u24 v68, 214749, v56
    v_lshrrev_b32 v68, 23, v68
    v_cmp_eq_u32 vcc, s53, v68
    s_and_b64 s[40:41], s[40:41], vcc
    v_subrev_u32 v72, s54, v56
    v_mul_u32_u24 v68, 1677, v60
    v_lshrrev_b32 v68, 20, v68
    v_lshl_or_b32 v72, v72, 4, v68
    v_lshl_or_b32 v72, v60, 10, v72
    v_mul_u32_u24 v69, 214749, v57
    v_lshrrev_b32 v69, 23, v69
    v_cmp_eq_u32 vcc, s53, v69
    s_and_b64 s[42:43], s[42:43], vcc
    v_subrev_u32 v74, s54, v57
    v_mul_u32_u24 v69, 1677, v61
    v_lshrrev_b32 v69, 20, v69
    v_lshl_or_b32 v74, v74, 4, v69
    v_lshl_or_b32 v74, v61, 10, v74
    v_mul_u32_u24 v70, 214749, v58
    v_lshrrev_b32 v70, 23, v70
    v_cmp_eq_u32 vcc, s53, v70
    s_and_b64 s[44:45], s[44:45], vcc
    v_subrev_u32 v76, s54, v58
    v_mul_u32_u24 v70, 1677, v62
    v_lshrrev_b32 v70, 20, v70
    v_lshl_or_b32 v76, v76, 4, v70
    v_lshl_or_b32 v76, v62, 10, v76
    v_mov_b32 v14, 0x42800000
    s_cmp_lg_u32 s47, 0
    s_cbranch_scc1 K_NOBAL2
    s_mov_b64 exec, s[40:41]
    v_lshrrev_b32 v92, 2, v72
    v_and_b32 v92, 0xfc, v92
    ds_add_f32 v92, v14 offset:512
    s_mov_b64 exec, s[42:43]
    v_lshrrev_b32 v93, 2, v74
    v_and_b32 v93, 0xfc, v93
    ds_add_f32 v93, v14 offset:512
    s_mov_b64 exec, s[44:45]
    v_lshrrev_b32 v94, 2, v76
    v_and_b32 v94, 0xfc, v94
    ds_add_f32 v94, v14 offset:512
    s_mov_b64 exec, -1
    s_waitcnt lgkmcnt(0)
    s_barrier
    s_branch K_BAL0
K_EPI:
    s_mov_b32 s56, 0xbf317218
    s_mov_b32 s57, s56
    s_add_u32 s58, s3, 0
    v_cmp_eq_u32 vcc, s58, v2
    v_pk_mul_f32 v[16:17], v[16:17], s[56:57]
    v_pk_mul_f32 v[18:19], v[18:19], s[56:57]
    v_pk_mul_f32 v[20:21], v[20:21], s[56:57]
    v_pk_mul_f32 v[22:23], v[22:23], s[56:57]
    s_ff1_i32_b64 s58, vcc
    s_mul_i32 s58, s58, 1152
    s_add_u32 s58, s58, 106752
    v_add_u32 v10, s58, v15
    v_cvt_pk_bf16_f32 v16, v16, v20
    ds_write_b32 v10, v16 offset:0
    v_cvt_pk_bf16_f32 v17, v17, v21
    ds_write_b32 v10, v17 offset:288
    v_cvt_pk_bf16_f32 v18, v18, v22
    ds_write_b32 v10, v18 offset:576
    v_cvt_pk_bf16_f32 v19, v19, v23
    ds_write_b32 v10, v19 offset:864
    s_add_u32 s58, s3, 8
    v_cmp_eq_u32 vcc, s58, v2
    v_pk_mul_f32 v[24:25], v[24:25], s[56:57]
    v_pk_mul_f32 v[26:27], v[26:27], s[56:57]
    v_pk_mul_f32 v[28:29], v[28:29], s[56:57]
    v_pk_mul_f32 v[30:31], v[30:31], s[56:57]
    s_ff1_i32_b64 s58, vcc
    s_mul_i32 s58, s58, 1152
    s_add_u32 s58, s58, 106752
    v_add_u32 v11, s58, v15
    v_cvt_pk_bf16_f32 v24, v24, v28
    ds_write_b32 v11, v24 offset:0
    v_cvt_pk_bf16_f32 v25, v25, v29
    ds_write_b32 v11, v25 offset:288
    v_cvt_pk_bf16_f32 v26, v26, v30
    ds_write_b32 v11, v26 offset:576
    v_cvt_pk_bf16_f32 v27, v27, v31
    ds_write_b32 v11, v27 offset:864
    s_add_u32 s58, s3, 16
    v_cmp_eq_u32 vcc, s58, v2
    v_pk_mul_f32 v[32:33], v[32:33], s[56:57]
    v_pk_mul_f32 v[34:35], v[34:35], s[56:57]
    v_pk_mul_f32 v[36:37], v[36:37], s[56:57]
    v_pk_mul_f32 v[38:39], v[38:39], s[56:57]
    s_ff1_i32_b64 s58, vcc
    s_mul_i32 s58, s58, 1152
    s_add_u32 s58, s58, 106752
    v_add_u32 v10, s58, v15
    v_cvt_pk_bf16_f32 v32, v32, v36
    ds_write_b32 v10, v32 offset:0
    v_cvt_pk_bf16_f32 v33, v33, v37
    ds_write_b32 v10, v33 offset:288
    v_cvt_pk_bf16_f32 v34, v34, v38
    ds_write_b32 v10, v34 offset:576
    v_cvt_pk_bf16_f32 v35, v35, v39
    ds_write_b32 v10, v35 offset:864
    s_add_u32 s58, s3, 24
    v_cmp_eq_u32 vcc, s58, v2
    v_pk_mul_f32 v[40:41], v[40:41], s[56:57]
    v_pk_mul_f32 v[42:43], v[42:43], s[56:57]
    v_pk_mul_f32 v[44:45], v[44:45], s[56:57]
    v_pk_mul_f32 v[46:47], v[46:47], s[56:57]
    s_ff1_i32_b64 s58, vcc
    s_mul_i32 s58, s58, 1152
    s_add_u32 s58, s58, 106752
    v_add_u32 v11, s58, v15
    v_cvt_pk_bf16_f32 v40, v40, v44
    ds_write_b32 v11, v40 offset:0
    v_cvt_pk_bf16_f32 v41, v41, v45
    ds_write_b32 v11, v41 offset:288
    v_cvt_pk_bf16_f32 v42, v42, v46
    ds_write_b32 v11, v42 offset:576
    v_cvt_pk_bf16_f32 v43, v43, v47
    ds_write_b32 v11, v43 offset:864
    s_add_u32 s58, s3, 32
    v_cmp_eq_u32 vcc, s58, v2
    v_pk_mul_f32 v[48:49], v[48:49], s[56:57]
    v_pk_mul_f32 v[50:51], v[50:51], s[56:57]
    v_pk_mul_f32 v[52:53], v[52:53], s[56:57]
    v_pk_mul_f32 v[54:55], v[54:55], s[56:57]
    s_ff1_i32_b64 s58, vcc
    s_mul_i32 s58, s58, 1152
    s_add_u32 s58, s58, 106752
    v_add_u32 v10, s58, v15
    v_cvt_pk_bf16_f32 v48, v48, v52
    ds_write_b32 v10, v48 offset:0
    v_cvt_pk_bf16_f32 v49, v49, v53
    ds_write_b32 v10, v49 offset:288
    v_cvt_pk_bf16_f32 v50, v50, v54
    ds_write_b32 v10, v50 offset:576
    v_cvt_pk_bf16_f32 v51, v51, v55
    ds_write_b32 v10, v51 offset:864
    v_and_b32 v12, 15, v1
    v_lshrrev_b32 v13, 4, v1
    s_lshr_b32 s58, s3, 2
    s_mul_i32 s59, s58, 4608
    s_add_u32 s59, s59, 106752
    v_mul_u32_u24 v14, 288, v12
    v_lshl_add_u32 v14, v13, 4, v14
    v_add_u32 v14, s59, v14
    s_lshl_b32 s58, s58, 2
    s_add_u32 s58, s58, s54
    s_lshl_b32 s58, s58, 10
    s_and_b32 s59, s3, 3
    s_lshl_b32 s59, s59, 8
    s_add_u32 s58, s58, s59
    v_lshlrev_b32 v13, 10, v13
    v_lshl_add_u32 v13, v12, 4, v13
    s_waitcnt vmcnt(0) lgkmcnt(0)
    s_barrier
    ds_read_b128 v[56:59], v14 offset:0
    ds_read_b128 v[60:63], v14 offset:64
    ds_read_b128 v[64:67], v14 offset:128
    ds_read_b128 v[68:71], v14 offset:192
    ds_read_b128 v[72:75], v14 offset:9216
    ds_read_b128 v[76:79], v14 offset:9280
    ds_read_b128 v[80:83], v14 offset:9344
    ds_read_b128 v[84:87], v14 offset:9408
    ds_read_b128 v[88:91], v14 offset:18432
    ds_read_b128 v[92:95], v14 offset:18496
    ds_read_b128 v[96:99], v14 offset:18560
    ds_read_b128 v[100:103], v14 offset:18624
    ds_read_b128 v[104:107], v14 offset:27648
    ds_read_b128 v[108:111], v14 offset:27712
    ds_read_b128 v[112:115], v14 offset:27776
    ds_read_b128 v[116:119], v14 offset:27840
    s_waitcnt lgkmcnt(15)
    v_mfma_f32_16x16x32_bf16 v[120:123], v[56:59], v[200:203], 0
    v_mfma_f32_16x16x32_bf16 v[124:127], v[56:59], v[216:219], 0
    s_waitcnt lgkmcnt(14)
    v_mfma_f32_16x16x32_bf16 v[120:123], v[60:63], v[204:207], v[120:123]
    v_mfma_f32_16x16x32_bf16 v[124:127], v[60:63], v[220:223], v[124:127]
    s_waitcnt lgkmcnt(13)
    v_mfma_f32_16x16x32_bf16 v[120:123], v[64:67], v[208:211], v[120:123]
    v_mfma_f32_16x16x32_bf16 v[124:127], v[64:67], v[224:227], v[124:127]
    s_waitcnt lgkmcnt(12)
    v_mfma_f32_16x16x32_bf16 v[120:123], v[68:71], v[212:215], v[120:123]
    v_mfma_f32_16x16x32_bf16 v[124:127], v[68:71], v[228:231], v[124:127]
    ds_read_b128 v[56:59], v14 offset:36864
    ds_read_b128 v[60:63], v14 offset:36928
    ds_read_b128 v[64:67], v14 offset:36992
    ds_read_b128 v[68:71], v14 offset:37056
    s_waitcnt lgkmcnt(15)
    v_mfma_f32_16x16x32_bf16 v[128:131], v[72:75], v[200:203], 0
    v_mfma_f32_16x16x32_bf16 v[132:135], v[72:75], v[216:219], 0
    s_waitcnt lgkmcnt(14)
    v_mfma_f32_16x16x32_bf16 v[128:131], v[76:79], v[204:207], v[128:131]
    v_mfma_f32_16x16x32_bf16 v[132:135], v[76:79], v[220:223], v[132:135]
    s_waitcnt lgkmcnt(13)
    v_mfma_f32_16x16x32_bf16 v[128:131], v[80:83], v[208:211], v[128:131]
    v_mfma_f32_16x16x32_bf16 v[132:135], v[80:83], v[224:227], v[132:135]
    s_waitcnt lgkmcnt(12)
    v_mfma_f32_16x16x32_bf16 v[128:131], v[84:87], v[212:215], v[128:131]
    v_mfma_f32_16x16x32_bf16 v[132:135], v[84:87], v[228:231], v[132:135]
    v_cvt_pk_bf16_f32 v136, v120, v121
    v_cvt_pk_bf16_f32 v137, v122, v123
    v_cvt_pk_bf16_f32 v138, v124, v125
    v_cvt_pk_bf16_f32 v139, v126, v127
    buffer_store_dwordx4 v[136:139], v13, s[32:35], s58 offen sc1
    s_add_u32 s58, s58, 8192
    s_waitcnt lgkmcnt(11)
    v_mfma_f32_16x16x32_bf16 v[120:123], v[88:91], v[200:203], 0
    v_mfma_f32_16x16x32_bf16 v[124:127], v[88:91], v[216:219], 0
    s_waitcnt lgkmcnt(10)
    v_mfma_f32_16x16x32_bf16 v[120:123], v[92:95], v[204:207], v[120:123]
    v_mfma_f32_16x16x32_bf16 v[124:127], v[92:95], v[220:223], v[124:127]
    s_waitcnt lgkmcnt(9)
    v_mfma_f32_16x16x32_bf16 v[120:123], v[96:99], v[208:211], v[120:123]
    v_mfma_f32_16x16x32_bf16 v[124:127], v[96:99], v[224:227], v[124:127]
    s_waitcnt lgkmcnt(8)
    v_mfma_f32_16x16x32_bf16 v[120:123], v[100:103], v[212:215], v[120:123]
    v_mfma_f32_16x16x32_bf16 v[124:127], v[100:103], v[228:231], v[124:127]
    v_cvt_pk_bf16_f32 v140, v128, v129
    v_cvt_pk_bf16_f32 v141, v130, v131
    v_cvt_pk_bf16_f32 v142, v132, v133
    v_cvt_pk_bf16_f32 v143, v134, v135
    buffer_store_dwordx4 v[140:143], v13, s[32:35], s58 offen sc1
    s_add_u32 s58, s58, 8192
    s_waitcnt lgkmcnt(7)
    v_mfma_f32_16x16x32_bf16 v[128:131], v[104:107], v[200:203], 0
    v_mfma_f32_16x16x32_bf16 v[132:135], v[104:107], v[216:219], 0
    s_waitcnt lgkmcnt(6)
    v_mfma_f32_16x16x32_bf16 v[128:131], v[108:111], v[204:207], v[128:131]
    v_mfma_f32_16x16x32_bf16 v[132:135], v[108:111], v[220:223], v[132:135]
    s_waitcnt lgkmcnt(5)
    v_mfma_f32_16x16x32_bf16 v[128:131], v[112:115], v[208:211], v[128:131]
    v_mfma_f32_16x16x32_bf16 v[132:135], v[112:115], v[224:227], v[132:135]
    s_waitcnt lgkmcnt(4)
    v_mfma_f32_16x16x32_bf16 v[128:131], v[116:119], v[212:215], v[128:131]
    v_mfma_f32_16x16x32_bf16 v[132:135], v[116:119], v[228:231], v[132:135]
    v_cvt_pk_bf16_f32 v136, v120, v121
    v_cvt_pk_bf16_f32 v137, v122, v123
    v_cvt_pk_bf16_f32 v138, v124, v125
    v_cvt_pk_bf16_f32 v139, v126, v127
    buffer_store_dwordx4 v[136:139], v13, s[32:35], s58 offen sc1
    s_add_u32 s58, s58, 8192
    s_waitcnt lgkmcnt(3)
    v_mfma_f32_16x16x32_bf16 v[120:123], v[56:59], v[200:203], 0
    v_mfma_f32_16x16x32_bf16 v[124:127], v[56:59], v[216:219], 0
    s_waitcnt lgkmcnt(2)
    v_mfma_f32_16x16x32_bf16 v[120:123], v[60:63], v[204:207], v[120:123]
    v_mfma_f32_16x16x32_bf16 v[124:127], v[60:63], v[220:223], v[124:127]
    s_waitcnt lgkmcnt(1)
    v_mfma_f32_16x16x32_bf16 v[120:123], v[64:67], v[208:211], v[120:123]
    v_mfma_f32_16x16x32_bf16 v[124:127], v[64:67], v[224:227], v[124:127]
    s_waitcnt lgkmcnt(0)
    v_mfma_f32_16x16x32_bf16 v[120:123], v[68:71], v[212:215], v[120:123]
    v_mfma_f32_16x16x32_bf16 v[124:127], v[68:71], v[228:231], v[124:127]
    v_cvt_pk_bf16_f32 v140, v128, v129
    v_cvt_pk_bf16_f32 v141, v130, v131
    v_cvt_pk_bf16_f32 v142, v132, v133
    v_cvt_pk_bf16_f32 v143, v134, v135
    buffer_store_dwordx4 v[140:143], v13, s[32:35], s58 offen sc1
    s_add_u32 s58, s58, 8192
    s_nop 0
    v_cvt_pk_bf16_f32 v136, v120, v121
    v_cvt_pk_bf16_f32 v137, v122, v123
    v_cvt_pk_bf16_f32 v138, v124, v125
    v_cvt_pk_bf16_f32 v139, v126, v127
    buffer_store_dwordx4 v[136:139], v13, s[32:35], s58 offen sc1
    s_cmp_eq_u32 s63, 0
    s_cbranch_scc1 K_NOEPO
    v_mov_b32 v10, s52
    s_mov_b64 exec, 1
    buffer_store_dword v10, v4, s[36:39], 0 offen offset:0 sc1
K_NOEPO:
K_END:
    s_endpgm
.p2align 6
.type K_TAB,@object
K_TAB:
.byte 6, 5, 14, 7, 4, 2, 0, 1, 3, 12, 22, 11, 10, 8, 30, 9, 19, 13, 15, 17, 16, 21, 23, 20, 18, 25, 29, 28, 31, 27, 26, 24, 34, 32, 39, 33, 35, 36, 37, 38, 255, 255, 255, 255, 255, 255, 255, 255, 255, 255, 255, 255, 255, 255, 255, 255, 255, 255, 255, 255, 255, 255, 255, 255
.byte 3, 2, 4, 7, 0, 1, 6, 8, 5, 9, 15, 13, 14, 11, 12, 22, 21, 16, 10, 23, 17, 20, 30, 19, 18, 25, 27, 24, 29, 28, 26, 31, 34, 37, 36, 39, 33, 38, 32, 35, 255, 255, 255, 255, 255, 255, 255, 255, 255, 255, 255, 255, 255, 255, 255, 255, 255, 255, 255, 255, 255, 255, 255, 255
.section .rodata,"a"
.p2align 6
.amdhsa_kernel gather_scatter__tensor_product_equiv_tfn__graph_kernel
  .amdhsa_next_free_vgpr 256
  .amdhsa_next_free_sgpr 72
  .amdhsa_accum_offset 256
  .amdhsa_group_segment_fixed_size 0
  .amdhsa_kernarg_size 88
  .amdhsa_user_sgpr_count 2
  .amdhsa_user_sgpr_kernarg_segment_ptr 1
  .amdhsa_system_sgpr_workgroup_id_x 1
  .amdhsa_float_denorm_mode_32 3
.end_amdhsa_kernel
```

```asm
; @launch grid=(256,1,1) block=(512,1,1) lds=152832
.amdgcn_target "amdgcn-amd-amdhsa--gfx950"
.text
.globl gather_scatter__tensor_product_equiv_tfn__graph_kernel
.p2align 8
.type gather_scatter__tensor_product_equiv_tfn__graph_kernel,@function
gather_scatter__tensor_product_equiv_tfn__graph_kernel:
    s_cmp_ge_u32 s2, 256
    s_cbranch_scc1 K_END
    s_load_dwordx16 s[4:19], s[0:1], 0
    s_load_dwordx2 s[20:21], s[0:1], 64
    s_load_dwordx2 s[24:25], s[0:1], 80
    v_lshrrev_b32 v2, 6, v0
    v_and_b32 v1, 63, v0
    v_lshlrev_b32 v3, 2, v0
    v_readfirstlane_b32 s3, v2
    v_mov_b32 v4, 0
    v_mov_b32 v5, 0
    v_mov_b32 v6, 0
    v_mov_b32 v7, 0
    v_or_b32 v13, 0x4b000000, v1
    v_lshlrev_b32 v10, 4, v0
    v_add_u32 v8, 106752, v10
    s_cmp_eq_u32 s3, 2
    s_cselect_b32 s56, -1, 0
    ds_write_b128 v8, v[4:7]
    v_and_b32 v13, s56, v13
    ds_write_b32 v3, v4 offset:2048
    ds_write_b32 v3, v13
    s_mul_i32 s57, s2, 5120
    v_add_u32 v11, s57, v10
    v_lshlrev_b32 v12, 1, v11
    s_and_b32 s53, s2, 7
    s_lshr_b32 s56, s2, 3
    s_lshl_b32 s53, s53, 5
    s_or_b32 s53, s53, s56
    s_cmp_lt_u32 s2, 250
    s_cselect_b32 s56, 5, 0
    s_cmp_lt_u32 s3, s56
    s_cselect_b32 s40, 1, 0
    v_lshlrev_b32 v9, 4, v1
    v_lshlrev_b32 v15, 2, v1
    s_waitcnt lgkmcnt(0)
    s_load_dword s52, s[24:25], 0
    s_cmp_eq_u32 s40, 0
    s_cbranch_scc1 K_HELP
    global_load_dwordx4 v[120:123], v11, s[8:9]
    global_load_dwordx4 v[124:127], v11, s[6:7]
    s_barrier
    global_load_dwordx4 v[128:131], v12, s[10:11] offset:0
    global_load_dwordx4 v[132:135], v12, s[10:11] offset:16
    global_load_dwordx4 v[136:139], v12, s[12:13] offset:0
    global_load_dwordx4 v[140:143], v12, s[12:13] offset:16
    s_mul_i32 s54, s53, 625
    s_add_u32 s57, s54, 640
    s_add_u32 s54, s54, 15
    s_lshr_b32 s54, s54, 4
    s_lshr_b32 s57, s57, 4
    s_mov_b32 s28, s4
    s_and_b32 s29, s5, 0xffff
    s_or_b32 s29, s29, 0x100000
    s_mov_b32 s30, 10240000
    s_mov_b32 s31, 0x800000
    s_mov_b32 s32, s20
    s_mov_b32 s33, s21
    s_lshl_b32 s34, s57, 10
    s_mov_b32 s35, 0x20000
    s_mov_b32 s36, s24
    s_mov_b32 s37, s25
    s_mov_b32 s38, 8388608
    s_mov_b32 s39, 0x20000
    s_mov_b32 s47, 0
    v_mov_b32 v14, 1
    s_lshr_b32 s27, s53, 5
    s_mul_i32 s27, s27, 20009
    s_add_u32 s27, s27, 14
    s_lshr_b32 s27, s27, 4
    s_lshl_b32 s27, s27, 10
    v_mov_b32 v16, 0
    v_mov_b32 v17, 0
    v_mov_b32 v18, 0
    v_mov_b32 v19, 0
    v_mov_b32 v20, 0
    v_mov_b32 v21, 0
    v_mov_b32 v22, 0
    v_mov_b32 v23, 0
    v_mov_b32 v24, 0
    v_mov_b32 v25, 0
    v_mov_b32 v26, 0
    v_mov_b32 v27, 0
    v_mov_b32 v28, 0
    v_mov_b32 v29, 0
    v_mov_b32 v30, 0
    v_mov_b32 v31, 0
    v_mov_b32 v32, 0
    v_mov_b32 v33, 0
    v_mov_b32 v34, 0
    v_mov_b32 v35, 0
    v_mov_b32 v36, 0
    v_mov_b32 v37, 0
    v_mov_b32 v38, 0
    v_mov_b32 v39, 0
    v_mov_b32 v40, 0
    v_mov_b32 v41, 0
    v_mov_b32 v42, 0
    v_mov_b32 v43, 0
    v_mov_b32 v44, 0
    v_mov_b32 v45, 0
    v_mov_b32 v46, 0
    v_mov_b32 v47, 0
    v_mov_b32 v48, 0
    v_mov_b32 v49, 0
    v_mov_b32 v50, 0
    v_mov_b32 v51, 0
    v_mov_b32 v52, 0
    v_mov_b32 v53, 0
    v_mov_b32 v54, 0
    v_mov_b32 v55, 0
    s_waitcnt vmcnt(5)
    v_mul_u32_u24 v60, 214749, v120
    v_lshrrev_b32 v60, 23, v60
    v_lshlrev_b32 v144, 2, v60
    ds_add_rtn_u32 v148, v144, v14 offset:768
    v_mul_u32_u24 v61, 214749, v121
    v_lshrrev_b32 v61, 23, v61
    v_lshlrev_b32 v145, 2, v61
    ds_add_rtn_u32 v149, v145, v14 offset:768
    v_mul_u32_u24 v62, 214749, v122
    v_lshrrev_b32 v62, 23, v62
    v_lshlrev_b32 v146, 2, v62
    ds_add_rtn_u32 v150, v146, v14 offset:768
    v_mul_u32_u24 v63, 214749, v123
    v_lshrrev_b32 v63, 23, v63
    v_lshlrev_b32 v147, 2, v63
    ds_add_rtn_u32 v151, v147, v14 offset:768
    v_mul_u32_u24 v64, 625, v60
    v_add_u32 v64, 15, v64
    v_lshrrev_b32 v64, 4, v64
    v_sub_u32 v56, v120, v64
    v_mul_u32_u24 v64, 625, v61
    v_add_u32 v64, 15, v64
    v_lshrrev_b32 v64, 4, v64
    v_sub_u32 v57, v121, v64
    v_mul_u32_u24 v64, 625, v62
    v_add_u32 v64, 15, v64
    v_lshrrev_b32 v64, 4, v64
    v_sub_u32 v58, v122, v64
    v_mul_u32_u24 v64, 625, v63
    v_add_u32 v64, 15, v64
    v_lshrrev_b32 v64, 4, v64
    v_sub_u32 v59, v123, v64
    s_branch K_BB
K_HELP:
    s_barrier
    s_cmp_eq_u32 s3, 7
    s_cbranch_scc1 K_HELP7
    s_cmp_lg_u32 s3, 6
    s_cbranch_scc1 K_HELP2
    s_and_b32 s56, s53, 31
    s_lshl_b32 s56, s56, 10
    v_lshl_add_u32 v13, v1, 7, s56
    s_mov_b64 exec, 0xff
    global_load_dword v255, v13, s[18:19]
    s_mov_b64 exec, -1
    s_branch K_HELP2
K_HELP7:
    s_mov_b32 m0, 147712
    s_getpc_b64 s[26:27]
K_PC:
    global_load_lds_dwordx4 v9, s[14:15]
    s_add_u32 s26, s26, K_TAB-K_PC
    s_addc_u32 s27, s27, 0
    s_mov_b32 m0, 148736
    s_mov_b64 exec, 0xff
    global_load_lds_dwordx4 v9, s[16:17]
    s_mov_b32 m0, 148864
    s_nop 0
    global_load_lds_dwordx4 v9, s[26:27]
    s_mov_b64 exec, -1
K_HELP2:
    s_mul_i32 s54, s53, 625
    s_add_u32 s57, s54, 640
    s_add_u32 s54, s54, 15
    s_lshr_b32 s54, s54, 4
    s_lshr_b32 s57, s57, 4
    s_mov_b32 s28, s4
    s_and_b32 s29, s5, 0xffff
    s_or_b32 s29, s29, 0x100000
    s_mov_b32 s30, 10240000
    s_mov_b32 s31, 0x800000
    s_mov_b32 s32, s20
    s_mov_b32 s33, s21
    s_lshl_b32 s34, s57, 10
    s_mov_b32 s35, 0x20000
    s_mov_b32 s36, s24
    s_mov_b32 s37, s25
    s_mov_b32 s38, 8388608
    s_mov_b32 s39, 0x20000
    s_mov_b32 s47, 0
    v_mov_b32 v14, 1
    s_lshr_b32 s27, s53, 5
    s_mul_i32 s27, s27, 20009
    s_add_u32 s27, s27, 14
    s_lshr_b32 s27, s27, 4
    s_lshl_b32 s27, s27, 10
    v_mov_b32 v16, 0
    v_mov_b32 v17, 0
    v_mov_b32 v18, 0
    v_mov_b32 v19, 0
    v_mov_b32 v20, 0
    v_mov_b32 v21, 0
    v_mov_b32 v22, 0
    v_mov_b32 v23, 0
    v_mov_b32 v24, 0
    v_mov_b32 v25, 0
    v_mov_b32 v26, 0
    v_mov_b32 v27, 0
    v_mov_b32 v28, 0
    v_mov_b32 v29, 0
    v_mov_b32 v30, 0
    v_mov_b32 v31, 0
    v_mov_b32 v32, 0
    v_mov_b32 v33, 0
    v_mov_b32 v34, 0
    v_mov_b32 v35, 0
    v_mov_b32 v36, 0
    v_mov_b32 v37, 0
    v_mov_b32 v38, 0
    v_mov_b32 v39, 0
    v_mov_b32 v40, 0
    v_mov_b32 v41, 0
    v_mov_b32 v42, 0
    v_mov_b32 v43, 0
    v_mov_b32 v44, 0
    v_mov_b32 v45, 0
    v_mov_b32 v46, 0
    v_mov_b32 v47, 0
    v_mov_b32 v48, 0
    v_mov_b32 v49, 0
    v_mov_b32 v50, 0
    v_mov_b32 v51, 0
    v_mov_b32 v52, 0
    v_mov_b32 v53, 0
    v_mov_b32 v54, 0
    v_mov_b32 v55, 0
K_BB:
    s_waitcnt lgkmcnt(0)
    s_barrier
    s_add_u32 s52, s52, 1
    s_and_b32 s56, s52, 0x3ff
    s_lshl_b32 s58, s56, 22
    s_lshl_b32 s26, s52, 24
    s_cmp_eq_u32 s3, 7
    s_cselect_b32 s56, 1, s40
    s_cmp_eq_u32 s56, 0
    s_cbranch_scc1 K_BC1
    ds_read_b128 v[152:155], v9 offset:768
    s_cmp_eq_u32 s3, 7
    s_cbranch_scc1 K_SC
    s_waitcnt vmcnt(4)
    v_mul_u32_u24 v60, 1677, v124
    v_lshrrev_b32 v60, 20, v60
    v_lshl_or_b32 v56, v56, 4, v60
    v_lshl_or_b32 v56, v124, 10, v56
    v_mul_u32_u24 v61, 1677, v125
    v_lshrrev_b32 v61, 20, v61
    v_lshl_or_b32 v57, v57, 4, v61
    v_lshl_or_b32 v57, v125, 10, v57
    v_mul_u32_u24 v62, 1677, v126
    v_lshrrev_b32 v62, 20, v62
    v_lshl_or_b32 v58, v58, 4, v62
    v_lshl_or_b32 v58, v126, 10, v58
    v_mul_u32_u24 v63, 1677, v127
    v_lshrrev_b32 v63, 20, v63
    v_lshl_or_b32 v59, v59, 4, v63
    v_lshl_or_b32 v59, v127, 10, v59
K_SC:
    s_waitcnt lgkmcnt(0)
    v_add_u32 v156, v152, v153
    v_add_u32 v157, v156, v154
    v_add_u32 v158, v157, v155
    v_mov_b32 v160, v158
    v_or_b32 v66, s26, v56
    v_mov_b32 v67, s52
    v_add_u32_dpp v160, v160, v160 row_shr:1 row_mask:0xf bank_mask:0xf
    v_or_b32 v68, s26, v57
    v_mov_b32 v69, s52
    v_add_u32_dpp v160, v160, v160 row_shr:2 row_mask:0xf bank_mask:0xf
    v_or_b32 v70, s26, v58
    v_mov_b32 v71, s52
    v_add_u32_dpp v160, v160, v160 row_shr:4 row_mask:0xf bank_mask:0xf
    v_or_b32 v72, s26, v59
    v_mov_b32 v73, s52
    v_add_u32_dpp v160, v160, v160 row_shr:8 row_mask:0xf bank_mask:0xf
    s_nop 1
    v_add_u32_dpp v160, v160, v160 row_bcast:15 row_mask:0xa bank_mask:0xf
    s_nop 1
    v_add_u32_dpp v160, v160, v160 row_bcast:31 row_mask:0xc bank_mask:0xf
    v_sub_u32 v160, v160, v158
    v_add_u32 v161, v160, v152
    v_add_u32 v162, v160, v156
    v_add_u32 v163, v160, v157
    s_cmp_lg_u32 s3, 7
    s_cbranch_scc1 K_NOROW
    v_lshl_or_b32 v168, v152, 11, v160
    v_or_b32 v168, s58, v168
    v_mov_b32 v169, s52
    v_lshl_or_b32 v170, v153, 11, v161
    v_or_b32 v170, s58, v170
    v_mov_b32 v171, s52
    v_lshl_or_b32 v172, v154, 11, v162
    v_or_b32 v172, s58, v172
    v_mov_b32 v173, s52
    v_lshl_or_b32 v174, v155, 11, v163
    v_or_b32 v174, s58, v174
    v_mov_b32 v175, s52
    s_lshl_b32 s57, s2, 11
    s_add_u32 s57, s57, 8192
    v_lshlrev_b32 v12, 5, v1
    buffer_store_dwordx4 v[168:171], v12, s[36:39], s57 offen sc1
    buffer_store_dwordx4 v[172:175], v12, s[36:39], s57 offen offset:16 sc1
    s_branch K_BC1
K_NOROW:
    ds_write_b128 v9, v[160:163] offset:4096
    ds_read_b32 v60, v144 offset:4096
    ds_read_b32 v61, v145 offset:4096
    ds_read_b32 v62, v146 offset:4096
    ds_read_b32 v63, v147 offset:4096
    s_waitcnt lgkmcnt(3)
    v_add_lshl_u32 v144, v60, v148, 3
    ds_write_b64 v144, v[66:67] offset:13824
    s_waitcnt lgkmcnt(3)
    v_add_lshl_u32 v145, v61, v149, 3
    ds_write_b64 v145, v[68:69] offset:13824
    s_waitcnt lgkmcnt(3)
    v_add_lshl_u32 v146, v62, v150, 3
    ds_write_b64 v146, v[70:71] offset:13824
    s_waitcnt lgkmcnt(3)
    v_add_lshl_u32 v147, v63, v151, 3
    ds_write_b64 v147, v[72:73] offset:13824
    s_mov_b32 s56, 44800
    v_lshl_add_u32 v144, v144, 1, s56
    v_lshl_add_u32 v145, v145, 1, s56
    v_lshl_add_u32 v146, v146, 1, s56
    v_lshl_add_u32 v147, v147, 1, s56
K_BC1:
    s_mul_i32 s60, s2, 10240
    s_add_u32 s60, s60, 532480
    s_sub_u32 s56, s3, 5
    s_lshl_b32 s57, s56, 14
    v_add_u32 v13, s57, v9
    s_add_u32 s57, s57, 114944
    s_waitcnt lgkmcnt(0)
    s_barrier
    s_cmp_ge_u32 s2, 250
    s_cbranch_scc1 K_KS2
    ds_read_b128 v[76:79], v10 offset:13824
    s_cmp_lt_u32 s56, 2
    s_cbranch_scc0 K_KS1
    ds_read_b128 v[80:83], v10 offset:16896
    s_add_u32 s59, s60, 3072
    s_waitcnt lgkmcnt(0)
    buffer_store_dwordx4 v[80:83], v10, s[36:39], s59 offen sc1
K_KS1:
    s_waitcnt lgkmcnt(0)
    buffer_store_dwordx4 v[76:79], v10, s[36:39], s60 offen sc1
K_KS2:
    s_cmp_lt_u32 s56, 2
    s_cbranch_scc1 K_DMA
    s_cmp_eq_u32 s40, 0
    s_cbranch_scc1 K_BC7
    s_waitcnt vmcnt(2)
    ds_write2_b64 v144, v[128:129], v[136:137] offset0:0 offset1:1
    ds_write2_b64 v145, v[130:131], v[138:139] offset0:0 offset1:1
    s_waitcnt vmcnt(1)
    ds_write2_b64 v146, v[132:133], v[140:141] offset0:0 offset1:1
    ds_write2_b64 v147, v[134:135], v[142:143] offset0:0 offset1:1
    s_branch K_BC
K_DMA:
    s_mov_b32 m0, s57
    s_add_u32 s57, s57, 4096
    global_load_lds_dwordx4 v13, s[18:19] offset:0
    global_load_lds_dwordx4 v13, s[18:19] offset:1024
    global_load_lds_dwordx4 v13, s[18:19] offset:2048
    global_load_lds_dwordx4 v13, s[18:19] offset:3072
    v_add_u32 v13, 4096, v13
    s_mov_b32 m0, s57
    s_add_u32 s57, s57, 4096
    global_load_lds_dwordx4 v13, s[18:19] offset:0
    global_load_lds_dwordx4 v13, s[18:19] offset:1024
    global_load_lds_dwordx4 v13, s[18:19] offset:2048
    global_load_lds_dwordx4 v13, s[18:19] offset:3072
    v_add_u32 v13, 4096, v13
    s_mov_b32 m0, s57
    s_add_u32 s57, s57, 4096
    global_load_lds_dwordx4 v13, s[18:19] offset:0
    global_load_lds_dwordx4 v13, s[18:19] offset:1024
    global_load_lds_dwordx4 v13, s[18:19] offset:2048
    global_load_lds_dwordx4 v13, s[18:19] offset:3072
    v_add_u32 v13, 4096, v13
    s_mov_b32 m0, s57
    s_add_u32 s57, s57, 4096
    global_load_lds_dwordx4 v13, s[18:19] offset:0
    global_load_lds_dwordx4 v13, s[18:19] offset:1024
    global_load_lds_dwordx4 v13, s[18:19] offset:2048
    global_load_lds_dwordx4 v13, s[18:19] offset:3072
    s_branch K_BC
K_BC7:
    s_cmp_ge_u32 s2, 250
    s_cbranch_scc0 K_BC8
    s_waitcnt vmcnt(2)
K_BC8:
    s_waitcnt vmcnt(3)
K_BC:
    s_mul_i32 s56, s2, 20480
    s_add_u32 s56, s56, 3145728
    s_add_u32 s57, s56, 8192
    s_add_u32 s59, s56, 16384
    v_lshlrev_b32 v11, 11, v0
    s_lshl_b32 s61, s53, 3
    s_add_u32 s61, s61, 8192
    s_waitcnt lgkmcnt(0)
    s_barrier
    s_cmp_ge_u32 s2, 250
    s_cbranch_scc1 K_NOST
    ds_read_b128 v[56:59], v10 offset:44800
    ds_read_b128 v[60:63], v10 offset:52992
    s_cmp_ge_u32 s3, 4
    s_cbranch_scc1 K_ST1
    ds_read_b128 v[64:67], v10 offset:61184
    s_waitcnt lgkmcnt(0)
    buffer_store_dwordx4 v[64:67], v10, s[36:39], s59 offen sc1
K_ST1:
    s_waitcnt lgkmcnt(1)
    buffer_store_dwordx4 v[56:59], v10, s[36:39], s56 offen sc1
    s_waitcnt lgkmcnt(0)
    buffer_store_dwordx4 v[60:63], v10, s[36:39], s57 offen sc1
K_NOST:
    s_lshr_b32 s56, s34, 10
    s_sub_u32 s56, s56, s54
    s_sub_u32 s56, s56, 39
    s_lshl_b32 s56, s56, 6
    s_add_u32 s56, s56, 148864
    v_add_u32 v2, s56, v1
    v_add_u32 v13, 147712, v15
    ds_read_u8 v2, v2
    ds_read2st64_b32 v[188:189], v13 offset0:0 offset1:1
    ds_read2st64_b32 v[190:191], v13 offset0:2 offset1:3
    v_and_b32 v12, 3, v1
    v_lshlrev_b32 v12, 5, v12
    v_bfe_u32 v13, v1, 2, 2
    v_lshl_or_b32 v12, v13, 1, v12
    v_add_u32 v12, 148736, v12
    ds_read_u16 v192, v12 offset:0
    ds_read_u16 v193, v12 offset:8
    ds_read_u16 v194, v12 offset:16
    ds_read_u16 v195, v12 offset:24
    v_mov_b32 v252, v3
    v_xor_b32 v253, 1024, v3
    v_mul_u32_u24 v185, 128, v0
    s_mov_b32 s56, 0xbfb8aa3b
    s_waitcnt lgkmcnt(0)
    v_lshlrev_b32 v136, 16, v188
    v_mul_f32 v140, s56, v136
    v_lshlrev_b32 v137, 16, v189
    v_mul_f32 v141, s56, v137
    v_lshlrev_b32 v138, 16, v190
    v_mul_f32 v142, s56, v138
    v_lshlrev_b32 v139, 16, v191
    v_mul_f32 v143, s56, v139
    v_cvt_pk_bf16_f32 v176, v140, v141
    v_cvt_pk_bf16_f32 v177, v142, v143
    v_lshlrev_b32 v140, 16, v176
    v_fma_f32 v140, s56, v136, -v140
    v_and_b32 v141, 0xffff0000, v176
    v_fma_f32 v141, s56, v137, -v141
    v_lshlrev_b32 v142, 16, v177
    v_fma_f32 v142, s56, v138, -v142
    v_and_b32 v143, 0xffff0000, v177
    v_fma_f32 v143, s56, v139, -v143
    v_cvt_pk_bf16_f32 v178, v140, v141
    v_cvt_pk_bf16_f32 v179, v142, v143
    v_and_b32 v136, 0xffff0000, v188
    v_mul_f32 v140, s56, v136
    v_and_b32 v137, 0xffff0000, v189
    v_mul_f32 v141, s56, v137
    v_and_b32 v138, 0xffff0000, v190
    v_mul_f32 v142, s56, v138
    v_and_b32 v139, 0xffff0000, v191
    v_mul_f32 v143, s56, v139
    v_cvt_pk_bf16_f32 v180, v140, v141
    v_cvt_pk_bf16_f32 v181, v142, v143
    v_lshlrev_b32 v140, 16, v180
    v_fma_f32 v140, s56, v136, -v140
    v_and_b32 v141, 0xffff0000, v180
    v_fma_f32 v141, s56, v137, -v141
    v_lshlrev_b32 v142, 16, v181
    v_fma_f32 v142, s56, v138, -v142
    v_and_b32 v143, 0xffff0000, v181
    v_fma_f32 v143, s56, v139, -v143
    v_cvt_pk_bf16_f32 v182, v140, v141
    v_cvt_pk_bf16_f32 v183, v142, v143
    v_lshl_or_b32 v136, v193, 16, v192
    v_lshl_or_b32 v137, v195, 16, v194
    v_lshrrev_b32 v13, 4, v1
    v_cmp_eq_u32 vcc, 0, v13
    s_nop 1
    v_cndmask_b32 v232, 0, v136, vcc
    v_cndmask_b32 v233, 0, v137, vcc
    v_cmp_eq_u32 vcc, 1, v13
    s_nop 1
    v_cndmask_b32 v234, 0, v136, vcc
    v_cndmask_b32 v235, 0, v137, vcc
    v_cmp_eq_u32 vcc, 2, v13
    s_nop 1
    v_cndmask_b32 v236, 0, v136, vcc
    v_cndmask_b32 v237, 0, v137, vcc
    v_cmp_eq_u32 vcc, 3, v13
    s_nop 1
    v_cndmask_b32 v238, 0, v136, vcc
    v_cndmask_b32 v239, 0, v137, vcc
    v_mul_u32_u24 v13, 5120, v1
    s_cmp_ge_u32 s3, 4
    s_cbranch_scc1 K_TABOK
    s_mov_b32 s59, 40000
    s_lshr_b32 s58, s58, 22
K_POLLA:
    buffer_load_dwordx2 v[152:153], v11, s[36:39], s61 offen sc1
    s_waitcnt vmcnt(0)
    v_lshrrev_b32 v154, 22, v152
    v_cmp_ne_u32 vcc, s52, v153
    v_cmp_ne_u32 s[56:57], s58, v154
    s_or_b64 vcc, vcc, s[56:57]
    s_cbranch_vccz K_POLLAOK
    s_sub_u32 s59, s59, 1
    s_cbranch_scc0 K_POLLA
    ds_write_b32 v4, v14 offset:1792
K_POLLAOK:
    ds_write_b32 v3, v152 offset:5120
K_TABOK:
    s_waitcnt vmcnt(0) lgkmcnt(0)
    s_barrier
    s_cmp_lg_u32 s3, 4
    s_cbranch_scc1 K_NOFLAG
    s_mul_i32 s56, s2, 128
    s_add_u32 s56, s56, 8323072
    v_mov_b32 v10, s52
    s_mov_b64 exec, 1
    buffer_store_dword v10, v4, s[36:39], s56 offen sc1
    s_mov_b64 exec, -1
K_NOFLAG:
    ds_read_b128 v[120:123], v9 offset:5120
    ds_read_b32 v10, v4 offset:1792
    s_waitcnt lgkmcnt(0)
    v_readfirstlane_b32 s55, v10
    v_bfe_u32 v124, v120, 11, 11
    v_bfe_u32 v125, v121, 11, 11
    v_bfe_u32 v126, v122, 11, 11
    v_bfe_u32 v127, v123, 11, 11
    v_add_u32 v129, v124, v125
    v_add_u32 v130, v129, v126
    v_add_u32 v131, v130, v127
    v_mov_b32 v132, v131
    v_and_b32 v120, 0x7ff, v120
    v_add_u32 v248, v13, v120
    v_add_u32_dpp v132, v132, v132 row_shr:1 row_mask:0xf bank_mask:0xf
    v_and_b32 v121, 0x7ff, v121
    v_add_u32 v249, v13, v121
    v_add_u32_dpp v132, v132, v132 row_shr:2 row_mask:0xf bank_mask:0xf
    v_add_u32 v249, 1280, v249
    v_and_b32 v122, 0x7ff, v122
    v_add_u32_dpp v132, v132, v132 row_shr:4 row_mask:0xf bank_mask:0xf
    v_add_u32 v250, v13, v122
    v_add_u32 v250, 2560, v250
    v_add_u32_dpp v132, v132, v132 row_shr:8 row_mask:0xf bank_mask:0xf
    v_and_b32 v123, 0x7ff, v123
    v_add_u32 v251, v13, v123
    v_add_u32_dpp v132, v132, v132 row_bcast:15 row_mask:0xa bank_mask:0xf
    v_add_u32 v251, 3840, v251
    s_nop 0
    v_add_u32_dpp v132, v132, v132 row_bcast:31 row_mask:0xc bank_mask:0xf
    s_cmp_lg_u32 s55, 0
    s_cbranch_scc1 K_FB0
    v_readlane_b32 s46, v132, 63
    v_sub_u32 v240, v132, v131
    v_add_u32 v241, v240, v124
    v_add_u32 v242, v240, v129
    v_add_u32 v243, v240, v130
    v_sub_u32 v248, v248, v240
    v_add_u32 v244, v240, v124
    v_sub_u32 v249, v249, v241
    v_add_u32 v245, v241, v125
    v_sub_u32 v250, v250, v242
    v_add_u32 v246, v242, v126
    v_sub_u32 v251, v251, v243
    v_add_u32 v247, v243, v127
K_ROUND:
    s_mul_i32 s56, s3, 192
    s_add_u32 s56, s56, s47
    s_add_u32 s57, s56, 192
    s_lshl_b32 s58, s3, 10
    s_add_u32 s58, s58, 106752
    v_cmp_lt_u32 vcc, s56, v244
    v_cmp_gt_u32 s[60:61], s57, v240
    v_subrev_u32 v56, s56, v240
    v_max_i32 v56, 0, v56
    v_lshl_add_u32 v56, v56, 2, s58
    s_and_b64 exec, vcc, s[60:61]
    ds_max_u32 v56, v248
    s_mov_b64 exec, -1
    v_cmp_lt_u32 vcc, s56, v245
    v_cmp_gt_u32 s[60:61], s57, v241
    v_subrev_u32 v57, s56, v241
    v_max_i32 v57, 0, v57
    v_lshl_add_u32 v57, v57, 2, s58
    s_and_b64 exec, vcc, s[60:61]
    ds_max_u32 v57, v249
    s_mov_b64 exec, -1
    v_cmp_lt_u32 vcc, s56, v246
    v_cmp_gt_u32 s[60:61], s57, v242
    v_subrev_u32 v58, s56, v242
    v_max_i32 v58, 0, v58
    v_lshl_add_u32 v58, v58, 2, s58
    s_and_b64 exec, vcc, s[60:61]
    ds_max_u32 v58, v250
    s_mov_b64 exec, -1
    v_cmp_lt_u32 vcc, s56, v247
    v_cmp_gt_u32 s[60:61], s57, v243
    v_subrev_u32 v59, s56, v243
    v_max_i32 v59, 0, v59
    v_lshl_add_u32 v59, v59, 2, s58
    s_and_b64 exec, vcc, s[60:61]
    ds_max_u32 v59, v251
    s_mov_b64 exec, -1
    v_add_u32 v60, s58, v15
    ds_read_b32 v64, v60 offset:0
    ds_read_b32 v65, v60 offset:256
    ds_read_b32 v66, v60 offset:512
    v_add_u32 v68, s56, v1
    v_add_u32 v69, 64, v68
    v_add_u32 v70, 128, v68
    v_cmp_gt_u32 s[40:41], s46, v68
    v_cmp_gt_u32 s[42:43], s46, v69
    v_cmp_gt_u32 s[44:45], s46, v70
    s_mov_b32 s60, 532480
    s_mov_b32 s61, 3145728
    s_lshr_b32 s62, s26, 24
    s_waitcnt lgkmcnt(0)
    v_max_u32_dpp v64, v64, v64 row_shr:1 row_mask:0xf bank_mask:0xf
    v_max_u32_dpp v65, v65, v65 row_shr:1 row_mask:0xf bank_mask:0xf
    v_max_u32_dpp v66, v66, v66 row_shr:1 row_mask:0xf bank_mask:0xf
    v_max_u32_dpp v64, v64, v64 row_shr:2 row_mask:0xf bank_mask:0xf
    v_max_u32_dpp v65, v65, v65 row_shr:2 row_mask:0xf bank_mask:0xf
    v_max_u32_dpp v66, v66, v66 row_shr:2 row_mask:0xf bank_mask:0xf
    v_max_u32_dpp v64, v64, v64 row_shr:4 row_mask:0xf bank_mask:0xf
    v_max_u32_dpp v65, v65, v65 row_shr:4 row_mask:0xf bank_mask:0xf
    v_max_u32_dpp v66, v66, v66 row_shr:4 row_mask:0xf bank_mask:0xf
    v_max_u32_dpp v64, v64, v64 row_shr:8 row_mask:0xf bank_mask:0xf
    v_max_u32_dpp v65, v65, v65 row_shr:8 row_mask:0xf bank_mask:0xf
    v_max_u32_dpp v66, v66, v66 row_shr:8 row_mask:0xf bank_mask:0xf
    v_max_u32_dpp v64, v64, v64 row_bcast:15 row_mask:0xa bank_mask:0xf
    v_max_u32_dpp v65, v65, v65 row_bcast:15 row_mask:0xa bank_mask:0xf
    v_max_u32_dpp v66, v66, v66 row_bcast:15 row_mask:0xa bank_mask:0xf
    v_max_u32_dpp v64, v64, v64 row_bcast:31 row_mask:0xc bank_mask:0xf
    v_max_u32_dpp v65, v65, v65 row_bcast:31 row_mask:0xc bank_mask:0xf
    v_max_u32_dpp v66, v66, v66 row_bcast:31 row_mask:0xc bank_mask:0xf
    v_readlane_b32 s56, v64, 63
    v_readlane_b32 s57, v65, 63
    v_add_u32 v68, v68, v64
    s_max_u32 s57, s56, s57
    v_max_u32 v65, s56, v65
    v_max_u32 v66, s57, v66
    v_add_u32 v69, v69, v65
    v_add_u32 v70, v70, v66
    v_lshlrev_b32 v81, 3, v68
    v_lshlrev_b32 v82, 3, v69
    v_lshlrev_b32 v83, 3, v70
    s_mov_b64 exec, s[40:41]
    buffer_load_dwordx2 v[72:73], v81, s[36:39], s60 offen sc1
    s_mov_b64 exec, s[42:43]
    buffer_load_dwordx2 v[74:75], v82, s[36:39], s60 offen sc1
    s_mov_b64 exec, s[44:45]
    buffer_load_dwordx2 v[76:77], v83, s[36:39], s60 offen sc1
    s_mov_b64 exec, -1
    v_lshlrev_b32 v100, 4, v68
    v_lshlrev_b32 v101, 4, v69
    v_lshlrev_b32 v102, 4, v70
    s_cmp_lg_u32 s47, 0
    s_cbranch_scc1 K_KEYS1
    s_and_b32 s56, s3, 3
    s_lshl_b32 s56, s56, 6
    s_add_u32 s56, s56, 114944
    v_lshrrev_b32 v10, 4, v1
    v_lshlrev_b32 v10, 11, v10
    v_and_b32 v12, 15, v1
    v_lshl_or_b32 v10, v12, 2, v10
    v_add_u32 v10, s56, v10
    s_mov_b32 s56, 0x05040100
    s_mov_b32 s57, 0x07060302
    ds_read2st64_b32 v[120:121], v10 offset0:0 offset1:1
    ds_read2st64_b32 v[122:123], v10 offset0:2 offset1:3
    ds_read2st64_b32 v[124:125], v10 offset0:4 offset1:5
    ds_read2st64_b32 v[126:127], v10 offset0:6 offset1:7
    ds_read2st64_b32 v[128:129], v10 offset0:32 offset1:33
    ds_read2st64_b32 v[130:131], v10 offset0:34 offset1:35
    ds_read2st64_b32 v[132:133], v10 offset0:36 offset1:37
    ds_read2st64_b32 v[134:135], v10 offset0:38 offset1:39
    ds_read2st64_b32 v[136:137], v10 offset0:64 offset1:65
    ds_read2st64_b32 v[138:139], v10 offset0:66 offset1:67
    ds_read2st64_b32 v[140:141], v10 offset0:68 offset1:69
    ds_read2st64_b32 v[142:143], v10 offset0:70 offset1:71
    ds_read2st64_b32 v[144:145], v10 offset0:96 offset1:97
    ds_read2st64_b32 v[146:147], v10 offset0:98 offset1:99
    ds_read2st64_b32 v[148:149], v10 offset0:100 offset1:101
    ds_read2st64_b32 v[150:151], v10 offset0:102 offset1:103
    s_waitcnt lgkmcnt(15)
    v_perm_b32 v200, v121, v120, s56
    v_perm_b32 v216, v121, v120, s57
    s_waitcnt lgkmcnt(14)
    v_perm_b32 v201, v123, v122, s56
    v_perm_b32 v217, v123, v122, s57
    s_waitcnt lgkmcnt(13)
    v_perm_b32 v202, v125, v124, s56
    v_perm_b32 v218, v125, v124, s57
    s_waitcnt lgkmcnt(12)
    v_perm_b32 v203, v127, v126, s56
    v_perm_b32 v219, v127, v126, s57
    s_waitcnt lgkmcnt(11)
    v_perm_b32 v204, v129, v128, s56
    v_perm_b32 v220, v129, v128, s57
    s_waitcnt lgkmcnt(10)
    v_perm_b32 v205, v131, v130, s56
    v_perm_b32 v221, v131, v130, s57
    s_waitcnt lgkmcnt(9)
    v_perm_b32 v206, v133, v132, s56
    v_perm_b32 v222, v133, v132, s57
    s_waitcnt lgkmcnt(8)
    v_perm_b32 v207, v135, v134, s56
    v_perm_b32 v223, v135, v134, s57
    s_waitcnt lgkmcnt(7)
    v_perm_b32 v208, v137, v136, s56
    v_perm_b32 v224, v137, v136, s57
    s_waitcnt lgkmcnt(6)
    v_perm_b32 v209, v139, v138, s56
    v_perm_b32 v225, v139, v138, s57
    s_waitcnt lgkmcnt(5)
    v_perm_b32 v210, v141, v140, s56
    v_perm_b32 v226, v141, v140, s57
    s_waitcnt lgkmcnt(4)
    v_perm_b32 v211, v143, v142, s56
    v_perm_b32 v227, v143, v142, s57
    s_waitcnt lgkmcnt(3)
    v_perm_b32 v212, v145, v144, s56
    v_perm_b32 v228, v145, v144, s57
    s_waitcnt lgkmcnt(2)
    v_perm_b32 v213, v147, v146, s56
    v_perm_b32 v229, v147, v146, s57
    s_waitcnt lgkmcnt(1)
    v_perm_b32 v214, v149, v148, s56
    v_perm_b32 v230, v149, v148, s57
    s_waitcnt lgkmcnt(0)
    v_perm_b32 v215, v151, v150, s56
    v_perm_b32 v231, v151, v150, s57
    s_branch K_KEYS1
K_KEYS:
    s_mov_b64 exec, s[40:41]
    buffer_load_dwordx2 v[72:73], v81, s[36:39], s60 offen sc1
    s_mov_b64 exec, s[42:43]
    buffer_load_dwordx2 v[74:75], v82, s[36:39], s60 offen sc1
    s_mov_b64 exec, s[44:45]
    buffer_load_dwordx2 v[76:77], v83, s[36:39], s60 offen sc1
    s_mov_b64 exec, -1
K_KEYS1:
    v_mov_b32 v14, 64
    s_mov_b64 s[58:59], 0
    s_waitcnt vmcnt(2)
    v_lshrrev_b32 v78, 24, v72
    v_cmp_ne_u32 vcc, s52, v73
    v_cmp_ne_u32 s[56:57], s62, v78
    s_or_b64 vcc, vcc, s[56:57]
    s_and_b64 vcc, vcc, s[40:41]
    s_or_b64 s[58:59], s[58:59], vcc
    s_waitcnt vmcnt(1)
    v_lshrrev_b32 v79, 24, v74
    v_cmp_ne_u32 vcc, s52, v75
    v_cmp_ne_u32 s[56:57], s62, v79
    s_or_b64 vcc, vcc, s[56:57]
    s_and_b64 vcc, vcc, s[42:43]
    s_or_b64 s[58:59], s[58:59], vcc
    s_waitcnt vmcnt(0)
    v_lshrrev_b32 v80, 24, v76
    v_cmp_ne_u32 vcc, s52, v77
    v_cmp_ne_u32 s[56:57], s62, v80
    s_or_b64 vcc, vcc, s[56:57]
    s_and_b64 vcc, vcc, s[44:45]
    s_or_b64 s[58:59], s[58:59], vcc
    s_cbranch_scc1 K_KEYS
    s_cmp_lg_u32 s47, 0
    s_cbranch_scc1 K_LATER
    s_mov_b32 s62, 8323072
    s_cmp_lt_u32 s3, 4
    s_cbranch_scc0 K_GOT
    buffer_load_dword v184, v185, s[36:39], s62 offen sc1
K_GOT:
    v_lshrrev_b32 v81, 2, v72
    v_and_b32 v81, 0xfc, v81
    v_lshrrev_b32 v82, 2, v74
    v_and_b32 v82, 0xfc, v82
    v_lshrrev_b32 v83, 2, v76
    v_and_b32 v83, 0xfc, v83
    s_mov_b64 exec, s[40:41]
    ds_add_u32 v81, v14 offset:512
    s_mov_b64 exec, s[42:43]
    ds_add_u32 v82, v14 offset:512
    s_mov_b64 exec, s[44:45]
    ds_add_u32 v83, v14 offset:512
    s_mov_b64 exec, -1
    s_lshr_b32 s56, s3, 2
    s_or_b32 s56, s56, s55
    s_cbranch_scc1 K_POLLBOK
K_POLLB:
    s_waitcnt vmcnt(0)
    v_cmp_ne_u32 vcc, s52, v184
    s_cbranch_vccz K_POLLBOK
    buffer_load_dword v184, v185, s[36:39], s62 offen sc1
    s_branch K_POLLB
K_POLLBOK:
    s_waitcnt lgkmcnt(0)
    s_barrier
    s_cmp_lg_u32 s55, 0
    s_cbranch_scc1 K_NOPF
    s_mov_b64 exec, s[40:41]
    buffer_load_dwordx4 v[88:91], v100, s[36:39], s61 offen sc1
    s_mov_b64 exec, s[42:43]
    buffer_load_dwordx4 v[92:95], v101, s[36:39], s61 offen sc1
    s_mov_b64 exec, s[44:45]
    buffer_load_dwordx4 v[96:99], v102, s[36:39], s61 offen sc1
    s_mov_b64 exec, -1
    s_cmp_lt_u32 s3, 5
    s_cbranch_scc1 K_NOPF
    s_mov_b32 s64, s4
    s_mov_b32 s65, s5
    s_mov_b32 s66, 10240000
    s_mov_b32 s67, 0x20000
    s_sub_u32 s68, 7, s3
    s_lshl_b32 s68, s68, 5
    s_and_b32 s69, s53, 31
    s_add_u32 s68, s68, s69
    s_lshl_b32 s68, s68, 13
    s_add_u32 s68, s68, s27
    v_lshlrev_b32 v10, 7, v1
    buffer_load_dword v255, v10, s[64:67], s68 offen
K_NOPF:
    ds_read_b32 v168, v15 offset:512
    ds_read_b128 v[120:123], v4 offset:512
    ds_read_b128 v[124:127], v4 offset:528
    ds_read_b128 v[128:131], v4 offset:544
    ds_read_b128 v[132:135], v4 offset:560
    ds_read_b128 v[136:139], v4 offset:576
    ds_read_b128 v[140:143], v4 offset:592
    ds_read_b128 v[144:147], v4 offset:608
    ds_read_b128 v[148:151], v4 offset:624
    ds_read_b128 v[152:155], v4 offset:640
    ds_read_b128 v[156:159], v4 offset:656
    v_cmp_gt_u32 vcc, 40, v1
    s_waitcnt lgkmcnt(9)
    v_pk_add_f32 v[120:121], v[120:121], v[168:169] op_sel_hi:[1,0] neg_lo:[0,1] neg_hi:[0,1] clamp
    v_pk_add_f32 v[122:123], v[122:123], v[168:169] op_sel_hi:[1,0] neg_lo:[0,1] neg_hi:[0,1] clamp
    s_waitcnt lgkmcnt(8)
    v_pk_add_f32 v[124:125], v[124:125], v[168:169] op_sel_hi:[1,0] neg_lo:[0,1] neg_hi:[0,1] clamp
    v_pk_add_f32 v[124:125], v[124:125], v[120:121]
    v_pk_add_f32 v[126:127], v[126:127], v[168:169] op_sel_hi:[1,0] neg_lo:[0,1] neg_hi:[0,1] clamp
    v_pk_add_f32 v[126:127], v[126:127], v[122:123]
    s_waitcnt lgkmcnt(7)
    v_pk_add_f32 v[128:129], v[128:129], v[168:169] op_sel_hi:[1,0] neg_lo:[0,1] neg_hi:[0,1] clamp
    v_pk_add_f32 v[128:129], v[128:129], v[124:125]
    v_pk_add_f32 v[130:131], v[130:131], v[168:169] op_sel_hi:[1,0] neg_lo:[0,1] neg_hi:[0,1] clamp
    v_pk_add_f32 v[130:131], v[130:131], v[126:127]
    s_waitcnt lgkmcnt(6)
    v_pk_add_f32 v[132:133], v[132:133], v[168:169] op_sel_hi:[1,0] neg_lo:[0,1] neg_hi:[0,1] clamp
    v_pk_add_f32 v[132:133], v[132:133], v[128:129]
    v_pk_add_f32 v[134:135], v[134:135], v[168:169] op_sel_hi:[1,0] neg_lo:[0,1] neg_hi:[0,1] clamp
    v_pk_add_f32 v[134:135], v[134:135], v[130:131]
    s_waitcnt lgkmcnt(5)
    v_pk_add_f32 v[136:137], v[136:137], v[168:169] op_sel_hi:[1,0] neg_lo:[0,1] neg_hi:[0,1] clamp
    v_pk_add_f32 v[136:137], v[136:137], v[132:133]
    v_pk_add_f32 v[138:139], v[138:139], v[168:169] op_sel_hi:[1,0] neg_lo:[0,1] neg_hi:[0,1] clamp
    v_pk_add_f32 v[138:139], v[138:139], v[134:135]
    s_waitcnt lgkmcnt(4)
    v_pk_add_f32 v[140:141], v[140:141], v[168:169] op_sel_hi:[1,0] neg_lo:[0,1] neg_hi:[0,1] clamp
    v_pk_add_f32 v[140:141], v[140:141], v[136:137]
    v_pk_add_f32 v[142:143], v[142:143], v[168:169] op_sel_hi:[1,0] neg_lo:[0,1] neg_hi:[0,1] clamp
    v_pk_add_f32 v[142:143], v[142:143], v[138:139]
    s_waitcnt lgkmcnt(3)
    v_pk_add_f32 v[144:145], v[144:145], v[168:169] op_sel_hi:[1,0] neg_lo:[0,1] neg_hi:[0,1] clamp
    v_pk_add_f32 v[144:145], v[144:145], v[140:141]
    v_pk_add_f32 v[146:147], v[146:147], v[168:169] op_sel_hi:[1,0] neg_lo:[0,1] neg_hi:[0,1] clamp
    v_pk_add_f32 v[146:147], v[146:147], v[142:143]
    s_waitcnt lgkmcnt(2)
    v_pk_add_f32 v[148:149], v[148:149], v[168:169] op_sel_hi:[1,0] neg_lo:[0,1] neg_hi:[0,1] clamp
    v_pk_add_f32 v[148:149], v[148:149], v[144:145]
    v_pk_add_f32 v[150:151], v[150:151], v[168:169] op_sel_hi:[1,0] neg_lo:[0,1] neg_hi:[0,1] clamp
    v_pk_add_f32 v[150:151], v[150:151], v[146:147]
    s_waitcnt lgkmcnt(1)
    v_pk_add_f32 v[152:153], v[152:153], v[168:169] op_sel_hi:[1,0] neg_lo:[0,1] neg_hi:[0,1] clamp
    v_pk_add_f32 v[152:153], v[152:153], v[148:149]
    v_pk_add_f32 v[154:155], v[154:155], v[168:169] op_sel_hi:[1,0] neg_lo:[0,1] neg_hi:[0,1] clamp
    v_pk_add_f32 v[154:155], v[154:155], v[150:151]
    s_waitcnt lgkmcnt(0)
    v_pk_add_f32 v[156:157], v[156:157], v[168:169] op_sel_hi:[1,0] neg_lo:[0,1] neg_hi:[0,1] clamp
    v_pk_add_f32 v[156:157], v[156:157], v[152:153]
    v_pk_add_f32 v[158:159], v[158:159], v[168:169] op_sel_hi:[1,0] neg_lo:[0,1] neg_hi:[0,1] clamp
    v_pk_add_f32 v[158:159], v[158:159], v[154:155]
    v_pk_add_f32 v[158:159], v[158:159], v[156:157]
    v_add_f32 v158, v158, v159
    v_cvt_u32_f32 v158, v158
    v_lshlrev_b32 v158, 2, v158
    ds_bpermute_b32 v2, v158, v2
    s_waitcnt lgkmcnt(0)
    v_cndmask_b32 v2, -1, v2, vcc
K_BAL:
    ds_bpermute_b32 v84, v81, v2
    ds_bpermute_b32 v85, v82, v2
    ds_bpermute_b32 v86, v83, v2
    v_mov_b32 v14, 1
    v_lshlrev_b32 v10, 3, v1
    s_lshr_b32 s56, s53, 4
    s_and_b32 s56, s56, 14
    v_subrev_u32 v103, s56, v72
    v_and_b32 v103, 15, v103
    v_subrev_u32 v104, s56, v74
    v_and_b32 v104, 15, v104
    v_subrev_u32 v105, s56, v76
    v_and_b32 v105, 15, v105
    s_waitcnt lgkmcnt(2)
    s_mov_b64 exec, s[40:41]
    v_and_b32 v81, 7, v84
    v_lshl_or_b32 v103, v81, 4, v103
    v_lshlrev_b32 v81, 2, v103
    ds_add_rtn_u32 v78, v81, v14 offset:0
    s_waitcnt lgkmcnt(2)
    s_mov_b64 exec, s[42:43]
    v_and_b32 v82, 7, v85
    v_lshl_or_b32 v104, v82, 4, v104
    v_lshlrev_b32 v82, 2, v104
    ds_add_rtn_u32 v79, v82, v14 offset:0
    s_waitcnt lgkmcnt(2)
    s_mov_b64 exec, s[44:45]
    v_and_b32 v83, 7, v86
    v_lshl_or_b32 v105, v83, 4, v105
    v_lshlrev_b32 v83, 2, v105
    ds_add_rtn_u32 v80, v83, v14 offset:0
    s_mov_b64 exec, -1
    v_lshlrev_b32 v81, 1, v103
    v_lshlrev_b32 v103, 4, v103
    v_and_b32 v84, 0x38, v84
    v_and_b32 v72, 16776192, v72
    v_lshlrev_b32 v82, 1, v104
    v_lshlrev_b32 v104, 4, v104
    v_and_b32 v85, 0x38, v85
    v_and_b32 v74, 16776192, v74
    v_lshlrev_b32 v83, 1, v105
    v_lshlrev_b32 v105, 4, v105
    v_and_b32 v86, 0x38, v86
    v_and_b32 v76, 16776192, v76
    s_lshl_b32 s56, s3, 3
    s_add_u32 s57, s56, 7
    v_lshrrev_b32 v114, 3, v1
    v_mul_u32_u24 v114, 48, v114
    s_waitcnt lgkmcnt(0)
    s_barrier
    ds_read_b64 v[108:109], v10 offset:0
    s_sub_u32 s58, s27, 1024
    s_cselect_b32 s58, 10238976, s58
    s_waitcnt lgkmcnt(0)
    v_add_u32 v110, v108, v109
    v_mov_b32 v111, v110
    v_and_b32 v12, 15, v1
    v_lshrrev_b32 v11, 4, v1
    v_add_u32_dpp v111, v111, v111 row_shr:1 row_mask:0xf bank_mask:0xf
    v_lshlrev_b32 v11, 3, v11
    v_lshl_add_u32 v11, v12, 5, v11
    v_add_u32_dpp v111, v111, v111 row_shr:2 row_mask:0xf bank_mask:0xf
    v_mov_b32 v115, s58
    v_mov_b32 v254, 0
    v_add_u32_dpp v111, v111, v111 row_shr:4 row_mask:0xf bank_mask:0xf
    s_nop 1
    v_add_u32_dpp v111, v111, v111 row_shr:8 row_mask:0xf bank_mask:0xf
    s_nop 1
    v_add_u32_dpp v111, v111, v111 row_bcast:15 row_mask:0xa bank_mask:0xf
    s_nop 1
    v_add_u32_dpp v111, v111, v111 row_bcast:31 row_mask:0xc bank_mask:0xf
    v_sub_u32 v110, v111, v110
    v_readlane_b32 s51, v111, s57
    s_nop 0
    v_mov_b32_dpp v112, v110 row_newbcast:0 row_mask:0xf bank_mask:0x3
    v_readlane_b32 s58, v110, s56
    s_nop 0
    v_mov_b32_dpp v112, v110 row_newbcast:8 row_mask:0xf bank_mask:0xc
    v_add_u32 v113, 15, v112
    v_and_b32 v113, -16, v113
    v_add_u32 v113, v113, v114
    v_sub_u32 v112, v113, v112
    v_add_u32 v112, v112, v110
    v_add_u32 v108, v112, v108
    v_lshl_or_b32 v108, v108, 16, v112
    v_readlane_b32 s50, v113, s56
    ds_bpermute_b32 v81, v81, v108
    ds_bpermute_b32 v82, v82, v108
    ds_bpermute_b32 v83, v83, v108
    s_sub_u32 s51, s51, s58
    s_add_u32 s56, s50, s51
    v_add_u32 v109, s56, v1
    v_lshlrev_b32 v110, 2, v109
    v_lshlrev_b32 v111, 4, v109
    s_mov_b64 exec, 0xfffff
    ds_write_b32 v110, v115 offset:4096
    ds_write_b8 v109, v4 offset:11840
    ds_write_b128 v111, v[4:7] offset:13824
    s_mov_b64 exec, s[40:41]
    s_waitcnt lgkmcnt(5)
    v_bfe_u32 v81, v81, v103, 16
    v_add_u32 v81, v81, v78
    v_lshlrev_b32 v78, 2, v81
    v_lshlrev_b32 v103, 4, v81
    ds_write_b32 v78, v72 offset:4096
    ds_write_b8 v81, v84 offset:11840
    s_mov_b64 exec, s[42:43]
    s_waitcnt lgkmcnt(6)
    v_bfe_u32 v82, v82, v104, 16
    v_add_u32 v82, v82, v79
    v_lshlrev_b32 v79, 2, v82
    v_lshlrev_b32 v104, 4, v82
    ds_write_b32 v79, v74 offset:4096
    ds_write_b8 v82, v85 offset:11840
    s_mov_b64 exec, s[44:45]
    s_waitcnt lgkmcnt(7)
    v_bfe_u32 v83, v83, v105, 16
    v_add_u32 v83, v83, v80
    v_lshlrev_b32 v80, 2, v83
    v_lshlrev_b32 v105, 4, v83
    ds_write_b32 v80, v76 offset:4096
    ds_write_b8 v83, v86 offset:11840
    s_cmp_lt_u32 s3, 5
    s_cselect_b32 s56, 1, s47
    s_or_b32 s56, s56, s55
    s_cbranch_scc0 K_PW1
    s_waitcnt vmcnt(0)
K_PW1:
    s_waitcnt vmcnt(1)
    s_mov_b64 exec, s[40:41]
    ds_write_b128 v103, v[88:91] offset:13824
    s_mov_b64 exec, s[42:43]
    ds_write_b128 v104, v[92:95] offset:13824
    s_mov_b64 exec, s[44:45]
    ds_write_b128 v105, v[96:99] offset:13824
    s_mov_b64 exec, -1
    s_lshl_b32 s56, s50, 2
    s_add_u32 s56, s56, 4096
    v_mov_b32 v196, s56
    s_add_u32 s56, s50, 11840
    v_mov_b32 v197, s56
    s_lshl_b32 s56, s50, 5
    s_add_u32 s56, s56, 44800
    v_add_u32 v198, s56, v10
    v_add_u32 v11, s56, v11
    s_lshl_b32 s57, s50, 4
    s_add_u32 s57, s57, 13824
    v_lshl_add_u32 v199, v12, 4, s57
    v_add_u32 v10, s57, v9
    s_add_u32 s48, s51, 3
    s_lshr_b32 s48, s48, 2
    s_waitcnt lgkmcnt(0)
    s_barrier
    s_cmp_eq_u32 s48, 0
    s_cbranch_scc1 K2_LOOPDONE
    ds_read_b128 v[120:123], v196 offset:0
    ds_read_b128 v[124:127], v196 offset:16
    ds_read_b64 v[152:153], v10
    ds_read_b128 v[188:191], v196 offset:32
    ds_read_b64 v[186:187], v199 offset:8
    ds_read_b128 v[192:195], v197
    s_lshl_b32 s56, s48, 2
    s_waitcnt lgkmcnt(5)
    buffer_load_dwordx4 v[56:59], v120, s[28:31], 0 offen
    buffer_load_dwordx4 v[60:63], v121, s[28:31], 0 offen
    buffer_load_dwordx4 v[64:67], v122, s[28:31], 0 offen
    buffer_load_dwordx4 v[68:71], v123, s[28:31], 0 offen
    s_waitcnt lgkmcnt(4)
    buffer_load_dwordx4 v[72:75], v124, s[28:31], 0 offen
    buffer_load_dwordx4 v[76:79], v125, s[28:31], 0 offen
    buffer_load_dwordx4 v[80:83], v126, s[28:31], 0 offen
    buffer_load_dwordx4 v[84:87], v127, s[28:31], 0 offen
K_APREP:
    v_cmp_gt_u32 vcc, s56, v1
    s_waitcnt lgkmcnt(0)
    s_nop 0
    v_cndmask_b32 v160, 0, v152, vcc
    v_cndmask_b32 v161, 0, v153, vcc
    ds_read_b64 v[152:153], v10 offset:1024
    v_add_u32 v10, 1024, v10
    v_mfma_f32_16x16x16_bf16 v[136:139], v[232:233], v[160:161], 0
    v_mfma_f32_16x16x16_bf16 v[140:143], v[234:235], v[160:161], 0
    v_mfma_f32_16x16x16_bf16 v[144:147], v[236:237], v[160:161], 0
    v_mfma_f32_16x16x16_bf16 v[148:151], v[238:239], v[160:161], 0
    s_nop 4
    v_cvt_pk_bf16_f32 v168, v136, v137
    v_cvt_pk_bf16_f32 v169, v138, v139
    ds_write_b64 v11, v[168:169] offset:0
    s_sub_u32 s56, s56, 16
    s_cmp_le_i32 s56, 0
    s_cbranch_scc1 K_APDONE
    v_cvt_pk_bf16_f32 v170, v140, v141
    v_cvt_pk_bf16_f32 v171, v142, v143
    ds_write_b64 v11, v[170:171] offset:512
    s_sub_u32 s56, s56, 16
    s_cmp_le_i32 s56, 0
    s_cbranch_scc1 K_APDONE
    v_cvt_pk_bf16_f32 v172, v144, v145
    v_cvt_pk_bf16_f32 v173, v146, v147
    ds_write_b64 v11, v[172:173] offset:1024
    s_sub_u32 s56, s56, 16
    s_cmp_le_i32 s56, 0
    s_cbranch_scc1 K_APDONE
    v_cvt_pk_bf16_f32 v174, v148, v149
    v_cvt_pk_bf16_f32 v175, v150, v151
    ds_write_b64 v11, v[174:175] offset:1536
    s_sub_u32 s56, s56, 16
    s_cmp_le_i32 s56, 0
    s_cbranch_scc1 K_APDONE
    v_add_u32 v11, 2048, v11
    s_branch K_APREP
K_APDONE:
    s_waitcnt lgkmcnt(0)
    ds_read_b64 v[184:185], v198
    v_mfma_f32_4x4x4_16b_bf16 v[152:155], v[186:187], v[176:177], 0 cbsz:4 abid:0
    v_mfma_f32_4x4x4_16b_bf16 v[156:159], v[186:187], v[180:181], 0 cbsz:4 abid:0
    s_nop 0
    v_mfma_f32_4x4x4_16b_bf16 v[152:155], v[186:187], v[178:179], v[152:155] cbsz:4 abid:0
    v_mfma_f32_4x4x4_16b_bf16 v[156:159], v[186:187], v[182:183], v[156:159] cbsz:4 abid:0
    s_sub_u32 s48, s48, 1
    s_nop 3
.p2align 4
K2_LOOP:
    s_waitcnt vmcnt(6) lgkmcnt(0)
    v_subrev_u32 v255, s27, v188
    v_cmp_gt_u32 vcc, v255, v254
    ds_write_b32 v252, v255 offset:2048
    s_setprio 0
    s_cbranch_vccnz K2_P0
    s_setprio 1
K2_P0:
    v_mfma_f32_4x4x4_16b_bf16 v[120:123], v[184:185], v[56:57], 0 cbsz:4 abid:0
    v_exp_f32 v168, v152
    v_mfma_f32_4x4x4_16b_bf16 v[124:127], v[184:185], v[58:59], 0 cbsz:4 abid:0
    v_exp_f32 v169, v153
    v_mfma_f32_4x4x4_16b_bf16 v[128:131], v[184:185], v[60:61], 0 cbsz:4 abid:1
    v_exp_f32 v170, v154
    v_mfma_f32_4x4x4_16b_bf16 v[132:135], v[184:185], v[62:63], 0 cbsz:4 abid:1
    buffer_load_dwordx4 v[88:91], v188, s[28:31], 0 offen
    buffer_load_dwordx4 v[92:95], v189, s[28:31], 0 offen
    v_exp_f32 v171, v155
    s_waitcnt vmcnt(6)
    v_mfma_f32_4x4x4_16b_bf16 v[136:139], v[184:185], v[64:65], 0 cbsz:4 abid:2
    v_exp_f32 v172, v156
    v_mfma_f32_4x4x4_16b_bf16 v[140:143], v[184:185], v[66:67], 0 cbsz:4 abid:2
    v_exp_f32 v173, v157
    v_exp_f32 v174, v158
    v_exp_f32 v175, v159
    v_pk_add_f32 v[168:169], v[168:169], 1.0 op_sel_hi:[1,0]
    v_pk_add_f32 v[170:171], v[170:171], 1.0 op_sel_hi:[1,0]
    v_pk_add_f32 v[172:173], v[172:173], 1.0 op_sel_hi:[1,0]
    v_pk_add_f32 v[174:175], v[174:175], 1.0 op_sel_hi:[1,0]
    v_mfma_f32_4x4x4_16b_bf16 v[144:147], v[184:185], v[68:69], 0 cbsz:4 abid:3
    v_rcp_f32 v168, v168
    v_mfma_f32_4x4x4_16b_bf16 v[148:151], v[184:185], v[70:71], 0 cbsz:4 abid:3
    buffer_load_dwordx4 v[96:99], v190, s[28:31], 0 offen
    buffer_load_dwordx4 v[100:103], v191, s[28:31], 0 offen
    v_rcp_f32 v169, v169
    ds_read_b128 v[188:191], v196 offset:48
    v_mfma_f32_4x4x4_16b_bf16 v[160:163], v[186:187], v[176:177], 0 cbsz:4 abid:1
    v_rcp_f32 v170, v170
    v_mfma_f32_4x4x4_16b_bf16 v[164:167], v[186:187], v[180:181], 0 cbsz:4 abid:1
    v_rcp_f32 v171, v171
    v_mfma_f32_4x4x4_16b_bf16 v[160:163], v[186:187], v[178:179], v[160:163] cbsz:4 abid:1
    v_rcp_f32 v172, v172
    v_mfma_f32_4x4x4_16b_bf16 v[164:167], v[186:187], v[182:183], v[164:167] cbsz:4 abid:1
    v_rcp_f32 v173, v173
    v_rcp_f32 v174, v174
    v_rcp_f32 v175, v175
    v_readfirstlane_b32 s49, v192
    v_pk_mul_f32 v[168:169], v[168:169], v[152:153]
    v_pk_mul_f32 v[170:171], v[170:171], v[154:155]
    v_pk_mul_f32 v[172:173], v[172:173], v[156:157]
    v_pk_mul_f32 v[174:175], v[174:175], v[158:159]
    s_set_gpr_idx_on s49, gpr_idx(SRC2,DST)
    v_pk_fma_f32 v[16:17], v[168:169], v[120:121], v[16:17] op_sel:[0,0,0] op_sel_hi:[0,1,1]
    v_pk_fma_f32 v[18:19], v[168:169], v[122:123], v[18:19] op_sel:[0,0,0] op_sel_hi:[0,1,1]
    v_pk_fma_f32 v[20:21], v[172:173], v[124:125], v[20:21] op_sel:[0,0,0] op_sel_hi:[0,1,1]
    v_pk_fma_f32 v[22:23], v[172:173], v[126:127], v[22:23] op_sel:[0,0,0] op_sel_hi:[0,1,1]
    s_lshr_b32 s49, s49, 8
    s_set_gpr_idx_idx s49
    v_pk_fma_f32 v[16:17], v[168:169], v[128:129], v[16:17] op_sel:[1,0,0] op_sel_hi:[1,1,1]
    v_pk_fma_f32 v[18:19], v[168:169], v[130:131], v[18:19] op_sel:[1,0,0] op_sel_hi:[1,1,1]
    v_pk_fma_f32 v[20:21], v[172:173], v[132:133], v[20:21] op_sel:[1,0,0] op_sel_hi:[1,1,1]
    v_pk_fma_f32 v[22:23], v[172:173], v[134:135], v[22:23] op_sel:[1,0,0] op_sel_hi:[1,1,1]
    s_lshr_b32 s49, s49, 8
    s_set_gpr_idx_idx s49
    v_pk_fma_f32 v[16:17], v[170:171], v[136:137], v[16:17] op_sel:[0,0,0] op_sel_hi:[0,1,1]
    v_pk_fma_f32 v[18:19], v[170:171], v[138:139], v[18:19] op_sel:[0,0,0] op_sel_hi:[0,1,1]
    v_pk_fma_f32 v[20:21], v[174:175], v[140:141], v[20:21] op_sel:[0,0,0] op_sel_hi:[0,1,1]
    v_pk_fma_f32 v[22:23], v[174:175], v[142:143], v[22:23] op_sel:[0,0,0] op_sel_hi:[0,1,1]
    s_lshr_b32 s49, s49, 8
    s_set_gpr_idx_idx s49
    v_pk_fma_f32 v[16:17], v[170:171], v[144:145], v[16:17] op_sel:[1,0,0] op_sel_hi:[1,1,1]
    v_pk_fma_f32 v[18:19], v[170:171], v[146:147], v[18:19] op_sel:[1,0,0] op_sel_hi:[1,1,1]
    v_pk_fma_f32 v[20:21], v[174:175], v[148:149], v[20:21] op_sel:[1,0,0] op_sel_hi:[1,1,1]
    v_pk_fma_f32 v[22:23], v[174:175], v[150:151], v[22:23] op_sel:[1,0,0] op_sel_hi:[1,1,1]
    s_set_gpr_idx_off
    s_sub_u32 s48, s48, 1
    s_cbranch_scc1 K2_LOOPDONE
    s_waitcnt vmcnt(6) lgkmcnt(0)
    v_mfma_f32_4x4x4_16b_bf16 v[120:123], v[184:185], v[72:73], 0 cbsz:4 abid:4
    v_exp_f32 v168, v160
    v_mfma_f32_4x4x4_16b_bf16 v[124:127], v[184:185], v[74:75], 0 cbsz:4 abid:4
    v_exp_f32 v169, v161
    v_mfma_f32_4x4x4_16b_bf16 v[128:131], v[184:185], v[76:77], 0 cbsz:4 abid:5
    v_exp_f32 v170, v162
    v_mfma_f32_4x4x4_16b_bf16 v[132:135], v[184:185], v[78:79], 0 cbsz:4 abid:5
    buffer_load_dwordx4 v[104:107], v188, s[28:31], 0 offen
    buffer_load_dwordx4 v[108:111], v189, s[28:31], 0 offen
    v_exp_f32 v171, v163
    s_waitcnt vmcnt(6)
    v_mfma_f32_4x4x4_16b_bf16 v[136:139], v[184:185], v[80:81], 0 cbsz:4 abid:6
    v_exp_f32 v172, v164
    v_mfma_f32_4x4x4_16b_bf16 v[140:143], v[184:185], v[82:83], 0 cbsz:4 abid:6
    v_exp_f32 v173, v165
    v_exp_f32 v174, v166
    v_exp_f32 v175, v167
    v_pk_add_f32 v[168:169], v[168:169], 1.0 op_sel_hi:[1,0]
    v_pk_add_f32 v[170:171], v[170:171], 1.0 op_sel_hi:[1,0]
    v_pk_add_f32 v[172:173], v[172:173], 1.0 op_sel_hi:[1,0]
    v_pk_add_f32 v[174:175], v[174:175], 1.0 op_sel_hi:[1,0]
    v_mfma_f32_4x4x4_16b_bf16 v[144:147], v[184:185], v[84:85], 0 cbsz:4 abid:7
    v_rcp_f32 v168, v168
    v_mfma_f32_4x4x4_16b_bf16 v[148:151], v[184:185], v[86:87], 0 cbsz:4 abid:7
    buffer_load_dwordx4 v[112:115], v190, s[28:31], 0 offen
    buffer_load_dwordx4 v[116:119], v191, s[28:31], 0 offen
    v_rcp_f32 v169, v169
    ds_read_b128 v[188:191], v196 offset:64
    ds_read_b32 v254, v253 offset:2048
    v_mfma_f32_4x4x4_16b_bf16 v[152:155], v[186:187], v[176:177], 0 cbsz:4 abid:2
    v_rcp_f32 v170, v170
    v_mfma_f32_4x4x4_16b_bf16 v[156:159], v[186:187], v[180:181], 0 cbsz:4 abid:2
    v_rcp_f32 v171, v171
    v_mfma_f32_4x4x4_16b_bf16 v[152:155], v[186:187], v[178:179], v[152:155] cbsz:4 abid:2
    v_rcp_f32 v172, v172
    v_mfma_f32_4x4x4_16b_bf16 v[156:159], v[186:187], v[182:183], v[156:159] cbsz:4 abid:2
    v_rcp_f32 v173, v173
    v_rcp_f32 v174, v174
    v_rcp_f32 v175, v175
    v_readfirstlane_b32 s49, v193
    v_pk_mul_f32 v[168:169], v[168:169], v[160:161]
    v_pk_mul_f32 v[170:171], v[170:171], v[162:163]
    v_pk_mul_f32 v[172:173], v[172:173], v[164:165]
    v_pk_mul_f32 v[174:175], v[174:175], v[166:167]
    s_set_gpr_idx_on s49, gpr_idx(SRC2,DST)
    v_pk_fma_f32 v[16:17], v[168:169], v[120:121], v[16:17] op_sel:[0,0,0] op_sel_hi:[0,1,1]
    v_pk_fma_f32 v[18:19], v[168:169], v[122:123], v[18:19] op_sel:[0,0,0] op_sel_hi:[0,1,1]
    v_pk_fma_f32 v[20:21], v[172:173], v[124:125], v[20:21] op_sel:[0,0,0] op_sel_hi:[0,1,1]
    v_pk_fma_f32 v[22:23], v[172:173], v[126:127], v[22:23] op_sel:[0,0,0] op_sel_hi:[0,1,1]
    s_lshr_b32 s49, s49, 8
    s_set_gpr_idx_idx s49
    v_pk_fma_f32 v[16:17], v[168:169], v[128:129], v[16:17] op_sel:[1,0,0] op_sel_hi:[1,1,1]
    v_pk_fma_f32 v[18:19], v[168:169], v[130:131], v[18:19] op_sel:[1,0,0] op_sel_hi:[1,1,1]
    v_pk_fma_f32 v[20:21], v[172:173], v[132:133], v[20:21] op_sel:[1,0,0] op_sel_hi:[1,1,1]
    v_pk_fma_f32 v[22:23], v[172:173], v[134:135], v[22:23] op_sel:[1,0,0] op_sel_hi:[1,1,1]
    s_lshr_b32 s49, s49, 8
    s_set_gpr_idx_idx s49
    v_pk_fma_f32 v[16:17], v[170:171], v[136:137], v[16:17] op_sel:[0,0,0] op_sel_hi:[0,1,1]
    v_pk_fma_f32 v[18:19], v[170:171], v[138:139], v[18:19] op_sel:[0,0,0] op_sel_hi:[0,1,1]
    v_pk_fma_f32 v[20:21], v[174:175], v[140:141], v[20:21] op_sel:[0,0,0] op_sel_hi:[0,1,1]
    v_pk_fma_f32 v[22:23], v[174:175], v[142:143], v[22:23] op_sel:[0,0,0] op_sel_hi:[0,1,1]
    s_lshr_b32 s49, s49, 8
    s_set_gpr_idx_idx s49
    v_pk_fma_f32 v[16:17], v[170:171], v[144:145], v[16:17] op_sel:[1,0,0] op_sel_hi:[1,1,1]
    v_pk_fma_f32 v[18:19], v[170:171], v[146:147], v[18:19] op_sel:[1,0,0] op_sel_hi:[1,1,1]
    v_pk_fma_f32 v[20:21], v[174:175], v[148:149], v[20:21] op_sel:[1,0,0] op_sel_hi:[1,1,1]
    v_pk_fma_f32 v[22:23], v[174:175], v[150:151], v[22:23] op_sel:[1,0,0] op_sel_hi:[1,1,1]
    s_set_gpr_idx_off
    s_sub_u32 s48, s48, 1
    s_cbranch_scc1 K2_LOOPDONE
    s_waitcnt vmcnt(6) lgkmcnt(0)
    v_subrev_u32 v255, s27, v188
    v_cmp_gt_u32 vcc, v255, v254
    ds_write_b32 v252, v255 offset:2048
    s_setprio 0
    s_cbranch_vccnz K2_P2
    s_setprio 1
K2_P2:
    v_mfma_f32_4x4x4_16b_bf16 v[120:123], v[184:185], v[88:89], 0 cbsz:4 abid:8
    v_exp_f32 v168, v152
    v_mfma_f32_4x4x4_16b_bf16 v[124:127], v[184:185], v[90:91], 0 cbsz:4 abid:8
    v_exp_f32 v169, v153
    v_mfma_f32_4x4x4_16b_bf16 v[128:131], v[184:185], v[92:93], 0 cbsz:4 abid:9
    v_exp_f32 v170, v154
    v_mfma_f32_4x4x4_16b_bf16 v[132:135], v[184:185], v[94:95], 0 cbsz:4 abid:9
    buffer_load_dwordx4 v[56:59], v188, s[28:31], 0 offen
    buffer_load_dwordx4 v[60:63], v189, s[28:31], 0 offen
    v_exp_f32 v171, v155
    s_waitcnt vmcnt(6)
    v_mfma_f32_4x4x4_16b_bf16 v[136:139], v[184:185], v[96:97], 0 cbsz:4 abid:10
    v_exp_f32 v172, v156
    v_mfma_f32_4x4x4_16b_bf16 v[140:143], v[184:185], v[98:99], 0 cbsz:4 abid:10
    v_exp_f32 v173, v157
    v_exp_f32 v174, v158
    v_exp_f32 v175, v159
    v_pk_add_f32 v[168:169], v[168:169], 1.0 op_sel_hi:[1,0]
    v_pk_add_f32 v[170:171], v[170:171], 1.0 op_sel_hi:[1,0]
    v_pk_add_f32 v[172:173], v[172:173], 1.0 op_sel_hi:[1,0]
    v_pk_add_f32 v[174:175], v[174:175], 1.0 op_sel_hi:[1,0]
    v_mfma_f32_4x4x4_16b_bf16 v[144:147], v[184:185], v[100:101], 0 cbsz:4 abid:11
    v_rcp_f32 v168, v168
    v_mfma_f32_4x4x4_16b_bf16 v[148:151], v[184:185], v[102:103], 0 cbsz:4 abid:11
    buffer_load_dwordx4 v[64:67], v190, s[28:31], 0 offen
    buffer_load_dwordx4 v[68:71], v191, s[28:31], 0 offen
    v_rcp_f32 v169, v169
    ds_read_b128 v[188:191], v196 offset:80
    v_mfma_f32_4x4x4_16b_bf16 v[160:163], v[186:187], v[176:177], 0 cbsz:4 abid:3
    v_rcp_f32 v170, v170
    v_mfma_f32_4x4x4_16b_bf16 v[164:167], v[186:187], v[180:181], 0 cbsz:4 abid:3
    v_rcp_f32 v171, v171
    v_mfma_f32_4x4x4_16b_bf16 v[160:163], v[186:187], v[178:179], v[160:163] cbsz:4 abid:3
    v_rcp_f32 v172, v172
    v_mfma_f32_4x4x4_16b_bf16 v[164:167], v[186:187], v[182:183], v[164:167] cbsz:4 abid:3
    ds_read_b64 v[186:187], v199 offset:264
    v_rcp_f32 v173, v173
    v_rcp_f32 v174, v174
    v_rcp_f32 v175, v175
    v_readfirstlane_b32 s49, v194
    v_pk_mul_f32 v[168:169], v[168:169], v[152:153]
    v_pk_mul_f32 v[170:171], v[170:171], v[154:155]
    v_pk_mul_f32 v[172:173], v[172:173], v[156:157]
    v_pk_mul_f32 v[174:175], v[174:175], v[158:159]
    s_set_gpr_idx_on s49, gpr_idx(SRC2,DST)
    v_pk_fma_f32 v[16:17], v[168:169], v[120:121], v[16:17] op_sel:[0,0,0] op_sel_hi:[0,1,1]
    v_pk_fma_f32 v[18:19], v[168:169], v[122:123], v[18:19] op_sel:[0,0,0] op_sel_hi:[0,1,1]
    v_pk_fma_f32 v[20:21], v[172:173], v[124:125], v[20:21] op_sel:[0,0,0] op_sel_hi:[0,1,1]
    v_pk_fma_f32 v[22:23], v[172:173], v[126:127], v[22:23] op_sel:[0,0,0] op_sel_hi:[0,1,1]
    s_lshr_b32 s49, s49, 8
    s_set_gpr_idx_idx s49
    v_pk_fma_f32 v[16:17], v[168:169], v[128:129], v[16:17] op_sel:[1,0,0] op_sel_hi:[1,1,1]
    v_pk_fma_f32 v[18:19], v[168:169], v[130:131], v[18:19] op_sel:[1,0,0] op_sel_hi:[1,1,1]
    v_pk_fma_f32 v[20:21], v[172:173], v[132:133], v[20:21] op_sel:[1,0,0] op_sel_hi:[1,1,1]
    v_pk_fma_f32 v[22:23], v[172:173], v[134:135], v[22:23] op_sel:[1,0,0] op_sel_hi:[1,1,1]
    s_lshr_b32 s49, s49, 8
    s_set_gpr_idx_idx s49
    v_pk_fma_f32 v[16:17], v[170:171], v[136:137], v[16:17] op_sel:[0,0,0] op_sel_hi:[0,1,1]
    v_pk_fma_f32 v[18:19], v[170:171], v[138:139], v[18:19] op_sel:[0,0,0] op_sel_hi:[0,1,1]
    v_pk_fma_f32 v[20:21], v[174:175], v[140:141], v[20:21] op_sel:[0,0,0] op_sel_hi:[0,1,1]
    v_pk_fma_f32 v[22:23], v[174:175], v[142:143], v[22:23] op_sel:[0,0,0] op_sel_hi:[0,1,1]
    s_lshr_b32 s49, s49, 8
    s_set_gpr_idx_idx s49
    v_pk_fma_f32 v[16:17], v[170:171], v[144:145], v[16:17] op_sel:[1,0,0] op_sel_hi:[1,1,1]
    v_pk_fma_f32 v[18:19], v[170:171], v[146:147], v[18:19] op_sel:[1,0,0] op_sel_hi:[1,1,1]
    v_pk_fma_f32 v[20:21], v[174:175], v[148:149], v[20:21] op_sel:[1,0,0] op_sel_hi:[1,1,1]
    v_pk_fma_f32 v[22:23], v[174:175], v[150:151], v[22:23] op_sel:[1,0,0] op_sel_hi:[1,1,1]
    s_set_gpr_idx_off
    s_sub_u32 s48, s48, 1
    s_cbranch_scc1 K2_LOOPDONE
    s_waitcnt vmcnt(6) lgkmcnt(0)
    v_mfma_f32_4x4x4_16b_bf16 v[120:123], v[184:185], v[104:105], 0 cbsz:4 abid:12
    v_exp_f32 v168, v160
    v_mfma_f32_4x4x4_16b_bf16 v[124:127], v[184:185], v[106:107], 0 cbsz:4 abid:12
    v_exp_f32 v169, v161
    v_mfma_f32_4x4x4_16b_bf16 v[128:131], v[184:185], v[108:109], 0 cbsz:4 abid:13
    v_exp_f32 v170, v162
    v_mfma_f32_4x4x4_16b_bf16 v[132:135], v[184:185], v[110:111], 0 cbsz:4 abid:13
    buffer_load_dwordx4 v[72:75], v188, s[28:31], 0 offen
    buffer_load_dwordx4 v[76:79], v189, s[28:31], 0 offen
    v_exp_f32 v171, v163
    s_waitcnt vmcnt(6)
    v_mfma_f32_4x4x4_16b_bf16 v[136:139], v[184:185], v[112:113], 0 cbsz:4 abid:14
    v_exp_f32 v172, v164
    v_mfma_f32_4x4x4_16b_bf16 v[140:143], v[184:185], v[114:115], 0 cbsz:4 abid:14
    v_exp_f32 v173, v165
    v_exp_f32 v174, v166
    v_exp_f32 v175, v167
    v_pk_add_f32 v[168:169], v[168:169], 1.0 op_sel_hi:[1,0]
    v_pk_add_f32 v[170:171], v[170:171], 1.0 op_sel_hi:[1,0]
    v_pk_add_f32 v[172:173], v[172:173], 1.0 op_sel_hi:[1,0]
    v_pk_add_f32 v[174:175], v[174:175], 1.0 op_sel_hi:[1,0]
    v_mfma_f32_4x4x4_16b_bf16 v[144:147], v[184:185], v[116:117], 0 cbsz:4 abid:15
    v_rcp_f32 v168, v168
    v_mfma_f32_4x4x4_16b_bf16 v[148:151], v[184:185], v[118:119], 0 cbsz:4 abid:15
    buffer_load_dwordx4 v[80:83], v190, s[28:31], 0 offen
    buffer_load_dwordx4 v[84:87], v191, s[28:31], 0 offen
    v_rcp_f32 v169, v169
    ds_read_b128 v[188:191], v196 offset:96
    ds_read_b64 v[184:185], v198 offset:512
    ds_read_b32 v254, v253 offset:2048
    v_mfma_f32_4x4x4_16b_bf16 v[152:155], v[186:187], v[176:177], 0 cbsz:4 abid:0
    v_rcp_f32 v170, v170
    v_mfma_f32_4x4x4_16b_bf16 v[156:159], v[186:187], v[180:181], 0 cbsz:4 abid:0
    v_rcp_f32 v171, v171
    v_mfma_f32_4x4x4_16b_bf16 v[152:155], v[186:187], v[178:179], v[152:155] cbsz:4 abid:0
    v_rcp_f32 v172, v172
    v_mfma_f32_4x4x4_16b_bf16 v[156:159], v[186:187], v[182:183], v[156:159] cbsz:4 abid:0
    v_rcp_f32 v173, v173
    v_rcp_f32 v174, v174
    v_rcp_f32 v175, v175
    v_readfirstlane_b32 s49, v195
    ds_read_b128 v[192:195], v197 offset:16
    v_add_u32 v196, 64, v196
    v_add_u32 v197, 16, v197
    v_add_u32 v198, 512, v198
    v_add_u32 v199, 256, v199
    v_pk_mul_f32 v[168:169], v[168:169], v[160:161]
    v_pk_mul_f32 v[170:171], v[170:171], v[162:163]
    v_pk_mul_f32 v[172:173], v[172:173], v[164:165]
    v_pk_mul_f32 v[174:175], v[174:175], v[166:167]
    s_set_gpr_idx_on s49, gpr_idx(SRC2,DST)
    v_pk_fma_f32 v[16:17], v[168:169], v[120:121], v[16:17] op_sel:[0,0,0] op_sel_hi:[0,1,1]
    v_pk_fma_f32 v[18:19], v[168:169], v[122:123], v[18:19] op_sel:[0,0,0] op_sel_hi:[0,1,1]
    v_pk_fma_f32 v[20:21], v[172:173], v[124:125], v[20:21] op_sel:[0,0,0] op_sel_hi:[0,1,1]
    v_pk_fma_f32 v[22:23], v[172:173], v[126:127], v[22:23] op_sel:[0,0,0] op_sel_hi:[0,1,1]
    s_lshr_b32 s49, s49, 8
    s_set_gpr_idx_idx s49
    v_pk_fma_f32 v[16:17], v[168:169], v[128:129], v[16:17] op_sel:[1,0,0] op_sel_hi:[1,1,1]
    v_pk_fma_f32 v[18:19], v[168:169], v[130:131], v[18:19] op_sel:[1,0,0] op_sel_hi:[1,1,1]
    v_pk_fma_f32 v[20:21], v[172:173], v[132:133], v[20:21] op_sel:[1,0,0] op_sel_hi:[1,1,1]
    v_pk_fma_f32 v[22:23], v[172:173], v[134:135], v[22:23] op_sel:[1,0,0] op_sel_hi:[1,1,1]
    s_lshr_b32 s49, s49, 8
    s_set_gpr_idx_idx s49
    v_pk_fma_f32 v[16:17], v[170:171], v[136:137], v[16:17] op_sel:[0,0,0] op_sel_hi:[0,1,1]
    v_pk_fma_f32 v[18:19], v[170:171], v[138:139], v[18:19] op_sel:[0,0,0] op_sel_hi:[0,1,1]
    v_pk_fma_f32 v[20:21], v[174:175], v[140:141], v[20:21] op_sel:[0,0,0] op_sel_hi:[0,1,1]
    v_pk_fma_f32 v[22:23], v[174:175], v[142:143], v[22:23] op_sel:[0,0,0] op_sel_hi:[0,1,1]
    s_lshr_b32 s49, s49, 8
    s_set_gpr_idx_idx s49
    v_pk_fma_f32 v[16:17], v[170:171], v[144:145], v[16:17] op_sel:[1,0,0] op_sel_hi:[1,1,1]
    v_pk_fma_f32 v[18:19], v[170:171], v[146:147], v[18:19] op_sel:[1,0,0] op_sel_hi:[1,1,1]
    v_pk_fma_f32 v[20:21], v[174:175], v[148:149], v[20:21] op_sel:[1,0,0] op_sel_hi:[1,1,1]
    v_pk_fma_f32 v[22:23], v[174:175], v[150:151], v[22:23] op_sel:[1,0,0] op_sel_hi:[1,1,1]
    s_set_gpr_idx_off
    s_sub_u32 s48, s48, 1
    s_cbranch_scc0 K2_LOOP
K2_LOOPDONE:
    v_mov_b32 v254, -1
    ds_write_b32 v252, v254 offset:2048
    s_setprio 0
    s_add_u32 s47, s47, 1536
    s_cmp_ge_u32 s47, s46
    s_cbranch_scc1 K_EPI
    s_waitcnt vmcnt(0) lgkmcnt(0)
    s_barrier
    ds_write_b128 v8, v[4:7]
    ds_write_b32 v3, v4 offset:2048
    v_cmp_gt_u32 vcc, 128, v0
    s_and_saveexec_b64 s[56:57], vcc
    ds_write_b32 v3, v4 offset:0
    s_mov_b64 exec, s[56:57]
    s_waitcnt lgkmcnt(0)
    s_barrier
    s_cmp_eq_u32 s55, 0
    s_cbranch_scc1 K_ROUND
    s_branch K_FB
K_LATER:
    s_mov_b64 exec, s[40:41]
    buffer_load_dwordx4 v[88:91], v100, s[36:39], s61 offen sc1
    s_mov_b64 exec, s[42:43]
    buffer_load_dwordx4 v[92:95], v101, s[36:39], s61 offen sc1
    s_mov_b64 exec, s[44:45]
    buffer_load_dwordx4 v[96:99], v102, s[36:39], s61 offen sc1
    s_mov_b64 exec, -1
K_LATER2:
    v_lshrrev_b32 v81, 2, v72
    v_and_b32 v81, 0xfc, v81
    v_lshrrev_b32 v82, 2, v74
    v_and_b32 v82, 0xfc, v82
    v_lshrrev_b32 v83, 2, v76
    v_and_b32 v83, 0xfc, v83
    s_branch K_BAL
K_FB0:
    s_mov_b32 s46, 320000
    s_and_b32 s56, s3, 3
    s_lshl_b32 s56, s56, 6
    s_add_u32 s56, s56, 114944
    v_lshrrev_b32 v10, 4, v1
    v_lshlrev_b32 v10, 11, v10
    v_and_b32 v12, 15, v1
    v_lshl_or_b32 v10, v12, 2, v10
    v_add_u32 v10, s56, v10
    s_mov_b32 s56, 0x05040100
    s_mov_b32 s57, 0x07060302
    ds_read2st64_b32 v[120:121], v10 offset0:0 offset1:1
    ds_read2st64_b32 v[122:123], v10 offset0:2 offset1:3
    ds_read2st64_b32 v[124:125], v10 offset0:4 offset1:5
    ds_read2st64_b32 v[126:127], v10 offset0:6 offset1:7
    ds_read2st64_b32 v[128:129], v10 offset0:32 offset1:33
    ds_read2st64_b32 v[130:131], v10 offset0:34 offset1:35
    ds_read2st64_b32 v[132:133], v10 offset0:36 offset1:37
    ds_read2st64_b32 v[134:135], v10 offset0:38 offset1:39
    ds_read2st64_b32 v[136:137], v10 offset0:64 offset1:65
    ds_read2st64_b32 v[138:139], v10 offset0:66 offset1:67
    ds_read2st64_b32 v[140:141], v10 offset0:68 offset1:69
    ds_read2st64_b32 v[142:143], v10 offset0:70 offset1:71
    ds_read2st64_b32 v[144:145], v10 offset0:96 offset1:97
    ds_read2st64_b32 v[146:147], v10 offset0:98 offset1:99
    ds_read2st64_b32 v[148:149], v10 offset0:100 offset1:101
    ds_read2st64_b32 v[150:151], v10 offset0:102 offset1:103
    s_waitcnt lgkmcnt(15)
    v_perm_b32 v200, v121, v120, s56
    v_perm_b32 v216, v121, v120, s57
    s_waitcnt lgkmcnt(14)
    v_perm_b32 v201, v123, v122, s56
    v_perm_b32 v217, v123, v122, s57
    s_waitcnt lgkmcnt(13)
    v_perm_b32 v202, v125, v124, s56
    v_perm_b32 v218, v125, v124, s57
    s_waitcnt lgkmcnt(12)
    v_perm_b32 v203, v127, v126, s56
    v_perm_b32 v219, v127, v126, s57
    s_waitcnt lgkmcnt(11)
    v_perm_b32 v204, v129, v128, s56
    v_perm_b32 v220, v129, v128, s57
    s_waitcnt lgkmcnt(10)
    v_perm_b32 v205, v131, v130, s56
    v_perm_b32 v221, v131, v130, s57
    s_waitcnt lgkmcnt(9)
    v_perm_b32 v206, v133, v132, s56
    v_perm_b32 v222, v133, v132, s57
    s_waitcnt lgkmcnt(8)
    v_perm_b32 v207, v135, v134, s56
    v_perm_b32 v223, v135, v134, s57
    s_waitcnt lgkmcnt(7)
    v_perm_b32 v208, v137, v136, s56
    v_perm_b32 v224, v137, v136, s57
    s_waitcnt lgkmcnt(6)
    v_perm_b32 v209, v139, v138, s56
    v_perm_b32 v225, v139, v138, s57
    s_waitcnt lgkmcnt(5)
    v_perm_b32 v210, v141, v140, s56
    v_perm_b32 v226, v141, v140, s57
    s_waitcnt lgkmcnt(4)
    v_perm_b32 v211, v143, v142, s56
    v_perm_b32 v227, v143, v142, s57
    s_waitcnt lgkmcnt(3)
    v_perm_b32 v212, v145, v144, s56
    v_perm_b32 v228, v145, v144, s57
    s_waitcnt lgkmcnt(2)
    v_perm_b32 v213, v147, v146, s56
    v_perm_b32 v229, v147, v146, s57
    s_waitcnt lgkmcnt(1)
    v_perm_b32 v214, v149, v148, s56
    v_perm_b32 v230, v149, v148, s57
    s_waitcnt lgkmcnt(0)
    v_perm_b32 v215, v151, v150, s56
    v_perm_b32 v231, v151, v150, s57
K_FB:
    s_mul_i32 s56, s3, 192
    s_add_u32 s56, s56, s47
    v_add_u32 v68, s56, v1
    v_add_u32 v69, 64, v68
    v_add_u32 v70, 128, v68
    v_cmp_gt_u32 s[40:41], s46, v68
    v_min_u32 v68, 319999, v68
    v_lshlrev_b32 v81, 2, v68
    v_lshlrev_b32 v100, 3, v68
    global_load_dword v56, v81, s[8:9]
    global_load_dword v60, v81, s[6:7]
    global_load_dwordx2 v[88:89], v100, s[10:11]
    global_load_dwordx2 v[90:91], v100, s[12:13]
    v_cmp_gt_u32 s[42:43], s46, v69
    v_min_u32 v69, 319999, v69
    v_lshlrev_b32 v82, 2, v69
    v_lshlrev_b32 v101, 3, v69
    global_load_dword v57, v82, s[8:9]
    global_load_dword v61, v82, s[6:7]
    global_load_dwordx2 v[92:93], v101, s[10:11]
    global_load_dwordx2 v[94:95], v101, s[12:13]
    v_cmp_gt_u32 s[44:45], s46, v70
    v_min_u32 v70, 319999, v70
    v_lshlrev_b32 v83, 2, v70
    v_lshlrev_b32 v102, 3, v70
    global_load_dword v58, v83, s[8:9]
    global_load_dword v62, v83, s[6:7]
    global_load_dwordx2 v[96:97], v102, s[10:11]
    global_load_dwordx2 v[98:99], v102, s[12:13]
    v_mov_b32 v14, 64
    s_waitcnt vmcnt(0)
    v_mul_u32_u24 v68, 214749, v56
    v_lshrrev_b32 v68, 23, v68
    v_cmp_eq_u32 vcc, s53, v68
    s_and_b64 s[40:41], s[40:41], vcc
    v_subrev_u32 v72, s54, v56
    v_mul_u32_u24 v68, 1677, v60
    v_lshrrev_b32 v68, 20, v68
    v_lshl_or_b32 v72, v72, 4, v68
    v_lshl_or_b32 v72, v60, 10, v72
    v_mul_u32_u24 v69, 214749, v57
    v_lshrrev_b32 v69, 23, v69
    v_cmp_eq_u32 vcc, s53, v69
    s_and_b64 s[42:43], s[42:43], vcc
    v_subrev_u32 v74, s54, v57
    v_mul_u32_u24 v69, 1677, v61
    v_lshrrev_b32 v69, 20, v69
    v_lshl_or_b32 v74, v74, 4, v69
    v_lshl_or_b32 v74, v61, 10, v74
    v_mul_u32_u24 v70, 214749, v58
    v_lshrrev_b32 v70, 23, v70
    v_cmp_eq_u32 vcc, s53, v70
    s_and_b64 s[44:45], s[44:45], vcc
    v_subrev_u32 v76, s54, v58
    v_mul_u32_u24 v70, 1677, v62
    v_lshrrev_b32 v70, 20, v70
    v_lshl_or_b32 v76, v76, 4, v70
    v_lshl_or_b32 v76, v62, 10, v76
    s_cmp_lg_u32 s47, 0
    s_cbranch_scc1 K_LATER2
    s_branch K_GOT
K_EPI:
    s_mov_b32 s56, 0xbf317218
    s_mov_b32 s57, s56
    s_add_u32 s58, s3, 0
    v_cmp_eq_u32 vcc, s58, v2
    v_pk_mul_f32 v[16:17], v[16:17], s[56:57]
    v_pk_mul_f32 v[18:19], v[18:19], s[56:57]
    v_pk_mul_f32 v[20:21], v[20:21], s[56:57]
    v_pk_mul_f32 v[22:23], v[22:23], s[56:57]
    s_ff1_i32_b64 s58, vcc
    s_mul_i32 s58, s58, 1152
    s_add_u32 s58, s58, 106752
    v_add_u32 v10, s58, v15
    v_cvt_pk_bf16_f32 v16, v16, v20
    ds_write_b32 v10, v16 offset:0
    v_cvt_pk_bf16_f32 v17, v17, v21
    ds_write_b32 v10, v17 offset:288
    v_cvt_pk_bf16_f32 v18, v18, v22
    ds_write_b32 v10, v18 offset:576
    v_cvt_pk_bf16_f32 v19, v19, v23
    ds_write_b32 v10, v19 offset:864
    s_add_u32 s58, s3, 8
    v_cmp_eq_u32 vcc, s58, v2
    v_pk_mul_f32 v[24:25], v[24:25], s[56:57]
    v_pk_mul_f32 v[26:27], v[26:27], s[56:57]
    v_pk_mul_f32 v[28:29], v[28:29], s[56:57]
    v_pk_mul_f32 v[30:31], v[30:31], s[56:57]
    s_ff1_i32_b64 s58, vcc
    s_mul_i32 s58, s58, 1152
    s_add_u32 s58, s58, 106752
    v_add_u32 v11, s58, v15
    v_cvt_pk_bf16_f32 v24, v24, v28
    ds_write_b32 v11, v24 offset:0
    v_cvt_pk_bf16_f32 v25, v25, v29
    ds_write_b32 v11, v25 offset:288
    v_cvt_pk_bf16_f32 v26, v26, v30
    ds_write_b32 v11, v26 offset:576
    v_cvt_pk_bf16_f32 v27, v27, v31
    ds_write_b32 v11, v27 offset:864
    s_add_u32 s58, s3, 16
    v_cmp_eq_u32 vcc, s58, v2
    v_pk_mul_f32 v[32:33], v[32:33], s[56:57]
    v_pk_mul_f32 v[34:35], v[34:35], s[56:57]
    v_pk_mul_f32 v[36:37], v[36:37], s[56:57]
    v_pk_mul_f32 v[38:39], v[38:39], s[56:57]
    s_ff1_i32_b64 s58, vcc
    s_mul_i32 s58, s58, 1152
    s_add_u32 s58, s58, 106752
    v_add_u32 v10, s58, v15
    v_cvt_pk_bf16_f32 v32, v32, v36
    ds_write_b32 v10, v32 offset:0
    v_cvt_pk_bf16_f32 v33, v33, v37
    ds_write_b32 v10, v33 offset:288
    v_cvt_pk_bf16_f32 v34, v34, v38
    ds_write_b32 v10, v34 offset:576
    v_cvt_pk_bf16_f32 v35, v35, v39
    ds_write_b32 v10, v35 offset:864
    s_add_u32 s58, s3, 24
    v_cmp_eq_u32 vcc, s58, v2
    v_pk_mul_f32 v[40:41], v[40:41], s[56:57]
    v_pk_mul_f32 v[42:43], v[42:43], s[56:57]
    v_pk_mul_f32 v[44:45], v[44:45], s[56:57]
    v_pk_mul_f32 v[46:47], v[46:47], s[56:57]
    s_ff1_i32_b64 s58, vcc
    s_mul_i32 s58, s58, 1152
    s_add_u32 s58, s58, 106752
    v_add_u32 v11, s58, v15
    v_cvt_pk_bf16_f32 v40, v40, v44
    ds_write_b32 v11, v40 offset:0
    v_cvt_pk_bf16_f32 v41, v41, v45
    ds_write_b32 v11, v41 offset:288
    v_cvt_pk_bf16_f32 v42, v42, v46
    ds_write_b32 v11, v42 offset:576
    v_cvt_pk_bf16_f32 v43, v43, v47
    ds_write_b32 v11, v43 offset:864
    s_add_u32 s58, s3, 32
    v_cmp_eq_u32 vcc, s58, v2
    v_pk_mul_f32 v[48:49], v[48:49], s[56:57]
    v_pk_mul_f32 v[50:51], v[50:51], s[56:57]
    v_pk_mul_f32 v[52:53], v[52:53], s[56:57]
    v_pk_mul_f32 v[54:55], v[54:55], s[56:57]
    s_ff1_i32_b64 s58, vcc
    s_mul_i32 s58, s58, 1152
    s_add_u32 s58, s58, 106752
    v_add_u32 v10, s58, v15
    v_cvt_pk_bf16_f32 v48, v48, v52
    ds_write_b32 v10, v48 offset:0
    v_cvt_pk_bf16_f32 v49, v49, v53
    ds_write_b32 v10, v49 offset:288
    v_cvt_pk_bf16_f32 v50, v50, v54
    ds_write_b32 v10, v50 offset:576
    v_cvt_pk_bf16_f32 v51, v51, v55
    ds_write_b32 v10, v51 offset:864
    v_and_b32 v12, 15, v1
    v_lshrrev_b32 v13, 4, v1
    s_lshr_b32 s58, s3, 2
    s_mul_i32 s59, s58, 4608
    s_add_u32 s59, s59, 106752
    v_mul_u32_u24 v14, 288, v12
    v_lshl_add_u32 v14, v13, 4, v14
    v_add_u32 v14, s59, v14
    s_lshl_b32 s58, s58, 2
    s_add_u32 s58, s58, s54
    s_lshl_b32 s58, s58, 10
    s_and_b32 s59, s3, 3
    s_lshl_b32 s59, s59, 8
    s_add_u32 s58, s58, s59
    v_lshlrev_b32 v13, 10, v13
    v_lshl_add_u32 v13, v12, 4, v13
    s_waitcnt vmcnt(0) lgkmcnt(0)
    s_barrier
    ds_read_b128 v[56:59], v14 offset:0
    ds_read_b128 v[60:63], v14 offset:64
    ds_read_b128 v[64:67], v14 offset:128
    ds_read_b128 v[68:71], v14 offset:192
    ds_read_b128 v[72:75], v14 offset:9216
    ds_read_b128 v[76:79], v14 offset:9280
    ds_read_b128 v[80:83], v14 offset:9344
    ds_read_b128 v[84:87], v14 offset:9408
    ds_read_b128 v[88:91], v14 offset:18432
    ds_read_b128 v[92:95], v14 offset:18496
    ds_read_b128 v[96:99], v14 offset:18560
    ds_read_b128 v[100:103], v14 offset:18624
    ds_read_b128 v[104:107], v14 offset:27648
    ds_read_b128 v[108:111], v14 offset:27712
    ds_read_b128 v[112:115], v14 offset:27776
    ds_read_b128 v[116:119], v14 offset:27840
    s_waitcnt lgkmcnt(15)
    v_mfma_f32_16x16x32_bf16 v[120:123], v[56:59], v[200:203], 0
    v_mfma_f32_16x16x32_bf16 v[124:127], v[56:59], v[216:219], 0
    s_waitcnt lgkmcnt(14)
    v_mfma_f32_16x16x32_bf16 v[120:123], v[60:63], v[204:207], v[120:123]
    v_mfma_f32_16x16x32_bf16 v[124:127], v[60:63], v[220:223], v[124:127]
    s_waitcnt lgkmcnt(13)
    v_mfma_f32_16x16x32_bf16 v[120:123], v[64:67], v[208:211], v[120:123]
    v_mfma_f32_16x16x32_bf16 v[124:127], v[64:67], v[224:227], v[124:127]
    s_waitcnt lgkmcnt(12)
    v_mfma_f32_16x16x32_bf16 v[120:123], v[68:71], v[212:215], v[120:123]
    v_mfma_f32_16x16x32_bf16 v[124:127], v[68:71], v[228:231], v[124:127]
    ds_read_b128 v[56:59], v14 offset:36864
    ds_read_b128 v[60:63], v14 offset:36928
    ds_read_b128 v[64:67], v14 offset:36992
    ds_read_b128 v[68:71], v14 offset:37056
    s_waitcnt lgkmcnt(15)
    v_mfma_f32_16x16x32_bf16 v[128:131], v[72:75], v[200:203], 0
    v_mfma_f32_16x16x32_bf16 v[132:135], v[72:75], v[216:219], 0
    s_waitcnt lgkmcnt(14)
    v_mfma_f32_16x16x32_bf16 v[128:131], v[76:79], v[204:207], v[128:131]
    v_mfma_f32_16x16x32_bf16 v[132:135], v[76:79], v[220:223], v[132:135]
    s_waitcnt lgkmcnt(13)
    v_mfma_f32_16x16x32_bf16 v[128:131], v[80:83], v[208:211], v[128:131]
    v_mfma_f32_16x16x32_bf16 v[132:135], v[80:83], v[224:227], v[132:135]
    s_waitcnt lgkmcnt(12)
    v_mfma_f32_16x16x32_bf16 v[128:131], v[84:87], v[212:215], v[128:131]
    v_mfma_f32_16x16x32_bf16 v[132:135], v[84:87], v[228:231], v[132:135]
    v_cvt_pk_bf16_f32 v136, v120, v121
    v_cvt_pk_bf16_f32 v137, v122, v123
    v_cvt_pk_bf16_f32 v138, v124, v125
    v_cvt_pk_bf16_f32 v139, v126, v127
    buffer_store_dwordx4 v[136:139], v13, s[32:35], s58 offen sc1
    s_add_u32 s58, s58, 8192
    s_waitcnt lgkmcnt(11)
    v_mfma_f32_16x16x32_bf16 v[120:123], v[88:91], v[200:203], 0
    v_mfma_f32_16x16x32_bf16 v[124:127], v[88:91], v[216:219], 0
    s_waitcnt lgkmcnt(10)
    v_mfma_f32_16x16x32_bf16 v[120:123], v[92:95], v[204:207], v[120:123]
    v_mfma_f32_16x16x32_bf16 v[124:127], v[92:95], v[220:223], v[124:127]
    s_waitcnt lgkmcnt(9)
    v_mfma_f32_16x16x32_bf16 v[120:123], v[96:99], v[208:211], v[120:123]
    v_mfma_f32_16x16x32_bf16 v[124:127], v[96:99], v[224:227], v[124:127]
    s_waitcnt lgkmcnt(8)
    v_mfma_f32_16x16x32_bf16 v[120:123], v[100:103], v[212:215], v[120:123]
    v_mfma_f32_16x16x32_bf16 v[124:127], v[100:103], v[228:231], v[124:127]
    v_cvt_pk_bf16_f32 v140, v128, v129
    v_cvt_pk_bf16_f32 v141, v130, v131
    v_cvt_pk_bf16_f32 v142, v132, v133
    v_cvt_pk_bf16_f32 v143, v134, v135
    buffer_store_dwordx4 v[140:143], v13, s[32:35], s58 offen sc1
    s_add_u32 s58, s58, 8192
    s_waitcnt lgkmcnt(7)
    v_mfma_f32_16x16x32_bf16 v[128:131], v[104:107], v[200:203], 0
    v_mfma_f32_16x16x32_bf16 v[132:135], v[104:107], v[216:219], 0
    s_waitcnt lgkmcnt(6)
    v_mfma_f32_16x16x32_bf16 v[128:131], v[108:111], v[204:207], v[128:131]
    v_mfma_f32_16x16x32_bf16 v[132:135], v[108:111], v[220:223], v[132:135]
    s_waitcnt lgkmcnt(5)
    v_mfma_f32_16x16x32_bf16 v[128:131], v[112:115], v[208:211], v[128:131]
    v_mfma_f32_16x16x32_bf16 v[132:135], v[112:115], v[224:227], v[132:135]
    s_waitcnt lgkmcnt(4)
    v_mfma_f32_16x16x32_bf16 v[128:131], v[116:119], v[212:215], v[128:131]
    v_mfma_f32_16x16x32_bf16 v[132:135], v[116:119], v[228:231], v[132:135]
    v_cvt_pk_bf16_f32 v136, v120, v121
    v_cvt_pk_bf16_f32 v137, v122, v123
    v_cvt_pk_bf16_f32 v138, v124, v125
    v_cvt_pk_bf16_f32 v139, v126, v127
    buffer_store_dwordx4 v[136:139], v13, s[32:35], s58 offen sc1
    s_add_u32 s58, s58, 8192
    s_waitcnt lgkmcnt(3)
    v_mfma_f32_16x16x32_bf16 v[120:123], v[56:59], v[200:203], 0
    v_mfma_f32_16x16x32_bf16 v[124:127], v[56:59], v[216:219], 0
    s_waitcnt lgkmcnt(2)
    v_mfma_f32_16x16x32_bf16 v[120:123], v[60:63], v[204:207], v[120:123]
    v_mfma_f32_16x16x32_bf16 v[124:127], v[60:63], v[220:223], v[124:127]
    s_waitcnt lgkmcnt(1)
    v_mfma_f32_16x16x32_bf16 v[120:123], v[64:67], v[208:211], v[120:123]
    v_mfma_f32_16x16x32_bf16 v[124:127], v[64:67], v[224:227], v[124:127]
    s_waitcnt lgkmcnt(0)
    v_mfma_f32_16x16x32_bf16 v[120:123], v[68:71], v[212:215], v[120:123]
    v_mfma_f32_16x16x32_bf16 v[124:127], v[68:71], v[228:231], v[124:127]
    v_cvt_pk_bf16_f32 v140, v128, v129
    v_cvt_pk_bf16_f32 v141, v130, v131
    v_cvt_pk_bf16_f32 v142, v132, v133
    v_cvt_pk_bf16_f32 v143, v134, v135
    buffer_store_dwordx4 v[140:143], v13, s[32:35], s58 offen sc1
    s_add_u32 s58, s58, 8192
    s_nop 0
    v_cvt_pk_bf16_f32 v136, v120, v121
    v_cvt_pk_bf16_f32 v137, v122, v123
    v_cvt_pk_bf16_f32 v138, v124, v125
    v_cvt_pk_bf16_f32 v139, v126, v127
    buffer_store_dwordx4 v[136:139], v13, s[32:35], s58 offen sc1
    s_or_b32 s56, s55, s3
    s_cmp_lg_u32 s56, 0
    s_cbranch_scc1 K_NOEPO
    v_mov_b32 v10, s52
    s_mov_b64 exec, 1
    buffer_store_dword v10, v4, s[36:39], 0 offen offset:0
K_NOEPO:
K_END:
    s_endpgm
.p2align 6
.type K_TAB,@object
K_TAB:
.byte 6, 5, 14, 7, 4, 2, 0, 1, 3, 12, 22, 11, 10, 8, 30, 9, 19, 13, 15, 17, 16, 21, 23, 20, 18, 25, 29, 28, 31, 27, 26, 24, 34, 32, 39, 33, 35, 36, 37, 38, 255, 255, 255, 255, 255, 255, 255, 255, 255, 255, 255, 255, 255, 255, 255, 255, 255, 255, 255, 255, 255, 255, 255, 255
.byte 3, 2, 4, 7, 0, 1, 6, 8, 5, 9, 15, 13, 14, 11, 12, 22, 21, 16, 10, 23, 17, 20, 30, 19, 18, 25, 27, 24, 29, 28, 26, 31, 34, 37, 36, 39, 33, 38, 32, 35, 255, 255, 255, 255, 255, 255, 255, 255, 255, 255, 255, 255, 255, 255, 255, 255, 255, 255, 255, 255, 255, 255, 255, 255
.section .rodata,"a"
.p2align 6
.amdhsa_kernel gather_scatter__tensor_product_equiv_tfn__graph_kernel
  .amdhsa_next_free_vgpr 256
  .amdhsa_next_free_sgpr 72
  .amdhsa_accum_offset 256
  .amdhsa_group_segment_fixed_size 0
  .amdhsa_kernarg_size 88
  .amdhsa_user_sgpr_count 2
  .amdhsa_user_sgpr_kernarg_segment_ptr 1
  .amdhsa_system_sgpr_workgroup_id_x 1
  .amdhsa_float_denorm_mode_32 3
.end_amdhsa_kernel
```

```asm
; @launch grid=(256,1,1) block=(512,1,1) lds=152832
.amdgcn_target "amdgcn-amd-amdhsa--gfx950"
.text
.globl gather_scatter__tensor_product_equiv_tfn__graph_kernel
.p2align 8
.type gather_scatter__tensor_product_equiv_tfn__graph_kernel,@function
gather_scatter__tensor_product_equiv_tfn__graph_kernel:
    s_cmp_ge_u32 s2, 256
    s_cbranch_scc1 K_END
    s_load_dwordx16 s[4:19], s[0:1], 0
    s_load_dwordx2 s[20:21], s[0:1], 64
    s_load_dwordx2 s[24:25], s[0:1], 80
    v_lshrrev_b32 v2, 6, v0
    v_and_b32 v1, 63, v0
    v_readfirstlane_b32 s3, v2
    v_lshlrev_b32 v10, 4, v0
    s_mul_i32 s57, s2, 5120
    v_lshlrev_b32 v3, 2, v0
    s_cmp_lg_u32 s3, 5
    s_cbranch_scc1 K_PF0
    s_getpc_b64 s[26:27]
K_PC3:
    v_lshlrev_b32 v13, 7, v1
    global_load_dword v255, v13, s[26:27]
    v_add_u32 v13, 8192, v13
    v_min_u32 v13, K_TAB-K_PC3, v13
    global_load_dword v255, v13, s[26:27]
K_PF0:
    v_or_b32 v13, 0x4b000000, v1
    s_cmp_eq_u32 s3, 2
    s_cselect_b32 s56, -1, 0
    v_add_u32 v11, s57, v10
    v_and_b32 v13, s56, v13
    v_lshlrev_b32 v12, 1, v11
    ds_write_b32 v3, v13
    s_cmp_lt_u32 s2, 250
    s_cselect_b32 s56, 5, 0
    s_cmp_lt_u32 s3, s56
    s_waitcnt lgkmcnt(0)
    s_cbranch_scc0 K_BA
    global_load_dwordx4 v[120:123], v11, s[8:9]
    global_load_dwordx4 v[124:127], v11, s[6:7]
K_BA:
    s_barrier
    s_cbranch_scc0 K_HELP
    global_load_dwordx4 v[128:131], v12, s[10:11] offset:0
    global_load_dwordx4 v[132:135], v12, s[10:11] offset:16
    global_load_dwordx4 v[136:139], v12, s[12:13] offset:0
    global_load_dwordx4 v[140:143], v12, s[12:13] offset:16
    s_mov_b32 s40, 1
    s_load_dword s52, s[24:25], 0
    v_mov_b32 v4, 0
    v_mov_b32 v5, 0
    v_mov_b32 v6, 0
    v_mov_b32 v7, 0
    v_add_u32 v8, 106752, v10
    v_lshlrev_b32 v9, 4, v1
    v_lshlrev_b32 v15, 2, v1
    ds_write_b128 v8, v[4:7]
    ds_write_b32 v3, v4 offset:2048
    s_and_b32 s53, s2, 7
    s_lshr_b32 s56, s2, 3
    s_lshl_b32 s53, s53, 5
    s_or_b32 s53, s53, s56
    s_mul_i32 s54, s53, 625
    s_add_u32 s57, s54, 640
    s_add_u32 s54, s54, 15
    s_lshr_b32 s54, s54, 4
    s_lshr_b32 s57, s57, 4
    s_mov_b32 s28, s4
    s_and_b32 s29, s5, 0xffff
    s_or_b32 s29, s29, 0x100000
    s_mov_b32 s30, 10240000
    s_mov_b32 s31, 0x800000
    s_mov_b32 s32, s20
    s_mov_b32 s33, s21
    s_lshl_b32 s34, s57, 10
    s_mov_b32 s35, 0x20000
    s_mov_b32 s36, s24
    s_mov_b32 s37, s25
    s_mov_b32 s38, 8388608
    s_mov_b32 s39, 0x20000
    s_mov_b32 s47, 0
    s_mov_b32 s63, 0
    v_mov_b32 v14, 1
    s_lshr_b32 s27, s53, 5
    s_mul_i32 s27, s27, 20009
    s_add_u32 s27, s27, 14
    s_lshr_b32 s27, s27, 4
    s_lshl_b32 s27, s27, 10
    v_mov_b32 v16, 0
    v_mov_b32 v17, 0
    v_mov_b32 v18, 0
    v_mov_b32 v19, 0
    v_mov_b32 v20, 0
    v_mov_b32 v21, 0
    v_mov_b32 v22, 0
    v_mov_b32 v23, 0
    v_mov_b32 v24, 0
    v_mov_b32 v25, 0
    v_mov_b32 v26, 0
    v_mov_b32 v27, 0
    v_mov_b32 v28, 0
    v_mov_b32 v29, 0
    v_mov_b32 v30, 0
    v_mov_b32 v31, 0
    v_mov_b32 v32, 0
    v_mov_b32 v33, 0
    v_mov_b32 v34, 0
    v_mov_b32 v35, 0
    v_mov_b32 v36, 0
    v_mov_b32 v37, 0
    v_mov_b32 v38, 0
    v_mov_b32 v39, 0
    v_mov_b32 v40, 0
    v_mov_b32 v41, 0
    v_mov_b32 v42, 0
    v_mov_b32 v43, 0
    v_mov_b32 v44, 0
    v_mov_b32 v45, 0
    v_mov_b32 v46, 0
    v_mov_b32 v47, 0
    v_mov_b32 v48, 0
    v_mov_b32 v49, 0
    v_mov_b32 v50, 0
    v_mov_b32 v51, 0
    v_mov_b32 v52, 0
    v_mov_b32 v53, 0
    v_mov_b32 v54, 0
    v_mov_b32 v55, 0
    s_waitcnt vmcnt(5)
    v_mul_u32_u24 v60, 214749, v120
    v_lshrrev_b32 v60, 23, v60
    v_lshlrev_b32 v144, 2, v60
    ds_add_rtn_u32 v148, v144, v14 offset:768
    v_mul_u32_u24 v61, 214749, v121
    v_lshrrev_b32 v61, 23, v61
    v_lshlrev_b32 v145, 2, v61
    ds_add_rtn_u32 v149, v145, v14 offset:768
    v_mul_u32_u24 v62, 214749, v122
    v_lshrrev_b32 v62, 23, v62
    v_lshlrev_b32 v146, 2, v62
    ds_add_rtn_u32 v150, v146, v14 offset:768
    v_mul_u32_u24 v63, 214749, v123
    v_lshrrev_b32 v63, 23, v63
    v_lshlrev_b32 v147, 2, v63
    ds_add_rtn_u32 v151, v147, v14 offset:768
    v_mul_u32_u24 v64, 625, v60
    v_add_u32 v64, 15, v64
    v_lshrrev_b32 v64, 4, v64
    v_sub_u32 v56, v120, v64
    v_mul_u32_u24 v64, 625, v61
    v_add_u32 v64, 15, v64
    v_lshrrev_b32 v64, 4, v64
    v_sub_u32 v57, v121, v64
    v_mul_u32_u24 v64, 625, v62
    v_add_u32 v64, 15, v64
    v_lshrrev_b32 v64, 4, v64
    v_sub_u32 v58, v122, v64
    v_mul_u32_u24 v64, 625, v63
    v_add_u32 v64, 15, v64
    v_lshrrev_b32 v64, 4, v64
    v_sub_u32 v59, v123, v64
    s_branch K_BB
K_HELP:
    s_mov_b32 s40, 0
    s_load_dword s52, s[24:25], 0
    v_mov_b32 v4, 0
    v_mov_b32 v5, 0
    v_mov_b32 v6, 0
    v_mov_b32 v7, 0
    v_add_u32 v8, 106752, v10
    v_lshlrev_b32 v9, 4, v1
    v_lshlrev_b32 v15, 2, v1
    ds_write_b128 v8, v[4:7]
    ds_write_b32 v3, v4 offset:2048
    s_and_b32 s53, s2, 7
    s_lshr_b32 s56, s2, 3
    s_lshl_b32 s53, s53, 5
    s_or_b32 s53, s53, s56
    s_cmp_eq_u32 s3, 7
    s_cbranch_scc1 K_HELP7
    s_cmp_lg_u32 s3, 6
    s_cbranch_scc1 K_HELP2
    s_and_b32 s56, s53, 31
    s_lshl_b32 s56, s56, 10
    v_lshl_add_u32 v13, v1, 7, s56
    s_mov_b64 exec, 0xff
    global_load_dword v255, v13, s[18:19]
    s_mov_b64 exec, -1
    s_branch K_HELP2
K_HELP7:
    s_mov_b32 m0, 147712
    s_getpc_b64 s[26:27]
K_PC:
    global_load_lds_dwordx4 v9, s[14:15]
    s_add_u32 s26, s26, K_TAB-K_PC
    s_addc_u32 s27, s27, 0
    s_mov_b32 m0, 148736
    s_mov_b64 exec, 0xff
    global_load_lds_dwordx4 v9, s[16:17]
    s_mov_b32 m0, 148864
    s_nop 0
    global_load_lds_dwordx4 v9, s[26:27]
    s_mov_b64 exec, -1
K_HELP2:
    s_mul_i32 s54, s53, 625
    s_add_u32 s57, s54, 640
    s_add_u32 s54, s54, 15
    s_lshr_b32 s54, s54, 4
    s_lshr_b32 s57, s57, 4
    s_mov_b32 s28, s4
    s_and_b32 s29, s5, 0xffff
    s_or_b32 s29, s29, 0x100000
    s_mov_b32 s30, 10240000
    s_mov_b32 s31, 0x800000
    s_mov_b32 s32, s20
    s_mov_b32 s33, s21
    s_lshl_b32 s34, s57, 10
    s_mov_b32 s35, 0x20000
    s_mov_b32 s36, s24
    s_mov_b32 s37, s25
    s_mov_b32 s38, 8388608
    s_mov_b32 s39, 0x20000
    s_mov_b32 s47, 0
    s_mov_b32 s63, 0
    v_mov_b32 v14, 1
    s_lshr_b32 s27, s53, 5
    s_mul_i32 s27, s27, 20009
    s_add_u32 s27, s27, 14
    s_lshr_b32 s27, s27, 4
    s_lshl_b32 s27, s27, 10
    v_mov_b32 v16, 0
    v_mov_b32 v17, 0
    v_mov_b32 v18, 0
    v_mov_b32 v19, 0
    v_mov_b32 v20, 0
    v_mov_b32 v21, 0
    v_mov_b32 v22, 0
    v_mov_b32 v23, 0
    v_mov_b32 v24, 0
    v_mov_b32 v25, 0
    v_mov_b32 v26, 0
    v_mov_b32 v27, 0
    v_mov_b32 v28, 0
    v_mov_b32 v29, 0
    v_mov_b32 v30, 0
    v_mov_b32 v31, 0
    v_mov_b32 v32, 0
    v_mov_b32 v33, 0
    v_mov_b32 v34, 0
    v_mov_b32 v35, 0
    v_mov_b32 v36, 0
    v_mov_b32 v37, 0
    v_mov_b32 v38, 0
    v_mov_b32 v39, 0
    v_mov_b32 v40, 0
    v_mov_b32 v41, 0
    v_mov_b32 v42, 0
    v_mov_b32 v43, 0
    v_mov_b32 v44, 0
    v_mov_b32 v45, 0
    v_mov_b32 v46, 0
    v_mov_b32 v47, 0
    v_mov_b32 v48, 0
    v_mov_b32 v49, 0
    v_mov_b32 v50, 0
    v_mov_b32 v51, 0
    v_mov_b32 v52, 0
    v_mov_b32 v53, 0
    v_mov_b32 v54, 0
    v_mov_b32 v55, 0
K_BB:
    s_waitcnt lgkmcnt(0)
    s_barrier
    s_add_u32 s52, s52, 1
    s_and_b32 s56, s52, 0x3ff
    s_lshl_b32 s58, s56, 22
    s_lshl_b32 s26, s52, 24
    s_cmp_eq_u32 s3, 7
    s_cselect_b32 s56, 1, s40
    s_cmp_eq_u32 s56, 0
    s_cbranch_scc1 K_BC1
    ds_read_b128 v[152:155], v9 offset:768
    s_cmp_eq_u32 s3, 7
    s_cbranch_scc1 K_SC
    s_waitcnt vmcnt(4)
    v_mul_u32_u24 v60, 1677, v124
    v_lshrrev_b32 v60, 20, v60
    v_lshl_or_b32 v56, v56, 4, v60
    v_lshl_or_b32 v56, v124, 10, v56
    v_mul_u32_u24 v61, 1677, v125
    v_lshrrev_b32 v61, 20, v61
    v_lshl_or_b32 v57, v57, 4, v61
    v_lshl_or_b32 v57, v125, 10, v57
    v_mul_u32_u24 v62, 1677, v126
    v_lshrrev_b32 v62, 20, v62
    v_lshl_or_b32 v58, v58, 4, v62
    v_lshl_or_b32 v58, v126, 10, v58
    v_mul_u32_u24 v63, 1677, v127
    v_lshrrev_b32 v63, 20, v63
    v_lshl_or_b32 v59, v59, 4, v63
    v_lshl_or_b32 v59, v127, 10, v59
K_SC:
    s_waitcnt lgkmcnt(0)
    v_add_u32 v156, v152, v153
    v_add_u32 v157, v156, v154
    v_add_u32 v158, v157, v155
    v_mov_b32 v160, v158
    v_or_b32 v66, s26, v56
    v_mov_b32 v67, s52
    v_add_u32_dpp v160, v160, v160 row_shr:1 row_mask:0xf bank_mask:0xf
    v_or_b32 v68, s26, v57
    v_mov_b32 v69, s52
    v_add_u32_dpp v160, v160, v160 row_shr:2 row_mask:0xf bank_mask:0xf
    v_or_b32 v70, s26, v58
    v_mov_b32 v71, s52
    v_add_u32_dpp v160, v160, v160 row_shr:4 row_mask:0xf bank_mask:0xf
    v_or_b32 v72, s26, v59
    v_mov_b32 v73, s52
    v_add_u32_dpp v160, v160, v160 row_shr:8 row_mask:0xf bank_mask:0xf
    s_nop 1
    v_add_u32_dpp v160, v160, v160 row_bcast:15 row_mask:0xa bank_mask:0xf
    s_nop 1
    v_add_u32_dpp v160, v160, v160 row_bcast:31 row_mask:0xc bank_mask:0xf
    v_sub_u32 v160, v160, v158
    v_add_u32 v161, v160, v152
    v_add_u32 v162, v160, v156
    v_add_u32 v163, v160, v157
    s_cmp_lg_u32 s3, 7
    s_cbranch_scc1 K_NOROW
    v_lshl_or_b32 v168, v152, 11, v160
    v_or_b32 v168, s58, v168
    v_mov_b32 v169, s52
    v_lshl_or_b32 v170, v153, 11, v161
    v_or_b32 v170, s58, v170
    v_mov_b32 v171, s52
    v_lshl_or_b32 v172, v154, 11, v162
    v_or_b32 v172, s58, v172
    v_mov_b32 v173, s52
    v_lshl_or_b32 v174, v155, 11, v163
    v_or_b32 v174, s58, v174
    v_mov_b32 v175, s52
    s_lshl_b32 s57, s2, 11
    s_add_u32 s57, s57, 8192
    v_lshlrev_b32 v12, 5, v1
    buffer_store_dwordx4 v[168:171], v12, s[36:39], s57 offen sc1
    buffer_store_dwordx4 v[172:175], v12, s[36:39], s57 offen offset:16 sc1
    s_branch K_BC1
K_NOROW:
    ds_write_b128 v9, v[160:163] offset:4096
    ds_read_b32 v60, v144 offset:4096
    ds_read_b32 v61, v145 offset:4096
    ds_read_b32 v62, v146 offset:4096
    ds_read_b32 v63, v147 offset:4096
    s_waitcnt lgkmcnt(3)
    v_add_lshl_u32 v144, v60, v148, 3
    ds_write_b64 v144, v[66:67] offset:13824
    s_waitcnt lgkmcnt(3)
    v_add_lshl_u32 v145, v61, v149, 3
    ds_write_b64 v145, v[68:69] offset:13824
    s_waitcnt lgkmcnt(3)
    v_add_lshl_u32 v146, v62, v150, 3
    ds_write_b64 v146, v[70:71] offset:13824
    s_waitcnt lgkmcnt(3)
    v_add_lshl_u32 v147, v63, v151, 3
    ds_write_b64 v147, v[72:73] offset:13824
    s_mov_b32 s56, 44800
    v_lshl_add_u32 v144, v144, 1, s56
    v_lshl_add_u32 v145, v145, 1, s56
    v_lshl_add_u32 v146, v146, 1, s56
    v_lshl_add_u32 v147, v147, 1, s56
K_BC1:
    s_mul_i32 s60, s2, 10240
    s_add_u32 s60, s60, 532480
    s_sub_u32 s56, s3, 5
    s_lshl_b32 s57, s56, 14
    v_add_u32 v13, s57, v9
    s_add_u32 s57, s57, 114944
    s_waitcnt lgkmcnt(0)
    s_barrier
    s_cmp_ge_u32 s2, 250
    s_cbranch_scc1 K_KS2
    ds_read_b128 v[76:79], v10 offset:13824
    s_cmp_lt_u32 s56, 2
    s_cbranch_scc0 K_KS1
    ds_read_b128 v[80:83], v10 offset:16896
    s_add_u32 s59, s60, 3072
    s_waitcnt lgkmcnt(0)
    buffer_store_dwordx4 v[80:83], v10, s[36:39], s59 offen sc1
K_KS1:
    s_waitcnt lgkmcnt(0)
    buffer_store_dwordx4 v[76:79], v10, s[36:39], s60 offen sc1
K_KS2:
    s_cmp_lt_u32 s56, 2
    s_cbranch_scc1 K_DMA
    s_cmp_eq_u32 s40, 0
    s_cbranch_scc1 K_BC7
    s_waitcnt vmcnt(2)
    ds_write2_b64 v144, v[128:129], v[136:137] offset0:0 offset1:1
    ds_write2_b64 v145, v[130:131], v[138:139] offset0:0 offset1:1
    s_waitcnt vmcnt(1)
    ds_write2_b64 v146, v[132:133], v[140:141] offset0:0 offset1:1
    ds_write2_b64 v147, v[134:135], v[142:143] offset0:0 offset1:1
    s_branch K_BC
K_DMA:
    s_mov_b32 m0, s57
    s_add_u32 s57, s57, 4096
    global_load_lds_dwordx4 v13, s[18:19] offset:0
    global_load_lds_dwordx4 v13, s[18:19] offset:1024
    global_load_lds_dwordx4 v13, s[18:19] offset:2048
    global_load_lds_dwordx4 v13, s[18:19] offset:3072
    v_add_u32 v13, 4096, v13
    s_mov_b32 m0, s57
    s_add_u32 s57, s57, 4096
    global_load_lds_dwordx4 v13, s[18:19] offset:0
    global_load_lds_dwordx4 v13, s[18:19] offset:1024
    global_load_lds_dwordx4 v13, s[18:19] offset:2048
    global_load_lds_dwordx4 v13, s[18:19] offset:3072
    v_add_u32 v13, 4096, v13
    s_mov_b32 m0, s57
    s_add_u32 s57, s57, 4096
    global_load_lds_dwordx4 v13, s[18:19] offset:0
    global_load_lds_dwordx4 v13, s[18:19] offset:1024
    global_load_lds_dwordx4 v13, s[18:19] offset:2048
    global_load_lds_dwordx4 v13, s[18:19] offset:3072
    v_add_u32 v13, 4096, v13
    s_mov_b32 m0, s57
    s_add_u32 s57, s57, 4096
    global_load_lds_dwordx4 v13, s[18:19] offset:0
    global_load_lds_dwordx4 v13, s[18:19] offset:1024
    global_load_lds_dwordx4 v13, s[18:19] offset:2048
    global_load_lds_dwordx4 v13, s[18:19] offset:3072
    s_branch K_BC
K_BC7:
    s_cmp_ge_u32 s2, 250
    s_cbranch_scc0 K_BC8
    s_waitcnt vmcnt(2)
K_BC8:
    s_waitcnt vmcnt(3)
K_BC:
    s_mul_i32 s56, s2, 20480
    s_add_u32 s56, s56, 3145728
    s_add_u32 s57, s56, 8192
    s_add_u32 s59, s56, 16384
    v_lshlrev_b32 v11, 11, v0
    s_lshl_b32 s61, s53, 3
    s_add_u32 s61, s61, 8192
    s_waitcnt lgkmcnt(0)
    s_barrier
    s_cmp_ge_u32 s2, 250
    s_cbranch_scc1 K_NOST
    ds_read_b128 v[56:59], v10 offset:44800
    ds_read_b128 v[60:63], v10 offset:52992
    s_cmp_ge_u32 s3, 4
    s_cbranch_scc1 K_ST1
    ds_read_b128 v[64:67], v10 offset:61184
    s_waitcnt lgkmcnt(0)
    buffer_store_dwordx4 v[64:67], v10, s[36:39], s59 offen sc1
K_ST1:
    s_waitcnt lgkmcnt(1)
    buffer_store_dwordx4 v[56:59], v10, s[36:39], s56 offen sc1
    s_waitcnt lgkmcnt(0)
    buffer_store_dwordx4 v[60:63], v10, s[36:39], s57 offen sc1
K_NOST:
    s_lshr_b32 s56, s34, 10
    s_sub_u32 s56, s56, s54
    s_sub_u32 s56, s56, 39
    s_lshl_b32 s56, s56, 6
    s_add_u32 s56, s56, 148864
    v_add_u32 v2, s56, v1
    v_add_u32 v13, 147712, v15
    ds_read_u8 v2, v2
    ds_read2st64_b32 v[188:189], v13 offset0:0 offset1:1
    ds_read2st64_b32 v[190:191], v13 offset0:2 offset1:3
    v_and_b32 v12, 3, v1
    v_lshlrev_b32 v12, 5, v12
    v_bfe_u32 v13, v1, 2, 2
    v_lshl_or_b32 v12, v13, 1, v12
    v_add_u32 v12, 148736, v12
    ds_read_u16 v192, v12 offset:0
    ds_read_u16 v193, v12 offset:8
    ds_read_u16 v194, v12 offset:16
    ds_read_u16 v195, v12 offset:24
    v_mov_b32 v252, v3
    v_xor_b32 v253, 1024, v3
    v_mul_u32_u24 v185, 128, v0
    s_mov_b32 s56, 0xbfb8aa3b
    s_waitcnt lgkmcnt(0)
    v_lshlrev_b32 v136, 16, v188
    v_mul_f32 v140, s56, v136
    v_lshlrev_b32 v137, 16, v189
    v_mul_f32 v141, s56, v137
    v_lshlrev_b32 v138, 16, v190
    v_mul_f32 v142, s56, v138
    v_lshlrev_b32 v139, 16, v191
    v_mul_f32 v143, s56, v139
    v_cvt_pk_bf16_f32 v176, v140, v141
    v_cvt_pk_bf16_f32 v177, v142, v143
    v_and_b32 v136, 0xffff0000, v188
    v_mul_f32 v140, s56, v136
    v_and_b32 v137, 0xffff0000, v189
    v_mul_f32 v141, s56, v137
    v_and_b32 v138, 0xffff0000, v190
    v_mul_f32 v142, s56, v138
    v_and_b32 v139, 0xffff0000, v191
    v_mul_f32 v143, s56, v139
    v_cvt_pk_bf16_f32 v180, v140, v141
    v_cvt_pk_bf16_f32 v181, v142, v143
    v_lshl_or_b32 v136, v193, 16, v192
    v_lshl_or_b32 v137, v195, 16, v194
    v_lshrrev_b32 v13, 4, v1
    v_cmp_eq_u32 vcc, 0, v13
    s_nop 1
    v_cndmask_b32 v232, 0, v136, vcc
    v_cndmask_b32 v233, 0, v137, vcc
    v_cmp_eq_u32 vcc, 1, v13
    s_nop 1
    v_cndmask_b32 v234, 0, v136, vcc
    v_cndmask_b32 v235, 0, v137, vcc
    v_cmp_eq_u32 vcc, 2, v13
    s_nop 1
    v_cndmask_b32 v236, 0, v136, vcc
    v_cndmask_b32 v237, 0, v137, vcc
    v_cmp_eq_u32 vcc, 3, v13
    s_nop 1
    v_cndmask_b32 v238, 0, v136, vcc
    v_cndmask_b32 v239, 0, v137, vcc
    v_mul_u32_u24 v13, 5120, v1
    s_cmp_ge_u32 s3, 4
    s_cbranch_scc1 K_TABOK
    s_mov_b32 s59, 40000
    s_lshr_b32 s58, s58, 22
K_POLLA:
    buffer_load_dwordx2 v[152:153], v11, s[36:39], s61 offen sc1
    s_waitcnt vmcnt(0)
    v_lshrrev_b32 v154, 22, v152
    v_cmp_ne_u32 vcc, s52, v153
    v_cmp_ne_u32 s[56:57], s58, v154
    s_or_b64 vcc, vcc, s[56:57]
    s_cbranch_vccz K_POLLAOK
    s_sub_u32 s59, s59, 1
    s_cbranch_scc0 K_POLLA
    ds_write_b32 v4, v14 offset:1792
K_POLLAOK:
    ds_write_b32 v3, v152 offset:5120
K_TABOK:
    s_waitcnt vmcnt(0) lgkmcnt(0)
    s_barrier
    s_cmp_lg_u32 s3, 4
    s_cbranch_scc1 K_NOFLAG
    s_mul_i32 s56, s2, 128
    s_add_u32 s56, s56, 8323072
    v_mov_b32 v10, s52
    s_mov_b64 exec, 1
    buffer_store_dword v10, v4, s[36:39], s56 offen sc1
    s_mov_b64 exec, -1
K_NOFLAG:
    ds_read_b128 v[120:123], v9 offset:5120
    ds_read_b32 v10, v4 offset:1792
    s_waitcnt lgkmcnt(0)
    v_readfirstlane_b32 s55, v10
    v_bfe_u32 v124, v120, 11, 11
    v_bfe_u32 v125, v121, 11, 11
    v_bfe_u32 v126, v122, 11, 11
    v_bfe_u32 v127, v123, 11, 11
    v_add_u32 v129, v124, v125
    v_add_u32 v130, v129, v126
    v_add_u32 v131, v130, v127
    v_mov_b32 v132, v131
    v_and_b32 v120, 0x7ff, v120
    v_add_u32 v248, v13, v120
    v_add_u32_dpp v132, v132, v132 row_shr:1 row_mask:0xf bank_mask:0xf
    v_and_b32 v121, 0x7ff, v121
    v_add_u32 v249, v13, v121
    v_add_u32_dpp v132, v132, v132 row_shr:2 row_mask:0xf bank_mask:0xf
    v_add_u32 v249, 1280, v249
    v_and_b32 v122, 0x7ff, v122
    v_add_u32_dpp v132, v132, v132 row_shr:4 row_mask:0xf bank_mask:0xf
    v_add_u32 v250, v13, v122
    v_add_u32 v250, 2560, v250
    v_add_u32_dpp v132, v132, v132 row_shr:8 row_mask:0xf bank_mask:0xf
    v_and_b32 v123, 0x7ff, v123
    v_add_u32 v251, v13, v123
    v_add_u32_dpp v132, v132, v132 row_bcast:15 row_mask:0xa bank_mask:0xf
    v_add_u32 v251, 3840, v251
    s_nop 0
    v_add_u32_dpp v132, v132, v132 row_bcast:31 row_mask:0xc bank_mask:0xf
    s_cmp_lg_u32 s55, 0
    s_cbranch_scc1 K_FB0
    v_readlane_b32 s46, v132, 63
    v_sub_u32 v240, v132, v131
    v_add_u32 v241, v240, v124
    v_add_u32 v242, v240, v129
    v_add_u32 v243, v240, v130
    v_sub_u32 v248, v248, v240
    v_add_u32 v244, v240, v124
    v_sub_u32 v249, v249, v241
    v_add_u32 v245, v241, v125
    v_sub_u32 v250, v250, v242
    v_add_u32 v246, v242, v126
    v_sub_u32 v251, v251, v243
    v_add_u32 v247, v243, v127
K_ROUND:
    s_mul_i32 s56, s3, 192
    s_add_u32 s56, s56, s47
    s_add_u32 s57, s56, 192
    s_lshl_b32 s58, s3, 10
    s_add_u32 s58, s58, 106752
    v_cmp_lt_u32 vcc, s56, v244
    v_cmp_gt_u32 s[60:61], s57, v240
    v_subrev_u32 v56, s56, v240
    v_max_i32 v56, 0, v56
    v_lshl_add_u32 v56, v56, 2, s58
    s_and_b64 exec, vcc, s[60:61]
    ds_max_u32 v56, v248
    s_mov_b64 exec, -1
    v_cmp_lt_u32 vcc, s56, v245
    v_cmp_gt_u32 s[60:61], s57, v241
    v_subrev_u32 v57, s56, v241
    v_max_i32 v57, 0, v57
    v_lshl_add_u32 v57, v57, 2, s58
    s_and_b64 exec, vcc, s[60:61]
    ds_max_u32 v57, v249
    s_mov_b64 exec, -1
    v_cmp_lt_u32 vcc, s56, v246
    v_cmp_gt_u32 s[60:61], s57, v242
    v_subrev_u32 v58, s56, v242
    v_max_i32 v58, 0, v58
    v_lshl_add_u32 v58, v58, 2, s58
    s_and_b64 exec, vcc, s[60:61]
    ds_max_u32 v58, v250
    s_mov_b64 exec, -1
    v_cmp_lt_u32 vcc, s56, v247
    v_cmp_gt_u32 s[60:61], s57, v243
    v_subrev_u32 v59, s56, v243
    v_max_i32 v59, 0, v59
    v_lshl_add_u32 v59, v59, 2, s58
    s_and_b64 exec, vcc, s[60:61]
    ds_max_u32 v59, v251
    s_mov_b64 exec, -1
    v_add_u32 v60, s58, v15
    ds_read_b32 v64, v60 offset:0
    ds_read_b32 v65, v60 offset:256
    ds_read_b32 v66, v60 offset:512
    v_add_u32 v68, s56, v1
    v_add_u32 v69, 64, v68
    v_add_u32 v70, 128, v68
    v_cmp_gt_u32 s[40:41], s46, v68
    v_cmp_gt_u32 s[42:43], s46, v69
    v_cmp_gt_u32 s[44:45], s46, v70
    s_mov_b32 s60, 532480
    s_mov_b32 s61, 3145728
    s_lshr_b32 s62, s26, 24
    s_waitcnt lgkmcnt(0)
    v_max_u32_dpp v64, v64, v64 row_shr:1 row_mask:0xf bank_mask:0xf
    v_max_u32_dpp v65, v65, v65 row_shr:1 row_mask:0xf bank_mask:0xf
    v_max_u32_dpp v66, v66, v66 row_shr:1 row_mask:0xf bank_mask:0xf
    v_max_u32_dpp v64, v64, v64 row_shr:2 row_mask:0xf bank_mask:0xf
    v_max_u32_dpp v65, v65, v65 row_shr:2 row_mask:0xf bank_mask:0xf
    v_max_u32_dpp v66, v66, v66 row_shr:2 row_mask:0xf bank_mask:0xf
    v_max_u32_dpp v64, v64, v64 row_shr:4 row_mask:0xf bank_mask:0xf
    v_max_u32_dpp v65, v65, v65 row_shr:4 row_mask:0xf bank_mask:0xf
    v_max_u32_dpp v66, v66, v66 row_shr:4 row_mask:0xf bank_mask:0xf
    v_max_u32_dpp v64, v64, v64 row_shr:8 row_mask:0xf bank_mask:0xf
    v_max_u32_dpp v65, v65, v65 row_shr:8 row_mask:0xf bank_mask:0xf
    v_max_u32_dpp v66, v66, v66 row_shr:8 row_mask:0xf bank_mask:0xf
    v_max_u32_dpp v64, v64, v64 row_bcast:15 row_mask:0xa bank_mask:0xf
    v_max_u32_dpp v65, v65, v65 row_bcast:15 row_mask:0xa bank_mask:0xf
    v_max_u32_dpp v66, v66, v66 row_bcast:15 row_mask:0xa bank_mask:0xf
    v_max_u32_dpp v64, v64, v64 row_bcast:31 row_mask:0xc bank_mask:0xf
    v_max_u32_dpp v65, v65, v65 row_bcast:31 row_mask:0xc bank_mask:0xf
    v_max_u32_dpp v66, v66, v66 row_bcast:31 row_mask:0xc bank_mask:0xf
    v_readlane_b32 s56, v64, 63
    v_readlane_b32 s57, v65, 63
    v_add_u32 v68, v68, v64
    s_max_u32 s57, s56, s57
    v_max_u32 v65, s56, v65
    v_max_u32 v66, s57, v66
    v_add_u32 v69, v69, v65
    v_add_u32 v70, v70, v66
    v_lshlrev_b32 v81, 3, v68
    v_lshlrev_b32 v82, 3, v69
    v_lshlrev_b32 v83, 3, v70
    s_mov_b64 exec, s[40:41]
    buffer_load_dwordx2 v[72:73], v81, s[36:39], s60 offen sc1
    s_mov_b64 exec, s[42:43]
    buffer_load_dwordx2 v[74:75], v82, s[36:39], s60 offen sc1
    s_mov_b64 exec, s[44:45]
    buffer_load_dwordx2 v[76:77], v83, s[36:39], s60 offen sc1
    s_mov_b64 exec, -1
    v_lshlrev_b32 v100, 4, v68
    v_lshlrev_b32 v101, 4, v69
    v_lshlrev_b32 v102, 4, v70
    s_cmp_lg_u32 s47, 0
    s_cbranch_scc1 K_KEYS1
    s_and_b32 s56, s3, 3
    s_lshl_b32 s56, s56, 6
    s_add_u32 s56, s56, 114944
    v_lshrrev_b32 v10, 4, v1
    v_lshlrev_b32 v10, 11, v10
    v_and_b32 v12, 15, v1
    v_lshl_or_b32 v10, v12, 2, v10
    v_add_u32 v10, s56, v10
    s_mov_b32 s56, 0x05040100
    s_mov_b32 s57, 0x07060302
    ds_read2st64_b32 v[120:121], v10 offset0:0 offset1:1
    ds_read2st64_b32 v[122:123], v10 offset0:2 offset1:3
    ds_read2st64_b32 v[124:125], v10 offset0:4 offset1:5
    ds_read2st64_b32 v[126:127], v10 offset0:6 offset1:7
    ds_read2st64_b32 v[128:129], v10 offset0:32 offset1:33
    ds_read2st64_b32 v[130:131], v10 offset0:34 offset1:35
    ds_read2st64_b32 v[132:133], v10 offset0:36 offset1:37
    ds_read2st64_b32 v[134:135], v10 offset0:38 offset1:39
    ds_read2st64_b32 v[136:137], v10 offset0:64 offset1:65
    ds_read2st64_b32 v[138:139], v10 offset0:66 offset1:67
    ds_read2st64_b32 v[140:141], v10 offset0:68 offset1:69
    ds_read2st64_b32 v[142:143], v10 offset0:70 offset1:71
    ds_read2st64_b32 v[144:145], v10 offset0:96 offset1:97
    ds_read2st64_b32 v[146:147], v10 offset0:98 offset1:99
    ds_read2st64_b32 v[148:149], v10 offset0:100 offset1:101
    ds_read2st64_b32 v[150:151], v10 offset0:102 offset1:103
    s_waitcnt lgkmcnt(15)
    v_perm_b32 v200, v121, v120, s56
    v_perm_b32 v216, v121, v120, s57
    s_waitcnt lgkmcnt(14)
    v_perm_b32 v201, v123, v122, s56
    v_perm_b32 v217, v123, v122, s57
    s_waitcnt lgkmcnt(13)
    v_perm_b32 v202, v125, v124, s56
    v_perm_b32 v218, v125, v124, s57
    s_waitcnt lgkmcnt(12)
    v_perm_b32 v203, v127, v126, s56
    v_perm_b32 v219, v127, v126, s57
    s_waitcnt lgkmcnt(11)
    v_perm_b32 v204, v129, v128, s56
    v_perm_b32 v220, v129, v128, s57
    s_waitcnt lgkmcnt(10)
    v_perm_b32 v205, v131, v130, s56
    v_perm_b32 v221, v131, v130, s57
    s_waitcnt lgkmcnt(9)
    v_perm_b32 v206, v133, v132, s56
    v_perm_b32 v222, v133, v132, s57
    s_waitcnt lgkmcnt(8)
    v_perm_b32 v207, v135, v134, s56
    v_perm_b32 v223, v135, v134, s57
    s_waitcnt lgkmcnt(7)
    v_perm_b32 v208, v137, v136, s56
    v_perm_b32 v224, v137, v136, s57
    s_waitcnt lgkmcnt(6)
    v_perm_b32 v209, v139, v138, s56
    v_perm_b32 v225, v139, v138, s57
    s_waitcnt lgkmcnt(5)
    v_perm_b32 v210, v141, v140, s56
    v_perm_b32 v226, v141, v140, s57
    s_waitcnt lgkmcnt(4)
    v_perm_b32 v211, v143, v142, s56
    v_perm_b32 v227, v143, v142, s57
    s_waitcnt lgkmcnt(3)
    v_perm_b32 v212, v145, v144, s56
    v_perm_b32 v228, v145, v144, s57
    s_waitcnt lgkmcnt(2)
    v_perm_b32 v213, v147, v146, s56
    v_perm_b32 v229, v147, v146, s57
    s_waitcnt lgkmcnt(1)
    v_perm_b32 v214, v149, v148, s56
    v_perm_b32 v230, v149, v148, s57
    s_waitcnt lgkmcnt(0)
    v_perm_b32 v215, v151, v150, s56
    v_perm_b32 v231, v151, v150, s57
    s_branch K_KEYS1
K_KEYS:
    s_mov_b64 exec, s[40:41]
    buffer_load_dwordx2 v[72:73], v81, s[36:39], s60 offen sc1
    s_mov_b64 exec, s[42:43]
    buffer_load_dwordx2 v[74:75], v82, s[36:39], s60 offen sc1
    s_mov_b64 exec, s[44:45]
    buffer_load_dwordx2 v[76:77], v83, s[36:39], s60 offen sc1
    s_mov_b64 exec, -1
K_KEYS1:
    v_mov_b32 v14, 64
    s_mov_b64 s[58:59], 0
    s_waitcnt vmcnt(2)
    v_lshrrev_b32 v78, 24, v72
    v_cmp_ne_u32 vcc, s52, v73
    v_cmp_ne_u32 s[56:57], s62, v78
    s_or_b64 vcc, vcc, s[56:57]
    s_and_b64 vcc, vcc, s[40:41]
    s_or_b64 s[58:59], s[58:59], vcc
    s_waitcnt vmcnt(1)
    v_lshrrev_b32 v79, 24, v74
    v_cmp_ne_u32 vcc, s52, v75
    v_cmp_ne_u32 s[56:57], s62, v79
    s_or_b64 vcc, vcc, s[56:57]
    s_and_b64 vcc, vcc, s[42:43]
    s_or_b64 s[58:59], s[58:59], vcc
    s_waitcnt vmcnt(0)
    v_lshrrev_b32 v80, 24, v76
    v_cmp_ne_u32 vcc, s52, v77
    v_cmp_ne_u32 s[56:57], s62, v80
    s_or_b64 vcc, vcc, s[56:57]
    s_and_b64 vcc, vcc, s[44:45]
    s_or_b64 s[58:59], s[58:59], vcc
    s_cbranch_scc1 K_KEYS
    s_cmp_lg_u32 s47, 0
    s_cbranch_scc1 K_LATER
    s_mov_b32 s62, 8323072
    s_cmp_lt_u32 s3, 4
    s_cbranch_scc0 K_GOT
    buffer_load_dword v184, v185, s[36:39], s62 offen sc1
K_GOT:
    v_lshrrev_b32 v81, 2, v72
    v_and_b32 v81, 0xfc, v81
    v_lshrrev_b32 v82, 2, v74
    v_and_b32 v82, 0xfc, v82
    v_lshrrev_b32 v83, 2, v76
    v_and_b32 v83, 0xfc, v83
    s_mov_b64 exec, s[40:41]
    ds_add_u32 v81, v14 offset:512
    s_mov_b64 exec, s[42:43]
    ds_add_u32 v82, v14 offset:512
    s_mov_b64 exec, s[44:45]
    ds_add_u32 v83, v14 offset:512
    s_mov_b64 exec, -1
    s_lshr_b32 s56, s3, 2
    s_or_b32 s56, s56, s55
    s_cbranch_scc1 K_POLLBOK
K_POLLB:
    s_waitcnt vmcnt(0)
    v_cmp_ne_u32 vcc, s52, v184
    s_cbranch_vccz K_POLLBOK
    buffer_load_dword v184, v185, s[36:39], s62 offen sc1
    s_branch K_POLLB
K_POLLBOK:
    s_waitcnt lgkmcnt(0)
    s_barrier
    s_cmp_lg_u32 s55, 0
    s_cbranch_scc1 K_NOPF
    s_mov_b64 exec, s[40:41]
    buffer_load_dwordx4 v[88:91], v100, s[36:39], s61 offen sc1
    s_mov_b64 exec, s[42:43]
    buffer_load_dwordx4 v[92:95], v101, s[36:39], s61 offen sc1
    s_mov_b64 exec, s[44:45]
    buffer_load_dwordx4 v[96:99], v102, s[36:39], s61 offen sc1
    s_mov_b64 exec, -1
    s_cmp_lt_u32 s3, 5
    s_cbranch_scc1 K_NOPF
    s_mov_b32 s64, s4
    s_mov_b32 s65, s5
    s_mov_b32 s66, 10240000
    s_mov_b32 s67, 0x20000
    s_sub_u32 s68, 7, s3
    s_lshl_b32 s68, s68, 5
    s_and_b32 s69, s53, 31
    s_add_u32 s68, s68, s69
    s_lshl_b32 s68, s68, 13
    s_add_u32 s68, s68, s27
    v_lshlrev_b32 v13, 7, v1
    buffer_load_dword v255, v13, s[64:67], s68 offen
K_NOPF:
    ds_read_b32 v168, v15 offset:512
    ds_read_b128 v[120:123], v4 offset:512
    ds_read_b128 v[124:127], v4 offset:528
    ds_read_b128 v[128:131], v4 offset:544
    ds_read_b128 v[132:135], v4 offset:560
    ds_read_b128 v[136:139], v4 offset:576
    ds_read_b128 v[140:143], v4 offset:592
    ds_read_b128 v[144:147], v4 offset:608
    ds_read_b128 v[148:151], v4 offset:624
    ds_read_b128 v[152:155], v4 offset:640
    ds_read_b128 v[156:159], v4 offset:656
    v_cmp_gt_u32 vcc, 40, v1
    s_waitcnt lgkmcnt(9)
    v_pk_add_f32 v[120:121], v[120:121], v[168:169] op_sel_hi:[1,0] neg_lo:[0,1] neg_hi:[0,1] clamp
    v_pk_add_f32 v[122:123], v[122:123], v[168:169] op_sel_hi:[1,0] neg_lo:[0,1] neg_hi:[0,1] clamp
    s_waitcnt lgkmcnt(8)
    v_pk_add_f32 v[124:125], v[124:125], v[168:169] op_sel_hi:[1,0] neg_lo:[0,1] neg_hi:[0,1] clamp
    v_pk_add_f32 v[124:125], v[124:125], v[120:121]
    v_pk_add_f32 v[126:127], v[126:127], v[168:169] op_sel_hi:[1,0] neg_lo:[0,1] neg_hi:[0,1] clamp
    v_pk_add_f32 v[126:127], v[126:127], v[122:123]
    s_waitcnt lgkmcnt(7)
    v_pk_add_f32 v[128:129], v[128:129], v[168:169] op_sel_hi:[1,0] neg_lo:[0,1] neg_hi:[0,1] clamp
    v_pk_add_f32 v[128:129], v[128:129], v[124:125]
    v_pk_add_f32 v[130:131], v[130:131], v[168:169] op_sel_hi:[1,0] neg_lo:[0,1] neg_hi:[0,1] clamp
    v_pk_add_f32 v[130:131], v[130:131], v[126:127]
    s_waitcnt lgkmcnt(6)
    v_pk_add_f32 v[132:133], v[132:133], v[168:169] op_sel_hi:[1,0] neg_lo:[0,1] neg_hi:[0,1] clamp
    v_pk_add_f32 v[132:133], v[132:133], v[128:129]
    v_pk_add_f32 v[134:135], v[134:135], v[168:169] op_sel_hi:[1,0] neg_lo:[0,1] neg_hi:[0,1] clamp
    v_pk_add_f32 v[134:135], v[134:135], v[130:131]
    s_waitcnt lgkmcnt(5)
    v_pk_add_f32 v[136:137], v[136:137], v[168:169] op_sel_hi:[1,0] neg_lo:[0,1] neg_hi:[0,1] clamp
    v_pk_add_f32 v[136:137], v[136:137], v[132:133]
    v_pk_add_f32 v[138:139], v[138:139], v[168:169] op_sel_hi:[1,0] neg_lo:[0,1] neg_hi:[0,1] clamp
    v_pk_add_f32 v[138:139], v[138:139], v[134:135]
    s_waitcnt lgkmcnt(4)
    v_pk_add_f32 v[140:141], v[140:141], v[168:169] op_sel_hi:[1,0] neg_lo:[0,1] neg_hi:[0,1] clamp
    v_pk_add_f32 v[140:141], v[140:141], v[136:137]
    v_pk_add_f32 v[142:143], v[142:143], v[168:169] op_sel_hi:[1,0] neg_lo:[0,1] neg_hi:[0,1] clamp
    v_pk_add_f32 v[142:143], v[142:143], v[138:139]
    s_waitcnt lgkmcnt(3)
    v_pk_add_f32 v[144:145], v[144:145], v[168:169] op_sel_hi:[1,0] neg_lo:[0,1] neg_hi:[0,1] clamp
    v_pk_add_f32 v[144:145], v[144:145], v[140:141]
    v_pk_add_f32 v[146:147], v[146:147], v[168:169] op_sel_hi:[1,0] neg_lo:[0,1] neg_hi:[0,1] clamp
    v_pk_add_f32 v[146:147], v[146:147], v[142:143]
    s_waitcnt lgkmcnt(2)
    v_pk_add_f32 v[148:149], v[148:149], v[168:169] op_sel_hi:[1,0] neg_lo:[0,1] neg_hi:[0,1] clamp
    v_pk_add_f32 v[148:149], v[148:149], v[144:145]
    v_pk_add_f32 v[150:151], v[150:151], v[168:169] op_sel_hi:[1,0] neg_lo:[0,1] neg_hi:[0,1] clamp
    v_pk_add_f32 v[150:151], v[150:151], v[146:147]
    s_waitcnt lgkmcnt(1)
    v_pk_add_f32 v[152:153], v[152:153], v[168:169] op_sel_hi:[1,0] neg_lo:[0,1] neg_hi:[0,1] clamp
    v_pk_add_f32 v[152:153], v[152:153], v[148:149]
    v_pk_add_f32 v[154:155], v[154:155], v[168:169] op_sel_hi:[1,0] neg_lo:[0,1] neg_hi:[0,1] clamp
    v_pk_add_f32 v[154:155], v[154:155], v[150:151]
    s_waitcnt lgkmcnt(0)
    v_pk_add_f32 v[156:157], v[156:157], v[168:169] op_sel_hi:[1,0] neg_lo:[0,1] neg_hi:[0,1] clamp
    v_pk_add_f32 v[156:157], v[156:157], v[152:153]
    v_pk_add_f32 v[158:159], v[158:159], v[168:169] op_sel_hi:[1,0] neg_lo:[0,1] neg_hi:[0,1] clamp
    v_pk_add_f32 v[158:159], v[158:159], v[154:155]
    v_pk_add_f32 v[158:159], v[158:159], v[156:157]
    v_add_f32 v158, v158, v159
    v_cvt_u32_f32 v158, v158
    v_lshlrev_b32 v158, 2, v158
    ds_bpermute_b32 v2, v158, v2
    s_waitcnt lgkmcnt(0)
    v_cndmask_b32 v2, -1, v2, vcc
K_BAL:
    ds_bpermute_b32 v84, v81, v2
    ds_bpermute_b32 v85, v82, v2
    ds_bpermute_b32 v86, v83, v2
    v_mov_b32 v14, 1
    v_lshlrev_b32 v10, 3, v1
    s_lshr_b32 s56, s53, 4
    s_and_b32 s56, s56, 14
    v_subrev_u32 v103, s56, v72
    v_and_b32 v103, 15, v103
    v_subrev_u32 v104, s56, v74
    v_and_b32 v104, 15, v104
    v_subrev_u32 v105, s56, v76
    v_and_b32 v105, 15, v105
    s_waitcnt lgkmcnt(2)
    s_mov_b64 exec, s[40:41]
    v_and_b32 v81, 7, v84
    v_lshl_or_b32 v103, v81, 4, v103
    v_lshlrev_b32 v81, 2, v103
    ds_add_rtn_u32 v78, v81, v14 offset:0
    s_waitcnt lgkmcnt(2)
    s_mov_b64 exec, s[42:43]
    v_and_b32 v82, 7, v85
    v_lshl_or_b32 v104, v82, 4, v104
    v_lshlrev_b32 v82, 2, v104
    ds_add_rtn_u32 v79, v82, v14 offset:0
    s_waitcnt lgkmcnt(2)
    s_mov_b64 exec, s[44:45]
    v_and_b32 v83, 7, v86
    v_lshl_or_b32 v105, v83, 4, v105
    v_lshlrev_b32 v83, 2, v105
    ds_add_rtn_u32 v80, v83, v14 offset:0
    s_mov_b64 exec, -1
    v_lshlrev_b32 v81, 1, v103
    v_lshlrev_b32 v103, 4, v103
    v_and_b32 v84, 0x38, v84
    v_and_b32 v72, 16776192, v72
    v_lshlrev_b32 v82, 1, v104
    v_lshlrev_b32 v104, 4, v104
    v_and_b32 v85, 0x38, v85
    v_and_b32 v74, 16776192, v74
    v_lshlrev_b32 v83, 1, v105
    v_lshlrev_b32 v105, 4, v105
    v_and_b32 v86, 0x38, v86
    v_and_b32 v76, 16776192, v76
    s_lshl_b32 s56, s3, 3
    s_add_u32 s57, s56, 7
    v_lshrrev_b32 v114, 3, v1
    v_mul_u32_u24 v114, 48, v114
    s_waitcnt lgkmcnt(0)
    s_barrier
    ds_read_b64 v[108:109], v10 offset:0
    s_sub_u32 s58, s27, 1024
    s_cselect_b32 s58, 10238976, s58
    s_waitcnt lgkmcnt(0)
    v_add_u32 v110, v108, v109
    v_mov_b32 v111, v110
    v_and_b32 v12, 15, v1
    v_lshrrev_b32 v11, 4, v1
    v_add_u32_dpp v111, v111, v111 row_shr:1 row_mask:0xf bank_mask:0xf
    v_lshlrev_b32 v11, 3, v11
    v_lshl_add_u32 v11, v12, 5, v11
    v_add_u32_dpp v111, v111, v111 row_shr:2 row_mask:0xf bank_mask:0xf
    v_mov_b32 v115, s58
    v_mov_b32 v254, 0
    v_add_u32_dpp v111, v111, v111 row_shr:4 row_mask:0xf bank_mask:0xf
    s_nop 1
    v_add_u32_dpp v111, v111, v111 row_shr:8 row_mask:0xf bank_mask:0xf
    s_nop 1
    v_add_u32_dpp v111, v111, v111 row_bcast:15 row_mask:0xa bank_mask:0xf
    s_nop 1
    v_add_u32_dpp v111, v111, v111 row_bcast:31 row_mask:0xc bank_mask:0xf
    v_sub_u32 v110, v111, v110
    v_readlane_b32 s51, v111, s57
    s_nop 0
    v_mov_b32_dpp v112, v110 row_newbcast:0 row_mask:0xf bank_mask:0x3
    v_readlane_b32 s58, v110, s56
    s_nop 0
    v_mov_b32_dpp v112, v110 row_newbcast:8 row_mask:0xf bank_mask:0xc
    v_add_u32 v113, 15, v112
    v_and_b32 v113, -16, v113
    v_add_u32 v113, v113, v114
    v_sub_u32 v112, v113, v112
    v_add_u32 v112, v112, v110
    v_add_u32 v108, v112, v108
    v_lshl_or_b32 v108, v108, 16, v112
    v_readlane_b32 s50, v113, s56
    ds_bpermute_b32 v81, v81, v108
    ds_bpermute_b32 v82, v82, v108
    ds_bpermute_b32 v83, v83, v108
    s_sub_u32 s51, s51, s58
    s_add_u32 s56, s50, s51
    v_add_u32 v109, s56, v1
    v_lshlrev_b32 v110, 2, v109
    v_lshlrev_b32 v111, 4, v109
    s_mov_b64 exec, 0xfffff
    ds_write_b32 v110, v115 offset:4096
    ds_write_b8 v109, v4 offset:11840
    ds_write_b128 v111, v[4:7] offset:13824
    s_mov_b64 exec, s[40:41]
    s_waitcnt lgkmcnt(5)
    v_bfe_u32 v81, v81, v103, 16
    v_add_u32 v81, v81, v78
    v_lshlrev_b32 v78, 2, v81
    v_lshlrev_b32 v103, 4, v81
    ds_write_b32 v78, v72 offset:4096
    ds_write_b8 v81, v84 offset:11840
    s_mov_b64 exec, s[42:43]
    s_waitcnt lgkmcnt(6)
    v_bfe_u32 v82, v82, v104, 16
    v_add_u32 v82, v82, v79
    v_lshlrev_b32 v79, 2, v82
    v_lshlrev_b32 v104, 4, v82
    ds_write_b32 v79, v74 offset:4096
    ds_write_b8 v82, v85 offset:11840
    s_mov_b64 exec, s[44:45]
    s_waitcnt lgkmcnt(7)
    v_bfe_u32 v83, v83, v105, 16
    v_add_u32 v83, v83, v80
    v_lshlrev_b32 v80, 2, v83
    v_lshlrev_b32 v105, 4, v83
    ds_write_b32 v80, v76 offset:4096
    ds_write_b8 v83, v86 offset:11840
    s_cmp_lt_u32 s3, 5
    s_cselect_b32 s56, 1, s47
    s_or_b32 s56, s56, s55
    s_cbranch_scc0 K_PW1
    s_waitcnt vmcnt(0)
K_PW1:
    s_waitcnt vmcnt(1)
    s_mov_b64 exec, s[40:41]
    ds_write_b128 v103, v[88:91] offset:13824
    s_mov_b64 exec, s[42:43]
    ds_write_b128 v104, v[92:95] offset:13824
    s_mov_b64 exec, s[44:45]
    ds_write_b128 v105, v[96:99] offset:13824
    s_mov_b64 exec, -1
    s_lshl_b32 s56, s50, 2
    s_add_u32 s56, s56, 4096
    v_mov_b32 v196, s56
    s_add_u32 s56, s50, 11840
    v_mov_b32 v197, s56
    s_lshl_b32 s56, s50, 5
    s_add_u32 s56, s56, 44800
    v_add_u32 v198, s56, v10
    v_add_u32 v11, s56, v11
    s_lshl_b32 s57, s50, 4
    s_add_u32 s57, s57, 13824
    v_lshl_add_u32 v199, v12, 4, s57
    v_add_u32 v10, s57, v9
    s_add_u32 s48, s51, 3
    s_lshr_b32 s48, s48, 2
    s_waitcnt lgkmcnt(0)
    s_barrier
    s_cmp_eq_u32 s48, 0
    s_cbranch_scc1 K2_LOOPDONE
    ds_read_b128 v[120:123], v196 offset:0
    ds_read_b128 v[124:127], v196 offset:16
    ds_read_b64 v[152:153], v10
    ds_read2_b64 v[188:191], v196 offset0:4 offset1:5
    ds_read_b64 v[186:187], v199 offset:8
    ds_read_b128 v[192:195], v197
    s_lshl_b32 s56, s48, 2
    s_waitcnt lgkmcnt(5)
    buffer_load_dwordx4 v[56:59], v120, s[28:31], 0 offen
    buffer_load_dwordx4 v[60:63], v121, s[28:31], 0 offen
    buffer_load_dwordx4 v[64:67], v122, s[28:31], 0 offen
    buffer_load_dwordx4 v[68:71], v123, s[28:31], 0 offen
    s_waitcnt lgkmcnt(4)
    buffer_load_dwordx4 v[72:75], v124, s[28:31], 0 offen
    buffer_load_dwordx4 v[76:79], v125, s[28:31], 0 offen
    buffer_load_dwordx4 v[80:83], v126, s[28:31], 0 offen
    buffer_load_dwordx4 v[84:87], v127, s[28:31], 0 offen
K_APREP:
    v_cmp_gt_u32 vcc, s56, v1
    s_waitcnt lgkmcnt(0)
    s_nop 0
    v_cndmask_b32 v160, 0, v152, vcc
    v_cndmask_b32 v161, 0, v153, vcc
    ds_read_b64 v[152:153], v10 offset:1024
    v_add_u32 v10, 1024, v10
    v_mfma_f32_16x16x16_bf16 v[136:139], v[232:233], v[160:161], 0
    v_mfma_f32_16x16x16_bf16 v[140:143], v[234:235], v[160:161], 0
    v_mfma_f32_16x16x16_bf16 v[144:147], v[236:237], v[160:161], 0
    v_mfma_f32_16x16x16_bf16 v[148:151], v[238:239], v[160:161], 0
    s_nop 4
    v_cvt_pk_bf16_f32 v168, v136, v137
    v_cvt_pk_bf16_f32 v169, v138, v139
    ds_write_b64 v11, v[168:169] offset:0
    s_sub_u32 s56, s56, 16
    s_cmp_le_i32 s56, 0
    s_cbranch_scc1 K_APDONE
    v_cvt_pk_bf16_f32 v170, v140, v141
    v_cvt_pk_bf16_f32 v171, v142, v143
    ds_write_b64 v11, v[170:171] offset:512
    s_sub_u32 s56, s56, 16
    s_cmp_le_i32 s56, 0
    s_cbranch_scc1 K_APDONE
    v_cvt_pk_bf16_f32 v172, v144, v145
    v_cvt_pk_bf16_f32 v173, v146, v147
    ds_write_b64 v11, v[172:173] offset:1024
    s_sub_u32 s56, s56, 16
    s_cmp_le_i32 s56, 0
    s_cbranch_scc1 K_APDONE
    v_cvt_pk_bf16_f32 v174, v148, v149
    v_cvt_pk_bf16_f32 v175, v150, v151
    ds_write_b64 v11, v[174:175] offset:1536
    s_sub_u32 s56, s56, 16
    s_cmp_le_i32 s56, 0
    s_cbranch_scc1 K_APDONE
    v_add_u32 v11, 2048, v11
    s_branch K_APREP
K_APDONE:
    s_waitcnt lgkmcnt(0)
    ds_read_b64 v[184:185], v198
    v_mfma_f32_4x4x4_16b_bf16 v[152:155], v[186:187], v[176:177], 0 cbsz:4 abid:0
    v_mfma_f32_4x4x4_16b_bf16 v[156:159], v[186:187], v[180:181], 0 cbsz:4 abid:0
    s_sub_u32 s48, s48, 3
    s_nop 2
    s_cbranch_scc1 K2_D0
.p2align 4
K2_LOOP:
    s_waitcnt vmcnt(6) lgkmcnt(0)
    v_subrev_u32 v255, s27, v188
    v_cmp_gt_u32 vcc, v255, v254
    ds_write_b32 v252, v255 offset:2048
    s_setprio 0
    s_cbranch_vccnz K2_P0
    s_setprio 1
K2_P0:
    v_mfma_f32_4x4x4_16b_bf16 v[120:123], v[184:185], v[56:57], 0 cbsz:4 abid:0
    v_exp_f32 v168, v152
    v_mfma_f32_4x4x4_16b_bf16 v[124:127], v[184:185], v[58:59], 0 cbsz:4 abid:0
    v_exp_f32 v169, v153
    v_mfma_f32_4x4x4_16b_bf16 v[128:131], v[184:185], v[60:61], 0 cbsz:4 abid:1
    v_exp_f32 v170, v154
    v_mfma_f32_4x4x4_16b_bf16 v[132:135], v[184:185], v[62:63], 0 cbsz:4 abid:1
    buffer_load_dwordx4 v[88:91], v188, s[28:31], 0 offen
    buffer_load_dwordx4 v[92:95], v189, s[28:31], 0 offen
    v_exp_f32 v171, v155
    s_waitcnt vmcnt(6)
    v_mfma_f32_4x4x4_16b_bf16 v[136:139], v[184:185], v[64:65], 0 cbsz:4 abid:2
    v_exp_f32 v172, v156
    v_mfma_f32_4x4x4_16b_bf16 v[140:143], v[184:185], v[66:67], 0 cbsz:4 abid:2
    v_exp_f32 v173, v157
    v_exp_f32 v174, v158
    v_exp_f32 v175, v159
    v_pk_add_f32 v[168:169], v[168:169], 1.0 op_sel_hi:[1,0]
    v_pk_add_f32 v[170:171], v[170:171], 1.0 op_sel_hi:[1,0]
    v_pk_add_f32 v[172:173], v[172:173], 1.0 op_sel_hi:[1,0]
    v_pk_add_f32 v[174:175], v[174:175], 1.0 op_sel_hi:[1,0]
    v_mfma_f32_4x4x4_16b_bf16 v[144:147], v[184:185], v[68:69], 0 cbsz:4 abid:3
    v_rcp_f32 v168, v168
    v_mfma_f32_4x4x4_16b_bf16 v[148:151], v[184:185], v[70:71], 0 cbsz:4 abid:3
    buffer_load_dwordx4 v[96:99], v190, s[28:31], 0 offen
    buffer_load_dwordx4 v[100:103], v191, s[28:31], 0 offen
    v_rcp_f32 v169, v169
    ds_read_b128 v[188:191], v196 offset:48
    v_mfma_f32_4x4x4_16b_bf16 v[160:163], v[186:187], v[176:177], 0 cbsz:4 abid:1
    v_rcp_f32 v170, v170
    v_mfma_f32_4x4x4_16b_bf16 v[164:167], v[186:187], v[180:181], 0 cbsz:4 abid:1
    v_rcp_f32 v171, v171
    v_rcp_f32 v172, v172
    v_rcp_f32 v173, v173
    v_rcp_f32 v174, v174
    v_rcp_f32 v175, v175
    v_readfirstlane_b32 s49, v192
    v_pk_mul_f32 v[168:169], v[168:169], v[152:153]
    v_pk_mul_f32 v[170:171], v[170:171], v[154:155]
    v_pk_mul_f32 v[172:173], v[172:173], v[156:157]
    v_pk_mul_f32 v[174:175], v[174:175], v[158:159]
    s_set_gpr_idx_on s49, gpr_idx(SRC2,DST)
    v_pk_fma_f32 v[16:17], v[168:169], v[120:121], v[16:17] op_sel:[0,0,0] op_sel_hi:[0,1,1]
    v_pk_fma_f32 v[18:19], v[168:169], v[122:123], v[18:19] op_sel:[0,0,0] op_sel_hi:[0,1,1]
    v_pk_fma_f32 v[20:21], v[172:173], v[124:125], v[20:21] op_sel:[0,0,0] op_sel_hi:[0,1,1]
    v_pk_fma_f32 v[22:23], v[172:173], v[126:127], v[22:23] op_sel:[0,0,0] op_sel_hi:[0,1,1]
    s_lshr_b32 s49, s49, 8
    s_set_gpr_idx_idx s49
    v_pk_fma_f32 v[16:17], v[168:169], v[128:129], v[16:17] op_sel:[1,0,0] op_sel_hi:[1,1,1]
    v_pk_fma_f32 v[18:19], v[168:169], v[130:131], v[18:19] op_sel:[1,0,0] op_sel_hi:[1,1,1]
    v_pk_fma_f32 v[20:21], v[172:173], v[132:133], v[20:21] op_sel:[1,0,0] op_sel_hi:[1,1,1]
    v_pk_fma_f32 v[22:23], v[172:173], v[134:135], v[22:23] op_sel:[1,0,0] op_sel_hi:[1,1,1]
    s_lshr_b32 s49, s49, 8
    s_set_gpr_idx_idx s49
    v_pk_fma_f32 v[16:17], v[170:171], v[136:137], v[16:17] op_sel:[0,0,0] op_sel_hi:[0,1,1]
    v_pk_fma_f32 v[18:19], v[170:171], v[138:139], v[18:19] op_sel:[0,0,0] op_sel_hi:[0,1,1]
    v_pk_fma_f32 v[20:21], v[174:175], v[140:141], v[20:21] op_sel:[0,0,0] op_sel_hi:[0,1,1]
    v_pk_fma_f32 v[22:23], v[174:175], v[142:143], v[22:23] op_sel:[0,0,0] op_sel_hi:[0,1,1]
    s_lshr_b32 s49, s49, 8
    s_set_gpr_idx_idx s49
    v_pk_fma_f32 v[16:17], v[170:171], v[144:145], v[16:17] op_sel:[1,0,0] op_sel_hi:[1,1,1]
    v_pk_fma_f32 v[18:19], v[170:171], v[146:147], v[18:19] op_sel:[1,0,0] op_sel_hi:[1,1,1]
    v_pk_fma_f32 v[20:21], v[174:175], v[148:149], v[20:21] op_sel:[1,0,0] op_sel_hi:[1,1,1]
    v_pk_fma_f32 v[22:23], v[174:175], v[150:151], v[22:23] op_sel:[1,0,0] op_sel_hi:[1,1,1]
    s_set_gpr_idx_off
    s_sub_u32 s48, s48, 1
    s_cbranch_scc1 K2_D1
    s_waitcnt vmcnt(6) lgkmcnt(0)
    v_mfma_f32_4x4x4_16b_bf16 v[120:123], v[184:185], v[72:73], 0 cbsz:4 abid:4
    v_exp_f32 v168, v160
    v_mfma_f32_4x4x4_16b_bf16 v[124:127], v[184:185], v[74:75], 0 cbsz:4 abid:4
    v_exp_f32 v169, v161
    v_mfma_f32_4x4x4_16b_bf16 v[128:131], v[184:185], v[76:77], 0 cbsz:4 abid:5
    v_exp_f32 v170, v162
    v_mfma_f32_4x4x4_16b_bf16 v[132:135], v[184:185], v[78:79], 0 cbsz:4 abid:5
    buffer_load_dwordx4 v[104:107], v188, s[28:31], 0 offen
    buffer_load_dwordx4 v[108:111], v189, s[28:31], 0 offen
    v_exp_f32 v171, v163
    s_waitcnt vmcnt(6)
    v_mfma_f32_4x4x4_16b_bf16 v[136:139], v[184:185], v[80:81], 0 cbsz:4 abid:6
    v_exp_f32 v172, v164
    v_mfma_f32_4x4x4_16b_bf16 v[140:143], v[184:185], v[82:83], 0 cbsz:4 abid:6
    v_exp_f32 v173, v165
    v_exp_f32 v174, v166
    v_exp_f32 v175, v167
    v_pk_add_f32 v[168:169], v[168:169], 1.0 op_sel_hi:[1,0]
    v_pk_add_f32 v[170:171], v[170:171], 1.0 op_sel_hi:[1,0]
    v_pk_add_f32 v[172:173], v[172:173], 1.0 op_sel_hi:[1,0]
    v_pk_add_f32 v[174:175], v[174:175], 1.0 op_sel_hi:[1,0]
    v_mfma_f32_4x4x4_16b_bf16 v[144:147], v[184:185], v[84:85], 0 cbsz:4 abid:7
    v_rcp_f32 v168, v168
    v_mfma_f32_4x4x4_16b_bf16 v[148:151], v[184:185], v[86:87], 0 cbsz:4 abid:7
    buffer_load_dwordx4 v[112:115], v190, s[28:31], 0 offen
    buffer_load_dwordx4 v[116:119], v191, s[28:31], 0 offen
    v_rcp_f32 v169, v169
    ds_read_b128 v[188:191], v196 offset:64
    ds_read_b32 v254, v253 offset:2048
    v_mfma_f32_4x4x4_16b_bf16 v[152:155], v[186:187], v[176:177], 0 cbsz:4 abid:2
    v_rcp_f32 v170, v170
    v_mfma_f32_4x4x4_16b_bf16 v[156:159], v[186:187], v[180:181], 0 cbsz:4 abid:2
    v_rcp_f32 v171, v171
    v_rcp_f32 v172, v172
    v_rcp_f32 v173, v173
    v_rcp_f32 v174, v174
    v_rcp_f32 v175, v175
    v_readfirstlane_b32 s49, v193
    v_pk_mul_f32 v[168:169], v[168:169], v[160:161]
    v_pk_mul_f32 v[170:171], v[170:171], v[162:163]
    v_pk_mul_f32 v[172:173], v[172:173], v[164:165]
    v_pk_mul_f32 v[174:175], v[174:175], v[166:167]
    s_set_gpr_idx_on s49, gpr_idx(SRC2,DST)
    v_pk_fma_f32 v[16:17], v[168:169], v[120:121], v[16:17] op_sel:[0,0,0] op_sel_hi:[0,1,1]
    v_pk_fma_f32 v[18:19], v[168:169], v[122:123], v[18:19] op_sel:[0,0,0] op_sel_hi:[0,1,1]
    v_pk_fma_f32 v[20:21], v[172:173], v[124:125], v[20:21] op_sel:[0,0,0] op_sel_hi:[0,1,1]
    v_pk_fma_f32 v[22:23], v[172:173], v[126:127], v[22:23] op_sel:[0,0,0] op_sel_hi:[0,1,1]
    s_lshr_b32 s49, s49, 8
    s_set_gpr_idx_idx s49
    v_pk_fma_f32 v[16:17], v[168:169], v[128:129], v[16:17] op_sel:[1,0,0] op_sel_hi:[1,1,1]
    v_pk_fma_f32 v[18:19], v[168:169], v[130:131], v[18:19] op_sel:[1,0,0] op_sel_hi:[1,1,1]
    v_pk_fma_f32 v[20:21], v[172:173], v[132:133], v[20:21] op_sel:[1,0,0] op_sel_hi:[1,1,1]
    v_pk_fma_f32 v[22:23], v[172:173], v[134:135], v[22:23] op_sel:[1,0,0] op_sel_hi:[1,1,1]
    s_lshr_b32 s49, s49, 8
    s_set_gpr_idx_idx s49
    v_pk_fma_f32 v[16:17], v[170:171], v[136:137], v[16:17] op_sel:[0,0,0] op_sel_hi:[0,1,1]
    v_pk_fma_f32 v[18:19], v[170:171], v[138:139], v[18:19] op_sel:[0,0,0] op_sel_hi:[0,1,1]
    v_pk_fma_f32 v[20:21], v[174:175], v[140:141], v[20:21] op_sel:[0,0,0] op_sel_hi:[0,1,1]
    v_pk_fma_f32 v[22:23], v[174:175], v[142:143], v[22:23] op_sel:[0,0,0] op_sel_hi:[0,1,1]
    s_lshr_b32 s49, s49, 8
    s_set_gpr_idx_idx s49
    v_pk_fma_f32 v[16:17], v[170:171], v[144:145], v[16:17] op_sel:[1,0,0] op_sel_hi:[1,1,1]
    v_pk_fma_f32 v[18:19], v[170:171], v[146:147], v[18:19] op_sel:[1,0,0] op_sel_hi:[1,1,1]
    v_pk_fma_f32 v[20:21], v[174:175], v[148:149], v[20:21] op_sel:[1,0,0] op_sel_hi:[1,1,1]
    v_pk_fma_f32 v[22:23], v[174:175], v[150:151], v[22:23] op_sel:[1,0,0] op_sel_hi:[1,1,1]
    s_set_gpr_idx_off
    s_sub_u32 s48, s48, 1
    s_cbranch_scc1 K2_D2
    s_waitcnt vmcnt(6) lgkmcnt(0)
    v_subrev_u32 v255, s27, v188
    v_cmp_gt_u32 vcc, v255, v254
    ds_write_b32 v252, v255 offset:2048
    s_setprio 0
    s_cbranch_vccnz K2_P2
    s_setprio 1
K2_P2:
    v_mfma_f32_4x4x4_16b_bf16 v[120:123], v[184:185], v[88:89], 0 cbsz:4 abid:8
    v_exp_f32 v168, v152
    v_mfma_f32_4x4x4_16b_bf16 v[124:127], v[184:185], v[90:91], 0 cbsz:4 abid:8
    v_exp_f32 v169, v153
    v_mfma_f32_4x4x4_16b_bf16 v[128:131], v[184:185], v[92:93], 0 cbsz:4 abid:9
    v_exp_f32 v170, v154
    v_mfma_f32_4x4x4_16b_bf16 v[132:135], v[184:185], v[94:95], 0 cbsz:4 abid:9
    buffer_load_dwordx4 v[56:59], v188, s[28:31], 0 offen
    buffer_load_dwordx4 v[60:63], v189, s[28:31], 0 offen
    v_exp_f32 v171, v155
    s_waitcnt vmcnt(6)
    v_mfma_f32_4x4x4_16b_bf16 v[136:139], v[184:185], v[96:97], 0 cbsz:4 abid:10
    v_exp_f32 v172, v156
    v_mfma_f32_4x4x4_16b_bf16 v[140:143], v[184:185], v[98:99], 0 cbsz:4 abid:10
    v_exp_f32 v173, v157
    v_exp_f32 v174, v158
    v_exp_f32 v175, v159
    v_pk_add_f32 v[168:169], v[168:169], 1.0 op_sel_hi:[1,0]
    v_pk_add_f32 v[170:171], v[170:171], 1.0 op_sel_hi:[1,0]
    v_pk_add_f32 v[172:173], v[172:173], 1.0 op_sel_hi:[1,0]
    v_pk_add_f32 v[174:175], v[174:175], 1.0 op_sel_hi:[1,0]
    v_mfma_f32_4x4x4_16b_bf16 v[144:147], v[184:185], v[100:101], 0 cbsz:4 abid:11
    v_rcp_f32 v168, v168
    v_mfma_f32_4x4x4_16b_bf16 v[148:151], v[184:185], v[102:103], 0 cbsz:4 abid:11
    buffer_load_dwordx4 v[64:67], v190, s[28:31], 0 offen
    buffer_load_dwordx4 v[68:71], v191, s[28:31], 0 offen
    v_rcp_f32 v169, v169
    ds_read_b128 v[188:191], v196 offset:80
    v_mfma_f32_4x4x4_16b_bf16 v[160:163], v[186:187], v[176:177], 0 cbsz:4 abid:3
    v_rcp_f32 v170, v170
    v_mfma_f32_4x4x4_16b_bf16 v[164:167], v[186:187], v[180:181], 0 cbsz:4 abid:3
    v_rcp_f32 v171, v171
    v_rcp_f32 v172, v172
    ds_read_b64 v[186:187], v199 offset:264
    v_rcp_f32 v173, v173
    v_rcp_f32 v174, v174
    v_rcp_f32 v175, v175
    v_readfirstlane_b32 s49, v194
    v_pk_mul_f32 v[168:169], v[168:169], v[152:153]
    v_pk_mul_f32 v[170:171], v[170:171], v[154:155]
    v_pk_mul_f32 v[172:173], v[172:173], v[156:157]
    v_pk_mul_f32 v[174:175], v[174:175], v[158:159]
    s_set_gpr_idx_on s49, gpr_idx(SRC2,DST)
    v_pk_fma_f32 v[16:17], v[168:169], v[120:121], v[16:17] op_sel:[0,0,0] op_sel_hi:[0,1,1]
    v_pk_fma_f32 v[18:19], v[168:169], v[122:123], v[18:19] op_sel:[0,0,0] op_sel_hi:[0,1,1]
    v_pk_fma_f32 v[20:21], v[172:173], v[124:125], v[20:21] op_sel:[0,0,0] op_sel_hi:[0,1,1]
    v_pk_fma_f32 v[22:23], v[172:173], v[126:127], v[22:23] op_sel:[0,0,0] op_sel_hi:[0,1,1]
    s_lshr_b32 s49, s49, 8
    s_set_gpr_idx_idx s49
    v_pk_fma_f32 v[16:17], v[168:169], v[128:129], v[16:17] op_sel:[1,0,0] op_sel_hi:[1,1,1]
    v_pk_fma_f32 v[18:19], v[168:169], v[130:131], v[18:19] op_sel:[1,0,0] op_sel_hi:[1,1,1]
    v_pk_fma_f32 v[20:21], v[172:173], v[132:133], v[20:21] op_sel:[1,0,0] op_sel_hi:[1,1,1]
    v_pk_fma_f32 v[22:23], v[172:173], v[134:135], v[22:23] op_sel:[1,0,0] op_sel_hi:[1,1,1]
    s_lshr_b32 s49, s49, 8
    s_set_gpr_idx_idx s49
    v_pk_fma_f32 v[16:17], v[170:171], v[136:137], v[16:17] op_sel:[0,0,0] op_sel_hi:[0,1,1]
    v_pk_fma_f32 v[18:19], v[170:171], v[138:139], v[18:19] op_sel:[0,0,0] op_sel_hi:[0,1,1]
    v_pk_fma_f32 v[20:21], v[174:175], v[140:141], v[20:21] op_sel:[0,0,0] op_sel_hi:[0,1,1]
    v_pk_fma_f32 v[22:23], v[174:175], v[142:143], v[22:23] op_sel:[0,0,0] op_sel_hi:[0,1,1]
    s_lshr_b32 s49, s49, 8
    s_set_gpr_idx_idx s49
    v_pk_fma_f32 v[16:17], v[170:171], v[144:145], v[16:17] op_sel:[1,0,0] op_sel_hi:[1,1,1]
    v_pk_fma_f32 v[18:19], v[170:171], v[146:147], v[18:19] op_sel:[1,0,0] op_sel_hi:[1,1,1]
    v_pk_fma_f32 v[20:21], v[174:175], v[148:149], v[20:21] op_sel:[1,0,0] op_sel_hi:[1,1,1]
    v_pk_fma_f32 v[22:23], v[174:175], v[150:151], v[22:23] op_sel:[1,0,0] op_sel_hi:[1,1,1]
    s_set_gpr_idx_off
    s_sub_u32 s48, s48, 1
    s_cbranch_scc1 K2_D3
    s_waitcnt vmcnt(6) lgkmcnt(0)
    v_mfma_f32_4x4x4_16b_bf16 v[120:123], v[184:185], v[104:105], 0 cbsz:4 abid:12
    v_exp_f32 v168, v160
    v_mfma_f32_4x4x4_16b_bf16 v[124:127], v[184:185], v[106:107], 0 cbsz:4 abid:12
    v_exp_f32 v169, v161
    v_mfma_f32_4x4x4_16b_bf16 v[128:131], v[184:185], v[108:109], 0 cbsz:4 abid:13
    v_exp_f32 v170, v162
    v_mfma_f32_4x4x4_16b_bf16 v[132:135], v[184:185], v[110:111], 0 cbsz:4 abid:13
    buffer_load_dwordx4 v[72:75], v188, s[28:31], 0 offen
    buffer_load_dwordx4 v[76:79], v189, s[28:31], 0 offen
    v_exp_f32 v171, v163
    s_waitcnt vmcnt(6)
    v_mfma_f32_4x4x4_16b_bf16 v[136:139], v[184:185], v[112:113], 0 cbsz:4 abid:14
    v_exp_f32 v172, v164
    v_mfma_f32_4x4x4_16b_bf16 v[140:143], v[184:185], v[114:115], 0 cbsz:4 abid:14
    v_exp_f32 v173, v165
    v_exp_f32 v174, v166
    v_exp_f32 v175, v167
    v_pk_add_f32 v[168:169], v[168:169], 1.0 op_sel_hi:[1,0]
    v_pk_add_f32 v[170:171], v[170:171], 1.0 op_sel_hi:[1,0]
    v_pk_add_f32 v[172:173], v[172:173], 1.0 op_sel_hi:[1,0]
    v_pk_add_f32 v[174:175], v[174:175], 1.0 op_sel_hi:[1,0]
    v_mfma_f32_4x4x4_16b_bf16 v[144:147], v[184:185], v[116:117], 0 cbsz:4 abid:15
    v_rcp_f32 v168, v168
    v_mfma_f32_4x4x4_16b_bf16 v[148:151], v[184:185], v[118:119], 0 cbsz:4 abid:15
    buffer_load_dwordx4 v[80:83], v190, s[28:31], 0 offen
    buffer_load_dwordx4 v[84:87], v191, s[28:31], 0 offen
    v_rcp_f32 v169, v169
    ds_read_b128 v[188:191], v196 offset:96
    ds_read_b64 v[184:185], v198 offset:512
    ds_read_b32 v254, v253 offset:2048
    v_mfma_f32_4x4x4_16b_bf16 v[152:155], v[186:187], v[176:177], 0 cbsz:4 abid:0
    v_rcp_f32 v170, v170
    v_mfma_f32_4x4x4_16b_bf16 v[156:159], v[186:187], v[180:181], 0 cbsz:4 abid:0
    v_rcp_f32 v171, v171
    v_rcp_f32 v172, v172
    v_rcp_f32 v173, v173
    v_rcp_f32 v174, v174
    v_rcp_f32 v175, v175
    v_readfirstlane_b32 s49, v195
    ds_read_b128 v[192:195], v197 offset:16
    v_add_u32 v196, 64, v196
    v_add_u32 v197, 16, v197
    v_add_u32 v198, 512, v198
    v_add_u32 v199, 256, v199
    v_pk_mul_f32 v[168:169], v[168:169], v[160:161]
    v_pk_mul_f32 v[170:171], v[170:171], v[162:163]
    v_pk_mul_f32 v[172:173], v[172:173], v[164:165]
    v_pk_mul_f32 v[174:175], v[174:175], v[166:167]
    s_set_gpr_idx_on s49, gpr_idx(SRC2,DST)
    v_pk_fma_f32 v[16:17], v[168:169], v[120:121], v[16:17] op_sel:[0,0,0] op_sel_hi:[0,1,1]
    v_pk_fma_f32 v[18:19], v[168:169], v[122:123], v[18:19] op_sel:[0,0,0] op_sel_hi:[0,1,1]
    v_pk_fma_f32 v[20:21], v[172:173], v[124:125], v[20:21] op_sel:[0,0,0] op_sel_hi:[0,1,1]
    v_pk_fma_f32 v[22:23], v[172:173], v[126:127], v[22:23] op_sel:[0,0,0] op_sel_hi:[0,1,1]
    s_lshr_b32 s49, s49, 8
    s_set_gpr_idx_idx s49
    v_pk_fma_f32 v[16:17], v[168:169], v[128:129], v[16:17] op_sel:[1,0,0] op_sel_hi:[1,1,1]
    v_pk_fma_f32 v[18:19], v[168:169], v[130:131], v[18:19] op_sel:[1,0,0] op_sel_hi:[1,1,1]
    v_pk_fma_f32 v[20:21], v[172:173], v[132:133], v[20:21] op_sel:[1,0,0] op_sel_hi:[1,1,1]
    v_pk_fma_f32 v[22:23], v[172:173], v[134:135], v[22:23] op_sel:[1,0,0] op_sel_hi:[1,1,1]
    s_lshr_b32 s49, s49, 8
    s_set_gpr_idx_idx s49
    v_pk_fma_f32 v[16:17], v[170:171], v[136:137], v[16:17] op_sel:[0,0,0] op_sel_hi:[0,1,1]
    v_pk_fma_f32 v[18:19], v[170:171], v[138:139], v[18:19] op_sel:[0,0,0] op_sel_hi:[0,1,1]
    v_pk_fma_f32 v[20:21], v[174:175], v[140:141], v[20:21] op_sel:[0,0,0] op_sel_hi:[0,1,1]
    v_pk_fma_f32 v[22:23], v[174:175], v[142:143], v[22:23] op_sel:[0,0,0] op_sel_hi:[0,1,1]
    s_lshr_b32 s49, s49, 8
    s_set_gpr_idx_idx s49
    v_pk_fma_f32 v[16:17], v[170:171], v[144:145], v[16:17] op_sel:[1,0,0] op_sel_hi:[1,1,1]
    v_pk_fma_f32 v[18:19], v[170:171], v[146:147], v[18:19] op_sel:[1,0,0] op_sel_hi:[1,1,1]
    v_pk_fma_f32 v[20:21], v[174:175], v[148:149], v[20:21] op_sel:[1,0,0] op_sel_hi:[1,1,1]
    v_pk_fma_f32 v[22:23], v[174:175], v[150:151], v[22:23] op_sel:[1,0,0] op_sel_hi:[1,1,1]
    s_set_gpr_idx_off
    s_sub_u32 s48, s48, 1
    s_cbranch_scc0 K2_LOOP
K2_D0:
    s_cmp_eq_u32 s48, -1
    s_cbranch_scc1 K2_WA0
    s_waitcnt vmcnt(2)
K2_WA0:
    s_waitcnt vmcnt(6) lgkmcnt(0)
    v_mfma_f32_4x4x4_16b_bf16 v[120:123], v[184:185], v[56:57], 0 cbsz:4 abid:0
    v_exp_f32 v168, v152
    v_mfma_f32_4x4x4_16b_bf16 v[124:127], v[184:185], v[58:59], 0 cbsz:4 abid:0
    v_exp_f32 v169, v153
    v_mfma_f32_4x4x4_16b_bf16 v[128:131], v[184:185], v[60:61], 0 cbsz:4 abid:1
    v_exp_f32 v170, v154
    v_mfma_f32_4x4x4_16b_bf16 v[132:135], v[184:185], v[62:63], 0 cbsz:4 abid:1
    v_exp_f32 v171, v155
    s_cmp_eq_u32 s48, -1
    s_cbranch_scc1 K2_WB0
    s_waitcnt vmcnt(0)
K2_WB0:
    s_waitcnt vmcnt(4)
    v_mfma_f32_4x4x4_16b_bf16 v[136:139], v[184:185], v[64:65], 0 cbsz:4 abid:2
    v_exp_f32 v172, v156
    v_mfma_f32_4x4x4_16b_bf16 v[140:143], v[184:185], v[66:67], 0 cbsz:4 abid:2
    v_exp_f32 v173, v157
    v_exp_f32 v174, v158
    v_exp_f32 v175, v159
    v_pk_add_f32 v[168:169], v[168:169], 1.0 op_sel_hi:[1,0]
    v_pk_add_f32 v[170:171], v[170:171], 1.0 op_sel_hi:[1,0]
    v_pk_add_f32 v[172:173], v[172:173], 1.0 op_sel_hi:[1,0]
    v_pk_add_f32 v[174:175], v[174:175], 1.0 op_sel_hi:[1,0]
    v_mfma_f32_4x4x4_16b_bf16 v[144:147], v[184:185], v[68:69], 0 cbsz:4 abid:3
    v_rcp_f32 v168, v168
    v_mfma_f32_4x4x4_16b_bf16 v[148:151], v[184:185], v[70:71], 0 cbsz:4 abid:3
    v_rcp_f32 v169, v169
    v_mfma_f32_4x4x4_16b_bf16 v[160:163], v[186:187], v[176:177], 0 cbsz:4 abid:1
    v_rcp_f32 v170, v170
    v_mfma_f32_4x4x4_16b_bf16 v[164:167], v[186:187], v[180:181], 0 cbsz:4 abid:1
    v_rcp_f32 v171, v171
    v_rcp_f32 v172, v172
    v_rcp_f32 v173, v173
    v_rcp_f32 v174, v174
    v_rcp_f32 v175, v175
    v_readfirstlane_b32 s49, v192
    v_pk_mul_f32 v[168:169], v[168:169], v[152:153]
    v_pk_mul_f32 v[170:171], v[170:171], v[154:155]
    v_pk_mul_f32 v[172:173], v[172:173], v[156:157]
    v_pk_mul_f32 v[174:175], v[174:175], v[158:159]
    s_set_gpr_idx_on s49, gpr_idx(SRC2,DST)
    v_pk_fma_f32 v[16:17], v[168:169], v[120:121], v[16:17] op_sel:[0,0,0] op_sel_hi:[0,1,1]
    v_pk_fma_f32 v[18:19], v[168:169], v[122:123], v[18:19] op_sel:[0,0,0] op_sel_hi:[0,1,1]
    v_pk_fma_f32 v[20:21], v[172:173], v[124:125], v[20:21] op_sel:[0,0,0] op_sel_hi:[0,1,1]
    v_pk_fma_f32 v[22:23], v[172:173], v[126:127], v[22:23] op_sel:[0,0,0] op_sel_hi:[0,1,1]
    s_lshr_b32 s49, s49, 8
    s_set_gpr_idx_idx s49
    v_pk_fma_f32 v[16:17], v[168:169], v[128:129], v[16:17] op_sel:[1,0,0] op_sel_hi:[1,1,1]
    v_pk_fma_f32 v[18:19], v[168:169], v[130:131], v[18:19] op_sel:[1,0,0] op_sel_hi:[1,1,1]
    v_pk_fma_f32 v[20:21], v[172:173], v[132:133], v[20:21] op_sel:[1,0,0] op_sel_hi:[1,1,1]
    v_pk_fma_f32 v[22:23], v[172:173], v[134:135], v[22:23] op_sel:[1,0,0] op_sel_hi:[1,1,1]
    s_lshr_b32 s49, s49, 8
    s_set_gpr_idx_idx s49
    v_pk_fma_f32 v[16:17], v[170:171], v[136:137], v[16:17] op_sel:[0,0,0] op_sel_hi:[0,1,1]
    v_pk_fma_f32 v[18:19], v[170:171], v[138:139], v[18:19] op_sel:[0,0,0] op_sel_hi:[0,1,1]
    v_pk_fma_f32 v[20:21], v[174:175], v[140:141], v[20:21] op_sel:[0,0,0] op_sel_hi:[0,1,1]
    v_pk_fma_f32 v[22:23], v[174:175], v[142:143], v[22:23] op_sel:[0,0,0] op_sel_hi:[0,1,1]
    s_lshr_b32 s49, s49, 8
    s_set_gpr_idx_idx s49
    v_pk_fma_f32 v[16:17], v[170:171], v[144:145], v[16:17] op_sel:[1,0,0] op_sel_hi:[1,1,1]
    v_pk_fma_f32 v[18:19], v[170:171], v[146:147], v[18:19] op_sel:[1,0,0] op_sel_hi:[1,1,1]
    v_pk_fma_f32 v[20:21], v[174:175], v[148:149], v[20:21] op_sel:[1,0,0] op_sel_hi:[1,1,1]
    v_pk_fma_f32 v[22:23], v[174:175], v[150:151], v[22:23] op_sel:[1,0,0] op_sel_hi:[1,1,1]
    s_set_gpr_idx_off
    s_sub_u32 s48, s48, 1
    s_cmp_eq_u32 s48, -3
    s_cbranch_scc1 K2_LOOPDONE
K2_D1:
    s_cmp_eq_u32 s48, -1
    s_cbranch_scc1 K2_WA1
    s_waitcnt vmcnt(2)
K2_WA1:
    s_waitcnt vmcnt(6) lgkmcnt(0)
    v_mfma_f32_4x4x4_16b_bf16 v[120:123], v[184:185], v[72:73], 0 cbsz:4 abid:4
    v_exp_f32 v168, v160
    v_mfma_f32_4x4x4_16b_bf16 v[124:127], v[184:185], v[74:75], 0 cbsz:4 abid:4
    v_exp_f32 v169, v161
    v_mfma_f32_4x4x4_16b_bf16 v[128:131], v[184:185], v[76:77], 0 cbsz:4 abid:5
    v_exp_f32 v170, v162
    v_mfma_f32_4x4x4_16b_bf16 v[132:135], v[184:185], v[78:79], 0 cbsz:4 abid:5
    v_exp_f32 v171, v163
    s_cmp_eq_u32 s48, -1
    s_cbranch_scc1 K2_WB1
    s_waitcnt vmcnt(0)
K2_WB1:
    s_waitcnt vmcnt(4)
    v_mfma_f32_4x4x4_16b_bf16 v[136:139], v[184:185], v[80:81], 0 cbsz:4 abid:6
    v_exp_f32 v172, v164
    v_mfma_f32_4x4x4_16b_bf16 v[140:143], v[184:185], v[82:83], 0 cbsz:4 abid:6
    v_exp_f32 v173, v165
    v_exp_f32 v174, v166
    v_exp_f32 v175, v167
    v_pk_add_f32 v[168:169], v[168:169], 1.0 op_sel_hi:[1,0]
    v_pk_add_f32 v[170:171], v[170:171], 1.0 op_sel_hi:[1,0]
    v_pk_add_f32 v[172:173], v[172:173], 1.0 op_sel_hi:[1,0]
    v_pk_add_f32 v[174:175], v[174:175], 1.0 op_sel_hi:[1,0]
    v_mfma_f32_4x4x4_16b_bf16 v[144:147], v[184:185], v[84:85], 0 cbsz:4 abid:7
    v_rcp_f32 v168, v168
    v_mfma_f32_4x4x4_16b_bf16 v[148:151], v[184:185], v[86:87], 0 cbsz:4 abid:7
    v_rcp_f32 v169, v169
    v_mfma_f32_4x4x4_16b_bf16 v[152:155], v[186:187], v[176:177], 0 cbsz:4 abid:2
    v_rcp_f32 v170, v170
    v_mfma_f32_4x4x4_16b_bf16 v[156:159], v[186:187], v[180:181], 0 cbsz:4 abid:2
    v_rcp_f32 v171, v171
    v_rcp_f32 v172, v172
    v_rcp_f32 v173, v173
    v_rcp_f32 v174, v174
    v_rcp_f32 v175, v175
    v_readfirstlane_b32 s49, v193
    v_pk_mul_f32 v[168:169], v[168:169], v[160:161]
    v_pk_mul_f32 v[170:171], v[170:171], v[162:163]
    v_pk_mul_f32 v[172:173], v[172:173], v[164:165]
    v_pk_mul_f32 v[174:175], v[174:175], v[166:167]
    s_set_gpr_idx_on s49, gpr_idx(SRC2,DST)
    v_pk_fma_f32 v[16:17], v[168:169], v[120:121], v[16:17] op_sel:[0,0,0] op_sel_hi:[0,1,1]
    v_pk_fma_f32 v[18:19], v[168:169], v[122:123], v[18:19] op_sel:[0,0,0] op_sel_hi:[0,1,1]
    v_pk_fma_f32 v[20:21], v[172:173], v[124:125], v[20:21] op_sel:[0,0,0] op_sel_hi:[0,1,1]
    v_pk_fma_f32 v[22:23], v[172:173], v[126:127], v[22:23] op_sel:[0,0,0] op_sel_hi:[0,1,1]
    s_lshr_b32 s49, s49, 8
    s_set_gpr_idx_idx s49
    v_pk_fma_f32 v[16:17], v[168:169], v[128:129], v[16:17] op_sel:[1,0,0] op_sel_hi:[1,1,1]
    v_pk_fma_f32 v[18:19], v[168:169], v[130:131], v[18:19] op_sel:[1,0,0] op_sel_hi:[1,1,1]
    v_pk_fma_f32 v[20:21], v[172:173], v[132:133], v[20:21] op_sel:[1,0,0] op_sel_hi:[1,1,1]
    v_pk_fma_f32 v[22:23], v[172:173], v[134:135], v[22:23] op_sel:[1,0,0] op_sel_hi:[1,1,1]
    s_lshr_b32 s49, s49, 8
    s_set_gpr_idx_idx s49
    v_pk_fma_f32 v[16:17], v[170:171], v[136:137], v[16:17] op_sel:[0,0,0] op_sel_hi:[0,1,1]
    v_pk_fma_f32 v[18:19], v[170:171], v[138:139], v[18:19] op_sel:[0,0,0] op_sel_hi:[0,1,1]
    v_pk_fma_f32 v[20:21], v[174:175], v[140:141], v[20:21] op_sel:[0,0,0] op_sel_hi:[0,1,1]
    v_pk_fma_f32 v[22:23], v[174:175], v[142:143], v[22:23] op_sel:[0,0,0] op_sel_hi:[0,1,1]
    s_lshr_b32 s49, s49, 8
    s_set_gpr_idx_idx s49
    v_pk_fma_f32 v[16:17], v[170:171], v[144:145], v[16:17] op_sel:[1,0,0] op_sel_hi:[1,1,1]
    v_pk_fma_f32 v[18:19], v[170:171], v[146:147], v[18:19] op_sel:[1,0,0] op_sel_hi:[1,1,1]
    v_pk_fma_f32 v[20:21], v[174:175], v[148:149], v[20:21] op_sel:[1,0,0] op_sel_hi:[1,1,1]
    v_pk_fma_f32 v[22:23], v[174:175], v[150:151], v[22:23] op_sel:[1,0,0] op_sel_hi:[1,1,1]
    s_set_gpr_idx_off
    s_sub_u32 s48, s48, 1
    s_cmp_eq_u32 s48, -3
    s_cbranch_scc1 K2_LOOPDONE
K2_D2:
    s_cmp_eq_u32 s48, -1
    s_cbranch_scc1 K2_WA2
    s_waitcnt vmcnt(2)
K2_WA2:
    s_waitcnt vmcnt(6) lgkmcnt(0)
    v_mfma_f32_4x4x4_16b_bf16 v[120:123], v[184:185], v[88:89], 0 cbsz:4 abid:8
    v_exp_f32 v168, v152
    v_mfma_f32_4x4x4_16b_bf16 v[124:127], v[184:185], v[90:91], 0 cbsz:4 abid:8
    v_exp_f32 v169, v153
    v_mfma_f32_4x4x4_16b_bf16 v[128:131], v[184:185], v[92:93], 0 cbsz:4 abid:9
    v_exp_f32 v170, v154
    v_mfma_f32_4x4x4_16b_bf16 v[132:135], v[184:185], v[94:95], 0 cbsz:4 abid:9
    v_exp_f32 v171, v155
    s_cmp_eq_u32 s48, -1
    s_cbranch_scc1 K2_WB2
    s_waitcnt vmcnt(0)
K2_WB2:
    s_waitcnt vmcnt(4)
    v_mfma_f32_4x4x4_16b_bf16 v[136:139], v[184:185], v[96:97], 0 cbsz:4 abid:10
    v_exp_f32 v172, v156
    v_mfma_f32_4x4x4_16b_bf16 v[140:143], v[184:185], v[98:99], 0 cbsz:4 abid:10
    v_exp_f32 v173, v157
    v_exp_f32 v174, v158
    v_exp_f32 v175, v159
    v_pk_add_f32 v[168:169], v[168:169], 1.0 op_sel_hi:[1,0]
    v_pk_add_f32 v[170:171], v[170:171], 1.0 op_sel_hi:[1,0]
    v_pk_add_f32 v[172:173], v[172:173], 1.0 op_sel_hi:[1,0]
    v_pk_add_f32 v[174:175], v[174:175], 1.0 op_sel_hi:[1,0]
    v_mfma_f32_4x4x4_16b_bf16 v[144:147], v[184:185], v[100:101], 0 cbsz:4 abid:11
    v_rcp_f32 v168, v168
    v_mfma_f32_4x4x4_16b_bf16 v[148:151], v[184:185], v[102:103], 0 cbsz:4 abid:11
    v_rcp_f32 v169, v169
    v_mfma_f32_4x4x4_16b_bf16 v[160:163], v[186:187], v[176:177], 0 cbsz:4 abid:3
    v_rcp_f32 v170, v170
    v_mfma_f32_4x4x4_16b_bf16 v[164:167], v[186:187], v[180:181], 0 cbsz:4 abid:3
    v_rcp_f32 v171, v171
    v_rcp_f32 v172, v172
    ds_read_b64 v[186:187], v199 offset:264
    v_rcp_f32 v173, v173
    v_rcp_f32 v174, v174
    v_rcp_f32 v175, v175
    v_readfirstlane_b32 s49, v194
    v_pk_mul_f32 v[168:169], v[168:169], v[152:153]
    v_pk_mul_f32 v[170:171], v[170:171], v[154:155]
    v_pk_mul_f32 v[172:173], v[172:173], v[156:157]
    v_pk_mul_f32 v[174:175], v[174:175], v[158:159]
    s_set_gpr_idx_on s49, gpr_idx(SRC2,DST)
    v_pk_fma_f32 v[16:17], v[168:169], v[120:121], v[16:17] op_sel:[0,0,0] op_sel_hi:[0,1,1]
    v_pk_fma_f32 v[18:19], v[168:169], v[122:123], v[18:19] op_sel:[0,0,0] op_sel_hi:[0,1,1]
    v_pk_fma_f32 v[20:21], v[172:173], v[124:125], v[20:21] op_sel:[0,0,0] op_sel_hi:[0,1,1]
    v_pk_fma_f32 v[22:23], v[172:173], v[126:127], v[22:23] op_sel:[0,0,0] op_sel_hi:[0,1,1]
    s_lshr_b32 s49, s49, 8
    s_set_gpr_idx_idx s49
    v_pk_fma_f32 v[16:17], v[168:169], v[128:129], v[16:17] op_sel:[1,0,0] op_sel_hi:[1,1,1]
    v_pk_fma_f32 v[18:19], v[168:169], v[130:131], v[18:19] op_sel:[1,0,0] op_sel_hi:[1,1,1]
    v_pk_fma_f32 v[20:21], v[172:173], v[132:133], v[20:21] op_sel:[1,0,0] op_sel_hi:[1,1,1]
    v_pk_fma_f32 v[22:23], v[172:173], v[134:135], v[22:23] op_sel:[1,0,0] op_sel_hi:[1,1,1]
    s_lshr_b32 s49, s49, 8
    s_set_gpr_idx_idx s49
    v_pk_fma_f32 v[16:17], v[170:171], v[136:137], v[16:17] op_sel:[0,0,0] op_sel_hi:[0,1,1]
    v_pk_fma_f32 v[18:19], v[170:171], v[138:139], v[18:19] op_sel:[0,0,0] op_sel_hi:[0,1,1]
    v_pk_fma_f32 v[20:21], v[174:175], v[140:141], v[20:21] op_sel:[0,0,0] op_sel_hi:[0,1,1]
    v_pk_fma_f32 v[22:23], v[174:175], v[142:143], v[22:23] op_sel:[0,0,0] op_sel_hi:[0,1,1]
    s_lshr_b32 s49, s49, 8
    s_set_gpr_idx_idx s49
    v_pk_fma_f32 v[16:17], v[170:171], v[144:145], v[16:17] op_sel:[1,0,0] op_sel_hi:[1,1,1]
    v_pk_fma_f32 v[18:19], v[170:171], v[146:147], v[18:19] op_sel:[1,0,0] op_sel_hi:[1,1,1]
    v_pk_fma_f32 v[20:21], v[174:175], v[148:149], v[20:21] op_sel:[1,0,0] op_sel_hi:[1,1,1]
    v_pk_fma_f32 v[22:23], v[174:175], v[150:151], v[22:23] op_sel:[1,0,0] op_sel_hi:[1,1,1]
    s_set_gpr_idx_off
    s_sub_u32 s48, s48, 1
    s_cmp_eq_u32 s48, -3
    s_cbranch_scc1 K2_LOOPDONE
K2_D3:
    s_cmp_eq_u32 s48, -1
    s_cbranch_scc1 K2_WA3
    s_waitcnt vmcnt(2)
K2_WA3:
    s_waitcnt vmcnt(6) lgkmcnt(0)
    v_mfma_f32_4x4x4_16b_bf16 v[120:123], v[184:185], v[104:105], 0 cbsz:4 abid:12
    v_exp_f32 v168, v160
    v_mfma_f32_4x4x4_16b_bf16 v[124:127], v[184:185], v[106:107], 0 cbsz:4 abid:12
    v_exp_f32 v169, v161
    v_mfma_f32_4x4x4_16b_bf16 v[128:131], v[184:185], v[108:109], 0 cbsz:4 abid:13
    v_exp_f32 v170, v162
    v_mfma_f32_4x4x4_16b_bf16 v[132:135], v[184:185], v[110:111], 0 cbsz:4 abid:13
    v_exp_f32 v171, v163
    s_cmp_eq_u32 s48, -1
    s_cbranch_scc1 K2_WB3
    s_waitcnt vmcnt(0)
K2_WB3:
    s_waitcnt vmcnt(4)
    v_mfma_f32_4x4x4_16b_bf16 v[136:139], v[184:185], v[112:113], 0 cbsz:4 abid:14
    v_exp_f32 v172, v164
    v_mfma_f32_4x4x4_16b_bf16 v[140:143], v[184:185], v[114:115], 0 cbsz:4 abid:14
    v_exp_f32 v173, v165
    v_exp_f32 v174, v166
    v_exp_f32 v175, v167
    v_pk_add_f32 v[168:169], v[168:169], 1.0 op_sel_hi:[1,0]
    v_pk_add_f32 v[170:171], v[170:171], 1.0 op_sel_hi:[1,0]
    v_pk_add_f32 v[172:173], v[172:173], 1.0 op_sel_hi:[1,0]
    v_pk_add_f32 v[174:175], v[174:175], 1.0 op_sel_hi:[1,0]
    v_mfma_f32_4x4x4_16b_bf16 v[144:147], v[184:185], v[116:117], 0 cbsz:4 abid:15
    v_rcp_f32 v168, v168
    v_mfma_f32_4x4x4_16b_bf16 v[148:151], v[184:185], v[118:119], 0 cbsz:4 abid:15
    v_rcp_f32 v169, v169
    ds_read_b64 v[184:185], v198 offset:512
    v_mfma_f32_4x4x4_16b_bf16 v[152:155], v[186:187], v[176:177], 0 cbsz:4 abid:0
    v_rcp_f32 v170, v170
    v_mfma_f32_4x4x4_16b_bf16 v[156:159], v[186:187], v[180:181], 0 cbsz:4 abid:0
    v_rcp_f32 v171, v171
    v_rcp_f32 v172, v172
    v_rcp_f32 v173, v173
    v_rcp_f32 v174, v174
    v_rcp_f32 v175, v175
    v_readfirstlane_b32 s49, v195
    ds_read_b128 v[192:195], v197 offset:16
    v_add_u32 v196, 64, v196
    v_add_u32 v197, 16, v197
    v_add_u32 v198, 512, v198
    v_add_u32 v199, 256, v199
    v_pk_mul_f32 v[168:169], v[168:169], v[160:161]
    v_pk_mul_f32 v[170:171], v[170:171], v[162:163]
    v_pk_mul_f32 v[172:173], v[172:173], v[164:165]
    v_pk_mul_f32 v[174:175], v[174:175], v[166:167]
    s_set_gpr_idx_on s49, gpr_idx(SRC2,DST)
    v_pk_fma_f32 v[16:17], v[168:169], v[120:121], v[16:17] op_sel:[0,0,0] op_sel_hi:[0,1,1]
    v_pk_fma_f32 v[18:19], v[168:169], v[122:123], v[18:19] op_sel:[0,0,0] op_sel_hi:[0,1,1]
    v_pk_fma_f32 v[20:21], v[172:173], v[124:125], v[20:21] op_sel:[0,0,0] op_sel_hi:[0,1,1]
    v_pk_fma_f32 v[22:23], v[172:173], v[126:127], v[22:23] op_sel:[0,0,0] op_sel_hi:[0,1,1]
    s_lshr_b32 s49, s49, 8
    s_set_gpr_idx_idx s49
    v_pk_fma_f32 v[16:17], v[168:169], v[128:129], v[16:17] op_sel:[1,0,0] op_sel_hi:[1,1,1]
    v_pk_fma_f32 v[18:19], v[168:169], v[130:131], v[18:19] op_sel:[1,0,0] op_sel_hi:[1,1,1]
    v_pk_fma_f32 v[20:21], v[172:173], v[132:133], v[20:21] op_sel:[1,0,0] op_sel_hi:[1,1,1]
    v_pk_fma_f32 v[22:23], v[172:173], v[134:135], v[22:23] op_sel:[1,0,0] op_sel_hi:[1,1,1]
    s_lshr_b32 s49, s49, 8
    s_set_gpr_idx_idx s49
    v_pk_fma_f32 v[16:17], v[170:171], v[136:137], v[16:17] op_sel:[0,0,0] op_sel_hi:[0,1,1]
    v_pk_fma_f32 v[18:19], v[170:171], v[138:139], v[18:19] op_sel:[0,0,0] op_sel_hi:[0,1,1]
    v_pk_fma_f32 v[20:21], v[174:175], v[140:141], v[20:21] op_sel:[0,0,0] op_sel_hi:[0,1,1]
    v_pk_fma_f32 v[22:23], v[174:175], v[142:143], v[22:23] op_sel:[0,0,0] op_sel_hi:[0,1,1]
    s_lshr_b32 s49, s49, 8
    s_set_gpr_idx_idx s49
    v_pk_fma_f32 v[16:17], v[170:171], v[144:145], v[16:17] op_sel:[1,0,0] op_sel_hi:[1,1,1]
    v_pk_fma_f32 v[18:19], v[170:171], v[146:147], v[18:19] op_sel:[1,0,0] op_sel_hi:[1,1,1]
    v_pk_fma_f32 v[20:21], v[174:175], v[148:149], v[20:21] op_sel:[1,0,0] op_sel_hi:[1,1,1]
    v_pk_fma_f32 v[22:23], v[174:175], v[150:151], v[22:23] op_sel:[1,0,0] op_sel_hi:[1,1,1]
    s_set_gpr_idx_off
    s_sub_u32 s48, s48, 1
    s_cmp_eq_u32 s48, -3
    s_cbranch_scc0 K2_D0
K2_LOOPDONE:
    v_mov_b32 v254, -1
    ds_write_b32 v252, v254 offset:2048
    s_setprio 0
    s_add_u32 s47, s47, 1536
    s_cmp_ge_u32 s47, s46
    s_cbranch_scc1 K_EPI
    s_waitcnt vmcnt(0) lgkmcnt(0)
    s_barrier
    ds_write_b128 v8, v[4:7]
    ds_write_b32 v3, v4 offset:2048
    v_cmp_gt_u32 vcc, 128, v0
    s_and_saveexec_b64 s[56:57], vcc
    ds_write_b32 v3, v4 offset:0
    s_mov_b64 exec, s[56:57]
    s_waitcnt lgkmcnt(0)
    s_barrier
    s_cmp_eq_u32 s55, 0
    s_cbranch_scc1 K_ROUND
    s_branch K_FB
K_LATER:
    s_mov_b64 exec, s[40:41]
    buffer_load_dwordx4 v[88:91], v100, s[36:39], s61 offen sc1
    s_mov_b64 exec, s[42:43]
    buffer_load_dwordx4 v[92:95], v101, s[36:39], s61 offen sc1
    s_mov_b64 exec, s[44:45]
    buffer_load_dwordx4 v[96:99], v102, s[36:39], s61 offen sc1
    s_mov_b64 exec, -1
K_LATER2:
    v_lshrrev_b32 v81, 2, v72
    v_and_b32 v81, 0xfc, v81
    v_lshrrev_b32 v82, 2, v74
    v_and_b32 v82, 0xfc, v82
    v_lshrrev_b32 v83, 2, v76
    v_and_b32 v83, 0xfc, v83
    s_branch K_BAL
K_FB0:
    s_mov_b32 s46, 320000
    s_and_b32 s56, s3, 3
    s_lshl_b32 s56, s56, 6
    s_add_u32 s56, s56, 114944
    v_lshrrev_b32 v10, 4, v1
    v_lshlrev_b32 v10, 11, v10
    v_and_b32 v12, 15, v1
    v_lshl_or_b32 v10, v12, 2, v10
    v_add_u32 v10, s56, v10
    s_mov_b32 s56, 0x05040100
    s_mov_b32 s57, 0x07060302
    ds_read2st64_b32 v[120:121], v10 offset0:0 offset1:1
    ds_read2st64_b32 v[122:123], v10 offset0:2 offset1:3
    ds_read2st64_b32 v[124:125], v10 offset0:4 offset1:5
    ds_read2st64_b32 v[126:127], v10 offset0:6 offset1:7
    ds_read2st64_b32 v[128:129], v10 offset0:32 offset1:33
    ds_read2st64_b32 v[130:131], v10 offset0:34 offset1:35
    ds_read2st64_b32 v[132:133], v10 offset0:36 offset1:37
    ds_read2st64_b32 v[134:135], v10 offset0:38 offset1:39
    ds_read2st64_b32 v[136:137], v10 offset0:64 offset1:65
    ds_read2st64_b32 v[138:139], v10 offset0:66 offset1:67
    ds_read2st64_b32 v[140:141], v10 offset0:68 offset1:69
    ds_read2st64_b32 v[142:143], v10 offset0:70 offset1:71
    ds_read2st64_b32 v[144:145], v10 offset0:96 offset1:97
    ds_read2st64_b32 v[146:147], v10 offset0:98 offset1:99
    ds_read2st64_b32 v[148:149], v10 offset0:100 offset1:101
    ds_read2st64_b32 v[150:151], v10 offset0:102 offset1:103
    s_waitcnt lgkmcnt(15)
    v_perm_b32 v200, v121, v120, s56
    v_perm_b32 v216, v121, v120, s57
    s_waitcnt lgkmcnt(14)
    v_perm_b32 v201, v123, v122, s56
    v_perm_b32 v217, v123, v122, s57
    s_waitcnt lgkmcnt(13)
    v_perm_b32 v202, v125, v124, s56
    v_perm_b32 v218, v125, v124, s57
    s_waitcnt lgkmcnt(12)
    v_perm_b32 v203, v127, v126, s56
    v_perm_b32 v219, v127, v126, s57
    s_waitcnt lgkmcnt(11)
    v_perm_b32 v204, v129, v128, s56
    v_perm_b32 v220, v129, v128, s57
    s_waitcnt lgkmcnt(10)
    v_perm_b32 v205, v131, v130, s56
    v_perm_b32 v221, v131, v130, s57
    s_waitcnt lgkmcnt(9)
    v_perm_b32 v206, v133, v132, s56
    v_perm_b32 v222, v133, v132, s57
    s_waitcnt lgkmcnt(8)
    v_perm_b32 v207, v135, v134, s56
    v_perm_b32 v223, v135, v134, s57
    s_waitcnt lgkmcnt(7)
    v_perm_b32 v208, v137, v136, s56
    v_perm_b32 v224, v137, v136, s57
    s_waitcnt lgkmcnt(6)
    v_perm_b32 v209, v139, v138, s56
    v_perm_b32 v225, v139, v138, s57
    s_waitcnt lgkmcnt(5)
    v_perm_b32 v210, v141, v140, s56
    v_perm_b32 v226, v141, v140, s57
    s_waitcnt lgkmcnt(4)
    v_perm_b32 v211, v143, v142, s56
    v_perm_b32 v227, v143, v142, s57
    s_waitcnt lgkmcnt(3)
    v_perm_b32 v212, v145, v144, s56
    v_perm_b32 v228, v145, v144, s57
    s_waitcnt lgkmcnt(2)
    v_perm_b32 v213, v147, v146, s56
    v_perm_b32 v229, v147, v146, s57
    s_waitcnt lgkmcnt(1)
    v_perm_b32 v214, v149, v148, s56
    v_perm_b32 v230, v149, v148, s57
    s_waitcnt lgkmcnt(0)
    v_perm_b32 v215, v151, v150, s56
    v_perm_b32 v231, v151, v150, s57
K_FB:
    s_mul_i32 s56, s3, 192
    s_add_u32 s56, s56, s47
    v_add_u32 v68, s56, v1
    v_add_u32 v69, 64, v68
    v_add_u32 v70, 128, v68
    v_cmp_gt_u32 s[40:41], s46, v68
    v_min_u32 v68, 319999, v68
    v_lshlrev_b32 v81, 2, v68
    v_lshlrev_b32 v100, 3, v68
    global_load_dword v56, v81, s[8:9]
    global_load_dword v60, v81, s[6:7]
    global_load_dwordx2 v[88:89], v100, s[10:11]
    global_load_dwordx2 v[90:91], v100, s[12:13]
    v_cmp_gt_u32 s[42:43], s46, v69
    v_min_u32 v69, 319999, v69
    v_lshlrev_b32 v82, 2, v69
    v_lshlrev_b32 v101, 3, v69
    global_load_dword v57, v82, s[8:9]
    global_load_dword v61, v82, s[6:7]
    global_load_dwordx2 v[92:93], v101, s[10:11]
    global_load_dwordx2 v[94:95], v101, s[12:13]
    v_cmp_gt_u32 s[44:45], s46, v70
    v_min_u32 v70, 319999, v70
    v_lshlrev_b32 v83, 2, v70
    v_lshlrev_b32 v102, 3, v70
    global_load_dword v58, v83, s[8:9]
    global_load_dword v62, v83, s[6:7]
    global_load_dwordx2 v[96:97], v102, s[10:11]
    global_load_dwordx2 v[98:99], v102, s[12:13]
    v_mov_b32 v14, 64
    s_waitcnt vmcnt(0)
    v_mul_u32_u24 v68, 214749, v56
    v_lshrrev_b32 v68, 23, v68
    v_cmp_eq_u32 vcc, s53, v68
    s_and_b64 s[40:41], s[40:41], vcc
    v_subrev_u32 v72, s54, v56
    v_mul_u32_u24 v68, 1677, v60
    v_lshrrev_b32 v68, 20, v68
    v_lshl_or_b32 v72, v72, 4, v68
    v_lshl_or_b32 v72, v60, 10, v72
    v_mul_u32_u24 v69, 214749, v57
    v_lshrrev_b32 v69, 23, v69
    v_cmp_eq_u32 vcc, s53, v69
    s_and_b64 s[42:43], s[42:43], vcc
    v_subrev_u32 v74, s54, v57
    v_mul_u32_u24 v69, 1677, v61
    v_lshrrev_b32 v69, 20, v69
    v_lshl_or_b32 v74, v74, 4, v69
    v_lshl_or_b32 v74, v61, 10, v74
    v_mul_u32_u24 v70, 214749, v58
    v_lshrrev_b32 v70, 23, v70
    v_cmp_eq_u32 vcc, s53, v70
    s_and_b64 s[44:45], s[44:45], vcc
    v_subrev_u32 v76, s54, v58
    v_mul_u32_u24 v70, 1677, v62
    v_lshrrev_b32 v70, 20, v70
    v_lshl_or_b32 v76, v76, 4, v70
    v_lshl_or_b32 v76, v62, 10, v76
    s_cmp_lg_u32 s47, 0
    s_cbranch_scc1 K_LATER2
    s_branch K_GOT
K_EPI:
    s_mov_b32 s56, 0xbf317218
    s_mov_b32 s57, s56
    s_add_u32 s58, s3, 0
    v_cmp_eq_u32 vcc, s58, v2
    v_pk_mul_f32 v[16:17], v[16:17], s[56:57]
    v_pk_mul_f32 v[18:19], v[18:19], s[56:57]
    v_pk_mul_f32 v[20:21], v[20:21], s[56:57]
    v_pk_mul_f32 v[22:23], v[22:23], s[56:57]
    s_ff1_i32_b64 s58, vcc
    s_mul_i32 s58, s58, 1152
    s_add_u32 s58, s58, 106752
    v_add_u32 v10, s58, v15
    v_cvt_pk_bf16_f32 v16, v16, v20
    ds_write_b32 v10, v16 offset:0
    v_cvt_pk_bf16_f32 v17, v17, v21
    ds_write_b32 v10, v17 offset:288
    v_cvt_pk_bf16_f32 v18, v18, v22
    ds_write_b32 v10, v18 offset:576
    v_cvt_pk_bf16_f32 v19, v19, v23
    ds_write_b32 v10, v19 offset:864
    s_add_u32 s58, s3, 8
    v_cmp_eq_u32 vcc, s58, v2
    v_pk_mul_f32 v[24:25], v[24:25], s[56:57]
    v_pk_mul_f32 v[26:27], v[26:27], s[56:57]
    v_pk_mul_f32 v[28:29], v[28:29], s[56:57]
    v_pk_mul_f32 v[30:31], v[30:31], s[56:57]
    s_ff1_i32_b64 s58, vcc
    s_mul_i32 s58, s58, 1152
    s_add_u32 s58, s58, 106752
    v_add_u32 v11, s58, v15
    v_cvt_pk_bf16_f32 v24, v24, v28
    ds_write_b32 v11, v24 offset:0
    v_cvt_pk_bf16_f32 v25, v25, v29
    ds_write_b32 v11, v25 offset:288
    v_cvt_pk_bf16_f32 v26, v26, v30
    ds_write_b32 v11, v26 offset:576
    v_cvt_pk_bf16_f32 v27, v27, v31
    ds_write_b32 v11, v27 offset:864
    s_add_u32 s58, s3, 16
    v_cmp_eq_u32 vcc, s58, v2
    v_pk_mul_f32 v[32:33], v[32:33], s[56:57]
    v_pk_mul_f32 v[34:35], v[34:35], s[56:57]
    v_pk_mul_f32 v[36:37], v[36:37], s[56:57]
    v_pk_mul_f32 v[38:39], v[38:39], s[56:57]
    s_ff1_i32_b64 s58, vcc
    s_mul_i32 s58, s58, 1152
    s_add_u32 s58, s58, 106752
    v_add_u32 v10, s58, v15
    v_cvt_pk_bf16_f32 v32, v32, v36
    ds_write_b32 v10, v32 offset:0
    v_cvt_pk_bf16_f32 v33, v33, v37
    ds_write_b32 v10, v33 offset:288
    v_cvt_pk_bf16_f32 v34, v34, v38
    ds_write_b32 v10, v34 offset:576
    v_cvt_pk_bf16_f32 v35, v35, v39
    ds_write_b32 v10, v35 offset:864
    s_add_u32 s58, s3, 24
    v_cmp_eq_u32 vcc, s58, v2
    v_pk_mul_f32 v[40:41], v[40:41], s[56:57]
    v_pk_mul_f32 v[42:43], v[42:43], s[56:57]
    v_pk_mul_f32 v[44:45], v[44:45], s[56:57]
    v_pk_mul_f32 v[46:47], v[46:47], s[56:57]
    s_ff1_i32_b64 s58, vcc
    s_mul_i32 s58, s58, 1152
    s_add_u32 s58, s58, 106752
    v_add_u32 v11, s58, v15
    v_cvt_pk_bf16_f32 v40, v40, v44
    ds_write_b32 v11, v40 offset:0
    v_cvt_pk_bf16_f32 v41, v41, v45
    ds_write_b32 v11, v41 offset:288
    v_cvt_pk_bf16_f32 v42, v42, v46
    ds_write_b32 v11, v42 offset:576
    v_cvt_pk_bf16_f32 v43, v43, v47
    ds_write_b32 v11, v43 offset:864
    s_add_u32 s58, s3, 32
    v_cmp_eq_u32 vcc, s58, v2
    v_pk_mul_f32 v[48:49], v[48:49], s[56:57]
    v_pk_mul_f32 v[50:51], v[50:51], s[56:57]
    v_pk_mul_f32 v[52:53], v[52:53], s[56:57]
    v_pk_mul_f32 v[54:55], v[54:55], s[56:57]
    s_ff1_i32_b64 s58, vcc
    s_mul_i32 s58, s58, 1152
    s_add_u32 s58, s58, 106752
    v_add_u32 v10, s58, v15
    v_cvt_pk_bf16_f32 v48, v48, v52
    ds_write_b32 v10, v48 offset:0
    v_cvt_pk_bf16_f32 v49, v49, v53
    ds_write_b32 v10, v49 offset:288
    v_cvt_pk_bf16_f32 v50, v50, v54
    ds_write_b32 v10, v50 offset:576
    v_cvt_pk_bf16_f32 v51, v51, v55
    ds_write_b32 v10, v51 offset:864
    v_and_b32 v12, 15, v1
    v_lshrrev_b32 v13, 4, v1
    s_lshr_b32 s58, s3, 2
    s_mul_i32 s59, s58, 4608
    s_add_u32 s59, s59, 106752
    v_mul_u32_u24 v14, 288, v12
    v_lshl_add_u32 v14, v13, 4, v14
    v_add_u32 v14, s59, v14
    s_lshl_b32 s58, s58, 2
    s_add_u32 s58, s58, s54
    s_lshl_b32 s58, s58, 10
    s_and_b32 s59, s3, 3
    s_lshl_b32 s59, s59, 8
    s_add_u32 s58, s58, s59
    v_lshlrev_b32 v13, 10, v13
    v_lshl_add_u32 v13, v12, 4, v13
    s_waitcnt vmcnt(0) lgkmcnt(0)
    s_barrier
    ds_read_b128 v[56:59], v14 offset:0
    ds_read_b128 v[60:63], v14 offset:64
    ds_read_b128 v[64:67], v14 offset:128
    ds_read_b128 v[68:71], v14 offset:192
    ds_read_b128 v[72:75], v14 offset:9216
    ds_read_b128 v[76:79], v14 offset:9280
    ds_read_b128 v[80:83], v14 offset:9344
    ds_read_b128 v[84:87], v14 offset:9408
    ds_read_b128 v[88:91], v14 offset:18432
    ds_read_b128 v[92:95], v14 offset:18496
    ds_read_b128 v[96:99], v14 offset:18560
    ds_read_b128 v[100:103], v14 offset:18624
    ds_read_b128 v[104:107], v14 offset:27648
    ds_read_b128 v[108:111], v14 offset:27712
    ds_read_b128 v[112:115], v14 offset:27776
    ds_read_b128 v[116:119], v14 offset:27840
    s_waitcnt lgkmcnt(15)
    v_mfma_f32_16x16x32_bf16 v[120:123], v[56:59], v[200:203], 0
    v_mfma_f32_16x16x32_bf16 v[124:127], v[56:59], v[216:219], 0
    s_waitcnt lgkmcnt(14)
    v_mfma_f32_16x16x32_bf16 v[120:123], v[60:63], v[204:207], v[120:123]
    v_mfma_f32_16x16x32_bf16 v[124:127], v[60:63], v[220:223], v[124:127]
    s_waitcnt lgkmcnt(13)
    v_mfma_f32_16x16x32_bf16 v[120:123], v[64:67], v[208:211], v[120:123]
    v_mfma_f32_16x16x32_bf16 v[124:127], v[64:67], v[224:227], v[124:127]
    s_waitcnt lgkmcnt(12)
    v_mfma_f32_16x16x32_bf16 v[120:123], v[68:71], v[212:215], v[120:123]
    v_mfma_f32_16x16x32_bf16 v[124:127], v[68:71], v[228:231], v[124:127]
    ds_read_b128 v[56:59], v14 offset:36864
    ds_read_b128 v[60:63], v14 offset:36928
    ds_read_b128 v[64:67], v14 offset:36992
    ds_read_b128 v[68:71], v14 offset:37056
    s_waitcnt lgkmcnt(15)
    v_mfma_f32_16x16x32_bf16 v[128:131], v[72:75], v[200:203], 0
    v_mfma_f32_16x16x32_bf16 v[132:135], v[72:75], v[216:219], 0
    s_waitcnt lgkmcnt(14)
    v_mfma_f32_16x16x32_bf16 v[128:131], v[76:79], v[204:207], v[128:131]
    v_mfma_f32_16x16x32_bf16 v[132:135], v[76:79], v[220:223], v[132:135]
    s_waitcnt lgkmcnt(13)
    v_mfma_f32_16x16x32_bf16 v[128:131], v[80:83], v[208:211], v[128:131]
    v_mfma_f32_16x16x32_bf16 v[132:135], v[80:83], v[224:227], v[132:135]
    s_waitcnt lgkmcnt(12)
    v_mfma_f32_16x16x32_bf16 v[128:131], v[84:87], v[212:215], v[128:131]
    v_mfma_f32_16x16x32_bf16 v[132:135], v[84:87], v[228:231], v[132:135]
    v_cvt_pk_bf16_f32 v136, v120, v121
    v_cvt_pk_bf16_f32 v137, v122, v123
    v_cvt_pk_bf16_f32 v138, v124, v125
    v_cvt_pk_bf16_f32 v139, v126, v127
    buffer_store_dwordx4 v[136:139], v13, s[32:35], s58 offen sc1
    s_add_u32 s58, s58, 8192
    s_waitcnt lgkmcnt(11)
    v_mfma_f32_16x16x32_bf16 v[120:123], v[88:91], v[200:203], 0
    v_mfma_f32_16x16x32_bf16 v[124:127], v[88:91], v[216:219], 0
    s_waitcnt lgkmcnt(10)
    v_mfma_f32_16x16x32_bf16 v[120:123], v[92:95], v[204:207], v[120:123]
    v_mfma_f32_16x16x32_bf16 v[124:127], v[92:95], v[220:223], v[124:127]
    s_waitcnt lgkmcnt(9)
    v_mfma_f32_16x16x32_bf16 v[120:123], v[96:99], v[208:211], v[120:123]
    v_mfma_f32_16x16x32_bf16 v[124:127], v[96:99], v[224:227], v[124:127]
    s_waitcnt lgkmcnt(8)
    v_mfma_f32_16x16x32_bf16 v[120:123], v[100:103], v[212:215], v[120:123]
    v_mfma_f32_16x16x32_bf16 v[124:127], v[100:103], v[228:231], v[124:127]
    v_cvt_pk_bf16_f32 v140, v128, v129
    v_cvt_pk_bf16_f32 v141, v130, v131
    v_cvt_pk_bf16_f32 v142, v132, v133
    v_cvt_pk_bf16_f32 v143, v134, v135
    buffer_store_dwordx4 v[140:143], v13, s[32:35], s58 offen sc1
    s_add_u32 s58, s58, 8192
    s_waitcnt lgkmcnt(7)
    v_mfma_f32_16x16x32_bf16 v[128:131], v[104:107], v[200:203], 0
    v_mfma_f32_16x16x32_bf16 v[132:135], v[104:107], v[216:219], 0
    s_waitcnt lgkmcnt(6)
    v_mfma_f32_16x16x32_bf16 v[128:131], v[108:111], v[204:207], v[128:131]
    v_mfma_f32_16x16x32_bf16 v[132:135], v[108:111], v[220:223], v[132:135]
    s_waitcnt lgkmcnt(5)
    v_mfma_f32_16x16x32_bf16 v[128:131], v[112:115], v[208:211], v[128:131]
    v_mfma_f32_16x16x32_bf16 v[132:135], v[112:115], v[224:227], v[132:135]
    s_waitcnt lgkmcnt(4)
    v_mfma_f32_16x16x32_bf16 v[128:131], v[116:119], v[212:215], v[128:131]
    v_mfma_f32_16x16x32_bf16 v[132:135], v[116:119], v[228:231], v[132:135]
    v_cvt_pk_bf16_f32 v136, v120, v121
    v_cvt_pk_bf16_f32 v137, v122, v123
    v_cvt_pk_bf16_f32 v138, v124, v125
    v_cvt_pk_bf16_f32 v139, v126, v127
    buffer_store_dwordx4 v[136:139], v13, s[32:35], s58 offen sc1
    s_add_u32 s58, s58, 8192
    s_waitcnt lgkmcnt(3)
    v_mfma_f32_16x16x32_bf16 v[120:123], v[56:59], v[200:203], 0
    v_mfma_f32_16x16x32_bf16 v[124:127], v[56:59], v[216:219], 0
    s_waitcnt lgkmcnt(2)
    v_mfma_f32_16x16x32_bf16 v[120:123], v[60:63], v[204:207], v[120:123]
    v_mfma_f32_16x16x32_bf16 v[124:127], v[60:63], v[220:223], v[124:127]
    s_waitcnt lgkmcnt(1)
    v_mfma_f32_16x16x32_bf16 v[120:123], v[64:67], v[208:211], v[120:123]
    v_mfma_f32_16x16x32_bf16 v[124:127], v[64:67], v[224:227], v[124:127]
    s_waitcnt lgkmcnt(0)
    v_mfma_f32_16x16x32_bf16 v[120:123], v[68:71], v[212:215], v[120:123]
    v_mfma_f32_16x16x32_bf16 v[124:127], v[68:71], v[228:231], v[124:127]
    v_cvt_pk_bf16_f32 v140, v128, v129
    v_cvt_pk_bf16_f32 v141, v130, v131
    v_cvt_pk_bf16_f32 v142, v132, v133
    v_cvt_pk_bf16_f32 v143, v134, v135
    buffer_store_dwordx4 v[140:143], v13, s[32:35], s58 offen sc1
    s_add_u32 s58, s58, 8192
    s_nop 0
    v_cvt_pk_bf16_f32 v136, v120, v121
    v_cvt_pk_bf16_f32 v137, v122, v123
    v_cvt_pk_bf16_f32 v138, v124, v125
    v_cvt_pk_bf16_f32 v139, v126, v127
    buffer_store_dwordx4 v[136:139], v13, s[32:35], s58 offen sc1
    s_or_b32 s56, s55, s3
    s_cmp_lg_u32 s56, 0
    s_cbranch_scc1 K_NOEPO
    v_mov_b32 v10, s52
    s_mov_b64 exec, 1
    buffer_store_dword v10, v4, s[36:39], 0 offen offset:0
K_NOEPO:
K_END:
    s_endpgm
.p2align 6
.type K_TAB,@object
K_TAB:
.byte 6, 5, 14, 7, 4, 2, 0, 1, 3, 12, 22, 11, 10, 8, 30, 9, 19, 13, 15, 17, 16, 21, 23, 20, 18, 25, 29, 28, 31, 27, 26, 24, 34, 32, 39, 33, 35, 36, 37, 38, 255, 255, 255, 255, 255, 255, 255, 255, 255, 255, 255, 255, 255, 255, 255, 255, 255, 255, 255, 255, 255, 255, 255, 255
.byte 3, 2, 4, 7, 0, 1, 6, 8, 5, 9, 15, 13, 14, 11, 12, 22, 21, 16, 10, 23, 17, 20, 30, 19, 18, 25, 27, 24, 29, 28, 26, 31, 34, 37, 36, 39, 33, 38, 32, 35, 255, 255, 255, 255, 255, 255, 255, 255, 255, 255, 255, 255, 255, 255, 255, 255, 255, 255, 255, 255, 255, 255, 255, 255
.section .rodata,"a"
.p2align 6
.amdhsa_kernel gather_scatter__tensor_product_equiv_tfn__graph_kernel
  .amdhsa_next_free_vgpr 256
  .amdhsa_next_free_sgpr 72
  .amdhsa_accum_offset 256
  .amdhsa_group_segment_fixed_size 0
  .amdhsa_kernarg_size 88
  .amdhsa_user_sgpr_count 2
  .amdhsa_user_sgpr_kernarg_segment_ptr 1
  .amdhsa_system_sgpr_workgroup_id_x 1
  .amdhsa_float_denorm_mode_32 3
.end_amdhsa_kernel
```

```asm
; @launch grid=(256,1,1) block=(512,1,1) lds=152832
.amdgcn_target "amdgcn-amd-amdhsa--gfx950"
.text
.globl gather_scatter__tensor_product_equiv_tfn__graph_kernel
.p2align 8
.type gather_scatter__tensor_product_equiv_tfn__graph_kernel,@function
gather_scatter__tensor_product_equiv_tfn__graph_kernel:
    s_cmp_ge_u32 s2, 256
    s_cbranch_scc1 K_END
    s_load_dwordx16 s[4:19], s[0:1], 0
    s_load_dwordx2 s[20:21], s[0:1], 64
    s_load_dwordx2 s[24:25], s[0:1], 80
    v_lshrrev_b32 v2, 6, v0
    v_and_b32 v1, 63, v0
    v_readfirstlane_b32 s3, v2
    v_lshlrev_b32 v10, 4, v0
    s_mul_i32 s57, s2, 5120
    v_lshlrev_b32 v3, 2, v0
    s_cmp_lg_u32 s3, 5
    s_cbranch_scc1 K_PF0
    s_getpc_b64 s[26:27]
K_PC3:
    v_lshlrev_b32 v13, 7, v1
    global_load_dword v255, v13, s[26:27]
    v_add_u32 v13, 8192, v13
    v_min_u32 v13, K_TAB-K_PC3, v13
    global_load_dword v255, v13, s[26:27]
K_PF0:
    v_or_b32 v13, 0x4b000000, v1
    s_cmp_eq_u32 s3, 2
    s_cselect_b32 s56, -1, 0
    v_add_u32 v11, s57, v10
    v_and_b32 v13, s56, v13
    v_lshlrev_b32 v12, 1, v11
    ds_write_b32 v3, v13
    s_cmp_lt_u32 s2, 250
    s_cselect_b32 s56, 5, 0
    s_cmp_lt_u32 s3, s56
    s_waitcnt lgkmcnt(0)
    s_cbranch_scc0 K_BA
    global_load_dwordx4 v[120:123], v11, s[8:9]
    global_load_dwordx4 v[124:127], v11, s[6:7]
K_BA:
    s_barrier
    s_cbranch_scc0 K_HELP
    global_load_dwordx4 v[128:131], v12, s[10:11] offset:0
    global_load_dwordx4 v[132:135], v12, s[10:11] offset:16
    global_load_dwordx4 v[136:139], v12, s[12:13] offset:0
    global_load_dwordx4 v[140:143], v12, s[12:13] offset:16
    s_mov_b32 s40, 1
    s_load_dword s52, s[24:25], 0
    v_mov_b32 v4, 0
    v_mov_b32 v5, 0
    v_mov_b32 v6, 0
    v_mov_b32 v7, 0
    v_add_u32 v8, 106752, v10
    v_lshlrev_b32 v9, 4, v1
    v_lshlrev_b32 v15, 2, v1
    ds_write_b128 v8, v[4:7]
    ds_write_b32 v3, v4 offset:2048
    s_and_b32 s53, s2, 7
    s_lshr_b32 s56, s2, 3
    s_lshl_b32 s53, s53, 5
    s_or_b32 s53, s53, s56
    s_mul_i32 s54, s53, 625
    s_add_u32 s57, s54, 640
    s_add_u32 s54, s54, 15
    s_lshr_b32 s54, s54, 4
    s_lshr_b32 s57, s57, 4
    s_mov_b32 s28, s4
    s_and_b32 s29, s5, 0xffff
    s_or_b32 s29, s29, 0x100000
    s_mov_b32 s30, 10240000
    s_mov_b32 s31, 0x800000
    s_mov_b32 s32, s20
    s_mov_b32 s33, s21
    s_lshl_b32 s34, s57, 10
    s_mov_b32 s35, 0x20000
    s_mov_b32 s36, s24
    s_mov_b32 s37, s25
    s_mov_b32 s38, 8388608
    s_mov_b32 s39, 0x20000
    s_mov_b32 s47, 0
    s_mov_b32 s63, 0
    v_mov_b32 v14, 1
    s_lshr_b32 s27, s53, 5
    s_mul_i32 s27, s27, 20009
    s_add_u32 s27, s27, 14
    s_lshr_b32 s27, s27, 4
    s_lshl_b32 s27, s27, 10
    v_mov_b32 v16, 0
    v_mov_b32 v17, 0
    v_mov_b32 v18, 0
    v_mov_b32 v19, 0
    v_mov_b32 v20, 0
    v_mov_b32 v21, 0
    v_mov_b32 v22, 0
    v_mov_b32 v23, 0
    v_mov_b32 v24, 0
    v_mov_b32 v25, 0
    v_mov_b32 v26, 0
    v_mov_b32 v27, 0
    v_mov_b32 v28, 0
    v_mov_b32 v29, 0
    v_mov_b32 v30, 0
    v_mov_b32 v31, 0
    v_mov_b32 v32, 0
    v_mov_b32 v33, 0
    v_mov_b32 v34, 0
    v_mov_b32 v35, 0
    v_mov_b32 v36, 0
    v_mov_b32 v37, 0
    v_mov_b32 v38, 0
    v_mov_b32 v39, 0
    v_mov_b32 v40, 0
    v_mov_b32 v41, 0
    v_mov_b32 v42, 0
    v_mov_b32 v43, 0
    v_mov_b32 v44, 0
    v_mov_b32 v45, 0
    v_mov_b32 v46, 0
    v_mov_b32 v47, 0
    v_mov_b32 v48, 0
    v_mov_b32 v49, 0
    v_mov_b32 v50, 0
    v_mov_b32 v51, 0
    v_mov_b32 v52, 0
    v_mov_b32 v53, 0
    v_mov_b32 v54, 0
    v_mov_b32 v55, 0
    s_waitcnt vmcnt(5)
    v_mul_u32_u24 v60, 214749, v120
    v_lshrrev_b32 v60, 23, v60
    v_lshlrev_b32 v144, 2, v60
    ds_add_rtn_u32 v148, v144, v14 offset:768
    v_mul_u32_u24 v61, 214749, v121
    v_lshrrev_b32 v61, 23, v61
    v_lshlrev_b32 v145, 2, v61
    ds_add_rtn_u32 v149, v145, v14 offset:768
    v_mul_u32_u24 v62, 214749, v122
    v_lshrrev_b32 v62, 23, v62
    v_lshlrev_b32 v146, 2, v62
    ds_add_rtn_u32 v150, v146, v14 offset:768
    v_mul_u32_u24 v63, 214749, v123
    v_lshrrev_b32 v63, 23, v63
    v_lshlrev_b32 v147, 2, v63
    ds_add_rtn_u32 v151, v147, v14 offset:768
    v_mul_u32_u24 v64, 625, v60
    v_add_u32 v64, 15, v64
    v_lshrrev_b32 v64, 4, v64
    v_sub_u32 v56, v120, v64
    v_mul_u32_u24 v64, 625, v61
    v_add_u32 v64, 15, v64
    v_lshrrev_b32 v64, 4, v64
    v_sub_u32 v57, v121, v64
    v_mul_u32_u24 v64, 625, v62
    v_add_u32 v64, 15, v64
    v_lshrrev_b32 v64, 4, v64
    v_sub_u32 v58, v122, v64
    v_mul_u32_u24 v64, 625, v63
    v_add_u32 v64, 15, v64
    v_lshrrev_b32 v64, 4, v64
    v_sub_u32 v59, v123, v64
    s_branch K_BB
K_HELP:
    s_mov_b32 s40, 0
    s_load_dword s52, s[24:25], 0
    v_mov_b32 v4, 0
    v_mov_b32 v5, 0
    v_mov_b32 v6, 0
    v_mov_b32 v7, 0
    v_add_u32 v8, 106752, v10
    v_lshlrev_b32 v9, 4, v1
    v_lshlrev_b32 v15, 2, v1
    ds_write_b128 v8, v[4:7]
    ds_write_b32 v3, v4 offset:2048
    s_and_b32 s53, s2, 7
    s_lshr_b32 s56, s2, 3
    s_lshl_b32 s53, s53, 5
    s_or_b32 s53, s53, s56
    s_cmp_eq_u32 s3, 7
    s_cbranch_scc1 K_HELP7
    s_cmp_lg_u32 s3, 6
    s_cbranch_scc1 K_HELP2
    s_and_b32 s56, s53, 31
    s_lshl_b32 s56, s56, 10
    v_lshl_add_u32 v13, v1, 7, s56
    s_mov_b64 exec, 0xff
    global_load_dword v255, v13, s[18:19]
    s_mov_b64 exec, -1
    s_branch K_HELP2
K_HELP7:
    s_mov_b32 m0, 147712
    s_getpc_b64 s[26:27]
K_PC:
    global_load_lds_dwordx4 v9, s[14:15]
    s_add_u32 s26, s26, K_TAB-K_PC
    s_addc_u32 s27, s27, 0
    s_mov_b32 m0, 148736
    s_mov_b64 exec, 0xff
    global_load_lds_dwordx4 v9, s[16:17]
    s_mov_b32 m0, 148864
    s_nop 0
    global_load_lds_dwordx4 v9, s[26:27]
    s_mov_b64 exec, -1
K_HELP2:
    s_mul_i32 s54, s53, 625
    s_add_u32 s57, s54, 640
    s_add_u32 s54, s54, 15
    s_lshr_b32 s54, s54, 4
    s_lshr_b32 s57, s57, 4
    s_mov_b32 s28, s4
    s_and_b32 s29, s5, 0xffff
    s_or_b32 s29, s29, 0x100000
    s_mov_b32 s30, 10240000
    s_mov_b32 s31, 0x800000
    s_mov_b32 s32, s20
    s_mov_b32 s33, s21
    s_lshl_b32 s34, s57, 10
    s_mov_b32 s35, 0x20000
    s_mov_b32 s36, s24
    s_mov_b32 s37, s25
    s_mov_b32 s38, 8388608
    s_mov_b32 s39, 0x20000
    s_mov_b32 s47, 0
    s_mov_b32 s63, 0
    v_mov_b32 v14, 1
    s_lshr_b32 s27, s53, 5
    s_mul_i32 s27, s27, 20009
    s_add_u32 s27, s27, 14
    s_lshr_b32 s27, s27, 4
    s_lshl_b32 s27, s27, 10
    v_mov_b32 v16, 0
    v_mov_b32 v17, 0
    v_mov_b32 v18, 0
    v_mov_b32 v19, 0
    v_mov_b32 v20, 0
    v_mov_b32 v21, 0
    v_mov_b32 v22, 0
    v_mov_b32 v23, 0
    v_mov_b32 v24, 0
    v_mov_b32 v25, 0
    v_mov_b32 v26, 0
    v_mov_b32 v27, 0
    v_mov_b32 v28, 0
    v_mov_b32 v29, 0
    v_mov_b32 v30, 0
    v_mov_b32 v31, 0
    v_mov_b32 v32, 0
    v_mov_b32 v33, 0
    v_mov_b32 v34, 0
    v_mov_b32 v35, 0
    v_mov_b32 v36, 0
    v_mov_b32 v37, 0
    v_mov_b32 v38, 0
    v_mov_b32 v39, 0
    v_mov_b32 v40, 0
    v_mov_b32 v41, 0
    v_mov_b32 v42, 0
    v_mov_b32 v43, 0
    v_mov_b32 v44, 0
    v_mov_b32 v45, 0
    v_mov_b32 v46, 0
    v_mov_b32 v47, 0
    v_mov_b32 v48, 0
    v_mov_b32 v49, 0
    v_mov_b32 v50, 0
    v_mov_b32 v51, 0
    v_mov_b32 v52, 0
    v_mov_b32 v53, 0
    v_mov_b32 v54, 0
    v_mov_b32 v55, 0
K_BB:
    s_waitcnt lgkmcnt(0)
    s_barrier
    s_add_u32 s52, s52, 1
    s_and_b32 s56, s52, 0x3ff
    s_lshl_b32 s58, s56, 22
    s_lshl_b32 s26, s52, 24
    s_cmp_eq_u32 s3, 7
    s_cselect_b32 s56, 1, s40
    s_cmp_eq_u32 s56, 0
    s_cbranch_scc1 K_BC1
    ds_read_b128 v[152:155], v9 offset:768
    s_cmp_eq_u32 s3, 7
    s_cbranch_scc1 K_SC
    s_waitcnt vmcnt(4)
    v_mul_u32_u24 v60, 1677, v124
    v_lshrrev_b32 v60, 20, v60
    v_lshl_or_b32 v56, v56, 4, v60
    v_lshl_or_b32 v56, v124, 10, v56
    v_mul_u32_u24 v61, 1677, v125
    v_lshrrev_b32 v61, 20, v61
    v_lshl_or_b32 v57, v57, 4, v61
    v_lshl_or_b32 v57, v125, 10, v57
    v_mul_u32_u24 v62, 1677, v126
    v_lshrrev_b32 v62, 20, v62
    v_lshl_or_b32 v58, v58, 4, v62
    v_lshl_or_b32 v58, v126, 10, v58
    v_mul_u32_u24 v63, 1677, v127
    v_lshrrev_b32 v63, 20, v63
    v_lshl_or_b32 v59, v59, 4, v63
    v_lshl_or_b32 v59, v127, 10, v59
K_SC:
    s_waitcnt lgkmcnt(0)
    v_add_u32 v156, v152, v153
    v_add_u32 v157, v156, v154
    v_add_u32 v158, v157, v155
    v_mov_b32 v160, v158
    v_or_b32 v66, s26, v56
    v_mov_b32 v67, s52
    v_add_u32_dpp v160, v160, v160 row_shr:1 row_mask:0xf bank_mask:0xf
    v_or_b32 v68, s26, v57
    v_mov_b32 v69, s52
    v_add_u32_dpp v160, v160, v160 row_shr:2 row_mask:0xf bank_mask:0xf
    v_or_b32 v70, s26, v58
    v_mov_b32 v71, s52
    v_add_u32_dpp v160, v160, v160 row_shr:4 row_mask:0xf bank_mask:0xf
    v_or_b32 v72, s26, v59
    v_mov_b32 v73, s52
    v_add_u32_dpp v160, v160, v160 row_shr:8 row_mask:0xf bank_mask:0xf
    s_nop 1
    v_add_u32_dpp v160, v160, v160 row_bcast:15 row_mask:0xa bank_mask:0xf
    s_nop 1
    v_add_u32_dpp v160, v160, v160 row_bcast:31 row_mask:0xc bank_mask:0xf
    v_sub_u32 v160, v160, v158
    v_add_u32 v161, v160, v152
    v_add_u32 v162, v160, v156
    v_add_u32 v163, v160, v157
    s_cmp_lg_u32 s3, 7
    s_cbranch_scc1 K_NOROW
    v_lshl_or_b32 v168, v152, 11, v160
    v_or_b32 v168, s58, v168
    v_mov_b32 v169, s52
    v_lshl_or_b32 v170, v153, 11, v161
    v_or_b32 v170, s58, v170
    v_mov_b32 v171, s52
    v_lshl_or_b32 v172, v154, 11, v162
    v_or_b32 v172, s58, v172
    v_mov_b32 v173, s52
    v_lshl_or_b32 v174, v155, 11, v163
    v_or_b32 v174, s58, v174
    v_mov_b32 v175, s52
    s_lshl_b32 s57, s2, 11
    s_add_u32 s57, s57, 8192
    v_lshlrev_b32 v12, 5, v1
    buffer_store_dwordx4 v[168:171], v12, s[36:39], s57 offen sc1
    buffer_store_dwordx4 v[172:175], v12, s[36:39], s57 offen offset:16 sc1
    s_branch K_BC1
K_NOROW:
    ds_write_b128 v9, v[160:163] offset:4096
    ds_read_b32 v60, v144 offset:4096
    ds_read_b32 v61, v145 offset:4096
    ds_read_b32 v62, v146 offset:4096
    ds_read_b32 v63, v147 offset:4096
    s_waitcnt lgkmcnt(3)
    v_add_lshl_u32 v144, v60, v148, 3
    ds_write_b64 v144, v[66:67] offset:13824
    s_waitcnt lgkmcnt(3)
    v_add_lshl_u32 v145, v61, v149, 3
    ds_write_b64 v145, v[68:69] offset:13824
    s_waitcnt lgkmcnt(3)
    v_add_lshl_u32 v146, v62, v150, 3
    ds_write_b64 v146, v[70:71] offset:13824
    s_waitcnt lgkmcnt(3)
    v_add_lshl_u32 v147, v63, v151, 3
    ds_write_b64 v147, v[72:73] offset:13824
    s_mov_b32 s56, 44800
    v_lshl_add_u32 v144, v144, 1, s56
    v_lshl_add_u32 v145, v145, 1, s56
    v_lshl_add_u32 v146, v146, 1, s56
    v_lshl_add_u32 v147, v147, 1, s56
K_BC1:
    s_mul_i32 s60, s2, 10240
    s_add_u32 s60, s60, 532480
    s_sub_u32 s56, s3, 5
    s_lshl_b32 s57, s56, 14
    v_add_u32 v13, s57, v9
    s_add_u32 s57, s57, 114944
    s_waitcnt lgkmcnt(0)
    s_barrier
    s_cmp_ge_u32 s2, 250
    s_cbranch_scc1 K_KS2
    ds_read_b128 v[76:79], v10 offset:13824
    s_cmp_lt_u32 s56, 2
    s_cbranch_scc0 K_KS1
    ds_read_b128 v[80:83], v10 offset:16896
    s_add_u32 s59, s60, 3072
    s_waitcnt lgkmcnt(0)
    buffer_store_dwordx4 v[80:83], v10, s[36:39], s59 offen sc1
K_KS1:
    s_waitcnt lgkmcnt(0)
    buffer_store_dwordx4 v[76:79], v10, s[36:39], s60 offen sc1
K_KS2:
    s_cmp_lt_u32 s56, 2
    s_cbranch_scc1 K_DMA
    s_cmp_eq_u32 s40, 0
    s_cbranch_scc1 K_BC7
    s_waitcnt vmcnt(2)
    ds_write2_b64 v144, v[128:129], v[136:137] offset0:0 offset1:1
    ds_write2_b64 v145, v[130:131], v[138:139] offset0:0 offset1:1
    s_waitcnt vmcnt(1)
    ds_write2_b64 v146, v[132:133], v[140:141] offset0:0 offset1:1
    ds_write2_b64 v147, v[134:135], v[142:143] offset0:0 offset1:1
    s_branch K_BC
K_DMA:
    s_mov_b32 m0, s57
    s_add_u32 s57, s57, 4096
    global_load_lds_dwordx4 v13, s[18:19] offset:0
    global_load_lds_dwordx4 v13, s[18:19] offset:1024
    global_load_lds_dwordx4 v13, s[18:19] offset:2048
    global_load_lds_dwordx4 v13, s[18:19] offset:3072
    v_add_u32 v13, 4096, v13
    s_mov_b32 m0, s57
    s_add_u32 s57, s57, 4096
    global_load_lds_dwordx4 v13, s[18:19] offset:0
    global_load_lds_dwordx4 v13, s[18:19] offset:1024
    global_load_lds_dwordx4 v13, s[18:19] offset:2048
    global_load_lds_dwordx4 v13, s[18:19] offset:3072
    v_add_u32 v13, 4096, v13
    s_mov_b32 m0, s57
    s_add_u32 s57, s57, 4096
    global_load_lds_dwordx4 v13, s[18:19] offset:0
    global_load_lds_dwordx4 v13, s[18:19] offset:1024
    global_load_lds_dwordx4 v13, s[18:19] offset:2048
    global_load_lds_dwordx4 v13, s[18:19] offset:3072
    v_add_u32 v13, 4096, v13
    s_mov_b32 m0, s57
    s_add_u32 s57, s57, 4096
    global_load_lds_dwordx4 v13, s[18:19] offset:0
    global_load_lds_dwordx4 v13, s[18:19] offset:1024
    global_load_lds_dwordx4 v13, s[18:19] offset:2048
    global_load_lds_dwordx4 v13, s[18:19] offset:3072
    s_branch K_BC
K_BC7:
    s_cmp_ge_u32 s2, 250
    s_cbranch_scc0 K_BC8
    s_waitcnt vmcnt(2)
K_BC8:
    s_waitcnt vmcnt(3)
K_BC:
    s_mul_i32 s56, s2, 20480
    s_add_u32 s56, s56, 3145728
    s_add_u32 s57, s56, 8192
    s_add_u32 s59, s56, 16384
    v_lshlrev_b32 v11, 11, v0
    s_lshl_b32 s61, s53, 3
    s_add_u32 s61, s61, 8192
    s_waitcnt lgkmcnt(0)
    s_barrier
    s_cmp_ge_u32 s2, 250
    s_cbranch_scc1 K_NOST
    ds_read_b128 v[56:59], v10 offset:44800
    ds_read_b128 v[60:63], v10 offset:52992
    s_cmp_ge_u32 s3, 4
    s_cbranch_scc1 K_ST1
    ds_read_b128 v[64:67], v10 offset:61184
    s_waitcnt lgkmcnt(0)
    buffer_store_dwordx4 v[64:67], v10, s[36:39], s59 offen sc1
K_ST1:
    s_waitcnt lgkmcnt(1)
    buffer_store_dwordx4 v[56:59], v10, s[36:39], s56 offen sc1
    s_waitcnt lgkmcnt(0)
    buffer_store_dwordx4 v[60:63], v10, s[36:39], s57 offen sc1
K_NOST:
    s_lshr_b32 s56, s34, 10
    s_sub_u32 s56, s56, s54
    s_sub_u32 s56, s56, 39
    s_lshl_b32 s56, s56, 6
    s_add_u32 s56, s56, 148864
    v_add_u32 v2, s56, v1
    v_add_u32 v13, 147712, v15
    ds_read_u8 v2, v2
    ds_read2st64_b32 v[188:189], v13 offset0:0 offset1:1
    ds_read2st64_b32 v[190:191], v13 offset0:2 offset1:3
    v_and_b32 v12, 3, v1
    v_lshlrev_b32 v12, 5, v12
    v_bfe_u32 v13, v1, 2, 2
    v_lshl_or_b32 v12, v13, 1, v12
    v_add_u32 v12, 148736, v12
    ds_read_u16 v192, v12 offset:0
    ds_read_u16 v193, v12 offset:8
    ds_read_u16 v194, v12 offset:16
    ds_read_u16 v195, v12 offset:24
    v_mov_b32 v252, v3
    v_xor_b32 v253, 1024, v3
    v_mul_u32_u24 v185, 128, v0
    s_mov_b32 s56, 0xbfb8aa3b
    s_waitcnt lgkmcnt(0)
    v_lshlrev_b32 v136, 16, v188
    v_mul_f32 v140, s56, v136
    v_lshlrev_b32 v137, 16, v189
    v_mul_f32 v141, s56, v137
    v_lshlrev_b32 v138, 16, v190
    v_mul_f32 v142, s56, v138
    v_lshlrev_b32 v139, 16, v191
    v_mul_f32 v143, s56, v139
    v_cvt_pk_bf16_f32 v176, v140, v141
    v_cvt_pk_bf16_f32 v177, v142, v143
    v_and_b32 v136, 0xffff0000, v188
    v_mul_f32 v140, s56, v136
    v_and_b32 v137, 0xffff0000, v189
    v_mul_f32 v141, s56, v137
    v_and_b32 v138, 0xffff0000, v190
    v_mul_f32 v142, s56, v138
    v_and_b32 v139, 0xffff0000, v191
    v_mul_f32 v143, s56, v139
    v_cvt_pk_bf16_f32 v180, v140, v141
    v_cvt_pk_bf16_f32 v181, v142, v143
    v_lshl_or_b32 v136, v193, 16, v192
    v_lshl_or_b32 v137, v195, 16, v194
    v_lshrrev_b32 v13, 4, v1
    v_cmp_eq_u32 vcc, 0, v13
    s_nop 1
    v_cndmask_b32 v232, 0, v136, vcc
    v_cndmask_b32 v233, 0, v137, vcc
    v_cmp_eq_u32 vcc, 1, v13
    s_nop 1
    v_cndmask_b32 v234, 0, v136, vcc
    v_cndmask_b32 v235, 0, v137, vcc
    v_cmp_eq_u32 vcc, 2, v13
    s_nop 1
    v_cndmask_b32 v236, 0, v136, vcc
    v_cndmask_b32 v237, 0, v137, vcc
    v_cmp_eq_u32 vcc, 3, v13
    s_nop 1
    v_cndmask_b32 v238, 0, v136, vcc
    v_cndmask_b32 v239, 0, v137, vcc
    v_mul_u32_u24 v13, 5120, v1
    s_cmp_ge_u32 s3, 4
    s_cbranch_scc1 K_TABOK
    s_mov_b32 s59, 40000
    s_lshr_b32 s58, s58, 22
K_POLLA:
    buffer_load_dwordx2 v[152:153], v11, s[36:39], s61 offen sc1
    s_waitcnt vmcnt(0)
    v_lshrrev_b32 v154, 22, v152
    v_cmp_ne_u32 vcc, s52, v153
    v_cmp_ne_u32 s[56:57], s58, v154
    s_or_b64 vcc, vcc, s[56:57]
    s_cbranch_vccz K_POLLAOK
    s_sub_u32 s59, s59, 1
    s_cbranch_scc0 K_POLLA
    ds_write_b32 v4, v14 offset:1792
K_POLLAOK:
    ds_write_b32 v3, v152 offset:5120
K_TABOK:
    s_waitcnt vmcnt(0) lgkmcnt(0)
    s_barrier
    s_cmp_lg_u32 s3, 4
    s_cbranch_scc1 K_NOFLAG
    s_mul_i32 s56, s2, 128
    s_add_u32 s56, s56, 8323072
    v_mov_b32 v10, s52
    s_mov_b64 exec, 1
    buffer_store_dword v10, v4, s[36:39], s56 offen sc1
    s_mov_b64 exec, -1
K_NOFLAG:
    ds_read_b128 v[120:123], v9 offset:5120
    ds_read_b32 v10, v4 offset:1792
    s_cmp_lt_u32 s3, 6
    s_cbranch_scc1 K_NOPFX
    s_mov_b32 s64, s4
    s_mov_b32 s65, s5
    s_mov_b32 s66, 10240000
    s_mov_b32 s67, 0x20000
    s_sub_u32 s68, 7, s3
    s_lshl_b32 s68, s68, 5
    s_and_b32 s69, s53, 31
    s_add_u32 s68, s68, s69
    s_lshl_b32 s68, s68, 13
    s_add_u32 s68, s68, s27
    v_lshlrev_b32 v12, 7, v1
    buffer_load_dword v255, v12, s[64:67], s68 offen
K_NOPFX:
    s_waitcnt lgkmcnt(0)
    v_readfirstlane_b32 s55, v10
    v_bfe_u32 v124, v120, 11, 11
    v_bfe_u32 v125, v121, 11, 11
    v_bfe_u32 v126, v122, 11, 11
    v_bfe_u32 v127, v123, 11, 11
    v_add_u32 v129, v124, v125
    v_add_u32 v130, v129, v126
    v_add_u32 v131, v130, v127
    v_mov_b32 v132, v131
    v_and_b32 v120, 0x7ff, v120
    v_add_u32 v248, v13, v120
    v_add_u32_dpp v132, v132, v132 row_shr:1 row_mask:0xf bank_mask:0xf
    v_and_b32 v121, 0x7ff, v121
    v_add_u32 v249, v13, v121
    v_add_u32_dpp v132, v132, v132 row_shr:2 row_mask:0xf bank_mask:0xf
    v_add_u32 v249, 1280, v249
    v_and_b32 v122, 0x7ff, v122
    v_add_u32_dpp v132, v132, v132 row_shr:4 row_mask:0xf bank_mask:0xf
    v_add_u32 v250, v13, v122
    v_add_u32 v250, 2560, v250
    v_add_u32_dpp v132, v132, v132 row_shr:8 row_mask:0xf bank_mask:0xf
    v_and_b32 v123, 0x7ff, v123
    v_add_u32 v251, v13, v123
    v_add_u32_dpp v132, v132, v132 row_bcast:15 row_mask:0xa bank_mask:0xf
    v_add_u32 v251, 3840, v251
    s_nop 0
    v_add_u32_dpp v132, v132, v132 row_bcast:31 row_mask:0xc bank_mask:0xf
    s_cmp_lg_u32 s55, 0
    s_cbranch_scc1 K_FB0
    v_readlane_b32 s46, v132, 63
    v_sub_u32 v240, v132, v131
    v_add_u32 v241, v240, v124
    v_add_u32 v242, v240, v129
    v_add_u32 v243, v240, v130
    v_sub_u32 v248, v248, v240
    v_add_u32 v244, v240, v124
    v_sub_u32 v249, v249, v241
    v_add_u32 v245, v241, v125
    v_sub_u32 v250, v250, v242
    v_add_u32 v246, v242, v126
    v_sub_u32 v251, v251, v243
    v_add_u32 v247, v243, v127
K_ROUND:
    s_mul_i32 s56, s3, 192
    s_add_u32 s56, s56, s47
    s_add_u32 s57, s56, 192
    s_lshl_b32 s58, s3, 10
    s_add_u32 s58, s58, 106752
    v_cmp_lt_u32 vcc, s56, v244
    v_cmp_gt_u32 s[60:61], s57, v240
    v_subrev_u32 v56, s56, v240
    v_max_i32 v56, 0, v56
    v_lshl_add_u32 v56, v56, 2, s58
    s_and_b64 exec, vcc, s[60:61]
    ds_max_u32 v56, v248
    s_mov_b64 exec, -1
    v_cmp_lt_u32 vcc, s56, v245
    v_cmp_gt_u32 s[60:61], s57, v241
    v_subrev_u32 v57, s56, v241
    v_max_i32 v57, 0, v57
    v_lshl_add_u32 v57, v57, 2, s58
    s_and_b64 exec, vcc, s[60:61]
    ds_max_u32 v57, v249
    s_mov_b64 exec, -1
    v_cmp_lt_u32 vcc, s56, v246
    v_cmp_gt_u32 s[60:61], s57, v242
    v_subrev_u32 v58, s56, v242
    v_max_i32 v58, 0, v58
    v_lshl_add_u32 v58, v58, 2, s58
    s_and_b64 exec, vcc, s[60:61]
    ds_max_u32 v58, v250
    s_mov_b64 exec, -1
    v_cmp_lt_u32 vcc, s56, v247
    v_cmp_gt_u32 s[60:61], s57, v243
    v_subrev_u32 v59, s56, v243
    v_max_i32 v59, 0, v59
    v_lshl_add_u32 v59, v59, 2, s58
    s_and_b64 exec, vcc, s[60:61]
    ds_max_u32 v59, v251
    s_mov_b64 exec, -1
    v_add_u32 v60, s58, v15
    ds_read_b32 v64, v60 offset:0
    ds_read_b32 v65, v60 offset:256
    ds_read_b32 v66, v60 offset:512
    v_add_u32 v68, s56, v1
    v_add_u32 v69, 64, v68
    v_add_u32 v70, 128, v68
    v_cmp_gt_u32 s[40:41], s46, v68
    v_cmp_gt_u32 s[42:43], s46, v69
    v_cmp_gt_u32 s[44:45], s46, v70
    s_mov_b32 s60, 532480
    s_mov_b32 s61, 3145728
    s_lshr_b32 s62, s26, 24
    s_waitcnt lgkmcnt(0)
    v_max_u32_dpp v64, v64, v64 row_shr:1 row_mask:0xf bank_mask:0xf
    v_max_u32_dpp v65, v65, v65 row_shr:1 row_mask:0xf bank_mask:0xf
    v_max_u32_dpp v66, v66, v66 row_shr:1 row_mask:0xf bank_mask:0xf
    v_max_u32_dpp v64, v64, v64 row_shr:2 row_mask:0xf bank_mask:0xf
    v_max_u32_dpp v65, v65, v65 row_shr:2 row_mask:0xf bank_mask:0xf
    v_max_u32_dpp v66, v66, v66 row_shr:2 row_mask:0xf bank_mask:0xf
    v_max_u32_dpp v64, v64, v64 row_shr:4 row_mask:0xf bank_mask:0xf
    v_max_u32_dpp v65, v65, v65 row_shr:4 row_mask:0xf bank_mask:0xf
    v_max_u32_dpp v66, v66, v66 row_shr:4 row_mask:0xf bank_mask:0xf
    v_max_u32_dpp v64, v64, v64 row_shr:8 row_mask:0xf bank_mask:0xf
    v_max_u32_dpp v65, v65, v65 row_shr:8 row_mask:0xf bank_mask:0xf
    v_max_u32_dpp v66, v66, v66 row_shr:8 row_mask:0xf bank_mask:0xf
    v_max_u32_dpp v64, v64, v64 row_bcast:15 row_mask:0xa bank_mask:0xf
    v_max_u32_dpp v65, v65, v65 row_bcast:15 row_mask:0xa bank_mask:0xf
    v_max_u32_dpp v66, v66, v66 row_bcast:15 row_mask:0xa bank_mask:0xf
    v_max_u32_dpp v64, v64, v64 row_bcast:31 row_mask:0xc bank_mask:0xf
    v_max_u32_dpp v65, v65, v65 row_bcast:31 row_mask:0xc bank_mask:0xf
    v_max_u32_dpp v66, v66, v66 row_bcast:31 row_mask:0xc bank_mask:0xf
    v_readlane_b32 s56, v64, 63
    v_readlane_b32 s57, v65, 63
    v_add_u32 v68, v68, v64
    s_max_u32 s57, s56, s57
    v_max_u32 v65, s56, v65
    v_max_u32 v66, s57, v66
    v_add_u32 v69, v69, v65
    v_add_u32 v70, v70, v66
    v_lshlrev_b32 v81, 3, v68
    v_lshlrev_b32 v82, 3, v69
    v_lshlrev_b32 v83, 3, v70
    s_mov_b64 exec, s[40:41]
    buffer_load_dwordx2 v[72:73], v81, s[36:39], s60 offen sc1
    s_mov_b64 exec, s[42:43]
    buffer_load_dwordx2 v[74:75], v82, s[36:39], s60 offen sc1
    s_mov_b64 exec, s[44:45]
    buffer_load_dwordx2 v[76:77], v83, s[36:39], s60 offen sc1
    s_mov_b64 exec, -1
    v_lshlrev_b32 v100, 4, v68
    v_lshlrev_b32 v101, 4, v69
    v_lshlrev_b32 v102, 4, v70
    s_cmp_lg_u32 s47, 0
    s_cbranch_scc1 K_KEYS1
    s_and_b32 s56, s3, 3
    s_lshl_b32 s56, s56, 6
    s_add_u32 s56, s56, 114944
    v_lshrrev_b32 v10, 4, v1
    v_lshlrev_b32 v10, 11, v10
    v_and_b32 v12, 15, v1
    v_lshl_or_b32 v10, v12, 2, v10
    v_add_u32 v10, s56, v10
    s_mov_b32 s56, 0x05040100
    s_mov_b32 s57, 0x07060302
    ds_read2st64_b32 v[120:121], v10 offset0:0 offset1:1
    ds_read2st64_b32 v[122:123], v10 offset0:2 offset1:3
    ds_read2st64_b32 v[124:125], v10 offset0:4 offset1:5
    ds_read2st64_b32 v[126:127], v10 offset0:6 offset1:7
    ds_read2st64_b32 v[128:129], v10 offset0:32 offset1:33
    ds_read2st64_b32 v[130:131], v10 offset0:34 offset1:35
    ds_read2st64_b32 v[132:133], v10 offset0:36 offset1:37
    ds_read2st64_b32 v[134:135], v10 offset0:38 offset1:39
    ds_read2st64_b32 v[136:137], v10 offset0:64 offset1:65
    ds_read2st64_b32 v[138:139], v10 offset0:66 offset1:67
    ds_read2st64_b32 v[140:141], v10 offset0:68 offset1:69
    ds_read2st64_b32 v[142:143], v10 offset0:70 offset1:71
    ds_read2st64_b32 v[144:145], v10 offset0:96 offset1:97
    ds_read2st64_b32 v[146:147], v10 offset0:98 offset1:99
    ds_read2st64_b32 v[148:149], v10 offset0:100 offset1:101
    ds_read2st64_b32 v[150:151], v10 offset0:102 offset1:103
    s_waitcnt lgkmcnt(15)
    v_perm_b32 v200, v121, v120, s56
    v_perm_b32 v216, v121, v120, s57
    s_waitcnt lgkmcnt(14)
    v_perm_b32 v201, v123, v122, s56
    v_perm_b32 v217, v123, v122, s57
    s_waitcnt lgkmcnt(13)
    v_perm_b32 v202, v125, v124, s56
    v_perm_b32 v218, v125, v124, s57
    s_waitcnt lgkmcnt(12)
    v_perm_b32 v203, v127, v126, s56
    v_perm_b32 v219, v127, v126, s57
    s_waitcnt lgkmcnt(11)
    v_perm_b32 v204, v129, v128, s56
    v_perm_b32 v220, v129, v128, s57
    s_waitcnt lgkmcnt(10)
    v_perm_b32 v205, v131, v130, s56
    v_perm_b32 v221, v131, v130, s57
    s_waitcnt lgkmcnt(9)
    v_perm_b32 v206, v133, v132, s56
    v_perm_b32 v222, v133, v132, s57
    s_waitcnt lgkmcnt(8)
    v_perm_b32 v207, v135, v134, s56
    v_perm_b32 v223, v135, v134, s57
    s_waitcnt lgkmcnt(7)
    v_perm_b32 v208, v137, v136, s56
    v_perm_b32 v224, v137, v136, s57
    s_waitcnt lgkmcnt(6)
    v_perm_b32 v209, v139, v138, s56
    v_perm_b32 v225, v139, v138, s57
    s_waitcnt lgkmcnt(5)
    v_perm_b32 v210, v141, v140, s56
    v_perm_b32 v226, v141, v140, s57
    s_waitcnt lgkmcnt(4)
    v_perm_b32 v211, v143, v142, s56
    v_perm_b32 v227, v143, v142, s57
    s_waitcnt lgkmcnt(3)
    v_perm_b32 v212, v145, v144, s56
    v_perm_b32 v228, v145, v144, s57
    s_waitcnt lgkmcnt(2)
    v_perm_b32 v213, v147, v146, s56
    v_perm_b32 v229, v147, v146, s57
    s_waitcnt lgkmcnt(1)
    v_perm_b32 v214, v149, v148, s56
    v_perm_b32 v230, v149, v148, s57
    s_waitcnt lgkmcnt(0)
    v_perm_b32 v215, v151, v150, s56
    v_perm_b32 v231, v151, v150, s57
    s_branch K_KEYS1
K_KEYS:
    s_mov_b64 exec, s[40:41]
    buffer_load_dwordx2 v[72:73], v81, s[36:39], s60 offen sc1
    s_mov_b64 exec, s[42:43]
    buffer_load_dwordx2 v[74:75], v82, s[36:39], s60 offen sc1
    s_mov_b64 exec, s[44:45]
    buffer_load_dwordx2 v[76:77], v83, s[36:39], s60 offen sc1
    s_mov_b64 exec, -1
K_KEYS1:
    v_mov_b32 v14, 64
    s_mov_b64 s[58:59], 0
    s_waitcnt vmcnt(2)
    v_lshrrev_b32 v78, 24, v72
    v_cmp_ne_u32 vcc, s52, v73
    v_cmp_ne_u32 s[56:57], s62, v78
    s_or_b64 vcc, vcc, s[56:57]
    s_and_b64 vcc, vcc, s[40:41]
    s_or_b64 s[58:59], s[58:59], vcc
    s_waitcnt vmcnt(1)
    v_lshrrev_b32 v79, 24, v74
    v_cmp_ne_u32 vcc, s52, v75
    v_cmp_ne_u32 s[56:57], s62, v79
    s_or_b64 vcc, vcc, s[56:57]
    s_and_b64 vcc, vcc, s[42:43]
    s_or_b64 s[58:59], s[58:59], vcc
    s_waitcnt vmcnt(0)
    v_lshrrev_b32 v80, 24, v76
    v_cmp_ne_u32 vcc, s52, v77
    v_cmp_ne_u32 s[56:57], s62, v80
    s_or_b64 vcc, vcc, s[56:57]
    s_and_b64 vcc, vcc, s[44:45]
    s_or_b64 s[58:59], s[58:59], vcc
    s_cbranch_scc1 K_KEYS
    s_cmp_lg_u32 s47, 0
    s_cbranch_scc1 K_LATER
    s_mov_b32 s62, 8323072
    s_cmp_lt_u32 s3, 4
    s_cbranch_scc0 K_GOT
    buffer_load_dword v184, v185, s[36:39], s62 offen sc1
K_GOT:
    v_lshrrev_b32 v81, 2, v72
    v_and_b32 v81, 0xfc, v81
    v_lshrrev_b32 v82, 2, v74
    v_and_b32 v82, 0xfc, v82
    v_lshrrev_b32 v83, 2, v76
    v_and_b32 v83, 0xfc, v83
    s_mov_b64 exec, s[40:41]
    ds_add_u32 v81, v14 offset:512
    s_mov_b64 exec, s[42:43]
    ds_add_u32 v82, v14 offset:512
    s_mov_b64 exec, s[44:45]
    ds_add_u32 v83, v14 offset:512
    s_mov_b64 exec, -1
    s_lshr_b32 s56, s3, 2
    s_or_b32 s56, s56, s55
    s_cbranch_scc1 K_POLLBOK
K_POLLB:
    s_waitcnt vmcnt(0)
    v_cmp_ne_u32 vcc, s52, v184
    s_cbranch_vccz K_POLLBOK
    buffer_load_dword v184, v185, s[36:39], s62 offen sc1
    s_branch K_POLLB
K_POLLBOK:
    s_waitcnt lgkmcnt(0)
    s_barrier
    s_cmp_lg_u32 s55, 0
    s_cbranch_scc1 K_NOPF
    s_mov_b64 exec, s[40:41]
    buffer_load_dwordx4 v[88:91], v100, s[36:39], s61 offen sc1
    s_mov_b64 exec, s[42:43]
    buffer_load_dwordx4 v[92:95], v101, s[36:39], s61 offen sc1
    s_mov_b64 exec, s[44:45]
    buffer_load_dwordx4 v[96:99], v102, s[36:39], s61 offen sc1
    s_mov_b64 exec, -1
    s_cmp_lt_u32 s3, 5
    s_cbranch_scc1 K_NOPF
    s_mov_b32 s64, s4
    s_mov_b32 s65, s5
    s_mov_b32 s66, 10240000
    s_mov_b32 s67, 0x20000
    s_sub_u32 s68, 9, s3
    s_lshl_b32 s68, s68, 5
    s_and_b32 s69, s53, 31
    s_add_u32 s68, s68, s69
    s_lshl_b32 s68, s68, 13
    s_add_u32 s68, s68, s27
    v_lshlrev_b32 v12, 7, v1
    buffer_load_dword v255, v12, s[64:67], s68 offen
K_NOPF:
    ds_read_b32 v168, v15 offset:512
    ds_read_b128 v[120:123], v4 offset:512
    ds_read_b128 v[124:127], v4 offset:528
    ds_read_b128 v[128:131], v4 offset:544
    ds_read_b128 v[132:135], v4 offset:560
    ds_read_b128 v[136:139], v4 offset:576
    ds_read_b128 v[140:143], v4 offset:592
    ds_read_b128 v[144:147], v4 offset:608
    ds_read_b128 v[148:151], v4 offset:624
    ds_read_b128 v[152:155], v4 offset:640
    ds_read_b128 v[156:159], v4 offset:656
    v_cmp_gt_u32 vcc, 40, v1
    s_waitcnt lgkmcnt(9)
    v_pk_add_f32 v[120:121], v[120:121], v[168:169] op_sel_hi:[1,0] neg_lo:[0,1] neg_hi:[0,1] clamp
    v_pk_add_f32 v[122:123], v[122:123], v[168:169] op_sel_hi:[1,0] neg_lo:[0,1] neg_hi:[0,1] clamp
    s_waitcnt lgkmcnt(8)
    v_pk_add_f32 v[124:125], v[124:125], v[168:169] op_sel_hi:[1,0] neg_lo:[0,1] neg_hi:[0,1] clamp
    v_pk_add_f32 v[124:125], v[124:125], v[120:121]
    v_pk_add_f32 v[126:127], v[126:127], v[168:169] op_sel_hi:[1,0] neg_lo:[0,1] neg_hi:[0,1] clamp
    v_pk_add_f32 v[126:127], v[126:127], v[122:123]
    s_waitcnt lgkmcnt(7)
    v_pk_add_f32 v[128:129], v[128:129], v[168:169] op_sel_hi:[1,0] neg_lo:[0,1] neg_hi:[0,1] clamp
    v_pk_add_f32 v[128:129], v[128:129], v[124:125]
    v_pk_add_f32 v[130:131], v[130:131], v[168:169] op_sel_hi:[1,0] neg_lo:[0,1] neg_hi:[0,1] clamp
    v_pk_add_f32 v[130:131], v[130:131], v[126:127]
    s_waitcnt lgkmcnt(6)
    v_pk_add_f32 v[132:133], v[132:133], v[168:169] op_sel_hi:[1,0] neg_lo:[0,1] neg_hi:[0,1] clamp
    v_pk_add_f32 v[132:133], v[132:133], v[128:129]
    v_pk_add_f32 v[134:135], v[134:135], v[168:169] op_sel_hi:[1,0] neg_lo:[0,1] neg_hi:[0,1] clamp
    v_pk_add_f32 v[134:135], v[134:135], v[130:131]
    s_waitcnt lgkmcnt(5)
    v_pk_add_f32 v[136:137], v[136:137], v[168:169] op_sel_hi:[1,0] neg_lo:[0,1] neg_hi:[0,1] clamp
    v_pk_add_f32 v[136:137], v[136:137], v[132:133]
    v_pk_add_f32 v[138:139], v[138:139], v[168:169] op_sel_hi:[1,0] neg_lo:[0,1] neg_hi:[0,1] clamp
    v_pk_add_f32 v[138:139], v[138:139], v[134:135]
    s_waitcnt lgkmcnt(4)
    v_pk_add_f32 v[140:141], v[140:141], v[168:169] op_sel_hi:[1,0] neg_lo:[0,1] neg_hi:[0,1] clamp
    v_pk_add_f32 v[140:141], v[140:141], v[136:137]
    v_pk_add_f32 v[142:143], v[142:143], v[168:169] op_sel_hi:[1,0] neg_lo:[0,1] neg_hi:[0,1] clamp
    v_pk_add_f32 v[142:143], v[142:143], v[138:139]
    s_waitcnt lgkmcnt(3)
    v_pk_add_f32 v[144:145], v[144:145], v[168:169] op_sel_hi:[1,0] neg_lo:[0,1] neg_hi:[0,1] clamp
    v_pk_add_f32 v[144:145], v[144:145], v[140:141]
    v_pk_add_f32 v[146:147], v[146:147], v[168:169] op_sel_hi:[1,0] neg_lo:[0,1] neg_hi:[0,1] clamp
    v_pk_add_f32 v[146:147], v[146:147], v[142:143]
    s_waitcnt lgkmcnt(2)
    v_pk_add_f32 v[148:149], v[148:149], v[168:169] op_sel_hi:[1,0] neg_lo:[0,1] neg_hi:[0,1] clamp
    v_pk_add_f32 v[148:149], v[148:149], v[144:145]
    v_pk_add_f32 v[150:151], v[150:151], v[168:169] op_sel_hi:[1,0] neg_lo:[0,1] neg_hi:[0,1] clamp
    v_pk_add_f32 v[150:151], v[150:151], v[146:147]
    s_waitcnt lgkmcnt(1)
    v_pk_add_f32 v[152:153], v[152:153], v[168:169] op_sel_hi:[1,0] neg_lo:[0,1] neg_hi:[0,1] clamp
    v_pk_add_f32 v[152:153], v[152:153], v[148:149]
    v_pk_add_f32 v[154:155], v[154:155], v[168:169] op_sel_hi:[1,0] neg_lo:[0,1] neg_hi:[0,1] clamp
    v_pk_add_f32 v[154:155], v[154:155], v[150:151]
    s_waitcnt lgkmcnt(0)
    v_pk_add_f32 v[156:157], v[156:157], v[168:169] op_sel_hi:[1,0] neg_lo:[0,1] neg_hi:[0,1] clamp
    v_pk_add_f32 v[156:157], v[156:157], v[152:153]
    v_pk_add_f32 v[158:159], v[158:159], v[168:169] op_sel_hi:[1,0] neg_lo:[0,1] neg_hi:[0,1] clamp
    v_pk_add_f32 v[158:159], v[158:159], v[154:155]
    v_pk_add_f32 v[158:159], v[158:159], v[156:157]
    v_add_f32 v158, v158, v159
    v_cvt_u32_f32 v158, v158
    v_lshlrev_b32 v158, 2, v158
    ds_bpermute_b32 v2, v158, v2
    s_waitcnt lgkmcnt(0)
    v_cndmask_b32 v2, -1, v2, vcc
K_BAL:
    ds_bpermute_b32 v84, v81, v2
    ds_bpermute_b32 v85, v82, v2
    ds_bpermute_b32 v86, v83, v2
    v_mov_b32 v14, 1
    v_lshlrev_b32 v10, 3, v1
    s_lshr_b32 s56, s53, 4
    s_and_b32 s56, s56, 14
    v_subrev_u32 v103, s56, v72
    v_and_b32 v103, 15, v103
    v_subrev_u32 v104, s56, v74
    v_and_b32 v104, 15, v104
    v_subrev_u32 v105, s56, v76
    v_and_b32 v105, 15, v105
    s_waitcnt lgkmcnt(2)
    s_mov_b64 exec, s[40:41]
    v_and_b32 v81, 7, v84
    v_lshl_or_b32 v103, v81, 4, v103
    v_lshlrev_b32 v81, 2, v103
    ds_add_rtn_u32 v78, v81, v14 offset:0
    s_waitcnt lgkmcnt(2)
    s_mov_b64 exec, s[42:43]
    v_and_b32 v82, 7, v85
    v_lshl_or_b32 v104, v82, 4, v104
    v_lshlrev_b32 v82, 2, v104
    ds_add_rtn_u32 v79, v82, v14 offset:0
    s_waitcnt lgkmcnt(2)
    s_mov_b64 exec, s[44:45]
    v_and_b32 v83, 7, v86
    v_lshl_or_b32 v105, v83, 4, v105
    v_lshlrev_b32 v83, 2, v105
    ds_add_rtn_u32 v80, v83, v14 offset:0
    s_mov_b64 exec, -1
    v_lshlrev_b32 v81, 1, v103
    v_lshlrev_b32 v103, 4, v103
    v_and_b32 v84, 0x38, v84
    v_and_b32 v72, 16776192, v72
    v_lshlrev_b32 v82, 1, v104
    v_lshlrev_b32 v104, 4, v104
    v_and_b32 v85, 0x38, v85
    v_and_b32 v74, 16776192, v74
    v_lshlrev_b32 v83, 1, v105
    v_lshlrev_b32 v105, 4, v105
    v_and_b32 v86, 0x38, v86
    v_and_b32 v76, 16776192, v76
    s_lshl_b32 s56, s3, 3
    s_add_u32 s57, s56, 7
    v_lshrrev_b32 v114, 3, v1
    v_mul_u32_u24 v114, 48, v114
    s_waitcnt lgkmcnt(0)
    s_barrier
    ds_read_b64 v[108:109], v10 offset:0
    s_sub_u32 s58, s27, 1024
    s_cselect_b32 s58, 10238976, s58
    s_waitcnt lgkmcnt(0)
    v_add_u32 v110, v108, v109
    v_mov_b32 v111, v110
    v_and_b32 v12, 15, v1
    v_lshrrev_b32 v11, 4, v1
    v_add_u32_dpp v111, v111, v111 row_shr:1 row_mask:0xf bank_mask:0xf
    v_lshlrev_b32 v11, 3, v11
    v_lshl_add_u32 v11, v12, 5, v11
    v_add_u32_dpp v111, v111, v111 row_shr:2 row_mask:0xf bank_mask:0xf
    v_mov_b32 v115, s58
    v_mov_b32 v254, 0
    v_add_u32_dpp v111, v111, v111 row_shr:4 row_mask:0xf bank_mask:0xf
    s_nop 1
    v_add_u32_dpp v111, v111, v111 row_shr:8 row_mask:0xf bank_mask:0xf
    s_nop 1
    v_add_u32_dpp v111, v111, v111 row_bcast:15 row_mask:0xa bank_mask:0xf
    s_nop 1
    v_add_u32_dpp v111, v111, v111 row_bcast:31 row_mask:0xc bank_mask:0xf
    v_sub_u32 v110, v111, v110
    v_readlane_b32 s51, v111, s57
    s_nop 0
    v_mov_b32_dpp v112, v110 row_newbcast:0 row_mask:0xf bank_mask:0x3
    v_readlane_b32 s58, v110, s56
    s_nop 0
    v_mov_b32_dpp v112, v110 row_newbcast:8 row_mask:0xf bank_mask:0xc
    v_add_u32 v113, 15, v112
    v_and_b32 v113, -16, v113
    v_add_u32 v113, v113, v114
    v_sub_u32 v112, v113, v112
    v_add_u32 v112, v112, v110
    v_add_u32 v108, v112, v108
    v_lshl_or_b32 v108, v108, 16, v112
    v_readlane_b32 s50, v113, s56
    ds_bpermute_b32 v81, v81, v108
    ds_bpermute_b32 v82, v82, v108
    ds_bpermute_b32 v83, v83, v108
    s_sub_u32 s51, s51, s58
    s_add_u32 s56, s50, s51
    v_add_u32 v109, s56, v1
    v_lshlrev_b32 v110, 2, v109
    v_lshlrev_b32 v111, 4, v109
    s_mov_b64 exec, 0xfffff
    ds_write_b32 v110, v115 offset:4096
    ds_write_b8 v109, v4 offset:11840
    ds_write_b128 v111, v[4:7] offset:13824
    s_mov_b64 exec, s[40:41]
    s_waitcnt lgkmcnt(5)
    v_bfe_u32 v81, v81, v103, 16
    v_add_u32 v81, v81, v78
    v_lshlrev_b32 v78, 2, v81
    v_lshlrev_b32 v103, 4, v81
    ds_write_b32 v78, v72 offset:4096
    ds_write_b8 v81, v84 offset:11840
    s_mov_b64 exec, s[42:43]
    s_waitcnt lgkmcnt(6)
    v_bfe_u32 v82, v82, v104, 16
    v_add_u32 v82, v82, v79
    v_lshlrev_b32 v79, 2, v82
    v_lshlrev_b32 v104, 4, v82
    ds_write_b32 v79, v74 offset:4096
    ds_write_b8 v82, v85 offset:11840
    s_mov_b64 exec, s[44:45]
    s_waitcnt lgkmcnt(7)
    v_bfe_u32 v83, v83, v105, 16
    v_add_u32 v83, v83, v80
    v_lshlrev_b32 v80, 2, v83
    v_lshlrev_b32 v105, 4, v83
    ds_write_b32 v80, v76 offset:4096
    ds_write_b8 v83, v86 offset:11840
    s_mov_b64 exec, -1
    s_add_u32 s58, s3, 0
    v_cmp_eq_u32 vcc, s58, v2
    s_ff1_i32_b64 s58, vcc
    s_mul_i32 s58, s58, 1152
    s_add_u32 s58, s58, 106752
    v_add_u32 v106, s58, v15
    s_add_u32 s58, s3, 8
    v_cmp_eq_u32 vcc, s58, v2
    s_ff1_i32_b64 s58, vcc
    s_mul_i32 s58, s58, 1152
    s_add_u32 s58, s58, 106752
    v_add_u32 v107, s58, v15
    s_add_u32 s58, s3, 16
    v_cmp_eq_u32 vcc, s58, v2
    s_ff1_i32_b64 s58, vcc
    s_mul_i32 s58, s58, 1152
    s_add_u32 s58, s58, 106752
    v_add_u32 v116, s58, v15
    s_add_u32 s58, s3, 24
    v_cmp_eq_u32 vcc, s58, v2
    s_ff1_i32_b64 s58, vcc
    s_mul_i32 s58, s58, 1152
    s_add_u32 s58, s58, 106752
    v_add_u32 v117, s58, v15
    s_add_u32 s58, s3, 32
    v_cmp_eq_u32 vcc, s58, v2
    s_ff1_i32_b64 s58, vcc
    s_mul_i32 s58, s58, 1152
    s_add_u32 s58, s58, 106752
    v_add_u32 v118, s58, v15
    s_cmp_lt_u32 s3, 5
    s_cselect_b32 s56, 1, s47
    s_or_b32 s56, s56, s55
    s_cbranch_scc0 K_PW1
    s_waitcnt vmcnt(0)
K_PW1:
    s_waitcnt vmcnt(1)
    s_mov_b64 exec, s[40:41]
    ds_write_b128 v103, v[88:91] offset:13824
    s_mov_b64 exec, s[42:43]
    ds_write_b128 v104, v[92:95] offset:13824
    s_mov_b64 exec, s[44:45]
    ds_write_b128 v105, v[96:99] offset:13824
    s_mov_b64 exec, -1
    s_lshl_b32 s56, s50, 2
    s_add_u32 s56, s56, 4096
    v_mov_b32 v196, s56
    s_add_u32 s56, s50, 11840
    v_mov_b32 v197, s56
    s_lshl_b32 s56, s50, 5
    s_add_u32 s56, s56, 44800
    v_add_u32 v198, s56, v10
    v_add_u32 v11, s56, v11
    s_lshl_b32 s57, s50, 4
    s_add_u32 s57, s57, 13824
    v_lshl_add_u32 v199, v12, 4, s57
    v_add_u32 v10, s57, v9
    s_add_u32 s48, s51, 3
    s_lshr_b32 s48, s48, 2
    s_waitcnt lgkmcnt(0)
    s_barrier
    s_cmp_eq_u32 s48, 0
    s_cbranch_scc1 K2_LOOPDONE
    ds_read_b128 v[120:123], v196 offset:0
    ds_read_b128 v[124:127], v196 offset:16
    ds_read_b64 v[152:153], v10
    ds_read2_b64 v[188:191], v196 offset0:4 offset1:5
    ds_read_b64 v[186:187], v199 offset:8
    ds_read_b128 v[192:195], v197
    s_lshl_b32 s56, s48, 2
    s_waitcnt lgkmcnt(5)
    buffer_load_dwordx4 v[56:59], v120, s[28:31], 0 offen
    buffer_load_dwordx4 v[60:63], v121, s[28:31], 0 offen
    buffer_load_dwordx4 v[64:67], v122, s[28:31], 0 offen
    buffer_load_dwordx4 v[68:71], v123, s[28:31], 0 offen
    s_waitcnt lgkmcnt(4)
    buffer_load_dwordx4 v[72:75], v124, s[28:31], 0 offen
    buffer_load_dwordx4 v[76:79], v125, s[28:31], 0 offen
    buffer_load_dwordx4 v[80:83], v126, s[28:31], 0 offen
    buffer_load_dwordx4 v[84:87], v127, s[28:31], 0 offen
K_APREP:
    v_cmp_gt_u32 vcc, s56, v1
    s_waitcnt lgkmcnt(0)
    s_nop 0
    v_cndmask_b32 v160, 0, v152, vcc
    v_cndmask_b32 v161, 0, v153, vcc
    ds_read_b64 v[152:153], v10 offset:1024
    v_add_u32 v10, 1024, v10
    v_mfma_f32_16x16x16_bf16 v[136:139], v[232:233], v[160:161], 0
    v_mfma_f32_16x16x16_bf16 v[140:143], v[234:235], v[160:161], 0
    v_mfma_f32_16x16x16_bf16 v[144:147], v[236:237], v[160:161], 0
    v_mfma_f32_16x16x16_bf16 v[148:151], v[238:239], v[160:161], 0
    s_nop 4
    v_cvt_pk_bf16_f32 v168, v136, v137
    v_cvt_pk_bf16_f32 v169, v138, v139
    ds_write_b64 v11, v[168:169] offset:0
    s_sub_u32 s56, s56, 16
    s_cmp_le_i32 s56, 0
    s_cbranch_scc1 K_APDONE
    v_cvt_pk_bf16_f32 v170, v140, v141
    v_cvt_pk_bf16_f32 v171, v142, v143
    ds_write_b64 v11, v[170:171] offset:512
    s_sub_u32 s56, s56, 16
    s_cmp_le_i32 s56, 0
    s_cbranch_scc1 K_APDONE
    v_cvt_pk_bf16_f32 v172, v144, v145
    v_cvt_pk_bf16_f32 v173, v146, v147
    ds_write_b64 v11, v[172:173] offset:1024
    s_sub_u32 s56, s56, 16
    s_cmp_le_i32 s56, 0
    s_cbranch_scc1 K_APDONE
    v_cvt_pk_bf16_f32 v174, v148, v149
    v_cvt_pk_bf16_f32 v175, v150, v151
    ds_write_b64 v11, v[174:175] offset:1536
    s_sub_u32 s56, s56, 16
    s_cmp_le_i32 s56, 0
    s_cbranch_scc1 K_APDONE
    v_add_u32 v11, 2048, v11
    s_branch K_APREP
K_APDONE:
    s_waitcnt lgkmcnt(0)
    ds_read_b64 v[184:185], v198
    v_mfma_f32_4x4x4_16b_bf16 v[152:155], v[186:187], v[176:177], 0 cbsz:4 abid:0
    v_mfma_f32_4x4x4_16b_bf16 v[156:159], v[186:187], v[180:181], 0 cbsz:4 abid:0
    s_sub_u32 s48, s48, 3
    s_nop 2
    s_cbranch_scc1 K2_D0
.p2align 4
K2_LOOP:
    s_waitcnt vmcnt(6) lgkmcnt(0)
    v_subrev_u32 v255, s27, v188
    v_cmp_gt_u32 vcc, v255, v254
    ds_write_b32 v252, v255 offset:2048
    s_setprio 0
    s_cbranch_vccnz K2_P0
    s_setprio 1
K2_P0:
    v_mfma_f32_4x4x4_16b_bf16 v[120:123], v[184:185], v[56:57], 0 cbsz:4 abid:0
    v_exp_f32 v168, v152
    v_mfma_f32_4x4x4_16b_bf16 v[124:127], v[184:185], v[58:59], 0 cbsz:4 abid:0
    v_exp_f32 v169, v153
    v_mfma_f32_4x4x4_16b_bf16 v[128:131], v[184:185], v[60:61], 0 cbsz:4 abid:1
    v_exp_f32 v170, v154
    v_mfma_f32_4x4x4_16b_bf16 v[132:135], v[184:185], v[62:63], 0 cbsz:4 abid:1
    buffer_load_dwordx4 v[56:59], v188, s[28:31], 0 offen
    buffer_load_dwordx4 v[60:63], v189, s[28:31], 0 offen
    v_exp_f32 v171, v155
    s_waitcnt vmcnt(6)
    v_mfma_f32_4x4x4_16b_bf16 v[136:139], v[184:185], v[64:65], 0 cbsz:4 abid:2
    v_exp_f32 v172, v156
    v_mfma_f32_4x4x4_16b_bf16 v[140:143], v[184:185], v[66:67], 0 cbsz:4 abid:2
    v_exp_f32 v173, v157
    v_exp_f32 v174, v158
    v_exp_f32 v175, v159
    v_pk_add_f32 v[168:169], v[168:169], 1.0 op_sel_hi:[1,0]
    v_pk_add_f32 v[170:171], v[170:171], 1.0 op_sel_hi:[1,0]
    v_pk_add_f32 v[172:173], v[172:173], 1.0 op_sel_hi:[1,0]
    v_pk_add_f32 v[174:175], v[174:175], 1.0 op_sel_hi:[1,0]
    v_mfma_f32_4x4x4_16b_bf16 v[144:147], v[184:185], v[68:69], 0 cbsz:4 abid:3
    v_rcp_f32 v168, v168
    v_mfma_f32_4x4x4_16b_bf16 v[148:151], v[184:185], v[70:71], 0 cbsz:4 abid:3
    buffer_load_dwordx4 v[64:67], v190, s[28:31], 0 offen
    buffer_load_dwordx4 v[68:71], v191, s[28:31], 0 offen
    v_rcp_f32 v169, v169
    ds_read_b128 v[188:191], v196 offset:48
    v_mfma_f32_4x4x4_16b_bf16 v[160:163], v[186:187], v[176:177], 0 cbsz:4 abid:1
    v_rcp_f32 v170, v170
    v_mfma_f32_4x4x4_16b_bf16 v[164:167], v[186:187], v[180:181], 0 cbsz:4 abid:1
    v_rcp_f32 v171, v171
    v_rcp_f32 v172, v172
    v_rcp_f32 v173, v173
    v_rcp_f32 v174, v174
    v_rcp_f32 v175, v175
    v_readfirstlane_b32 s49, v192
    v_pk_mul_f32 v[168:169], v[168:169], v[152:153]
    v_pk_mul_f32 v[170:171], v[170:171], v[154:155]
    v_pk_mul_f32 v[172:173], v[172:173], v[156:157]
    v_pk_mul_f32 v[174:175], v[174:175], v[158:159]
    s_set_gpr_idx_on s49, gpr_idx(SRC2,DST)
    v_pk_fma_f32 v[16:17], v[168:169], v[120:121], v[16:17] op_sel:[0,0,0] op_sel_hi:[0,1,1]
    v_pk_fma_f32 v[18:19], v[168:169], v[122:123], v[18:19] op_sel:[0,0,0] op_sel_hi:[0,1,1]
    v_pk_fma_f32 v[20:21], v[172:173], v[124:125], v[20:21] op_sel:[0,0,0] op_sel_hi:[0,1,1]
    v_pk_fma_f32 v[22:23], v[172:173], v[126:127], v[22:23] op_sel:[0,0,0] op_sel_hi:[0,1,1]
    s_lshr_b32 s49, s49, 8
    s_set_gpr_idx_idx s49
    v_pk_fma_f32 v[16:17], v[168:169], v[128:129], v[16:17] op_sel:[1,0,0] op_sel_hi:[1,1,1]
    v_pk_fma_f32 v[18:19], v[168:169], v[130:131], v[18:19] op_sel:[1,0,0] op_sel_hi:[1,1,1]
    v_pk_fma_f32 v[20:21], v[172:173], v[132:133], v[20:21] op_sel:[1,0,0] op_sel_hi:[1,1,1]
    v_pk_fma_f32 v[22:23], v[172:173], v[134:135], v[22:23] op_sel:[1,0,0] op_sel_hi:[1,1,1]
    s_lshr_b32 s49, s49, 8
    s_set_gpr_idx_idx s49
    v_pk_fma_f32 v[16:17], v[170:171], v[136:137], v[16:17] op_sel:[0,0,0] op_sel_hi:[0,1,1]
    v_pk_fma_f32 v[18:19], v[170:171], v[138:139], v[18:19] op_sel:[0,0,0] op_sel_hi:[0,1,1]
    v_pk_fma_f32 v[20:21], v[174:175], v[140:141], v[20:21] op_sel:[0,0,0] op_sel_hi:[0,1,1]
    v_pk_fma_f32 v[22:23], v[174:175], v[142:143], v[22:23] op_sel:[0,0,0] op_sel_hi:[0,1,1]
    s_lshr_b32 s49, s49, 8
    s_set_gpr_idx_idx s49
    v_pk_fma_f32 v[16:17], v[170:171], v[144:145], v[16:17] op_sel:[1,0,0] op_sel_hi:[1,1,1]
    v_pk_fma_f32 v[18:19], v[170:171], v[146:147], v[18:19] op_sel:[1,0,0] op_sel_hi:[1,1,1]
    v_pk_fma_f32 v[20:21], v[174:175], v[148:149], v[20:21] op_sel:[1,0,0] op_sel_hi:[1,1,1]
    v_pk_fma_f32 v[22:23], v[174:175], v[150:151], v[22:23] op_sel:[1,0,0] op_sel_hi:[1,1,1]
    s_set_gpr_idx_off
    s_sub_u32 s48, s48, 1
    s_cbranch_scc1 K2_D1
    s_waitcnt vmcnt(6) lgkmcnt(0)
    v_mfma_f32_4x4x4_16b_bf16 v[120:123], v[184:185], v[72:73], 0 cbsz:4 abid:4
    v_exp_f32 v168, v160
    v_mfma_f32_4x4x4_16b_bf16 v[124:127], v[184:185], v[74:75], 0 cbsz:4 abid:4
    v_exp_f32 v169, v161
    v_mfma_f32_4x4x4_16b_bf16 v[128:131], v[184:185], v[76:77], 0 cbsz:4 abid:5
    v_exp_f32 v170, v162
    v_mfma_f32_4x4x4_16b_bf16 v[132:135], v[184:185], v[78:79], 0 cbsz:4 abid:5
    buffer_load_dwordx4 v[72:75], v188, s[28:31], 0 offen
    buffer_load_dwordx4 v[76:79], v189, s[28:31], 0 offen
    v_exp_f32 v171, v163
    s_waitcnt vmcnt(6)
    v_mfma_f32_4x4x4_16b_bf16 v[136:139], v[184:185], v[80:81], 0 cbsz:4 abid:6
    v_exp_f32 v172, v164
    v_mfma_f32_4x4x4_16b_bf16 v[140:143], v[184:185], v[82:83], 0 cbsz:4 abid:6
    v_exp_f32 v173, v165
    v_exp_f32 v174, v166
    v_exp_f32 v175, v167
    v_pk_add_f32 v[168:169], v[168:169], 1.0 op_sel_hi:[1,0]
    v_pk_add_f32 v[170:171], v[170:171], 1.0 op_sel_hi:[1,0]
    v_pk_add_f32 v[172:173], v[172:173], 1.0 op_sel_hi:[1,0]
    v_pk_add_f32 v[174:175], v[174:175], 1.0 op_sel_hi:[1,0]
    v_mfma_f32_4x4x4_16b_bf16 v[144:147], v[184:185], v[84:85], 0 cbsz:4 abid:7
    v_rcp_f32 v168, v168
    v_mfma_f32_4x4x4_16b_bf16 v[148:151], v[184:185], v[86:87], 0 cbsz:4 abid:7
    buffer_load_dwordx4 v[80:83], v190, s[28:31], 0 offen
    buffer_load_dwordx4 v[84:87], v191, s[28:31], 0 offen
    v_rcp_f32 v169, v169
    ds_read_b128 v[188:191], v196 offset:64
    ds_read_b32 v254, v253 offset:2048
    v_mfma_f32_4x4x4_16b_bf16 v[152:155], v[186:187], v[176:177], 0 cbsz:4 abid:2
    v_rcp_f32 v170, v170
    v_mfma_f32_4x4x4_16b_bf16 v[156:159], v[186:187], v[180:181], 0 cbsz:4 abid:2
    v_rcp_f32 v171, v171
    v_rcp_f32 v172, v172
    v_rcp_f32 v173, v173
    v_rcp_f32 v174, v174
    v_rcp_f32 v175, v175
    v_readfirstlane_b32 s49, v193
    v_pk_mul_f32 v[168:169], v[168:169], v[160:161]
    v_pk_mul_f32 v[170:171], v[170:171], v[162:163]
    v_pk_mul_f32 v[172:173], v[172:173], v[164:165]
    v_pk_mul_f32 v[174:175], v[174:175], v[166:167]
    s_set_gpr_idx_on s49, gpr_idx(SRC2,DST)
    v_pk_fma_f32 v[16:17], v[168:169], v[120:121], v[16:17] op_sel:[0,0,0] op_sel_hi:[0,1,1]
    v_pk_fma_f32 v[18:19], v[168:169], v[122:123], v[18:19] op_sel:[0,0,0] op_sel_hi:[0,1,1]
    v_pk_fma_f32 v[20:21], v[172:173], v[124:125], v[20:21] op_sel:[0,0,0] op_sel_hi:[0,1,1]
    v_pk_fma_f32 v[22:23], v[172:173], v[126:127], v[22:23] op_sel:[0,0,0] op_sel_hi:[0,1,1]
    s_lshr_b32 s49, s49, 8
    s_set_gpr_idx_idx s49
    v_pk_fma_f32 v[16:17], v[168:169], v[128:129], v[16:17] op_sel:[1,0,0] op_sel_hi:[1,1,1]
    v_pk_fma_f32 v[18:19], v[168:169], v[130:131], v[18:19] op_sel:[1,0,0] op_sel_hi:[1,1,1]
    v_pk_fma_f32 v[20:21], v[172:173], v[132:133], v[20:21] op_sel:[1,0,0] op_sel_hi:[1,1,1]
    v_pk_fma_f32 v[22:23], v[172:173], v[134:135], v[22:23] op_sel:[1,0,0] op_sel_hi:[1,1,1]
    s_lshr_b32 s49, s49, 8
    s_set_gpr_idx_idx s49
    v_pk_fma_f32 v[16:17], v[170:171], v[136:137], v[16:17] op_sel:[0,0,0] op_sel_hi:[0,1,1]
    v_pk_fma_f32 v[18:19], v[170:171], v[138:139], v[18:19] op_sel:[0,0,0] op_sel_hi:[0,1,1]
    v_pk_fma_f32 v[20:21], v[174:175], v[140:141], v[20:21] op_sel:[0,0,0] op_sel_hi:[0,1,1]
    v_pk_fma_f32 v[22:23], v[174:175], v[142:143], v[22:23] op_sel:[0,0,0] op_sel_hi:[0,1,1]
    s_lshr_b32 s49, s49, 8
    s_set_gpr_idx_idx s49
    v_pk_fma_f32 v[16:17], v[170:171], v[144:145], v[16:17] op_sel:[1,0,0] op_sel_hi:[1,1,1]
    v_pk_fma_f32 v[18:19], v[170:171], v[146:147], v[18:19] op_sel:[1,0,0] op_sel_hi:[1,1,1]
    v_pk_fma_f32 v[20:21], v[174:175], v[148:149], v[20:21] op_sel:[1,0,0] op_sel_hi:[1,1,1]
    v_pk_fma_f32 v[22:23], v[174:175], v[150:151], v[22:23] op_sel:[1,0,0] op_sel_hi:[1,1,1]
    s_set_gpr_idx_off
    s_sub_u32 s48, s48, 1
    s_cbranch_scc1 K2_D2
    s_waitcnt vmcnt(6) lgkmcnt(0)
    v_subrev_u32 v255, s27, v188
    v_cmp_gt_u32 vcc, v255, v254
    ds_write_b32 v252, v255 offset:2048
    s_setprio 0
    s_cbranch_vccnz K2_P2
    s_setprio 1
K2_P2:
    v_mfma_f32_4x4x4_16b_bf16 v[120:123], v[184:185], v[56:57], 0 cbsz:4 abid:8
    v_exp_f32 v168, v152
    v_mfma_f32_4x4x4_16b_bf16 v[124:127], v[184:185], v[58:59], 0 cbsz:4 abid:8
    v_exp_f32 v169, v153
    v_mfma_f32_4x4x4_16b_bf16 v[128:131], v[184:185], v[60:61], 0 cbsz:4 abid:9
    v_exp_f32 v170, v154
    v_mfma_f32_4x4x4_16b_bf16 v[132:135], v[184:185], v[62:63], 0 cbsz:4 abid:9
    buffer_load_dwordx4 v[56:59], v188, s[28:31], 0 offen
    buffer_load_dwordx4 v[60:63], v189, s[28:31], 0 offen
    v_exp_f32 v171, v155
    s_waitcnt vmcnt(6)
    v_mfma_f32_4x4x4_16b_bf16 v[136:139], v[184:185], v[64:65], 0 cbsz:4 abid:10
    v_exp_f32 v172, v156
    v_mfma_f32_4x4x4_16b_bf16 v[140:143], v[184:185], v[66:67], 0 cbsz:4 abid:10
    v_exp_f32 v173, v157
    v_exp_f32 v174, v158
    v_exp_f32 v175, v159
    v_pk_add_f32 v[168:169], v[168:169], 1.0 op_sel_hi:[1,0]
    v_pk_add_f32 v[170:171], v[170:171], 1.0 op_sel_hi:[1,0]
    v_pk_add_f32 v[172:173], v[172:173], 1.0 op_sel_hi:[1,0]
    v_pk_add_f32 v[174:175], v[174:175], 1.0 op_sel_hi:[1,0]
    v_mfma_f32_4x4x4_16b_bf16 v[144:147], v[184:185], v[68:69], 0 cbsz:4 abid:11
    v_rcp_f32 v168, v168
    v_mfma_f32_4x4x4_16b_bf16 v[148:151], v[184:185], v[70:71], 0 cbsz:4 abid:11
    buffer_load_dwordx4 v[64:67], v190, s[28:31], 0 offen
    buffer_load_dwordx4 v[68:71], v191, s[28:31], 0 offen
    v_rcp_f32 v169, v169
    ds_read_b128 v[188:191], v196 offset:80
    v_mfma_f32_4x4x4_16b_bf16 v[160:163], v[186:187], v[176:177], 0 cbsz:4 abid:3
    v_rcp_f32 v170, v170
    v_mfma_f32_4x4x4_16b_bf16 v[164:167], v[186:187], v[180:181], 0 cbsz:4 abid:3
    v_rcp_f32 v171, v171
    v_rcp_f32 v172, v172
    ds_read_b64 v[186:187], v199 offset:264
    v_rcp_f32 v173, v173
    v_rcp_f32 v174, v174
    v_rcp_f32 v175, v175
    v_readfirstlane_b32 s49, v194
    v_pk_mul_f32 v[168:169], v[168:169], v[152:153]
    v_pk_mul_f32 v[170:171], v[170:171], v[154:155]
    v_pk_mul_f32 v[172:173], v[172:173], v[156:157]
    v_pk_mul_f32 v[174:175], v[174:175], v[158:159]
    s_set_gpr_idx_on s49, gpr_idx(SRC2,DST)
    v_pk_fma_f32 v[16:17], v[168:169], v[120:121], v[16:17] op_sel:[0,0,0] op_sel_hi:[0,1,1]
    v_pk_fma_f32 v[18:19], v[168:169], v[122:123], v[18:19] op_sel:[0,0,0] op_sel_hi:[0,1,1]
    v_pk_fma_f32 v[20:21], v[172:173], v[124:125], v[20:21] op_sel:[0,0,0] op_sel_hi:[0,1,1]
    v_pk_fma_f32 v[22:23], v[172:173], v[126:127], v[22:23] op_sel:[0,0,0] op_sel_hi:[0,1,1]
    s_lshr_b32 s49, s49, 8
    s_set_gpr_idx_idx s49
    v_pk_fma_f32 v[16:17], v[168:169], v[128:129], v[16:17] op_sel:[1,0,0] op_sel_hi:[1,1,1]
    v_pk_fma_f32 v[18:19], v[168:169], v[130:131], v[18:19] op_sel:[1,0,0] op_sel_hi:[1,1,1]
    v_pk_fma_f32 v[20:21], v[172:173], v[132:133], v[20:21] op_sel:[1,0,0] op_sel_hi:[1,1,1]
    v_pk_fma_f32 v[22:23], v[172:173], v[134:135], v[22:23] op_sel:[1,0,0] op_sel_hi:[1,1,1]
    s_lshr_b32 s49, s49, 8
    s_set_gpr_idx_idx s49
    v_pk_fma_f32 v[16:17], v[170:171], v[136:137], v[16:17] op_sel:[0,0,0] op_sel_hi:[0,1,1]
    v_pk_fma_f32 v[18:19], v[170:171], v[138:139], v[18:19] op_sel:[0,0,0] op_sel_hi:[0,1,1]
    v_pk_fma_f32 v[20:21], v[174:175], v[140:141], v[20:21] op_sel:[0,0,0] op_sel_hi:[0,1,1]
    v_pk_fma_f32 v[22:23], v[174:175], v[142:143], v[22:23] op_sel:[0,0,0] op_sel_hi:[0,1,1]
    s_lshr_b32 s49, s49, 8
    s_set_gpr_idx_idx s49
    v_pk_fma_f32 v[16:17], v[170:171], v[144:145], v[16:17] op_sel:[1,0,0] op_sel_hi:[1,1,1]
    v_pk_fma_f32 v[18:19], v[170:171], v[146:147], v[18:19] op_sel:[1,0,0] op_sel_hi:[1,1,1]
    v_pk_fma_f32 v[20:21], v[174:175], v[148:149], v[20:21] op_sel:[1,0,0] op_sel_hi:[1,1,1]
    v_pk_fma_f32 v[22:23], v[174:175], v[150:151], v[22:23] op_sel:[1,0,0] op_sel_hi:[1,1,1]
    s_set_gpr_idx_off
    s_sub_u32 s48, s48, 1
    s_cbranch_scc1 K2_D3
    s_waitcnt vmcnt(6) lgkmcnt(0)
    v_mfma_f32_4x4x4_16b_bf16 v[120:123], v[184:185], v[72:73], 0 cbsz:4 abid:12
    v_exp_f32 v168, v160
    v_mfma_f32_4x4x4_16b_bf16 v[124:127], v[184:185], v[74:75], 0 cbsz:4 abid:12
    v_exp_f32 v169, v161
    v_mfma_f32_4x4x4_16b_bf16 v[128:131], v[184:185], v[76:77], 0 cbsz:4 abid:13
    v_exp_f32 v170, v162
    v_mfma_f32_4x4x4_16b_bf16 v[132:135], v[184:185], v[78:79], 0 cbsz:4 abid:13
    buffer_load_dwordx4 v[72:75], v188, s[28:31], 0 offen
    buffer_load_dwordx4 v[76:79], v189, s[28:31], 0 offen
    v_exp_f32 v171, v163
    s_waitcnt vmcnt(6)
    v_mfma_f32_4x4x4_16b_bf16 v[136:139], v[184:185], v[80:81], 0 cbsz:4 abid:14
    v_exp_f32 v172, v164
    v_mfma_f32_4x4x4_16b_bf16 v[140:143], v[184:185], v[82:83], 0 cbsz:4 abid:14
    v_exp_f32 v173, v165
    v_exp_f32 v174, v166
    v_exp_f32 v175, v167
    v_pk_add_f32 v[168:169], v[168:169], 1.0 op_sel_hi:[1,0]
    v_pk_add_f32 v[170:171], v[170:171], 1.0 op_sel_hi:[1,0]
    v_pk_add_f32 v[172:173], v[172:173], 1.0 op_sel_hi:[1,0]
    v_pk_add_f32 v[174:175], v[174:175], 1.0 op_sel_hi:[1,0]
    v_mfma_f32_4x4x4_16b_bf16 v[144:147], v[184:185], v[84:85], 0 cbsz:4 abid:15
    v_rcp_f32 v168, v168
    v_mfma_f32_4x4x4_16b_bf16 v[148:151], v[184:185], v[86:87], 0 cbsz:4 abid:15
    buffer_load_dwordx4 v[80:83], v190, s[28:31], 0 offen
    buffer_load_dwordx4 v[84:87], v191, s[28:31], 0 offen
    v_rcp_f32 v169, v169
    ds_read_b128 v[188:191], v196 offset:96
    ds_read_b64 v[184:185], v198 offset:512
    ds_read_b32 v254, v253 offset:2048
    v_mfma_f32_4x4x4_16b_bf16 v[152:155], v[186:187], v[176:177], 0 cbsz:4 abid:0
    v_rcp_f32 v170, v170
    v_mfma_f32_4x4x4_16b_bf16 v[156:159], v[186:187], v[180:181], 0 cbsz:4 abid:0
    v_rcp_f32 v171, v171
    v_rcp_f32 v172, v172
    v_rcp_f32 v173, v173
    v_rcp_f32 v174, v174
    v_rcp_f32 v175, v175
    v_readfirstlane_b32 s49, v195
    ds_read_b128 v[192:195], v197 offset:16
    v_add_u32 v196, 64, v196
    v_add_u32 v197, 16, v197
    v_add_u32 v198, 512, v198
    v_add_u32 v199, 256, v199
    v_pk_mul_f32 v[168:169], v[168:169], v[160:161]
    v_pk_mul_f32 v[170:171], v[170:171], v[162:163]
    v_pk_mul_f32 v[172:173], v[172:173], v[164:165]
    v_pk_mul_f32 v[174:175], v[174:175], v[166:167]
    s_set_gpr_idx_on s49, gpr_idx(SRC2,DST)
    v_pk_fma_f32 v[16:17], v[168:169], v[120:121], v[16:17] op_sel:[0,0,0] op_sel_hi:[0,1,1]
    v_pk_fma_f32 v[18:19], v[168:169], v[122:123], v[18:19] op_sel:[0,0,0] op_sel_hi:[0,1,1]
    v_pk_fma_f32 v[20:21], v[172:173], v[124:125], v[20:21] op_sel:[0,0,0] op_sel_hi:[0,1,1]
    v_pk_fma_f32 v[22:23], v[172:173], v[126:127], v[22:23] op_sel:[0,0,0] op_sel_hi:[0,1,1]
    s_lshr_b32 s49, s49, 8
    s_set_gpr_idx_idx s49
    v_pk_fma_f32 v[16:17], v[168:169], v[128:129], v[16:17] op_sel:[1,0,0] op_sel_hi:[1,1,1]
    v_pk_fma_f32 v[18:19], v[168:169], v[130:131], v[18:19] op_sel:[1,0,0] op_sel_hi:[1,1,1]
    v_pk_fma_f32 v[20:21], v[172:173], v[132:133], v[20:21] op_sel:[1,0,0] op_sel_hi:[1,1,1]
    v_pk_fma_f32 v[22:23], v[172:173], v[134:135], v[22:23] op_sel:[1,0,0] op_sel_hi:[1,1,1]
    s_lshr_b32 s49, s49, 8
    s_set_gpr_idx_idx s49
    v_pk_fma_f32 v[16:17], v[170:171], v[136:137], v[16:17] op_sel:[0,0,0] op_sel_hi:[0,1,1]
    v_pk_fma_f32 v[18:19], v[170:171], v[138:139], v[18:19] op_sel:[0,0,0] op_sel_hi:[0,1,1]
    v_pk_fma_f32 v[20:21], v[174:175], v[140:141], v[20:21] op_sel:[0,0,0] op_sel_hi:[0,1,1]
    v_pk_fma_f32 v[22:23], v[174:175], v[142:143], v[22:23] op_sel:[0,0,0] op_sel_hi:[0,1,1]
    s_lshr_b32 s49, s49, 8
    s_set_gpr_idx_idx s49
    v_pk_fma_f32 v[16:17], v[170:171], v[144:145], v[16:17] op_sel:[1,0,0] op_sel_hi:[1,1,1]
    v_pk_fma_f32 v[18:19], v[170:171], v[146:147], v[18:19] op_sel:[1,0,0] op_sel_hi:[1,1,1]
    v_pk_fma_f32 v[20:21], v[174:175], v[148:149], v[20:21] op_sel:[1,0,0] op_sel_hi:[1,1,1]
    v_pk_fma_f32 v[22:23], v[174:175], v[150:151], v[22:23] op_sel:[1,0,0] op_sel_hi:[1,1,1]
    s_set_gpr_idx_off
    s_sub_u32 s48, s48, 1
    s_cbranch_scc0 K2_LOOP
K2_D0:
    s_cmp_eq_u32 s48, -1
    s_cbranch_scc1 K2_WA0
    s_waitcnt vmcnt(2)
K2_WA0:
    s_waitcnt vmcnt(6) lgkmcnt(0)
    v_mfma_f32_4x4x4_16b_bf16 v[120:123], v[184:185], v[56:57], 0 cbsz:4 abid:0
    v_exp_f32 v168, v152
    v_mfma_f32_4x4x4_16b_bf16 v[124:127], v[184:185], v[58:59], 0 cbsz:4 abid:0
    v_exp_f32 v169, v153
    v_mfma_f32_4x4x4_16b_bf16 v[128:131], v[184:185], v[60:61], 0 cbsz:4 abid:1
    v_exp_f32 v170, v154
    v_mfma_f32_4x4x4_16b_bf16 v[132:135], v[184:185], v[62:63], 0 cbsz:4 abid:1
    v_exp_f32 v171, v155
    s_cmp_eq_u32 s48, -1
    s_cbranch_scc1 K2_WB0
    s_waitcnt vmcnt(0)
K2_WB0:
    s_waitcnt vmcnt(4)
    v_mfma_f32_4x4x4_16b_bf16 v[136:139], v[184:185], v[64:65], 0 cbsz:4 abid:2
    v_exp_f32 v172, v156
    v_mfma_f32_4x4x4_16b_bf16 v[140:143], v[184:185], v[66:67], 0 cbsz:4 abid:2
    v_exp_f32 v173, v157
    v_exp_f32 v174, v158
    v_exp_f32 v175, v159
    v_pk_add_f32 v[168:169], v[168:169], 1.0 op_sel_hi:[1,0]
    v_pk_add_f32 v[170:171], v[170:171], 1.0 op_sel_hi:[1,0]
    v_pk_add_f32 v[172:173], v[172:173], 1.0 op_sel_hi:[1,0]
    v_pk_add_f32 v[174:175], v[174:175], 1.0 op_sel_hi:[1,0]
    v_mfma_f32_4x4x4_16b_bf16 v[144:147], v[184:185], v[68:69], 0 cbsz:4 abid:3
    v_rcp_f32 v168, v168
    v_mfma_f32_4x4x4_16b_bf16 v[148:151], v[184:185], v[70:71], 0 cbsz:4 abid:3
    v_rcp_f32 v169, v169
    v_mfma_f32_4x4x4_16b_bf16 v[160:163], v[186:187], v[176:177], 0 cbsz:4 abid:1
    v_rcp_f32 v170, v170
    v_mfma_f32_4x4x4_16b_bf16 v[164:167], v[186:187], v[180:181], 0 cbsz:4 abid:1
    v_rcp_f32 v171, v171
    v_rcp_f32 v172, v172
    v_rcp_f32 v173, v173
    v_rcp_f32 v174, v174
    v_rcp_f32 v175, v175
    v_readfirstlane_b32 s49, v192
    v_pk_mul_f32 v[168:169], v[168:169], v[152:153]
    v_pk_mul_f32 v[170:171], v[170:171], v[154:155]
    v_pk_mul_f32 v[172:173], v[172:173], v[156:157]
    v_pk_mul_f32 v[174:175], v[174:175], v[158:159]
    s_set_gpr_idx_on s49, gpr_idx(SRC2,DST)
    v_pk_fma_f32 v[16:17], v[168:169], v[120:121], v[16:17] op_sel:[0,0,0] op_sel_hi:[0,1,1]
    v_pk_fma_f32 v[18:19], v[168:169], v[122:123], v[18:19] op_sel:[0,0,0] op_sel_hi:[0,1,1]
    v_pk_fma_f32 v[20:21], v[172:173], v[124:125], v[20:21] op_sel:[0,0,0] op_sel_hi:[0,1,1]
    v_pk_fma_f32 v[22:23], v[172:173], v[126:127], v[22:23] op_sel:[0,0,0] op_sel_hi:[0,1,1]
    s_lshr_b32 s49, s49, 8
    s_set_gpr_idx_idx s49
    v_pk_fma_f32 v[16:17], v[168:169], v[128:129], v[16:17] op_sel:[1,0,0] op_sel_hi:[1,1,1]
    v_pk_fma_f32 v[18:19], v[168:169], v[130:131], v[18:19] op_sel:[1,0,0] op_sel_hi:[1,1,1]
    v_pk_fma_f32 v[20:21], v[172:173], v[132:133], v[20:21] op_sel:[1,0,0] op_sel_hi:[1,1,1]
    v_pk_fma_f32 v[22:23], v[172:173], v[134:135], v[22:23] op_sel:[1,0,0] op_sel_hi:[1,1,1]
    s_lshr_b32 s49, s49, 8
    s_set_gpr_idx_idx s49
    v_pk_fma_f32 v[16:17], v[170:171], v[136:137], v[16:17] op_sel:[0,0,0] op_sel_hi:[0,1,1]
    v_pk_fma_f32 v[18:19], v[170:171], v[138:139], v[18:19] op_sel:[0,0,0] op_sel_hi:[0,1,1]
    v_pk_fma_f32 v[20:21], v[174:175], v[140:141], v[20:21] op_sel:[0,0,0] op_sel_hi:[0,1,1]
    v_pk_fma_f32 v[22:23], v[174:175], v[142:143], v[22:23] op_sel:[0,0,0] op_sel_hi:[0,1,1]
    s_lshr_b32 s49, s49, 8
    s_set_gpr_idx_idx s49
    v_pk_fma_f32 v[16:17], v[170:171], v[144:145], v[16:17] op_sel:[1,0,0] op_sel_hi:[1,1,1]
    v_pk_fma_f32 v[18:19], v[170:171], v[146:147], v[18:19] op_sel:[1,0,0] op_sel_hi:[1,1,1]
    v_pk_fma_f32 v[20:21], v[174:175], v[148:149], v[20:21] op_sel:[1,0,0] op_sel_hi:[1,1,1]
    v_pk_fma_f32 v[22:23], v[174:175], v[150:151], v[22:23] op_sel:[1,0,0] op_sel_hi:[1,1,1]
    s_set_gpr_idx_off
    s_sub_u32 s48, s48, 1
    s_cmp_eq_u32 s48, -3
    s_cbranch_scc1 K2_LOOPDONE
K2_D1:
    s_cmp_eq_u32 s48, -1
    s_cbranch_scc1 K2_WA1
    s_waitcnt vmcnt(2)
K2_WA1:
    s_waitcnt vmcnt(6) lgkmcnt(0)
    v_mfma_f32_4x4x4_16b_bf16 v[120:123], v[184:185], v[72:73], 0 cbsz:4 abid:4
    v_exp_f32 v168, v160
    v_mfma_f32_4x4x4_16b_bf16 v[124:127], v[184:185], v[74:75], 0 cbsz:4 abid:4
    v_exp_f32 v169, v161
    v_mfma_f32_4x4x4_16b_bf16 v[128:131], v[184:185], v[76:77], 0 cbsz:4 abid:5
    v_exp_f32 v170, v162
    v_mfma_f32_4x4x4_16b_bf16 v[132:135], v[184:185], v[78:79], 0 cbsz:4 abid:5
    v_exp_f32 v171, v163
    s_cmp_eq_u32 s48, -1
    s_cbranch_scc1 K2_WB1
    s_waitcnt vmcnt(0)
K2_WB1:
    s_waitcnt vmcnt(4)
    v_mfma_f32_4x4x4_16b_bf16 v[136:139], v[184:185], v[80:81], 0 cbsz:4 abid:6
    v_exp_f32 v172, v164
    v_mfma_f32_4x4x4_16b_bf16 v[140:143], v[184:185], v[82:83], 0 cbsz:4 abid:6
    v_exp_f32 v173, v165
    v_exp_f32 v174, v166
    v_exp_f32 v175, v167
    v_pk_add_f32 v[168:169], v[168:169], 1.0 op_sel_hi:[1,0]
    v_pk_add_f32 v[170:171], v[170:171], 1.0 op_sel_hi:[1,0]
    v_pk_add_f32 v[172:173], v[172:173], 1.0 op_sel_hi:[1,0]
    v_pk_add_f32 v[174:175], v[174:175], 1.0 op_sel_hi:[1,0]
    v_mfma_f32_4x4x4_16b_bf16 v[144:147], v[184:185], v[84:85], 0 cbsz:4 abid:7
    v_rcp_f32 v168, v168
    v_mfma_f32_4x4x4_16b_bf16 v[148:151], v[184:185], v[86:87], 0 cbsz:4 abid:7
    v_rcp_f32 v169, v169
    v_mfma_f32_4x4x4_16b_bf16 v[152:155], v[186:187], v[176:177], 0 cbsz:4 abid:2
    v_rcp_f32 v170, v170
    v_mfma_f32_4x4x4_16b_bf16 v[156:159], v[186:187], v[180:181], 0 cbsz:4 abid:2
    v_rcp_f32 v171, v171
    v_rcp_f32 v172, v172
    v_rcp_f32 v173, v173
    v_rcp_f32 v174, v174
    v_rcp_f32 v175, v175
    v_readfirstlane_b32 s49, v193
    v_pk_mul_f32 v[168:169], v[168:169], v[160:161]
    v_pk_mul_f32 v[170:171], v[170:171], v[162:163]
    v_pk_mul_f32 v[172:173], v[172:173], v[164:165]
    v_pk_mul_f32 v[174:175], v[174:175], v[166:167]
    s_set_gpr_idx_on s49, gpr_idx(SRC2,DST)
    v_pk_fma_f32 v[16:17], v[168:169], v[120:121], v[16:17] op_sel:[0,0,0] op_sel_hi:[0,1,1]
    v_pk_fma_f32 v[18:19], v[168:169], v[122:123], v[18:19] op_sel:[0,0,0] op_sel_hi:[0,1,1]
    v_pk_fma_f32 v[20:21], v[172:173], v[124:125], v[20:21] op_sel:[0,0,0] op_sel_hi:[0,1,1]
    v_pk_fma_f32 v[22:23], v[172:173], v[126:127], v[22:23] op_sel:[0,0,0] op_sel_hi:[0,1,1]
    s_lshr_b32 s49, s49, 8
    s_set_gpr_idx_idx s49
    v_pk_fma_f32 v[16:17], v[168:169], v[128:129], v[16:17] op_sel:[1,0,0] op_sel_hi:[1,1,1]
    v_pk_fma_f32 v[18:19], v[168:169], v[130:131], v[18:19] op_sel:[1,0,0] op_sel_hi:[1,1,1]
    v_pk_fma_f32 v[20:21], v[172:173], v[132:133], v[20:21] op_sel:[1,0,0] op_sel_hi:[1,1,1]
    v_pk_fma_f32 v[22:23], v[172:173], v[134:135], v[22:23] op_sel:[1,0,0] op_sel_hi:[1,1,1]
    s_lshr_b32 s49, s49, 8
    s_set_gpr_idx_idx s49
    v_pk_fma_f32 v[16:17], v[170:171], v[136:137], v[16:17] op_sel:[0,0,0] op_sel_hi:[0,1,1]
    v_pk_fma_f32 v[18:19], v[170:171], v[138:139], v[18:19] op_sel:[0,0,0] op_sel_hi:[0,1,1]
    v_pk_fma_f32 v[20:21], v[174:175], v[140:141], v[20:21] op_sel:[0,0,0] op_sel_hi:[0,1,1]
    v_pk_fma_f32 v[22:23], v[174:175], v[142:143], v[22:23] op_sel:[0,0,0] op_sel_hi:[0,1,1]
    s_lshr_b32 s49, s49, 8
    s_set_gpr_idx_idx s49
    v_pk_fma_f32 v[16:17], v[170:171], v[144:145], v[16:17] op_sel:[1,0,0] op_sel_hi:[1,1,1]
    v_pk_fma_f32 v[18:19], v[170:171], v[146:147], v[18:19] op_sel:[1,0,0] op_sel_hi:[1,1,1]
    v_pk_fma_f32 v[20:21], v[174:175], v[148:149], v[20:21] op_sel:[1,0,0] op_sel_hi:[1,1,1]
    v_pk_fma_f32 v[22:23], v[174:175], v[150:151], v[22:23] op_sel:[1,0,0] op_sel_hi:[1,1,1]
    s_set_gpr_idx_off
    s_sub_u32 s48, s48, 1
    s_cmp_eq_u32 s48, -3
    s_cbranch_scc1 K2_LOOPDONE
K2_D2:
    s_cmp_eq_u32 s48, -1
    s_cbranch_scc1 K2_WA2
    s_waitcnt vmcnt(2)
K2_WA2:
    s_waitcnt vmcnt(6) lgkmcnt(0)
    v_mfma_f32_4x4x4_16b_bf16 v[120:123], v[184:185], v[56:57], 0 cbsz:4 abid:8
    v_exp_f32 v168, v152
    v_mfma_f32_4x4x4_16b_bf16 v[124:127], v[184:185], v[58:59], 0 cbsz:4 abid:8
    v_exp_f32 v169, v153
    v_mfma_f32_4x4x4_16b_bf16 v[128:131], v[184:185], v[60:61], 0 cbsz:4 abid:9
    v_exp_f32 v170, v154
    v_mfma_f32_4x4x4_16b_bf16 v[132:135], v[184:185], v[62:63], 0 cbsz:4 abid:9
    v_exp_f32 v171, v155
    s_cmp_eq_u32 s48, -1
    s_cbranch_scc1 K2_WB2
    s_waitcnt vmcnt(0)
K2_WB2:
    s_waitcnt vmcnt(4)
    v_mfma_f32_4x4x4_16b_bf16 v[136:139], v[184:185], v[64:65], 0 cbsz:4 abid:10
    v_exp_f32 v172, v156
    v_mfma_f32_4x4x4_16b_bf16 v[140:143], v[184:185], v[66:67], 0 cbsz:4 abid:10
    v_exp_f32 v173, v157
    v_exp_f32 v174, v158
    v_exp_f32 v175, v159
    v_pk_add_f32 v[168:169], v[168:169], 1.0 op_sel_hi:[1,0]
    v_pk_add_f32 v[170:171], v[170:171], 1.0 op_sel_hi:[1,0]
    v_pk_add_f32 v[172:173], v[172:173], 1.0 op_sel_hi:[1,0]
    v_pk_add_f32 v[174:175], v[174:175], 1.0 op_sel_hi:[1,0]
    v_mfma_f32_4x4x4_16b_bf16 v[144:147], v[184:185], v[68:69], 0 cbsz:4 abid:11
    v_rcp_f32 v168, v168
    v_mfma_f32_4x4x4_16b_bf16 v[148:151], v[184:185], v[70:71], 0 cbsz:4 abid:11
    v_rcp_f32 v169, v169
    v_mfma_f32_4x4x4_16b_bf16 v[160:163], v[186:187], v[176:177], 0 cbsz:4 abid:3
    v_rcp_f32 v170, v170
    v_mfma_f32_4x4x4_16b_bf16 v[164:167], v[186:187], v[180:181], 0 cbsz:4 abid:3
    v_rcp_f32 v171, v171
    v_rcp_f32 v172, v172
    ds_read_b64 v[186:187], v199 offset:264
    v_rcp_f32 v173, v173
    v_rcp_f32 v174, v174
    v_rcp_f32 v175, v175
    v_readfirstlane_b32 s49, v194
    v_pk_mul_f32 v[168:169], v[168:169], v[152:153]
    v_pk_mul_f32 v[170:171], v[170:171], v[154:155]
    v_pk_mul_f32 v[172:173], v[172:173], v[156:157]
    v_pk_mul_f32 v[174:175], v[174:175], v[158:159]
    s_set_gpr_idx_on s49, gpr_idx(SRC2,DST)
    v_pk_fma_f32 v[16:17], v[168:169], v[120:121], v[16:17] op_sel:[0,0,0] op_sel_hi:[0,1,1]
    v_pk_fma_f32 v[18:19], v[168:169], v[122:123], v[18:19] op_sel:[0,0,0] op_sel_hi:[0,1,1]
    v_pk_fma_f32 v[20:21], v[172:173], v[124:125], v[20:21] op_sel:[0,0,0] op_sel_hi:[0,1,1]
    v_pk_fma_f32 v[22:23], v[172:173], v[126:127], v[22:23] op_sel:[0,0,0] op_sel_hi:[0,1,1]
    s_lshr_b32 s49, s49, 8
    s_set_gpr_idx_idx s49
    v_pk_fma_f32 v[16:17], v[168:169], v[128:129], v[16:17] op_sel:[1,0,0] op_sel_hi:[1,1,1]
    v_pk_fma_f32 v[18:19], v[168:169], v[130:131], v[18:19] op_sel:[1,0,0] op_sel_hi:[1,1,1]
    v_pk_fma_f32 v[20:21], v[172:173], v[132:133], v[20:21] op_sel:[1,0,0] op_sel_hi:[1,1,1]
    v_pk_fma_f32 v[22:23], v[172:173], v[134:135], v[22:23] op_sel:[1,0,0] op_sel_hi:[1,1,1]
    s_lshr_b32 s49, s49, 8
    s_set_gpr_idx_idx s49
    v_pk_fma_f32 v[16:17], v[170:171], v[136:137], v[16:17] op_sel:[0,0,0] op_sel_hi:[0,1,1]
    v_pk_fma_f32 v[18:19], v[170:171], v[138:139], v[18:19] op_sel:[0,0,0] op_sel_hi:[0,1,1]
    v_pk_fma_f32 v[20:21], v[174:175], v[140:141], v[20:21] op_sel:[0,0,0] op_sel_hi:[0,1,1]
    v_pk_fma_f32 v[22:23], v[174:175], v[142:143], v[22:23] op_sel:[0,0,0] op_sel_hi:[0,1,1]
    s_lshr_b32 s49, s49, 8
    s_set_gpr_idx_idx s49
    v_pk_fma_f32 v[16:17], v[170:171], v[144:145], v[16:17] op_sel:[1,0,0] op_sel_hi:[1,1,1]
    v_pk_fma_f32 v[18:19], v[170:171], v[146:147], v[18:19] op_sel:[1,0,0] op_sel_hi:[1,1,1]
    v_pk_fma_f32 v[20:21], v[174:175], v[148:149], v[20:21] op_sel:[1,0,0] op_sel_hi:[1,1,1]
    v_pk_fma_f32 v[22:23], v[174:175], v[150:151], v[22:23] op_sel:[1,0,0] op_sel_hi:[1,1,1]
    s_set_gpr_idx_off
    s_sub_u32 s48, s48, 1
    s_cmp_eq_u32 s48, -3
    s_cbranch_scc1 K2_LOOPDONE
K2_D3:
    s_cmp_eq_u32 s48, -1
    s_cbranch_scc1 K2_WA3
    s_waitcnt vmcnt(2)
K2_WA3:
    s_waitcnt vmcnt(6) lgkmcnt(0)
    v_mfma_f32_4x4x4_16b_bf16 v[120:123], v[184:185], v[72:73], 0 cbsz:4 abid:12
    v_exp_f32 v168, v160
    v_mfma_f32_4x4x4_16b_bf16 v[124:127], v[184:185], v[74:75], 0 cbsz:4 abid:12
    v_exp_f32 v169, v161
    v_mfma_f32_4x4x4_16b_bf16 v[128:131], v[184:185], v[76:77], 0 cbsz:4 abid:13
    v_exp_f32 v170, v162
    v_mfma_f32_4x4x4_16b_bf16 v[132:135], v[184:185], v[78:79], 0 cbsz:4 abid:13
    v_exp_f32 v171, v163
    s_cmp_eq_u32 s48, -1
    s_cbranch_scc1 K2_WB3
    s_waitcnt vmcnt(0)
K2_WB3:
    s_waitcnt vmcnt(4)
    v_mfma_f32_4x4x4_16b_bf16 v[136:139], v[184:185], v[80:81], 0 cbsz:4 abid:14
    v_exp_f32 v172, v164
    v_mfma_f32_4x4x4_16b_bf16 v[140:143], v[184:185], v[82:83], 0 cbsz:4 abid:14
    v_exp_f32 v173, v165
    v_exp_f32 v174, v166
    v_exp_f32 v175, v167
    v_pk_add_f32 v[168:169], v[168:169], 1.0 op_sel_hi:[1,0]
    v_pk_add_f32 v[170:171], v[170:171], 1.0 op_sel_hi:[1,0]
    v_pk_add_f32 v[172:173], v[172:173], 1.0 op_sel_hi:[1,0]
    v_pk_add_f32 v[174:175], v[174:175], 1.0 op_sel_hi:[1,0]
    v_mfma_f32_4x4x4_16b_bf16 v[144:147], v[184:185], v[84:85], 0 cbsz:4 abid:15
    v_rcp_f32 v168, v168
    v_mfma_f32_4x4x4_16b_bf16 v[148:151], v[184:185], v[86:87], 0 cbsz:4 abid:15
    v_rcp_f32 v169, v169
    ds_read_b64 v[184:185], v198 offset:512
    v_mfma_f32_4x4x4_16b_bf16 v[152:155], v[186:187], v[176:177], 0 cbsz:4 abid:0
    v_rcp_f32 v170, v170
    v_mfma_f32_4x4x4_16b_bf16 v[156:159], v[186:187], v[180:181], 0 cbsz:4 abid:0
    v_rcp_f32 v171, v171
    v_rcp_f32 v172, v172
    v_rcp_f32 v173, v173
    v_rcp_f32 v174, v174
    v_rcp_f32 v175, v175
    v_readfirstlane_b32 s49, v195
    ds_read_b128 v[192:195], v197 offset:16
    v_add_u32 v196, 64, v196
    v_add_u32 v197, 16, v197
    v_add_u32 v198, 512, v198
    v_add_u32 v199, 256, v199
    v_pk_mul_f32 v[168:169], v[168:169], v[160:161]
    v_pk_mul_f32 v[170:171], v[170:171], v[162:163]
    v_pk_mul_f32 v[172:173], v[172:173], v[164:165]
    v_pk_mul_f32 v[174:175], v[174:175], v[166:167]
    s_set_gpr_idx_on s49, gpr_idx(SRC2,DST)
    v_pk_fma_f32 v[16:17], v[168:169], v[120:121], v[16:17] op_sel:[0,0,0] op_sel_hi:[0,1,1]
    v_pk_fma_f32 v[18:19], v[168:169], v[122:123], v[18:19] op_sel:[0,0,0] op_sel_hi:[0,1,1]
    v_pk_fma_f32 v[20:21], v[172:173], v[124:125], v[20:21] op_sel:[0,0,0] op_sel_hi:[0,1,1]
    v_pk_fma_f32 v[22:23], v[172:173], v[126:127], v[22:23] op_sel:[0,0,0] op_sel_hi:[0,1,1]
    s_lshr_b32 s49, s49, 8
    s_set_gpr_idx_idx s49
    v_pk_fma_f32 v[16:17], v[168:169], v[128:129], v[16:17] op_sel:[1,0,0] op_sel_hi:[1,1,1]
    v_pk_fma_f32 v[18:19], v[168:169], v[130:131], v[18:19] op_sel:[1,0,0] op_sel_hi:[1,1,1]
    v_pk_fma_f32 v[20:21], v[172:173], v[132:133], v[20:21] op_sel:[1,0,0] op_sel_hi:[1,1,1]
    v_pk_fma_f32 v[22:23], v[172:173], v[134:135], v[22:23] op_sel:[1,0,0] op_sel_hi:[1,1,1]
    s_lshr_b32 s49, s49, 8
    s_set_gpr_idx_idx s49
    v_pk_fma_f32 v[16:17], v[170:171], v[136:137], v[16:17] op_sel:[0,0,0] op_sel_hi:[0,1,1]
    v_pk_fma_f32 v[18:19], v[170:171], v[138:139], v[18:19] op_sel:[0,0,0] op_sel_hi:[0,1,1]
    v_pk_fma_f32 v[20:21], v[174:175], v[140:141], v[20:21] op_sel:[0,0,0] op_sel_hi:[0,1,1]
    v_pk_fma_f32 v[22:23], v[174:175], v[142:143], v[22:23] op_sel:[0,0,0] op_sel_hi:[0,1,1]
    s_lshr_b32 s49, s49, 8
    s_set_gpr_idx_idx s49
    v_pk_fma_f32 v[16:17], v[170:171], v[144:145], v[16:17] op_sel:[1,0,0] op_sel_hi:[1,1,1]
    v_pk_fma_f32 v[18:19], v[170:171], v[146:147], v[18:19] op_sel:[1,0,0] op_sel_hi:[1,1,1]
    v_pk_fma_f32 v[20:21], v[174:175], v[148:149], v[20:21] op_sel:[1,0,0] op_sel_hi:[1,1,1]
    v_pk_fma_f32 v[22:23], v[174:175], v[150:151], v[22:23] op_sel:[1,0,0] op_sel_hi:[1,1,1]
    s_set_gpr_idx_off
    s_sub_u32 s48, s48, 1
    s_cmp_eq_u32 s48, -3
    s_cbranch_scc0 K2_D0
K2_LOOPDONE:
    v_mov_b32 v254, -1
    ds_write_b32 v252, v254 offset:2048
    s_setprio 0
    s_add_u32 s47, s47, 1536
    s_cmp_ge_u32 s47, s46
    s_cbranch_scc1 K_EPI
    s_waitcnt vmcnt(0) lgkmcnt(0)
    s_barrier
    ds_write_b128 v8, v[4:7]
    ds_write_b32 v3, v4 offset:2048
    v_cmp_gt_u32 vcc, 128, v0
    s_and_saveexec_b64 s[56:57], vcc
    ds_write_b32 v3, v4 offset:0
    s_mov_b64 exec, s[56:57]
    s_waitcnt lgkmcnt(0)
    s_barrier
    s_cmp_eq_u32 s55, 0
    s_cbranch_scc1 K_ROUND
    s_branch K_FB
K_LATER:
    s_mov_b64 exec, s[40:41]
    buffer_load_dwordx4 v[88:91], v100, s[36:39], s61 offen sc1
    s_mov_b64 exec, s[42:43]
    buffer_load_dwordx4 v[92:95], v101, s[36:39], s61 offen sc1
    s_mov_b64 exec, s[44:45]
    buffer_load_dwordx4 v[96:99], v102, s[36:39], s61 offen sc1
    s_mov_b64 exec, -1
K_LATER2:
    v_lshrrev_b32 v81, 2, v72
    v_and_b32 v81, 0xfc, v81
    v_lshrrev_b32 v82, 2, v74
    v_and_b32 v82, 0xfc, v82
    v_lshrrev_b32 v83, 2, v76
    v_and_b32 v83, 0xfc, v83
    s_branch K_BAL
K_FB0:
    s_mov_b32 s46, 320000
    s_and_b32 s56, s3, 3
    s_lshl_b32 s56, s56, 6
    s_add_u32 s56, s56, 114944
    v_lshrrev_b32 v10, 4, v1
    v_lshlrev_b32 v10, 11, v10
    v_and_b32 v12, 15, v1
    v_lshl_or_b32 v10, v12, 2, v10
    v_add_u32 v10, s56, v10
    s_mov_b32 s56, 0x05040100
    s_mov_b32 s57, 0x07060302
    ds_read2st64_b32 v[120:121], v10 offset0:0 offset1:1
    ds_read2st64_b32 v[122:123], v10 offset0:2 offset1:3
    ds_read2st64_b32 v[124:125], v10 offset0:4 offset1:5
    ds_read2st64_b32 v[126:127], v10 offset0:6 offset1:7
    ds_read2st64_b32 v[128:129], v10 offset0:32 offset1:33
    ds_read2st64_b32 v[130:131], v10 offset0:34 offset1:35
    ds_read2st64_b32 v[132:133], v10 offset0:36 offset1:37
    ds_read2st64_b32 v[134:135], v10 offset0:38 offset1:39
    ds_read2st64_b32 v[136:137], v10 offset0:64 offset1:65
    ds_read2st64_b32 v[138:139], v10 offset0:66 offset1:67
    ds_read2st64_b32 v[140:141], v10 offset0:68 offset1:69
    ds_read2st64_b32 v[142:143], v10 offset0:70 offset1:71
    ds_read2st64_b32 v[144:145], v10 offset0:96 offset1:97
    ds_read2st64_b32 v[146:147], v10 offset0:98 offset1:99
    ds_read2st64_b32 v[148:149], v10 offset0:100 offset1:101
    ds_read2st64_b32 v[150:151], v10 offset0:102 offset1:103
    s_waitcnt lgkmcnt(15)
    v_perm_b32 v200, v121, v120, s56
    v_perm_b32 v216, v121, v120, s57
    s_waitcnt lgkmcnt(14)
    v_perm_b32 v201, v123, v122, s56
    v_perm_b32 v217, v123, v122, s57
    s_waitcnt lgkmcnt(13)
    v_perm_b32 v202, v125, v124, s56
    v_perm_b32 v218, v125, v124, s57
    s_waitcnt lgkmcnt(12)
    v_perm_b32 v203, v127, v126, s56
    v_perm_b32 v219, v127, v126, s57
    s_waitcnt lgkmcnt(11)
    v_perm_b32 v204, v129, v128, s56
    v_perm_b32 v220, v129, v128, s57
    s_waitcnt lgkmcnt(10)
    v_perm_b32 v205, v131, v130, s56
    v_perm_b32 v221, v131, v130, s57
    s_waitcnt lgkmcnt(9)
    v_perm_b32 v206, v133, v132, s56
    v_perm_b32 v222, v133, v132, s57
    s_waitcnt lgkmcnt(8)
    v_perm_b32 v207, v135, v134, s56
    v_perm_b32 v223, v135, v134, s57
    s_waitcnt lgkmcnt(7)
    v_perm_b32 v208, v137, v136, s56
    v_perm_b32 v224, v137, v136, s57
    s_waitcnt lgkmcnt(6)
    v_perm_b32 v209, v139, v138, s56
    v_perm_b32 v225, v139, v138, s57
    s_waitcnt lgkmcnt(5)
    v_perm_b32 v210, v141, v140, s56
    v_perm_b32 v226, v141, v140, s57
    s_waitcnt lgkmcnt(4)
    v_perm_b32 v211, v143, v142, s56
    v_perm_b32 v227, v143, v142, s57
    s_waitcnt lgkmcnt(3)
    v_perm_b32 v212, v145, v144, s56
    v_perm_b32 v228, v145, v144, s57
    s_waitcnt lgkmcnt(2)
    v_perm_b32 v213, v147, v146, s56
    v_perm_b32 v229, v147, v146, s57
    s_waitcnt lgkmcnt(1)
    v_perm_b32 v214, v149, v148, s56
    v_perm_b32 v230, v149, v148, s57
    s_waitcnt lgkmcnt(0)
    v_perm_b32 v215, v151, v150, s56
    v_perm_b32 v231, v151, v150, s57
K_FB:
    s_mul_i32 s56, s3, 192
    s_add_u32 s56, s56, s47
    v_add_u32 v68, s56, v1
    v_add_u32 v69, 64, v68
    v_add_u32 v70, 128, v68
    v_cmp_gt_u32 s[40:41], s46, v68
    v_min_u32 v68, 319999, v68
    v_lshlrev_b32 v81, 2, v68
    v_lshlrev_b32 v100, 3, v68
    global_load_dword v56, v81, s[8:9]
    global_load_dword v60, v81, s[6:7]
    global_load_dwordx2 v[88:89], v100, s[10:11]
    global_load_dwordx2 v[90:91], v100, s[12:13]
    v_cmp_gt_u32 s[42:43], s46, v69
    v_min_u32 v69, 319999, v69
    v_lshlrev_b32 v82, 2, v69
    v_lshlrev_b32 v101, 3, v69
    global_load_dword v57, v82, s[8:9]
    global_load_dword v61, v82, s[6:7]
    global_load_dwordx2 v[92:93], v101, s[10:11]
    global_load_dwordx2 v[94:95], v101, s[12:13]
    v_cmp_gt_u32 s[44:45], s46, v70
    v_min_u32 v70, 319999, v70
    v_lshlrev_b32 v83, 2, v70
    v_lshlrev_b32 v102, 3, v70
    global_load_dword v58, v83, s[8:9]
    global_load_dword v62, v83, s[6:7]
    global_load_dwordx2 v[96:97], v102, s[10:11]
    global_load_dwordx2 v[98:99], v102, s[12:13]
    v_mov_b32 v14, 64
    s_waitcnt vmcnt(0)
    v_mul_u32_u24 v68, 214749, v56
    v_lshrrev_b32 v68, 23, v68
    v_cmp_eq_u32 vcc, s53, v68
    s_and_b64 s[40:41], s[40:41], vcc
    v_subrev_u32 v72, s54, v56
    v_mul_u32_u24 v68, 1677, v60
    v_lshrrev_b32 v68, 20, v68
    v_lshl_or_b32 v72, v72, 4, v68
    v_lshl_or_b32 v72, v60, 10, v72
    v_mul_u32_u24 v69, 214749, v57
    v_lshrrev_b32 v69, 23, v69
    v_cmp_eq_u32 vcc, s53, v69
    s_and_b64 s[42:43], s[42:43], vcc
    v_subrev_u32 v74, s54, v57
    v_mul_u32_u24 v69, 1677, v61
    v_lshrrev_b32 v69, 20, v69
    v_lshl_or_b32 v74, v74, 4, v69
    v_lshl_or_b32 v74, v61, 10, v74
    v_mul_u32_u24 v70, 214749, v58
    v_lshrrev_b32 v70, 23, v70
    v_cmp_eq_u32 vcc, s53, v70
    s_and_b64 s[44:45], s[44:45], vcc
    v_subrev_u32 v76, s54, v58
    v_mul_u32_u24 v70, 1677, v62
    v_lshrrev_b32 v70, 20, v70
    v_lshl_or_b32 v76, v76, 4, v70
    v_lshl_or_b32 v76, v62, 10, v76
    s_cmp_lg_u32 s47, 0
    s_cbranch_scc1 K_LATER2
    s_branch K_GOT
K_EPI:
    s_mov_b32 s56, 0xbf317218
    s_mov_b32 s57, s56
    v_pk_mul_f32 v[16:17], v[16:17], s[56:57]
    v_pk_mul_f32 v[18:19], v[18:19], s[56:57]
    v_pk_mul_f32 v[20:21], v[20:21], s[56:57]
    v_pk_mul_f32 v[22:23], v[22:23], s[56:57]
    v_cvt_pk_bf16_f32 v16, v16, v20
    ds_write_b32 v106, v16 offset:0
    v_cvt_pk_bf16_f32 v17, v17, v21
    ds_write_b32 v106, v17 offset:288
    v_cvt_pk_bf16_f32 v18, v18, v22
    ds_write_b32 v106, v18 offset:576
    v_cvt_pk_bf16_f32 v19, v19, v23
    ds_write_b32 v106, v19 offset:864
    v_pk_mul_f32 v[24:25], v[24:25], s[56:57]
    v_pk_mul_f32 v[26:27], v[26:27], s[56:57]
    v_pk_mul_f32 v[28:29], v[28:29], s[56:57]
    v_pk_mul_f32 v[30:31], v[30:31], s[56:57]
    v_cvt_pk_bf16_f32 v24, v24, v28
    ds_write_b32 v107, v24 offset:0
    v_cvt_pk_bf16_f32 v25, v25, v29
    ds_write_b32 v107, v25 offset:288
    v_cvt_pk_bf16_f32 v26, v26, v30
    ds_write_b32 v107, v26 offset:576
    v_cvt_pk_bf16_f32 v27, v27, v31
    ds_write_b32 v107, v27 offset:864
    v_pk_mul_f32 v[32:33], v[32:33], s[56:57]
    v_pk_mul_f32 v[34:35], v[34:35], s[56:57]
    v_pk_mul_f32 v[36:37], v[36:37], s[56:57]
    v_pk_mul_f32 v[38:39], v[38:39], s[56:57]
    v_cvt_pk_bf16_f32 v32, v32, v36
    ds_write_b32 v116, v32 offset:0
    v_cvt_pk_bf16_f32 v33, v33, v37
    ds_write_b32 v116, v33 offset:288
    v_cvt_pk_bf16_f32 v34, v34, v38
    ds_write_b32 v116, v34 offset:576
    v_cvt_pk_bf16_f32 v35, v35, v39
    ds_write_b32 v116, v35 offset:864
    v_pk_mul_f32 v[40:41], v[40:41], s[56:57]
    v_pk_mul_f32 v[42:43], v[42:43], s[56:57]
    v_pk_mul_f32 v[44:45], v[44:45], s[56:57]
    v_pk_mul_f32 v[46:47], v[46:47], s[56:57]
    v_cvt_pk_bf16_f32 v40, v40, v44
    ds_write_b32 v117, v40 offset:0
    v_cvt_pk_bf16_f32 v41, v41, v45
    ds_write_b32 v117, v41 offset:288
    v_cvt_pk_bf16_f32 v42, v42, v46
    ds_write_b32 v117, v42 offset:576
    v_cvt_pk_bf16_f32 v43, v43, v47
    ds_write_b32 v117, v43 offset:864
    v_pk_mul_f32 v[48:49], v[48:49], s[56:57]
    v_pk_mul_f32 v[50:51], v[50:51], s[56:57]
    v_pk_mul_f32 v[52:53], v[52:53], s[56:57]
    v_pk_mul_f32 v[54:55], v[54:55], s[56:57]
    v_cvt_pk_bf16_f32 v48, v48, v52
    ds_write_b32 v118, v48 offset:0
    v_cvt_pk_bf16_f32 v49, v49, v53
    ds_write_b32 v118, v49 offset:288
    v_cvt_pk_bf16_f32 v50, v50, v54
    ds_write_b32 v118, v50 offset:576
    v_cvt_pk_bf16_f32 v51, v51, v55
    ds_write_b32 v118, v51 offset:864
    v_and_b32 v12, 15, v1
    v_lshrrev_b32 v13, 4, v1
    s_lshr_b32 s58, s3, 2
    s_mul_i32 s59, s58, 4608
    s_add_u32 s59, s59, 106752
    v_mul_u32_u24 v14, 288, v12
    v_lshl_add_u32 v14, v13, 4, v14
    v_add_u32 v14, s59, v14
    s_lshl_b32 s58, s58, 2
    s_add_u32 s58, s58, s54
    s_lshl_b32 s58, s58, 10
    s_and_b32 s59, s3, 3
    s_lshl_b32 s59, s59, 8
    s_add_u32 s58, s58, s59
    v_lshlrev_b32 v13, 10, v13
    v_lshl_add_u32 v13, v12, 4, v13
    s_waitcnt vmcnt(0) lgkmcnt(0)
    s_barrier
    ds_read_b128 v[56:59], v14 offset:0
    ds_read_b128 v[60:63], v14 offset:64
    ds_read_b128 v[64:67], v14 offset:128
    ds_read_b128 v[68:71], v14 offset:192
    ds_read_b128 v[72:75], v14 offset:9216
    ds_read_b128 v[76:79], v14 offset:9280
    ds_read_b128 v[80:83], v14 offset:9344
    ds_read_b128 v[84:87], v14 offset:9408
    ds_read_b128 v[88:91], v14 offset:18432
    ds_read_b128 v[92:95], v14 offset:18496
    ds_read_b128 v[96:99], v14 offset:18560
    ds_read_b128 v[100:103], v14 offset:18624
    ds_read_b128 v[104:107], v14 offset:27648
    ds_read_b128 v[108:111], v14 offset:27712
    ds_read_b128 v[112:115], v14 offset:27776
    ds_read_b128 v[116:119], v14 offset:27840
    s_waitcnt lgkmcnt(15)
    v_mfma_f32_16x16x32_bf16 v[120:123], v[56:59], v[200:203], 0
    v_mfma_f32_16x16x32_bf16 v[124:127], v[56:59], v[216:219], 0
    s_waitcnt lgkmcnt(14)
    v_mfma_f32_16x16x32_bf16 v[120:123], v[60:63], v[204:207], v[120:123]
    v_mfma_f32_16x16x32_bf16 v[124:127], v[60:63], v[220:223], v[124:127]
    s_waitcnt lgkmcnt(13)
    v_mfma_f32_16x16x32_bf16 v[120:123], v[64:67], v[208:211], v[120:123]
    v_mfma_f32_16x16x32_bf16 v[124:127], v[64:67], v[224:227], v[124:127]
    s_waitcnt lgkmcnt(12)
    v_mfma_f32_16x16x32_bf16 v[120:123], v[68:71], v[212:215], v[120:123]
    v_mfma_f32_16x16x32_bf16 v[124:127], v[68:71], v[228:231], v[124:127]
    ds_read_b128 v[56:59], v14 offset:36864
    ds_read_b128 v[60:63], v14 offset:36928
    ds_read_b128 v[64:67], v14 offset:36992
    ds_read_b128 v[68:71], v14 offset:37056
    s_waitcnt lgkmcnt(15)
    v_mfma_f32_16x16x32_bf16 v[128:131], v[72:75], v[200:203], 0
    v_mfma_f32_16x16x32_bf16 v[132:135], v[72:75], v[216:219], 0
    s_waitcnt lgkmcnt(14)
    v_mfma_f32_16x16x32_bf16 v[128:131], v[76:79], v[204:207], v[128:131]
    v_mfma_f32_16x16x32_bf16 v[132:135], v[76:79], v[220:223], v[132:135]
    s_waitcnt lgkmcnt(13)
    v_mfma_f32_16x16x32_bf16 v[128:131], v[80:83], v[208:211], v[128:131]
    v_mfma_f32_16x16x32_bf16 v[132:135], v[80:83], v[224:227], v[132:135]
    s_waitcnt lgkmcnt(12)
    v_mfma_f32_16x16x32_bf16 v[128:131], v[84:87], v[212:215], v[128:131]
    v_mfma_f32_16x16x32_bf16 v[132:135], v[84:87], v[228:231], v[132:135]
    v_cvt_pk_bf16_f32 v136, v120, v121
    v_cvt_pk_bf16_f32 v137, v122, v123
    v_cvt_pk_bf16_f32 v138, v124, v125
    v_cvt_pk_bf16_f32 v139, v126, v127
    buffer_store_dwordx4 v[136:139], v13, s[32:35], s58 offen sc1
    s_add_u32 s58, s58, 8192
    s_waitcnt lgkmcnt(11)
    v_mfma_f32_16x16x32_bf16 v[120:123], v[88:91], v[200:203], 0
    v_mfma_f32_16x16x32_bf16 v[124:127], v[88:91], v[216:219], 0
    s_waitcnt lgkmcnt(10)
    v_mfma_f32_16x16x32_bf16 v[120:123], v[92:95], v[204:207], v[120:123]
    v_mfma_f32_16x16x32_bf16 v[124:127], v[92:95], v[220:223], v[124:127]
    s_waitcnt lgkmcnt(9)
    v_mfma_f32_16x16x32_bf16 v[120:123], v[96:99], v[208:211], v[120:123]
    v_mfma_f32_16x16x32_bf16 v[124:127], v[96:99], v[224:227], v[124:127]
    s_waitcnt lgkmcnt(8)
    v_mfma_f32_16x16x32_bf16 v[120:123], v[100:103], v[212:215], v[120:123]
    v_mfma_f32_16x16x32_bf16 v[124:127], v[100:103], v[228:231], v[124:127]
    v_cvt_pk_bf16_f32 v140, v128, v129
    v_cvt_pk_bf16_f32 v141, v130, v131
    v_cvt_pk_bf16_f32 v142, v132, v133
    v_cvt_pk_bf16_f32 v143, v134, v135
    buffer_store_dwordx4 v[140:143], v13, s[32:35], s58 offen sc1
    s_add_u32 s58, s58, 8192
    s_waitcnt lgkmcnt(7)
    v_mfma_f32_16x16x32_bf16 v[128:131], v[104:107], v[200:203], 0
    v_mfma_f32_16x16x32_bf16 v[132:135], v[104:107], v[216:219], 0
    s_waitcnt lgkmcnt(6)
    v_mfma_f32_16x16x32_bf16 v[128:131], v[108:111], v[204:207], v[128:131]
    v_mfma_f32_16x16x32_bf16 v[132:135], v[108:111], v[220:223], v[132:135]
    s_waitcnt lgkmcnt(5)
    v_mfma_f32_16x16x32_bf16 v[128:131], v[112:115], v[208:211], v[128:131]
    v_mfma_f32_16x16x32_bf16 v[132:135], v[112:115], v[224:227], v[132:135]
    s_waitcnt lgkmcnt(4)
    v_mfma_f32_16x16x32_bf16 v[128:131], v[116:119], v[212:215], v[128:131]
    v_mfma_f32_16x16x32_bf16 v[132:135], v[116:119], v[228:231], v[132:135]
    v_cvt_pk_bf16_f32 v136, v120, v121
    v_cvt_pk_bf16_f32 v137, v122, v123
    v_cvt_pk_bf16_f32 v138, v124, v125
    v_cvt_pk_bf16_f32 v139, v126, v127
    buffer_store_dwordx4 v[136:139], v13, s[32:35], s58 offen sc1
    s_add_u32 s58, s58, 8192
    s_waitcnt lgkmcnt(3)
    v_mfma_f32_16x16x32_bf16 v[120:123], v[56:59], v[200:203], 0
    v_mfma_f32_16x16x32_bf16 v[124:127], v[56:59], v[216:219], 0
    s_waitcnt lgkmcnt(2)
    v_mfma_f32_16x16x32_bf16 v[120:123], v[60:63], v[204:207], v[120:123]
    v_mfma_f32_16x16x32_bf16 v[124:127], v[60:63], v[220:223], v[124:127]
    s_waitcnt lgkmcnt(1)
    v_mfma_f32_16x16x32_bf16 v[120:123], v[64:67], v[208:211], v[120:123]
    v_mfma_f32_16x16x32_bf16 v[124:127], v[64:67], v[224:227], v[124:127]
    s_waitcnt lgkmcnt(0)
    v_mfma_f32_16x16x32_bf16 v[120:123], v[68:71], v[212:215], v[120:123]
    v_mfma_f32_16x16x32_bf16 v[124:127], v[68:71], v[228:231], v[124:127]
    v_cvt_pk_bf16_f32 v140, v128, v129
    v_cvt_pk_bf16_f32 v141, v130, v131
    v_cvt_pk_bf16_f32 v142, v132, v133
    v_cvt_pk_bf16_f32 v143, v134, v135
    buffer_store_dwordx4 v[140:143], v13, s[32:35], s58 offen sc1
    s_add_u32 s58, s58, 8192
    s_nop 0
    v_cvt_pk_bf16_f32 v136, v120, v121
    v_cvt_pk_bf16_f32 v137, v122, v123
    v_cvt_pk_bf16_f32 v138, v124, v125
    v_cvt_pk_bf16_f32 v139, v126, v127
    buffer_store_dwordx4 v[136:139], v13, s[32:35], s58 offen sc1
    s_or_b32 s56, s55, s3
    s_cmp_lg_u32 s56, 0
    s_cbranch_scc1 K_NOEPO
    v_mov_b32 v10, s52
    s_mov_b64 exec, 1
    buffer_store_dword v10, v4, s[36:39], 0 offen offset:0
K_NOEPO:
K_END:
    s_endpgm
.p2align 6
.type K_TAB,@object
K_TAB:
.byte 6, 5, 14, 7, 4, 2, 0, 1, 3, 12, 22, 11, 10, 8, 30, 9, 19, 13, 15, 17, 16, 21, 23, 20, 18, 25, 29, 28, 31, 27, 26, 24, 34, 32, 39, 33, 35, 36, 37, 38, 255, 255, 255, 255, 255, 255, 255, 255, 255, 255, 255, 255, 255, 255, 255, 255, 255, 255, 255, 255, 255, 255, 255, 255
.byte 3, 2, 4, 7, 0, 1, 6, 8, 5, 9, 15, 13, 14, 11, 12, 22, 21, 16, 10, 23, 17, 20, 30, 19, 18, 25, 27, 24, 29, 28, 26, 31, 34, 37, 36, 39, 33, 38, 32, 35, 255, 255, 255, 255, 255, 255, 255, 255, 255, 255, 255, 255, 255, 255, 255, 255, 255, 255, 255, 255, 255, 255, 255, 255
.section .rodata,"a"
.p2align 6
.amdhsa_kernel gather_scatter__tensor_product_equiv_tfn__graph_kernel
  .amdhsa_next_free_vgpr 256
  .amdhsa_next_free_sgpr 72
  .amdhsa_accum_offset 256
  .amdhsa_group_segment_fixed_size 0
  .amdhsa_kernarg_size 88
  .amdhsa_user_sgpr_count 2
  .amdhsa_user_sgpr_kernarg_segment_ptr 1
  .amdhsa_system_sgpr_workgroup_id_x 1
  .amdhsa_float_denorm_mode_32 3
.end_amdhsa_kernel
```

```asm
; @launch grid=(256,1,1) block=(512,1,1) lds=152832
.amdgcn_target "amdgcn-amd-amdhsa--gfx950"
.text
.globl gather_scatter__tensor_product_equiv_tfn__graph_kernel
.p2align 8
.type gather_scatter__tensor_product_equiv_tfn__graph_kernel,@function
gather_scatter__tensor_product_equiv_tfn__graph_kernel:
    s_cmp_ge_u32 s2, 256
    s_cbranch_scc1 K_END
    s_load_dwordx16 s[4:19], s[0:1], 0
    s_load_dwordx2 s[20:21], s[0:1], 64
    s_load_dwordx2 s[24:25], s[0:1], 80
    v_lshrrev_b32 v2, 6, v0
    v_and_b32 v1, 63, v0
    v_readfirstlane_b32 s3, v2
    v_lshlrev_b32 v10, 4, v0
    s_mul_i32 s57, s2, 5120
    v_lshlrev_b32 v3, 2, v0
    s_cmp_lg_u32 s3, 5
    s_cbranch_scc1 K_PF0
    s_getpc_b64 s[26:27]
K_PC3:
    v_lshlrev_b32 v13, 7, v1
    global_load_dword v255, v13, s[26:27]
    v_add_u32 v13, 8192, v13
    v_min_u32 v13, K_TAB-K_PC3, v13
    global_load_dword v255, v13, s[26:27]
K_PF0:
    v_or_b32 v13, 0x4b000000, v1
    s_cmp_eq_u32 s3, 2
    s_cselect_b32 s56, -1, 0
    v_add_u32 v11, s57, v10
    v_and_b32 v13, s56, v13
    v_lshlrev_b32 v12, 1, v11
    ds_write_b32 v3, v13
    s_cmp_lt_u32 s2, 250
    s_cselect_b32 s56, 5, 0
    s_cmp_lt_u32 s3, s56
    s_waitcnt lgkmcnt(0)
    s_cbranch_scc0 K_BA
    global_load_dwordx4 v[120:123], v11, s[8:9]
    global_load_dwordx4 v[124:127], v11, s[6:7]
K_BA:
    s_barrier
    s_cbranch_scc0 K_HELP
    global_load_dwordx4 v[128:131], v12, s[10:11] offset:0
    global_load_dwordx4 v[132:135], v12, s[10:11] offset:16
    global_load_dwordx4 v[136:139], v12, s[12:13] offset:0
    global_load_dwordx4 v[140:143], v12, s[12:13] offset:16
    s_mov_b32 s40, 1
    s_load_dword s52, s[24:25], 0
    v_mov_b32 v4, 0
    v_mov_b32 v5, 0
    v_mov_b32 v6, 0
    v_mov_b32 v7, 0
    v_add_u32 v8, 106752, v10
    v_lshlrev_b32 v9, 4, v1
    v_lshlrev_b32 v15, 2, v1
    ds_write_b128 v8, v[4:7]
    ds_write_b32 v3, v4 offset:2048
    s_and_b32 s53, s2, 7
    s_lshr_b32 s56, s2, 3
    s_lshl_b32 s53, s53, 5
    s_or_b32 s53, s53, s56
    s_mul_i32 s54, s53, 625
    s_add_u32 s57, s54, 640
    s_add_u32 s54, s54, 15
    s_lshr_b32 s54, s54, 4
    s_lshr_b32 s57, s57, 4
    s_mov_b32 s28, s4
    s_and_b32 s29, s5, 0xffff
    s_or_b32 s29, s29, 0x100000
    s_mov_b32 s30, 10240000
    s_mov_b32 s31, 0x800000
    s_mov_b32 s32, s20
    s_mov_b32 s33, s21
    s_lshl_b32 s34, s57, 10
    s_mov_b32 s35, 0x20000
    s_mov_b32 s36, s24
    s_mov_b32 s37, s25
    s_mov_b32 s38, 8388608
    s_mov_b32 s39, 0x20000
    s_mov_b32 s47, 0
    s_mov_b32 s63, 0
    v_mov_b32 v14, 1
    s_lshr_b32 s27, s53, 5
    s_mul_i32 s27, s27, 20009
    s_add_u32 s27, s27, 14
    s_lshr_b32 s27, s27, 4
    s_lshl_b32 s27, s27, 10
    v_mov_b32 v16, 0
    v_mov_b32 v17, 0
    v_mov_b32 v18, 0
    v_mov_b32 v19, 0
    v_mov_b32 v20, 0
    v_mov_b32 v21, 0
    v_mov_b32 v22, 0
    v_mov_b32 v23, 0
    v_mov_b32 v24, 0
    v_mov_b32 v25, 0
    v_mov_b32 v26, 0
    v_mov_b32 v27, 0
    v_mov_b32 v28, 0
    v_mov_b32 v29, 0
    v_mov_b32 v30, 0
    v_mov_b32 v31, 0
    v_mov_b32 v32, 0
    v_mov_b32 v33, 0
    v_mov_b32 v34, 0
    v_mov_b32 v35, 0
    v_mov_b32 v36, 0
    v_mov_b32 v37, 0
    v_mov_b32 v38, 0
    v_mov_b32 v39, 0
    v_mov_b32 v40, 0
    v_mov_b32 v41, 0
    v_mov_b32 v42, 0
    v_mov_b32 v43, 0
    v_mov_b32 v44, 0
    v_mov_b32 v45, 0
    v_mov_b32 v46, 0
    v_mov_b32 v47, 0
    v_mov_b32 v48, 0
    v_mov_b32 v49, 0
    v_mov_b32 v50, 0
    v_mov_b32 v51, 0
    v_mov_b32 v52, 0
    v_mov_b32 v53, 0
    v_mov_b32 v54, 0
    v_mov_b32 v55, 0
    s_waitcnt vmcnt(5)
    v_mul_u32_u24 v60, 214749, v120
    v_lshrrev_b32 v60, 23, v60
    v_lshlrev_b32 v144, 2, v60
    ds_add_rtn_u32 v148, v144, v14 offset:768
    v_mul_u32_u24 v61, 214749, v121
    v_lshrrev_b32 v61, 23, v61
    v_lshlrev_b32 v145, 2, v61
    ds_add_rtn_u32 v149, v145, v14 offset:768
    v_mul_u32_u24 v62, 214749, v122
    v_lshrrev_b32 v62, 23, v62
    v_lshlrev_b32 v146, 2, v62
    ds_add_rtn_u32 v150, v146, v14 offset:768
    v_mul_u32_u24 v63, 214749, v123
    v_lshrrev_b32 v63, 23, v63
    v_lshlrev_b32 v147, 2, v63
    ds_add_rtn_u32 v151, v147, v14 offset:768
    v_mul_u32_u24 v64, 625, v60
    v_add_u32 v64, 15, v64
    v_lshrrev_b32 v64, 4, v64
    v_sub_u32 v56, v120, v64
    v_mul_u32_u24 v64, 625, v61
    v_add_u32 v64, 15, v64
    v_lshrrev_b32 v64, 4, v64
    v_sub_u32 v57, v121, v64
    v_mul_u32_u24 v64, 625, v62
    v_add_u32 v64, 15, v64
    v_lshrrev_b32 v64, 4, v64
    v_sub_u32 v58, v122, v64
    v_mul_u32_u24 v64, 625, v63
    v_add_u32 v64, 15, v64
    v_lshrrev_b32 v64, 4, v64
    v_sub_u32 v59, v123, v64
    s_branch K_BB
K_HELP:
    s_mov_b32 s40, 0
    s_load_dword s52, s[24:25], 0
    v_mov_b32 v4, 0
    v_mov_b32 v5, 0
    v_mov_b32 v6, 0
    v_mov_b32 v7, 0
    v_add_u32 v8, 106752, v10
    v_lshlrev_b32 v9, 4, v1
    v_lshlrev_b32 v15, 2, v1
    ds_write_b128 v8, v[4:7]
    ds_write_b32 v3, v4 offset:2048
    s_and_b32 s53, s2, 7
    s_lshr_b32 s56, s2, 3
    s_lshl_b32 s53, s53, 5
    s_or_b32 s53, s53, s56
    s_cmp_eq_u32 s3, 7
    s_cbranch_scc1 K_HELP7
    s_cmp_lg_u32 s3, 6
    s_cbranch_scc1 K_HELP2
    s_and_b32 s56, s53, 31
    s_lshl_b32 s56, s56, 10
    v_lshl_add_u32 v13, v1, 7, s56
    s_mov_b64 exec, 0xff
    global_load_dword v255, v13, s[18:19]
    s_mov_b64 exec, -1
    s_branch K_HELP2
K_HELP7:
    s_mov_b32 m0, 147712
    s_getpc_b64 s[26:27]
K_PC:
    global_load_lds_dwordx4 v9, s[14:15]
    s_add_u32 s26, s26, K_TAB-K_PC
    s_addc_u32 s27, s27, 0
    s_mov_b32 m0, 148736
    s_mov_b64 exec, 0xff
    global_load_lds_dwordx4 v9, s[16:17]
    s_mov_b32 m0, 148864
    s_nop 0
    global_load_lds_dwordx4 v9, s[26:27]
    s_mov_b64 exec, -1
K_HELP2:
    s_mul_i32 s54, s53, 625
    s_add_u32 s57, s54, 640
    s_add_u32 s54, s54, 15
    s_lshr_b32 s54, s54, 4
    s_lshr_b32 s57, s57, 4
    s_mov_b32 s28, s4
    s_and_b32 s29, s5, 0xffff
    s_or_b32 s29, s29, 0x100000
    s_mov_b32 s30, 10240000
    s_mov_b32 s31, 0x800000
    s_mov_b32 s32, s20
    s_mov_b32 s33, s21
    s_lshl_b32 s34, s57, 10
    s_mov_b32 s35, 0x20000
    s_mov_b32 s36, s24
    s_mov_b32 s37, s25
    s_mov_b32 s38, 8388608
    s_mov_b32 s39, 0x20000
    s_mov_b32 s47, 0
    s_mov_b32 s63, 0
    v_mov_b32 v14, 1
    s_lshr_b32 s27, s53, 5
    s_mul_i32 s27, s27, 20009
    s_add_u32 s27, s27, 14
    s_lshr_b32 s27, s27, 4
    s_lshl_b32 s27, s27, 10
    v_mov_b32 v16, 0
    v_mov_b32 v17, 0
    v_mov_b32 v18, 0
    v_mov_b32 v19, 0
    v_mov_b32 v20, 0
    v_mov_b32 v21, 0
    v_mov_b32 v22, 0
    v_mov_b32 v23, 0
    v_mov_b32 v24, 0
    v_mov_b32 v25, 0
    v_mov_b32 v26, 0
    v_mov_b32 v27, 0
    v_mov_b32 v28, 0
    v_mov_b32 v29, 0
    v_mov_b32 v30, 0
    v_mov_b32 v31, 0
    v_mov_b32 v32, 0
    v_mov_b32 v33, 0
    v_mov_b32 v34, 0
    v_mov_b32 v35, 0
    v_mov_b32 v36, 0
    v_mov_b32 v37, 0
    v_mov_b32 v38, 0
    v_mov_b32 v39, 0
    v_mov_b32 v40, 0
    v_mov_b32 v41, 0
    v_mov_b32 v42, 0
    v_mov_b32 v43, 0
    v_mov_b32 v44, 0
    v_mov_b32 v45, 0
    v_mov_b32 v46, 0
    v_mov_b32 v47, 0
    v_mov_b32 v48, 0
    v_mov_b32 v49, 0
    v_mov_b32 v50, 0
    v_mov_b32 v51, 0
    v_mov_b32 v52, 0
    v_mov_b32 v53, 0
    v_mov_b32 v54, 0
    v_mov_b32 v55, 0
K_BB:
    s_waitcnt lgkmcnt(0)
    s_barrier
    s_add_u32 s52, s52, 1
    s_and_b32 s56, s52, 0x3ff
    s_lshl_b32 s58, s56, 22
    s_lshl_b32 s26, s52, 24
    s_cmp_eq_u32 s3, 7
    s_cselect_b32 s56, 1, s40
    s_cmp_eq_u32 s56, 0
    s_cbranch_scc1 K_BC1
    ds_read_b128 v[152:155], v9 offset:768
    s_cmp_eq_u32 s3, 7
    s_cbranch_scc1 K_SC
    s_waitcnt vmcnt(4)
    v_mul_u32_u24 v60, 1677, v124
    v_lshrrev_b32 v60, 20, v60
    v_lshl_or_b32 v56, v56, 4, v60
    v_lshl_or_b32 v56, v124, 10, v56
    v_mul_u32_u24 v61, 1677, v125
    v_lshrrev_b32 v61, 20, v61
    v_lshl_or_b32 v57, v57, 4, v61
    v_lshl_or_b32 v57, v125, 10, v57
    v_mul_u32_u24 v62, 1677, v126
    v_lshrrev_b32 v62, 20, v62
    v_lshl_or_b32 v58, v58, 4, v62
    v_lshl_or_b32 v58, v126, 10, v58
    v_mul_u32_u24 v63, 1677, v127
    v_lshrrev_b32 v63, 20, v63
    v_lshl_or_b32 v59, v59, 4, v63
    v_lshl_or_b32 v59, v127, 10, v59
K_SC:
    s_waitcnt lgkmcnt(0)
    v_add_u32 v156, v152, v153
    v_add_u32 v157, v156, v154
    v_add_u32 v158, v157, v155
    v_mov_b32 v160, v158
    v_or_b32 v66, s26, v56
    v_mov_b32 v67, s52
    v_add_u32_dpp v160, v160, v160 row_shr:1 row_mask:0xf bank_mask:0xf
    v_or_b32 v68, s26, v57
    v_mov_b32 v69, s52
    v_add_u32_dpp v160, v160, v160 row_shr:2 row_mask:0xf bank_mask:0xf
    v_or_b32 v70, s26, v58
    v_mov_b32 v71, s52
    v_add_u32_dpp v160, v160, v160 row_shr:4 row_mask:0xf bank_mask:0xf
    v_or_b32 v72, s26, v59
    v_mov_b32 v73, s52
    v_add_u32_dpp v160, v160, v160 row_shr:8 row_mask:0xf bank_mask:0xf
    s_nop 1
    v_add_u32_dpp v160, v160, v160 row_bcast:15 row_mask:0xa bank_mask:0xf
    s_nop 1
    v_add_u32_dpp v160, v160, v160 row_bcast:31 row_mask:0xc bank_mask:0xf
    v_sub_u32 v160, v160, v158
    v_add_u32 v161, v160, v152
    v_add_u32 v162, v160, v156
    v_add_u32 v163, v160, v157
    s_cmp_lg_u32 s3, 7
    s_cbranch_scc1 K_NOROW
    v_lshl_or_b32 v168, v152, 11, v160
    v_or_b32 v168, s58, v168
    v_mov_b32 v169, s52
    v_lshl_or_b32 v170, v153, 11, v161
    v_or_b32 v170, s58, v170
    v_mov_b32 v171, s52
    v_lshl_or_b32 v172, v154, 11, v162
    v_or_b32 v172, s58, v172
    v_mov_b32 v173, s52
    v_lshl_or_b32 v174, v155, 11, v163
    v_or_b32 v174, s58, v174
    v_mov_b32 v175, s52
    s_lshl_b32 s57, s2, 11
    s_add_u32 s57, s57, 8192
    v_lshlrev_b32 v12, 5, v1
    buffer_store_dwordx4 v[168:171], v12, s[36:39], s57 offen sc1
    buffer_store_dwordx4 v[172:175], v12, s[36:39], s57 offen offset:16 sc1
    s_branch K_BC1
K_NOROW:
    ds_write_b128 v9, v[160:163] offset:4096
    ds_read_b32 v60, v144 offset:4096
    ds_read_b32 v61, v145 offset:4096
    ds_read_b32 v62, v146 offset:4096
    ds_read_b32 v63, v147 offset:4096
    s_waitcnt lgkmcnt(3)
    v_add_lshl_u32 v144, v60, v148, 3
    ds_write_b64 v144, v[66:67] offset:13824
    s_waitcnt lgkmcnt(3)
    v_add_lshl_u32 v145, v61, v149, 3
    ds_write_b64 v145, v[68:69] offset:13824
    s_waitcnt lgkmcnt(3)
    v_add_lshl_u32 v146, v62, v150, 3
    ds_write_b64 v146, v[70:71] offset:13824
    s_waitcnt lgkmcnt(3)
    v_add_lshl_u32 v147, v63, v151, 3
    ds_write_b64 v147, v[72:73] offset:13824
    s_mov_b32 s56, 44800
    v_lshl_add_u32 v144, v144, 1, s56
    v_lshl_add_u32 v145, v145, 1, s56
    v_lshl_add_u32 v146, v146, 1, s56
    v_lshl_add_u32 v147, v147, 1, s56
K_BC1:
    s_mul_i32 s60, s2, 10240
    s_add_u32 s60, s60, 532480
    s_sub_u32 s56, s3, 5
    s_lshl_b32 s57, s56, 14
    v_add_u32 v13, s57, v9
    s_add_u32 s57, s57, 114944
    s_waitcnt lgkmcnt(0)
    s_barrier
    s_cmp_ge_u32 s2, 250
    s_cbranch_scc1 K_KS2
    ds_read_b128 v[76:79], v10 offset:13824
    s_cmp_lt_u32 s56, 2
    s_cbranch_scc0 K_KS1
    ds_read_b128 v[80:83], v10 offset:16896
    s_add_u32 s59, s60, 3072
    s_waitcnt lgkmcnt(0)
    buffer_store_dwordx4 v[80:83], v10, s[36:39], s59 offen sc1
K_KS1:
    s_waitcnt lgkmcnt(0)
    buffer_store_dwordx4 v[76:79], v10, s[36:39], s60 offen sc1
K_KS2:
    s_cmp_lt_u32 s56, 2
    s_cbranch_scc1 K_DMA
    s_cmp_eq_u32 s40, 0
    s_cbranch_scc1 K_BC7
    s_waitcnt vmcnt(2)
    ds_write2_b64 v144, v[128:129], v[136:137] offset0:0 offset1:1
    ds_write2_b64 v145, v[130:131], v[138:139] offset0:0 offset1:1
    s_waitcnt vmcnt(1)
    ds_write2_b64 v146, v[132:133], v[140:141] offset0:0 offset1:1
    ds_write2_b64 v147, v[134:135], v[142:143] offset0:0 offset1:1
    s_branch K_BC
K_DMA:
    s_mov_b32 m0, s57
    s_add_u32 s57, s57, 4096
    global_load_lds_dwordx4 v13, s[18:19] offset:0
    global_load_lds_dwordx4 v13, s[18:19] offset:1024
    global_load_lds_dwordx4 v13, s[18:19] offset:2048
    global_load_lds_dwordx4 v13, s[18:19] offset:3072
    v_add_u32 v13, 4096, v13
    s_mov_b32 m0, s57
    s_add_u32 s57, s57, 4096
    global_load_lds_dwordx4 v13, s[18:19] offset:0
    global_load_lds_dwordx4 v13, s[18:19] offset:1024
    global_load_lds_dwordx4 v13, s[18:19] offset:2048
    global_load_lds_dwordx4 v13, s[18:19] offset:3072
    v_add_u32 v13, 4096, v13
    s_mov_b32 m0, s57
    s_add_u32 s57, s57, 4096
    global_load_lds_dwordx4 v13, s[18:19] offset:0
    global_load_lds_dwordx4 v13, s[18:19] offset:1024
    global_load_lds_dwordx4 v13, s[18:19] offset:2048
    global_load_lds_dwordx4 v13, s[18:19] offset:3072
    v_add_u32 v13, 4096, v13
    s_mov_b32 m0, s57
    s_add_u32 s57, s57, 4096
    global_load_lds_dwordx4 v13, s[18:19] offset:0
    global_load_lds_dwordx4 v13, s[18:19] offset:1024
    global_load_lds_dwordx4 v13, s[18:19] offset:2048
    global_load_lds_dwordx4 v13, s[18:19] offset:3072
    s_branch K_BC
K_BC7:
    s_cmp_ge_u32 s2, 250
    s_cbranch_scc0 K_BC8
    s_waitcnt vmcnt(2)
K_BC8:
    s_waitcnt vmcnt(3)
K_BC:
    s_mul_i32 s56, s2, 20480
    s_add_u32 s56, s56, 3145728
    s_add_u32 s57, s56, 8192
    s_add_u32 s59, s56, 16384
    v_lshlrev_b32 v11, 11, v0
    s_lshl_b32 s61, s53, 3
    s_add_u32 s61, s61, 8192
    s_waitcnt lgkmcnt(0)
    s_barrier
    s_cmp_ge_u32 s2, 250
    s_cbranch_scc1 K_NOST
    ds_read_b128 v[56:59], v10 offset:44800
    ds_read_b128 v[60:63], v10 offset:52992
    s_cmp_ge_u32 s3, 4
    s_cbranch_scc1 K_ST1
    ds_read_b128 v[64:67], v10 offset:61184
    s_waitcnt lgkmcnt(0)
    buffer_store_dwordx4 v[64:67], v10, s[36:39], s59 offen sc1
K_ST1:
    s_waitcnt lgkmcnt(1)
    buffer_store_dwordx4 v[56:59], v10, s[36:39], s56 offen sc1
    s_waitcnt lgkmcnt(0)
    buffer_store_dwordx4 v[60:63], v10, s[36:39], s57 offen sc1
K_NOST:
    s_lshr_b32 s56, s34, 10
    s_sub_u32 s56, s56, s54
    s_sub_u32 s56, s56, 39
    s_lshl_b32 s56, s56, 6
    s_add_u32 s56, s56, 148864
    v_add_u32 v2, s56, v1
    v_add_u32 v13, 147712, v15
    ds_read_u8 v2, v2
    ds_read2st64_b32 v[188:189], v13 offset0:0 offset1:1
    ds_read2st64_b32 v[190:191], v13 offset0:2 offset1:3
    v_and_b32 v12, 3, v1
    v_lshlrev_b32 v12, 5, v12
    v_bfe_u32 v13, v1, 2, 2
    v_lshl_or_b32 v12, v13, 1, v12
    v_add_u32 v12, 148736, v12
    ds_read_u16 v192, v12 offset:0
    ds_read_u16 v193, v12 offset:8
    ds_read_u16 v194, v12 offset:16
    ds_read_u16 v195, v12 offset:24
    v_mov_b32 v252, v3
    v_xor_b32 v253, 1024, v3
    v_mul_u32_u24 v185, 128, v0
    s_mov_b32 s56, 0xbfb8aa3b
    s_waitcnt lgkmcnt(0)
    v_lshlrev_b32 v136, 16, v188
    v_mul_f32 v140, s56, v136
    v_lshlrev_b32 v137, 16, v189
    v_mul_f32 v141, s56, v137
    v_lshlrev_b32 v138, 16, v190
    v_mul_f32 v142, s56, v138
    v_lshlrev_b32 v139, 16, v191
    v_mul_f32 v143, s56, v139
    v_cvt_pk_bf16_f32 v176, v140, v141
    v_cvt_pk_bf16_f32 v177, v142, v143
    v_and_b32 v136, 0xffff0000, v188
    v_mul_f32 v140, s56, v136
    v_and_b32 v137, 0xffff0000, v189
    v_mul_f32 v141, s56, v137
    v_and_b32 v138, 0xffff0000, v190
    v_mul_f32 v142, s56, v138
    v_and_b32 v139, 0xffff0000, v191
    v_mul_f32 v143, s56, v139
    v_cvt_pk_bf16_f32 v180, v140, v141
    v_cvt_pk_bf16_f32 v181, v142, v143
    v_lshl_or_b32 v136, v193, 16, v192
    v_lshl_or_b32 v137, v195, 16, v194
    v_lshrrev_b32 v13, 4, v1
    v_cmp_eq_u32 vcc, 0, v13
    s_nop 1
    v_cndmask_b32 v232, 0, v136, vcc
    v_cndmask_b32 v233, 0, v137, vcc
    v_cmp_eq_u32 vcc, 1, v13
    s_nop 1
    v_cndmask_b32 v234, 0, v136, vcc
    v_cndmask_b32 v235, 0, v137, vcc
    v_cmp_eq_u32 vcc, 2, v13
    s_nop 1
    v_cndmask_b32 v236, 0, v136, vcc
    v_cndmask_b32 v237, 0, v137, vcc
    v_cmp_eq_u32 vcc, 3, v13
    s_nop 1
    v_cndmask_b32 v238, 0, v136, vcc
    v_cndmask_b32 v239, 0, v137, vcc
    v_mul_u32_u24 v13, 5120, v1
    s_cmp_ge_u32 s3, 4
    s_cbranch_scc1 K_TABOK
    s_mov_b32 s59, 40000
    s_lshr_b32 s58, s58, 22
K_POLLA:
    buffer_load_dwordx2 v[152:153], v11, s[36:39], s61 offen sc1
    s_waitcnt vmcnt(0)
    v_lshrrev_b32 v154, 22, v152
    v_cmp_ne_u32 vcc, s52, v153
    v_cmp_ne_u32 s[56:57], s58, v154
    s_or_b64 vcc, vcc, s[56:57]
    s_cbranch_vccz K_POLLAOK
    s_sub_u32 s59, s59, 1
    s_cbranch_scc0 K_POLLA
    ds_write_b32 v4, v14 offset:1792
K_POLLAOK:
    ds_write_b32 v3, v152 offset:5120
K_TABOK:
    s_waitcnt vmcnt(0) lgkmcnt(0)
    s_barrier
    s_cmp_lg_u32 s3, 4
    s_cbranch_scc1 K_NOFLAG
    s_mul_i32 s56, s2, 128
    s_add_u32 s56, s56, 8323072
    v_mov_b32 v10, s52
    s_mov_b64 exec, 1
    buffer_store_dword v10, v4, s[36:39], s56 offen sc1
    s_mov_b64 exec, -1
K_NOFLAG:
    ds_read_b128 v[120:123], v9 offset:5120
    ds_read_b32 v10, v4 offset:1792
    s_cmp_lt_u32 s3, 6
    s_cbranch_scc1 K_NOPFX
    s_mov_b32 s64, s4
    s_mov_b32 s65, s5
    s_mov_b32 s66, 10240000
    s_mov_b32 s67, 0x20000
    s_sub_u32 s68, 7, s3
    s_lshl_b32 s68, s68, 5
    s_and_b32 s69, s53, 31
    s_add_u32 s68, s68, s69
    s_lshl_b32 s68, s68, 13
    s_add_u32 s68, s68, s27
    v_lshlrev_b32 v12, 7, v1
    buffer_load_dword v255, v12, s[64:67], s68 offen
K_NOPFX:
    s_waitcnt lgkmcnt(0)
    v_readfirstlane_b32 s55, v10
    v_bfe_u32 v124, v120, 11, 11
    v_bfe_u32 v125, v121, 11, 11
    v_bfe_u32 v126, v122, 11, 11
    v_bfe_u32 v127, v123, 11, 11
    v_add_u32 v129, v124, v125
    v_add_u32 v130, v129, v126
    v_add_u32 v131, v130, v127
    v_mov_b32 v132, v131
    v_and_b32 v120, 0x7ff, v120
    v_add_u32 v248, v13, v120
    v_add_u32_dpp v132, v132, v132 row_shr:1 row_mask:0xf bank_mask:0xf
    v_and_b32 v121, 0x7ff, v121
    v_add_u32 v249, v13, v121
    v_add_u32_dpp v132, v132, v132 row_shr:2 row_mask:0xf bank_mask:0xf
    v_add_u32 v249, 1280, v249
    v_and_b32 v122, 0x7ff, v122
    v_add_u32_dpp v132, v132, v132 row_shr:4 row_mask:0xf bank_mask:0xf
    v_add_u32 v250, v13, v122
    v_add_u32 v250, 2560, v250
    v_add_u32_dpp v132, v132, v132 row_shr:8 row_mask:0xf bank_mask:0xf
    v_and_b32 v123, 0x7ff, v123
    v_add_u32 v251, v13, v123
    v_add_u32_dpp v132, v132, v132 row_bcast:15 row_mask:0xa bank_mask:0xf
    v_add_u32 v251, 3840, v251
    s_nop 0
    v_add_u32_dpp v132, v132, v132 row_bcast:31 row_mask:0xc bank_mask:0xf
    s_cmp_lg_u32 s55, 0
    s_cbranch_scc1 K_FB0
    v_readlane_b32 s46, v132, 63
    v_sub_u32 v240, v132, v131
    v_add_u32 v241, v240, v124
    v_add_u32 v242, v240, v129
    v_add_u32 v243, v240, v130
    v_sub_u32 v248, v248, v240
    v_add_u32 v244, v240, v124
    v_sub_u32 v249, v249, v241
    v_add_u32 v245, v241, v125
    v_sub_u32 v250, v250, v242
    v_add_u32 v246, v242, v126
    v_sub_u32 v251, v251, v243
    v_add_u32 v247, v243, v127
K_ROUND:
    s_mul_i32 s56, s3, 192
    s_add_u32 s56, s56, s47
    s_add_u32 s57, s56, 192
    s_lshl_b32 s58, s3, 10
    s_add_u32 s58, s58, 106752
    v_cmp_lt_u32 vcc, s56, v244
    v_cmp_gt_u32 s[60:61], s57, v240
    v_subrev_u32 v56, s56, v240
    v_max_i32 v56, 0, v56
    v_lshl_add_u32 v56, v56, 2, s58
    s_and_b64 exec, vcc, s[60:61]
    ds_max_u32 v56, v248
    s_mov_b64 exec, -1
    v_cmp_lt_u32 vcc, s56, v245
    v_cmp_gt_u32 s[60:61], s57, v241
    v_subrev_u32 v57, s56, v241
    v_max_i32 v57, 0, v57
    v_lshl_add_u32 v57, v57, 2, s58
    s_and_b64 exec, vcc, s[60:61]
    ds_max_u32 v57, v249
    s_mov_b64 exec, -1
    v_cmp_lt_u32 vcc, s56, v246
    v_cmp_gt_u32 s[60:61], s57, v242
    v_subrev_u32 v58, s56, v242
    v_max_i32 v58, 0, v58
    v_lshl_add_u32 v58, v58, 2, s58
    s_and_b64 exec, vcc, s[60:61]
    ds_max_u32 v58, v250
    s_mov_b64 exec, -1
    v_cmp_lt_u32 vcc, s56, v247
    v_cmp_gt_u32 s[60:61], s57, v243
    v_subrev_u32 v59, s56, v243
    v_max_i32 v59, 0, v59
    v_lshl_add_u32 v59, v59, 2, s58
    s_and_b64 exec, vcc, s[60:61]
    ds_max_u32 v59, v251
    s_mov_b64 exec, -1
    v_add_u32 v60, s58, v15
    ds_read_b32 v64, v60 offset:0
    ds_read_b32 v65, v60 offset:256
    ds_read_b32 v66, v60 offset:512
    v_add_u32 v68, s56, v1
    v_add_u32 v69, 64, v68
    v_add_u32 v70, 128, v68
    v_cmp_gt_u32 s[40:41], s46, v68
    v_cmp_gt_u32 s[42:43], s46, v69
    v_cmp_gt_u32 s[44:45], s46, v70
    s_mov_b32 s60, 532480
    s_mov_b32 s61, 3145728
    s_lshr_b32 s62, s26, 24
    s_waitcnt lgkmcnt(0)
    v_max_u32_dpp v64, v64, v64 row_shr:1 row_mask:0xf bank_mask:0xf
    v_max_u32_dpp v65, v65, v65 row_shr:1 row_mask:0xf bank_mask:0xf
    v_max_u32_dpp v66, v66, v66 row_shr:1 row_mask:0xf bank_mask:0xf
    v_max_u32_dpp v64, v64, v64 row_shr:2 row_mask:0xf bank_mask:0xf
    v_max_u32_dpp v65, v65, v65 row_shr:2 row_mask:0xf bank_mask:0xf
    v_max_u32_dpp v66, v66, v66 row_shr:2 row_mask:0xf bank_mask:0xf
    v_max_u32_dpp v64, v64, v64 row_shr:4 row_mask:0xf bank_mask:0xf
    v_max_u32_dpp v65, v65, v65 row_shr:4 row_mask:0xf bank_mask:0xf
    v_max_u32_dpp v66, v66, v66 row_shr:4 row_mask:0xf bank_mask:0xf
    v_max_u32_dpp v64, v64, v64 row_shr:8 row_mask:0xf bank_mask:0xf
    v_max_u32_dpp v65, v65, v65 row_shr:8 row_mask:0xf bank_mask:0xf
    v_max_u32_dpp v66, v66, v66 row_shr:8 row_mask:0xf bank_mask:0xf
    v_max_u32_dpp v64, v64, v64 row_bcast:15 row_mask:0xa bank_mask:0xf
    v_max_u32_dpp v65, v65, v65 row_bcast:15 row_mask:0xa bank_mask:0xf
    v_max_u32_dpp v66, v66, v66 row_bcast:15 row_mask:0xa bank_mask:0xf
    v_max_u32_dpp v64, v64, v64 row_bcast:31 row_mask:0xc bank_mask:0xf
    v_max_u32_dpp v65, v65, v65 row_bcast:31 row_mask:0xc bank_mask:0xf
    v_max_u32_dpp v66, v66, v66 row_bcast:31 row_mask:0xc bank_mask:0xf
    v_readlane_b32 s56, v64, 63
    v_readlane_b32 s57, v65, 63
    v_add_u32 v68, v68, v64
    s_max_u32 s57, s56, s57
    v_max_u32 v65, s56, v65
    v_max_u32 v66, s57, v66
    v_add_u32 v69, v69, v65
    v_add_u32 v70, v70, v66
    v_lshlrev_b32 v81, 3, v68
    v_lshlrev_b32 v82, 3, v69
    v_lshlrev_b32 v83, 3, v70
    s_mov_b64 exec, s[40:41]
    buffer_load_dwordx2 v[72:73], v81, s[36:39], s60 offen sc1
    s_mov_b64 exec, s[42:43]
    buffer_load_dwordx2 v[74:75], v82, s[36:39], s60 offen sc1
    s_mov_b64 exec, s[44:45]
    buffer_load_dwordx2 v[76:77], v83, s[36:39], s60 offen sc1
    s_mov_b64 exec, -1
    v_lshlrev_b32 v100, 4, v68
    v_lshlrev_b32 v101, 4, v69
    v_lshlrev_b32 v102, 4, v70
    s_cmp_lg_u32 s47, 0
    s_cbranch_scc1 K_KEYS1
    s_and_b32 s56, s3, 3
    s_lshl_b32 s56, s56, 6
    s_add_u32 s56, s56, 114944
    v_lshrrev_b32 v10, 4, v1
    v_lshlrev_b32 v10, 11, v10
    v_and_b32 v12, 15, v1
    v_lshl_or_b32 v10, v12, 2, v10
    v_add_u32 v10, s56, v10
    s_mov_b32 s56, 0x05040100
    s_mov_b32 s57, 0x07060302
    ds_read2st64_b32 v[120:121], v10 offset0:0 offset1:1
    ds_read2st64_b32 v[122:123], v10 offset0:2 offset1:3
    ds_read2st64_b32 v[124:125], v10 offset0:4 offset1:5
    ds_read2st64_b32 v[126:127], v10 offset0:6 offset1:7
    ds_read2st64_b32 v[128:129], v10 offset0:32 offset1:33
    ds_read2st64_b32 v[130:131], v10 offset0:34 offset1:35
    ds_read2st64_b32 v[132:133], v10 offset0:36 offset1:37
    ds_read2st64_b32 v[134:135], v10 offset0:38 offset1:39
    ds_read2st64_b32 v[136:137], v10 offset0:64 offset1:65
    ds_read2st64_b32 v[138:139], v10 offset0:66 offset1:67
    ds_read2st64_b32 v[140:141], v10 offset0:68 offset1:69
    ds_read2st64_b32 v[142:143], v10 offset0:70 offset1:71
    ds_read2st64_b32 v[144:145], v10 offset0:96 offset1:97
    ds_read2st64_b32 v[146:147], v10 offset0:98 offset1:99
    ds_read2st64_b32 v[148:149], v10 offset0:100 offset1:101
    ds_read2st64_b32 v[150:151], v10 offset0:102 offset1:103
    s_waitcnt lgkmcnt(15)
    v_perm_b32 v200, v121, v120, s56
    v_perm_b32 v216, v121, v120, s57
    s_waitcnt lgkmcnt(14)
    v_perm_b32 v201, v123, v122, s56
    v_perm_b32 v217, v123, v122, s57
    s_waitcnt lgkmcnt(13)
    v_perm_b32 v202, v125, v124, s56
    v_perm_b32 v218, v125, v124, s57
    s_waitcnt lgkmcnt(12)
    v_perm_b32 v203, v127, v126, s56
    v_perm_b32 v219, v127, v126, s57
    s_waitcnt lgkmcnt(11)
    v_perm_b32 v204, v129, v128, s56
    v_perm_b32 v220, v129, v128, s57
    s_waitcnt lgkmcnt(10)
    v_perm_b32 v205, v131, v130, s56
    v_perm_b32 v221, v131, v130, s57
    s_waitcnt lgkmcnt(9)
    v_perm_b32 v206, v133, v132, s56
    v_perm_b32 v222, v133, v132, s57
    s_waitcnt lgkmcnt(8)
    v_perm_b32 v207, v135, v134, s56
    v_perm_b32 v223, v135, v134, s57
    s_waitcnt lgkmcnt(7)
    v_perm_b32 v208, v137, v136, s56
    v_perm_b32 v224, v137, v136, s57
    s_waitcnt lgkmcnt(6)
    v_perm_b32 v209, v139, v138, s56
    v_perm_b32 v225, v139, v138, s57
    s_waitcnt lgkmcnt(5)
    v_perm_b32 v210, v141, v140, s56
    v_perm_b32 v226, v141, v140, s57
    s_waitcnt lgkmcnt(4)
    v_perm_b32 v211, v143, v142, s56
    v_perm_b32 v227, v143, v142, s57
    s_waitcnt lgkmcnt(3)
    v_perm_b32 v212, v145, v144, s56
    v_perm_b32 v228, v145, v144, s57
    s_waitcnt lgkmcnt(2)
    v_perm_b32 v213, v147, v146, s56
    v_perm_b32 v229, v147, v146, s57
    s_waitcnt lgkmcnt(1)
    v_perm_b32 v214, v149, v148, s56
    v_perm_b32 v230, v149, v148, s57
    s_waitcnt lgkmcnt(0)
    v_perm_b32 v215, v151, v150, s56
    v_perm_b32 v231, v151, v150, s57
    s_branch K_KEYS1
K_KEYS:
    s_mov_b64 exec, s[40:41]
    buffer_load_dwordx2 v[72:73], v81, s[36:39], s60 offen sc1
    s_mov_b64 exec, s[42:43]
    buffer_load_dwordx2 v[74:75], v82, s[36:39], s60 offen sc1
    s_mov_b64 exec, s[44:45]
    buffer_load_dwordx2 v[76:77], v83, s[36:39], s60 offen sc1
    s_mov_b64 exec, -1
K_KEYS1:
    v_mov_b32 v14, 64
    s_mov_b64 s[58:59], 0
    s_waitcnt vmcnt(2)
    v_lshrrev_b32 v78, 24, v72
    v_cmp_ne_u32 vcc, s52, v73
    v_cmp_ne_u32 s[56:57], s62, v78
    s_or_b64 vcc, vcc, s[56:57]
    s_and_b64 vcc, vcc, s[40:41]
    s_or_b64 s[58:59], s[58:59], vcc
    s_waitcnt vmcnt(1)
    v_lshrrev_b32 v79, 24, v74
    v_cmp_ne_u32 vcc, s52, v75
    v_cmp_ne_u32 s[56:57], s62, v79
    s_or_b64 vcc, vcc, s[56:57]
    s_and_b64 vcc, vcc, s[42:43]
    s_or_b64 s[58:59], s[58:59], vcc
    s_waitcnt vmcnt(0)
    v_lshrrev_b32 v80, 24, v76
    v_cmp_ne_u32 vcc, s52, v77
    v_cmp_ne_u32 s[56:57], s62, v80
    s_or_b64 vcc, vcc, s[56:57]
    s_and_b64 vcc, vcc, s[44:45]
    s_or_b64 s[58:59], s[58:59], vcc
    s_cbranch_scc1 K_KEYS
    s_cmp_lg_u32 s47, 0
    s_cbranch_scc1 K_LATER
    s_mov_b32 s62, 8323072
    s_cmp_lt_u32 s3, 4
    s_cbranch_scc0 K_GOT
    buffer_load_dword v184, v185, s[36:39], s62 offen sc1
K_GOT:
    v_lshrrev_b32 v81, 2, v72
    v_and_b32 v81, 0xfc, v81
    v_lshrrev_b32 v82, 2, v74
    v_and_b32 v82, 0xfc, v82
    v_lshrrev_b32 v83, 2, v76
    v_and_b32 v83, 0xfc, v83
    s_mov_b64 exec, s[40:41]
    ds_add_u32 v81, v14 offset:512
    s_mov_b64 exec, s[42:43]
    ds_add_u32 v82, v14 offset:512
    s_mov_b64 exec, s[44:45]
    ds_add_u32 v83, v14 offset:512
    s_mov_b64 exec, -1
    s_lshr_b32 s56, s3, 2
    s_or_b32 s56, s56, s55
    s_cbranch_scc1 K_POLLBOK
K_POLLB:
    s_waitcnt vmcnt(0)
    v_cmp_ne_u32 vcc, s52, v184
    s_cbranch_vccz K_POLLBOK
    buffer_load_dword v184, v185, s[36:39], s62 offen sc1
    s_branch K_POLLB
K_POLLBOK:
    s_waitcnt lgkmcnt(0)
    s_barrier
    s_cmp_lg_u32 s55, 0
    s_cbranch_scc1 K_NOPF
    s_mov_b64 exec, s[40:41]
    buffer_load_dwordx4 v[88:91], v100, s[36:39], s61 offen sc1
    s_mov_b64 exec, s[42:43]
    buffer_load_dwordx4 v[92:95], v101, s[36:39], s61 offen sc1
    s_mov_b64 exec, s[44:45]
    buffer_load_dwordx4 v[96:99], v102, s[36:39], s61 offen sc1
    s_mov_b64 exec, -1
    s_cmp_lt_u32 s3, 5
    s_cbranch_scc1 K_NOPF
    s_mov_b32 s64, s4
    s_mov_b32 s65, s5
    s_mov_b32 s66, 10240000
    s_mov_b32 s67, 0x20000
    s_sub_u32 s68, 9, s3
    s_lshl_b32 s68, s68, 5
    s_and_b32 s69, s53, 31
    s_add_u32 s68, s68, s69
    s_lshl_b32 s68, s68, 13
    s_add_u32 s68, s68, s27
    v_lshlrev_b32 v12, 7, v1
    buffer_load_dword v255, v12, s[64:67], s68 offen
K_NOPF:
    ds_read_b32 v168, v15 offset:512
    ds_read_b128 v[120:123], v4 offset:512
    ds_read_b128 v[124:127], v4 offset:528
    ds_read_b128 v[128:131], v4 offset:544
    ds_read_b128 v[132:135], v4 offset:560
    ds_read_b128 v[136:139], v4 offset:576
    ds_read_b128 v[140:143], v4 offset:592
    ds_read_b128 v[144:147], v4 offset:608
    ds_read_b128 v[148:151], v4 offset:624
    ds_read_b128 v[152:155], v4 offset:640
    ds_read_b128 v[156:159], v4 offset:656
    v_cmp_gt_u32 vcc, 40, v1
    s_waitcnt lgkmcnt(9)
    v_pk_add_f32 v[120:121], v[120:121], v[168:169] op_sel_hi:[1,0] neg_lo:[0,1] neg_hi:[0,1] clamp
    v_pk_add_f32 v[122:123], v[122:123], v[168:169] op_sel_hi:[1,0] neg_lo:[0,1] neg_hi:[0,1] clamp
    s_waitcnt lgkmcnt(8)
    v_pk_add_f32 v[124:125], v[124:125], v[168:169] op_sel_hi:[1,0] neg_lo:[0,1] neg_hi:[0,1] clamp
    v_pk_add_f32 v[124:125], v[124:125], v[120:121]
    v_pk_add_f32 v[126:127], v[126:127], v[168:169] op_sel_hi:[1,0] neg_lo:[0,1] neg_hi:[0,1] clamp
    v_pk_add_f32 v[126:127], v[126:127], v[122:123]
    s_waitcnt lgkmcnt(7)
    v_pk_add_f32 v[128:129], v[128:129], v[168:169] op_sel_hi:[1,0] neg_lo:[0,1] neg_hi:[0,1] clamp
    v_pk_add_f32 v[128:129], v[128:129], v[124:125]
    v_pk_add_f32 v[130:131], v[130:131], v[168:169] op_sel_hi:[1,0] neg_lo:[0,1] neg_hi:[0,1] clamp
    v_pk_add_f32 v[130:131], v[130:131], v[126:127]
    s_waitcnt lgkmcnt(6)
    v_pk_add_f32 v[132:133], v[132:133], v[168:169] op_sel_hi:[1,0] neg_lo:[0,1] neg_hi:[0,1] clamp
    v_pk_add_f32 v[132:133], v[132:133], v[128:129]
    v_pk_add_f32 v[134:135], v[134:135], v[168:169] op_sel_hi:[1,0] neg_lo:[0,1] neg_hi:[0,1] clamp
    v_pk_add_f32 v[134:135], v[134:135], v[130:131]
    s_waitcnt lgkmcnt(5)
    v_pk_add_f32 v[136:137], v[136:137], v[168:169] op_sel_hi:[1,0] neg_lo:[0,1] neg_hi:[0,1] clamp
    v_pk_add_f32 v[136:137], v[136:137], v[132:133]
    v_pk_add_f32 v[138:139], v[138:139], v[168:169] op_sel_hi:[1,0] neg_lo:[0,1] neg_hi:[0,1] clamp
    v_pk_add_f32 v[138:139], v[138:139], v[134:135]
    s_waitcnt lgkmcnt(4)
    v_pk_add_f32 v[140:141], v[140:141], v[168:169] op_sel_hi:[1,0] neg_lo:[0,1] neg_hi:[0,1] clamp
    v_pk_add_f32 v[140:141], v[140:141], v[136:137]
    v_pk_add_f32 v[142:143], v[142:143], v[168:169] op_sel_hi:[1,0] neg_lo:[0,1] neg_hi:[0,1] clamp
    v_pk_add_f32 v[142:143], v[142:143], v[138:139]
    s_waitcnt lgkmcnt(3)
    v_pk_add_f32 v[144:145], v[144:145], v[168:169] op_sel_hi:[1,0] neg_lo:[0,1] neg_hi:[0,1] clamp
    v_pk_add_f32 v[144:145], v[144:145], v[140:141]
    v_pk_add_f32 v[146:147], v[146:147], v[168:169] op_sel_hi:[1,0] neg_lo:[0,1] neg_hi:[0,1] clamp
    v_pk_add_f32 v[146:147], v[146:147], v[142:143]
    s_waitcnt lgkmcnt(2)
    v_pk_add_f32 v[148:149], v[148:149], v[168:169] op_sel_hi:[1,0] neg_lo:[0,1] neg_hi:[0,1] clamp
    v_pk_add_f32 v[148:149], v[148:149], v[144:145]
    v_pk_add_f32 v[150:151], v[150:151], v[168:169] op_sel_hi:[1,0] neg_lo:[0,1] neg_hi:[0,1] clamp
    v_pk_add_f32 v[150:151], v[150:151], v[146:147]
    s_waitcnt lgkmcnt(1)
    v_pk_add_f32 v[152:153], v[152:153], v[168:169] op_sel_hi:[1,0] neg_lo:[0,1] neg_hi:[0,1] clamp
    v_pk_add_f32 v[152:153], v[152:153], v[148:149]
    v_pk_add_f32 v[154:155], v[154:155], v[168:169] op_sel_hi:[1,0] neg_lo:[0,1] neg_hi:[0,1] clamp
    v_pk_add_f32 v[154:155], v[154:155], v[150:151]
    s_waitcnt lgkmcnt(0)
    v_pk_add_f32 v[156:157], v[156:157], v[168:169] op_sel_hi:[1,0] neg_lo:[0,1] neg_hi:[0,1] clamp
    v_pk_add_f32 v[156:157], v[156:157], v[152:153]
    v_pk_add_f32 v[158:159], v[158:159], v[168:169] op_sel_hi:[1,0] neg_lo:[0,1] neg_hi:[0,1] clamp
    v_pk_add_f32 v[158:159], v[158:159], v[154:155]
    v_pk_add_f32 v[158:159], v[158:159], v[156:157]
    v_add_f32 v158, v158, v159
    v_cvt_u32_f32 v158, v158
    v_lshlrev_b32 v158, 2, v158
    ds_bpermute_b32 v2, v158, v2
    s_waitcnt lgkmcnt(0)
    v_cndmask_b32 v2, -1, v2, vcc
K_BAL:
    ds_bpermute_b32 v84, v81, v2
    ds_bpermute_b32 v85, v82, v2
    ds_bpermute_b32 v86, v83, v2
    v_mov_b32 v14, 1
    v_lshlrev_b32 v10, 3, v1
    s_lshr_b32 s56, s53, 4
    s_and_b32 s56, s56, 14
    v_subrev_u32 v103, s56, v72
    v_and_b32 v103, 15, v103
    v_subrev_u32 v104, s56, v74
    v_and_b32 v104, 15, v104
    v_subrev_u32 v105, s56, v76
    v_and_b32 v105, 15, v105
    s_waitcnt lgkmcnt(2)
    s_mov_b64 exec, s[40:41]
    v_and_b32 v81, 7, v84
    v_lshl_or_b32 v103, v81, 4, v103
    v_lshlrev_b32 v81, 2, v103
    ds_add_rtn_u32 v78, v81, v14 offset:0
    s_waitcnt lgkmcnt(2)
    s_mov_b64 exec, s[42:43]
    v_and_b32 v82, 7, v85
    v_lshl_or_b32 v104, v82, 4, v104
    v_lshlrev_b32 v82, 2, v104
    ds_add_rtn_u32 v79, v82, v14 offset:0
    s_waitcnt lgkmcnt(2)
    s_mov_b64 exec, s[44:45]
    v_and_b32 v83, 7, v86
    v_lshl_or_b32 v105, v83, 4, v105
    v_lshlrev_b32 v83, 2, v105
    ds_add_rtn_u32 v80, v83, v14 offset:0
    s_mov_b64 exec, -1
    v_lshlrev_b32 v81, 1, v103
    v_lshlrev_b32 v103, 4, v103
    v_and_b32 v84, 0x38, v84
    v_and_b32 v72, 16776192, v72
    v_lshlrev_b32 v82, 1, v104
    v_lshlrev_b32 v104, 4, v104
    v_and_b32 v85, 0x38, v85
    v_and_b32 v74, 16776192, v74
    v_lshlrev_b32 v83, 1, v105
    v_lshlrev_b32 v105, 4, v105
    v_and_b32 v86, 0x38, v86
    v_and_b32 v76, 16776192, v76
    s_lshl_b32 s56, s3, 3
    s_add_u32 s57, s56, 7
    v_lshrrev_b32 v114, 3, v1
    v_mul_u32_u24 v114, 48, v114
    s_waitcnt lgkmcnt(0)
    s_barrier
    ds_read_b64 v[108:109], v10 offset:0
    s_sub_u32 s58, s27, 1024
    s_cselect_b32 s58, 10238976, s58
    s_waitcnt lgkmcnt(0)
    v_add_u32 v110, v108, v109
    v_mov_b32 v111, v110
    v_and_b32 v12, 15, v1
    v_lshrrev_b32 v11, 2, v1
    v_add_u32_dpp v111, v111, v111 row_shr:1 row_mask:0xf bank_mask:0xf
    v_and_b32 v11, 8, v11
    v_xor_b32 v11, v11, v1
    v_add_u32_dpp v111, v111, v111 row_shr:2 row_mask:0xf bank_mask:0xf
    v_mov_b32 v115, s58
    v_mov_b32 v254, 0
    v_add_u32_dpp v111, v111, v111 row_shr:4 row_mask:0xf bank_mask:0xf
    v_lshlrev_b32 v11, 3, v11
    v_lshrrev_b32 v13, 2, v1
    v_add_u32_dpp v111, v111, v111 row_shr:8 row_mask:0xf bank_mask:0xf
    v_and_b32 v10, 3, v1
    v_lshl_or_b32 v13, v10, 4, v13
    v_add_u32_dpp v111, v111, v111 row_bcast:15 row_mask:0xa bank_mask:0xf
    v_lshlrev_b32 v10, 2, v10
    v_and_b32 v10, 8, v10
    v_add_u32_dpp v111, v111, v111 row_bcast:31 row_mask:0xc bank_mask:0xf
    v_sub_u32 v110, v111, v110
    v_readlane_b32 s51, v111, s57
    v_xor_b32 v10, v10, v13
    v_lshlrev_b32 v10, 3, v10
    v_mov_b32_dpp v112, v110 row_newbcast:0 row_mask:0xf bank_mask:0x3
    v_readlane_b32 s58, v110, s56
    s_nop 0
    v_mov_b32_dpp v112, v110 row_newbcast:8 row_mask:0xf bank_mask:0xc
    v_add_u32 v113, 15, v112
    v_and_b32 v113, -16, v113
    v_add_u32 v113, v113, v114
    v_sub_u32 v112, v113, v112
    v_add_u32 v112, v112, v110
    v_add_u32 v108, v112, v108
    v_lshl_or_b32 v108, v108, 16, v112
    v_readlane_b32 s50, v113, s56
    ds_bpermute_b32 v81, v81, v108
    ds_bpermute_b32 v82, v82, v108
    ds_bpermute_b32 v83, v83, v108
    s_sub_u32 s51, s51, s58
    s_add_u32 s56, s50, s51
    v_add_u32 v109, s56, v1
    v_lshlrev_b32 v110, 2, v109
    v_lshlrev_b32 v111, 4, v109
    s_mov_b64 exec, 0xfffff
    ds_write_b32 v110, v115 offset:4096
    ds_write_b8 v109, v4 offset:11840
    ds_write_b128 v111, v[4:7] offset:13824
    s_mov_b64 exec, s[40:41]
    s_waitcnt lgkmcnt(5)
    v_bfe_u32 v81, v81, v103, 16
    v_add_u32 v81, v81, v78
    v_lshlrev_b32 v78, 2, v81
    v_lshlrev_b32 v103, 4, v81
    ds_write_b32 v78, v72 offset:4096
    ds_write_b8 v81, v84 offset:11840
    s_mov_b64 exec, s[42:43]
    s_waitcnt lgkmcnt(6)
    v_bfe_u32 v82, v82, v104, 16
    v_add_u32 v82, v82, v79
    v_lshlrev_b32 v79, 2, v82
    v_lshlrev_b32 v104, 4, v82
    ds_write_b32 v79, v74 offset:4096
    ds_write_b8 v82, v85 offset:11840
    s_mov_b64 exec, s[44:45]
    s_waitcnt lgkmcnt(7)
    v_bfe_u32 v83, v83, v105, 16
    v_add_u32 v83, v83, v80
    v_lshlrev_b32 v80, 2, v83
    v_lshlrev_b32 v105, 4, v83
    ds_write_b32 v80, v76 offset:4096
    ds_write_b8 v83, v86 offset:11840
    s_mov_b64 exec, -1
    s_add_u32 s58, s3, 0
    v_cmp_eq_u32 vcc, s58, v2
    s_ff1_i32_b64 s58, vcc
    s_mul_i32 s58, s58, 1152
    s_add_u32 s58, s58, 106752
    v_add_u32 v106, s58, v15
    s_add_u32 s58, s3, 8
    v_cmp_eq_u32 vcc, s58, v2
    s_ff1_i32_b64 s58, vcc
    s_mul_i32 s58, s58, 1152
    s_add_u32 s58, s58, 106752
    v_add_u32 v107, s58, v15
    s_add_u32 s58, s3, 16
    v_cmp_eq_u32 vcc, s58, v2
    s_ff1_i32_b64 s58, vcc
    s_mul_i32 s58, s58, 1152
    s_add_u32 s58, s58, 106752
    v_add_u32 v116, s58, v15
    s_add_u32 s58, s3, 24
    v_cmp_eq_u32 vcc, s58, v2
    s_ff1_i32_b64 s58, vcc
    s_mul_i32 s58, s58, 1152
    s_add_u32 s58, s58, 106752
    v_add_u32 v117, s58, v15
    s_add_u32 s58, s3, 32
    v_cmp_eq_u32 vcc, s58, v2
    s_ff1_i32_b64 s58, vcc
    s_mul_i32 s58, s58, 1152
    s_add_u32 s58, s58, 106752
    v_add_u32 v118, s58, v15
    s_cmp_lt_u32 s3, 5
    s_cselect_b32 s56, 1, s47
    s_or_b32 s56, s56, s55
    s_cbranch_scc0 K_PW1
    s_waitcnt vmcnt(0)
K_PW1:
    s_waitcnt vmcnt(1)
    s_mov_b64 exec, s[40:41]
    ds_write_b128 v103, v[88:91] offset:13824
    s_mov_b64 exec, s[42:43]
    ds_write_b128 v104, v[92:95] offset:13824
    s_mov_b64 exec, s[44:45]
    ds_write_b128 v105, v[96:99] offset:13824
    s_mov_b64 exec, -1
    s_lshl_b32 s56, s50, 2
    s_add_u32 s56, s56, 4096
    v_mov_b32 v196, s56
    s_add_u32 s56, s50, 11840
    v_mov_b32 v197, s56
    s_lshl_b32 s56, s50, 5
    s_add_u32 s56, s56, 44800
    v_add_u32 v198, s56, v10
    v_add_u32 v11, s56, v11
    s_lshl_b32 s57, s50, 4
    s_add_u32 s57, s57, 13824
    v_lshl_add_u32 v199, v12, 4, s57
    v_add_u32 v10, s57, v9
    s_add_u32 s48, s51, 3
    s_lshr_b32 s48, s48, 2
    s_waitcnt lgkmcnt(0)
    s_barrier
    s_cmp_eq_u32 s48, 0
    s_cbranch_scc1 K2_LOOPDONE
    ds_read_b128 v[120:123], v196 offset:0
    ds_read_b128 v[124:127], v196 offset:16
    ds_read_b64 v[152:153], v10
    ds_read2_b64 v[188:191], v196 offset0:4 offset1:5
    ds_read_b64 v[186:187], v199 offset:8
    ds_read_b128 v[192:195], v197
    s_lshl_b32 s56, s48, 2
    s_waitcnt lgkmcnt(5)
    buffer_load_dwordx4 v[56:59], v120, s[28:31], 0 offen
    buffer_load_dwordx4 v[60:63], v121, s[28:31], 0 offen
    buffer_load_dwordx4 v[64:67], v122, s[28:31], 0 offen
    buffer_load_dwordx4 v[68:71], v123, s[28:31], 0 offen
    s_waitcnt lgkmcnt(4)
    buffer_load_dwordx4 v[72:75], v124, s[28:31], 0 offen
    buffer_load_dwordx4 v[76:79], v125, s[28:31], 0 offen
    buffer_load_dwordx4 v[80:83], v126, s[28:31], 0 offen
    buffer_load_dwordx4 v[84:87], v127, s[28:31], 0 offen
K_APREP:
    v_cmp_gt_u32 vcc, s56, v1
    s_waitcnt lgkmcnt(0)
    s_nop 0
    v_cndmask_b32 v160, 0, v152, vcc
    v_cndmask_b32 v161, 0, v153, vcc
    ds_read_b64 v[152:153], v10 offset:1024
    v_add_u32 v10, 1024, v10
    v_mfma_f32_16x16x16_bf16 v[136:139], v[232:233], v[160:161], 0
    v_mfma_f32_16x16x16_bf16 v[140:143], v[234:235], v[160:161], 0
    v_mfma_f32_16x16x16_bf16 v[144:147], v[236:237], v[160:161], 0
    v_mfma_f32_16x16x16_bf16 v[148:151], v[238:239], v[160:161], 0
    s_nop 4
    v_cvt_pk_bf16_f32 v168, v136, v137
    v_cvt_pk_bf16_f32 v169, v138, v139
    ds_write_b64 v11, v[168:169] offset:0
    s_sub_u32 s56, s56, 16
    s_cmp_le_i32 s56, 0
    s_cbranch_scc1 K_APDONE
    v_cvt_pk_bf16_f32 v170, v140, v141
    v_cvt_pk_bf16_f32 v171, v142, v143
    ds_write_b64 v11, v[170:171] offset:512
    s_sub_u32 s56, s56, 16
    s_cmp_le_i32 s56, 0
    s_cbranch_scc1 K_APDONE
    v_cvt_pk_bf16_f32 v172, v144, v145
    v_cvt_pk_bf16_f32 v173, v146, v147
    ds_write_b64 v11, v[172:173] offset:1024
    s_sub_u32 s56, s56, 16
    s_cmp_le_i32 s56, 0
    s_cbranch_scc1 K_APDONE
    v_cvt_pk_bf16_f32 v174, v148, v149
    v_cvt_pk_bf16_f32 v175, v150, v151
    ds_write_b64 v11, v[174:175] offset:1536
    s_sub_u32 s56, s56, 16
    s_cmp_le_i32 s56, 0
    s_cbranch_scc1 K_APDONE
    v_add_u32 v11, 2048, v11
    s_branch K_APREP
K_APDONE:
    s_waitcnt lgkmcnt(0)
    ds_read_b64 v[184:185], v198
    v_mfma_f32_4x4x4_16b_bf16 v[152:155], v[186:187], v[176:177], 0 cbsz:4 abid:0
    v_mfma_f32_4x4x4_16b_bf16 v[156:159], v[186:187], v[180:181], 0 cbsz:4 abid:0
    s_sub_u32 s48, s48, 3
    s_nop 2
    s_cbranch_scc1 K2_D0
.p2align 4
K2_LOOP:
    s_waitcnt vmcnt(6) lgkmcnt(0)
    v_subrev_u32 v255, s27, v188
    v_cmp_gt_u32 vcc, v255, v254
    ds_write_b32 v252, v255 offset:2048
    s_setprio 0
    s_cbranch_vccnz K2_P0
    s_setprio 1
K2_P0:
    v_mfma_f32_4x4x4_16b_bf16 v[120:123], v[184:185], v[56:57], 0 cbsz:4 abid:0
    v_exp_f32 v168, v152
    v_mfma_f32_4x4x4_16b_bf16 v[124:127], v[184:185], v[58:59], 0 cbsz:4 abid:0
    v_exp_f32 v169, v153
    v_mfma_f32_4x4x4_16b_bf16 v[128:131], v[184:185], v[60:61], 0 cbsz:4 abid:1
    v_exp_f32 v170, v154
    v_mfma_f32_4x4x4_16b_bf16 v[132:135], v[184:185], v[62:63], 0 cbsz:4 abid:1
    buffer_load_dwordx4 v[56:59], v188, s[28:31], 0 offen
    buffer_load_dwordx4 v[60:63], v189, s[28:31], 0 offen
    v_exp_f32 v171, v155
    s_waitcnt vmcnt(6)
    v_mfma_f32_4x4x4_16b_bf16 v[136:139], v[184:185], v[64:65], 0 cbsz:4 abid:2
    v_exp_f32 v172, v156
    v_mfma_f32_4x4x4_16b_bf16 v[140:143], v[184:185], v[66:67], 0 cbsz:4 abid:2
    v_exp_f32 v173, v157
    v_exp_f32 v174, v158
    v_exp_f32 v175, v159
    v_pk_add_f32 v[168:169], v[168:169], 1.0 op_sel_hi:[1,0]
    v_pk_add_f32 v[170:171], v[170:171], 1.0 op_sel_hi:[1,0]
    v_pk_add_f32 v[172:173], v[172:173], 1.0 op_sel_hi:[1,0]
    v_pk_add_f32 v[174:175], v[174:175], 1.0 op_sel_hi:[1,0]
    v_mfma_f32_4x4x4_16b_bf16 v[144:147], v[184:185], v[68:69], 0 cbsz:4 abid:3
    v_rcp_f32 v168, v168
    v_mfma_f32_4x4x4_16b_bf16 v[148:151], v[184:185], v[70:71], 0 cbsz:4 abid:3
    buffer_load_dwordx4 v[64:67], v190, s[28:31], 0 offen
    buffer_load_dwordx4 v[68:71], v191, s[28:31], 0 offen
    v_rcp_f32 v169, v169
    ds_read_b128 v[188:191], v196 offset:48
    v_mfma_f32_4x4x4_16b_bf16 v[160:163], v[186:187], v[176:177], 0 cbsz:4 abid:1
    v_rcp_f32 v170, v170
    v_mfma_f32_4x4x4_16b_bf16 v[164:167], v[186:187], v[180:181], 0 cbsz:4 abid:1
    v_rcp_f32 v171, v171
    v_rcp_f32 v172, v172
    v_rcp_f32 v173, v173
    v_rcp_f32 v174, v174
    v_rcp_f32 v175, v175
    v_readfirstlane_b32 s49, v192
    v_pk_mul_f32 v[168:169], v[168:169], v[152:153]
    v_pk_mul_f32 v[170:171], v[170:171], v[154:155]
    v_pk_mul_f32 v[172:173], v[172:173], v[156:157]
    v_pk_mul_f32 v[174:175], v[174:175], v[158:159]
    s_set_gpr_idx_on s49, gpr_idx(SRC2,DST)
    v_pk_fma_f32 v[16:17], v[168:169], v[120:121], v[16:17] op_sel:[0,0,0] op_sel_hi:[0,1,1]
    v_pk_fma_f32 v[18:19], v[168:169], v[122:123], v[18:19] op_sel:[0,0,0] op_sel_hi:[0,1,1]
    v_pk_fma_f32 v[20:21], v[172:173], v[124:125], v[20:21] op_sel:[0,0,0] op_sel_hi:[0,1,1]
    v_pk_fma_f32 v[22:23], v[172:173], v[126:127], v[22:23] op_sel:[0,0,0] op_sel_hi:[0,1,1]
    s_lshr_b32 s49, s49, 8
    s_set_gpr_idx_idx s49
    v_pk_fma_f32 v[16:17], v[168:169], v[128:129], v[16:17] op_sel:[1,0,0] op_sel_hi:[1,1,1]
    v_pk_fma_f32 v[18:19], v[168:169], v[130:131], v[18:19] op_sel:[1,0,0] op_sel_hi:[1,1,1]
    v_pk_fma_f32 v[20:21], v[172:173], v[132:133], v[20:21] op_sel:[1,0,0] op_sel_hi:[1,1,1]
    v_pk_fma_f32 v[22:23], v[172:173], v[134:135], v[22:23] op_sel:[1,0,0] op_sel_hi:[1,1,1]
    s_lshr_b32 s49, s49, 8
    s_set_gpr_idx_idx s49
    v_pk_fma_f32 v[16:17], v[170:171], v[136:137], v[16:17] op_sel:[0,0,0] op_sel_hi:[0,1,1]
    v_pk_fma_f32 v[18:19], v[170:171], v[138:139], v[18:19] op_sel:[0,0,0] op_sel_hi:[0,1,1]
    v_pk_fma_f32 v[20:21], v[174:175], v[140:141], v[20:21] op_sel:[0,0,0] op_sel_hi:[0,1,1]
    v_pk_fma_f32 v[22:23], v[174:175], v[142:143], v[22:23] op_sel:[0,0,0] op_sel_hi:[0,1,1]
    s_lshr_b32 s49, s49, 8
    s_set_gpr_idx_idx s49
    v_pk_fma_f32 v[16:17], v[170:171], v[144:145], v[16:17] op_sel:[1,0,0] op_sel_hi:[1,1,1]
    v_pk_fma_f32 v[18:19], v[170:171], v[146:147], v[18:19] op_sel:[1,0,0] op_sel_hi:[1,1,1]
    v_pk_fma_f32 v[20:21], v[174:175], v[148:149], v[20:21] op_sel:[1,0,0] op_sel_hi:[1,1,1]
    v_pk_fma_f32 v[22:23], v[174:175], v[150:151], v[22:23] op_sel:[1,0,0] op_sel_hi:[1,1,1]
    s_set_gpr_idx_off
    s_sub_u32 s48, s48, 1
    s_cbranch_scc1 K2_D1
    s_waitcnt vmcnt(6) lgkmcnt(0)
    v_mfma_f32_4x4x4_16b_bf16 v[120:123], v[184:185], v[72:73], 0 cbsz:4 abid:4
    v_exp_f32 v168, v160
    v_mfma_f32_4x4x4_16b_bf16 v[124:127], v[184:185], v[74:75], 0 cbsz:4 abid:4
    v_exp_f32 v169, v161
    v_mfma_f32_4x4x4_16b_bf16 v[128:131], v[184:185], v[76:77], 0 cbsz:4 abid:5
    v_exp_f32 v170, v162
    v_mfma_f32_4x4x4_16b_bf16 v[132:135], v[184:185], v[78:79], 0 cbsz:4 abid:5
    buffer_load_dwordx4 v[72:75], v188, s[28:31], 0 offen
    buffer_load_dwordx4 v[76:79], v189, s[28:31], 0 offen
    v_exp_f32 v171, v163
    s_waitcnt vmcnt(6)
    v_mfma_f32_4x4x4_16b_bf16 v[136:139], v[184:185], v[80:81], 0 cbsz:4 abid:6
    v_exp_f32 v172, v164
    v_mfma_f32_4x4x4_16b_bf16 v[140:143], v[184:185], v[82:83], 0 cbsz:4 abid:6
    v_exp_f32 v173, v165
    v_exp_f32 v174, v166
    v_exp_f32 v175, v167
    v_pk_add_f32 v[168:169], v[168:169], 1.0 op_sel_hi:[1,0]
    v_pk_add_f32 v[170:171], v[170:171], 1.0 op_sel_hi:[1,0]
    v_pk_add_f32 v[172:173], v[172:173], 1.0 op_sel_hi:[1,0]
    v_pk_add_f32 v[174:175], v[174:175], 1.0 op_sel_hi:[1,0]
    v_mfma_f32_4x4x4_16b_bf16 v[144:147], v[184:185], v[84:85], 0 cbsz:4 abid:7
    v_rcp_f32 v168, v168
    v_mfma_f32_4x4x4_16b_bf16 v[148:151], v[184:185], v[86:87], 0 cbsz:4 abid:7
    buffer_load_dwordx4 v[80:83], v190, s[28:31], 0 offen
    buffer_load_dwordx4 v[84:87], v191, s[28:31], 0 offen
    v_rcp_f32 v169, v169
    ds_read_b128 v[188:191], v196 offset:64
    ds_read_b32 v254, v253 offset:2048
    v_mfma_f32_4x4x4_16b_bf16 v[152:155], v[186:187], v[176:177], 0 cbsz:4 abid:2
    v_rcp_f32 v170, v170
    v_mfma_f32_4x4x4_16b_bf16 v[156:159], v[186:187], v[180:181], 0 cbsz:4 abid:2
    v_rcp_f32 v171, v171
    v_rcp_f32 v172, v172
    v_rcp_f32 v173, v173
    v_rcp_f32 v174, v174
    v_rcp_f32 v175, v175
    v_readfirstlane_b32 s49, v193
    v_pk_mul_f32 v[168:169], v[168:169], v[160:161]
    v_pk_mul_f32 v[170:171], v[170:171], v[162:163]
    v_pk_mul_f32 v[172:173], v[172:173], v[164:165]
    v_pk_mul_f32 v[174:175], v[174:175], v[166:167]
    s_set_gpr_idx_on s49, gpr_idx(SRC2,DST)
    v_pk_fma_f32 v[16:17], v[168:169], v[120:121], v[16:17] op_sel:[0,0,0] op_sel_hi:[0,1,1]
    v_pk_fma_f32 v[18:19], v[168:169], v[122:123], v[18:19] op_sel:[0,0,0] op_sel_hi:[0,1,1]
    v_pk_fma_f32 v[20:21], v[172:173], v[124:125], v[20:21] op_sel:[0,0,0] op_sel_hi:[0,1,1]
    v_pk_fma_f32 v[22:23], v[172:173], v[126:127], v[22:23] op_sel:[0,0,0] op_sel_hi:[0,1,1]
    s_lshr_b32 s49, s49, 8
    s_set_gpr_idx_idx s49
    v_pk_fma_f32 v[16:17], v[168:169], v[128:129], v[16:17] op_sel:[1,0,0] op_sel_hi:[1,1,1]
    v_pk_fma_f32 v[18:19], v[168:169], v[130:131], v[18:19] op_sel:[1,0,0] op_sel_hi:[1,1,1]
    v_pk_fma_f32 v[20:21], v[172:173], v[132:133], v[20:21] op_sel:[1,0,0] op_sel_hi:[1,1,1]
    v_pk_fma_f32 v[22:23], v[172:173], v[134:135], v[22:23] op_sel:[1,0,0] op_sel_hi:[1,1,1]
    s_lshr_b32 s49, s49, 8
    s_set_gpr_idx_idx s49
    v_pk_fma_f32 v[16:17], v[170:171], v[136:137], v[16:17] op_sel:[0,0,0] op_sel_hi:[0,1,1]
    v_pk_fma_f32 v[18:19], v[170:171], v[138:139], v[18:19] op_sel:[0,0,0] op_sel_hi:[0,1,1]
    v_pk_fma_f32 v[20:21], v[174:175], v[140:141], v[20:21] op_sel:[0,0,0] op_sel_hi:[0,1,1]
    v_pk_fma_f32 v[22:23], v[174:175], v[142:143], v[22:23] op_sel:[0,0,0] op_sel_hi:[0,1,1]
    s_lshr_b32 s49, s49, 8
    s_set_gpr_idx_idx s49
    v_pk_fma_f32 v[16:17], v[170:171], v[144:145], v[16:17] op_sel:[1,0,0] op_sel_hi:[1,1,1]
    v_pk_fma_f32 v[18:19], v[170:171], v[146:147], v[18:19] op_sel:[1,0,0] op_sel_hi:[1,1,1]
    v_pk_fma_f32 v[20:21], v[174:175], v[148:149], v[20:21] op_sel:[1,0,0] op_sel_hi:[1,1,1]
    v_pk_fma_f32 v[22:23], v[174:175], v[150:151], v[22:23] op_sel:[1,0,0] op_sel_hi:[1,1,1]
    s_set_gpr_idx_off
    s_sub_u32 s48, s48, 1
    s_cbranch_scc1 K2_D2
    s_waitcnt vmcnt(6) lgkmcnt(0)
    v_subrev_u32 v255, s27, v188
    v_cmp_gt_u32 vcc, v255, v254
    ds_write_b32 v252, v255 offset:2048
    s_setprio 0
    s_cbranch_vccnz K2_P2
    s_setprio 1
K2_P2:
    v_mfma_f32_4x4x4_16b_bf16 v[120:123], v[184:185], v[56:57], 0 cbsz:4 abid:8
    v_exp_f32 v168, v152
    v_mfma_f32_4x4x4_16b_bf16 v[124:127], v[184:185], v[58:59], 0 cbsz:4 abid:8
    v_exp_f32 v169, v153
    v_mfma_f32_4x4x4_16b_bf16 v[128:131], v[184:185], v[60:61], 0 cbsz:4 abid:9
    v_exp_f32 v170, v154
    v_mfma_f32_4x4x4_16b_bf16 v[132:135], v[184:185], v[62:63], 0 cbsz:4 abid:9
    buffer_load_dwordx4 v[56:59], v188, s[28:31], 0 offen
    buffer_load_dwordx4 v[60:63], v189, s[28:31], 0 offen
    v_exp_f32 v171, v155
    s_waitcnt vmcnt(6)
    v_mfma_f32_4x4x4_16b_bf16 v[136:139], v[184:185], v[64:65], 0 cbsz:4 abid:10
    v_exp_f32 v172, v156
    v_mfma_f32_4x4x4_16b_bf16 v[140:143], v[184:185], v[66:67], 0 cbsz:4 abid:10
    v_exp_f32 v173, v157
    v_exp_f32 v174, v158
    v_exp_f32 v175, v159
    v_pk_add_f32 v[168:169], v[168:169], 1.0 op_sel_hi:[1,0]
    v_pk_add_f32 v[170:171], v[170:171], 1.0 op_sel_hi:[1,0]
    v_pk_add_f32 v[172:173], v[172:173], 1.0 op_sel_hi:[1,0]
    v_pk_add_f32 v[174:175], v[174:175], 1.0 op_sel_hi:[1,0]
    v_mfma_f32_4x4x4_16b_bf16 v[144:147], v[184:185], v[68:69], 0 cbsz:4 abid:11
    v_rcp_f32 v168, v168
    v_mfma_f32_4x4x4_16b_bf16 v[148:151], v[184:185], v[70:71], 0 cbsz:4 abid:11
    buffer_load_dwordx4 v[64:67], v190, s[28:31], 0 offen
    buffer_load_dwordx4 v[68:71], v191, s[28:31], 0 offen
    v_rcp_f32 v169, v169
    ds_read_b128 v[188:191], v196 offset:80
    v_mfma_f32_4x4x4_16b_bf16 v[160:163], v[186:187], v[176:177], 0 cbsz:4 abid:3
    v_rcp_f32 v170, v170
    v_mfma_f32_4x4x4_16b_bf16 v[164:167], v[186:187], v[180:181], 0 cbsz:4 abid:3
    v_rcp_f32 v171, v171
    v_rcp_f32 v172, v172
    ds_read_b64 v[186:187], v199 offset:264
    v_rcp_f32 v173, v173
    v_rcp_f32 v174, v174
    v_rcp_f32 v175, v175
    v_readfirstlane_b32 s49, v194
    v_pk_mul_f32 v[168:169], v[168:169], v[152:153]
    v_pk_mul_f32 v[170:171], v[170:171], v[154:155]
    v_pk_mul_f32 v[172:173], v[172:173], v[156:157]
    v_pk_mul_f32 v[174:175], v[174:175], v[158:159]
    s_set_gpr_idx_on s49, gpr_idx(SRC2,DST)
    v_pk_fma_f32 v[16:17], v[168:169], v[120:121], v[16:17] op_sel:[0,0,0] op_sel_hi:[0,1,1]
    v_pk_fma_f32 v[18:19], v[168:169], v[122:123], v[18:19] op_sel:[0,0,0] op_sel_hi:[0,1,1]
    v_pk_fma_f32 v[20:21], v[172:173], v[124:125], v[20:21] op_sel:[0,0,0] op_sel_hi:[0,1,1]
    v_pk_fma_f32 v[22:23], v[172:173], v[126:127], v[22:23] op_sel:[0,0,0] op_sel_hi:[0,1,1]
    s_lshr_b32 s49, s49, 8
    s_set_gpr_idx_idx s49
    v_pk_fma_f32 v[16:17], v[168:169], v[128:129], v[16:17] op_sel:[1,0,0] op_sel_hi:[1,1,1]
    v_pk_fma_f32 v[18:19], v[168:169], v[130:131], v[18:19] op_sel:[1,0,0] op_sel_hi:[1,1,1]
    v_pk_fma_f32 v[20:21], v[172:173], v[132:133], v[20:21] op_sel:[1,0,0] op_sel_hi:[1,1,1]
    v_pk_fma_f32 v[22:23], v[172:173], v[134:135], v[22:23] op_sel:[1,0,0] op_sel_hi:[1,1,1]
    s_lshr_b32 s49, s49, 8
    s_set_gpr_idx_idx s49
    v_pk_fma_f32 v[16:17], v[170:171], v[136:137], v[16:17] op_sel:[0,0,0] op_sel_hi:[0,1,1]
    v_pk_fma_f32 v[18:19], v[170:171], v[138:139], v[18:19] op_sel:[0,0,0] op_sel_hi:[0,1,1]
    v_pk_fma_f32 v[20:21], v[174:175], v[140:141], v[20:21] op_sel:[0,0,0] op_sel_hi:[0,1,1]
    v_pk_fma_f32 v[22:23], v[174:175], v[142:143], v[22:23] op_sel:[0,0,0] op_sel_hi:[0,1,1]
    s_lshr_b32 s49, s49, 8
    s_set_gpr_idx_idx s49
    v_pk_fma_f32 v[16:17], v[170:171], v[144:145], v[16:17] op_sel:[1,0,0] op_sel_hi:[1,1,1]
    v_pk_fma_f32 v[18:19], v[170:171], v[146:147], v[18:19] op_sel:[1,0,0] op_sel_hi:[1,1,1]
    v_pk_fma_f32 v[20:21], v[174:175], v[148:149], v[20:21] op_sel:[1,0,0] op_sel_hi:[1,1,1]
    v_pk_fma_f32 v[22:23], v[174:175], v[150:151], v[22:23] op_sel:[1,0,0] op_sel_hi:[1,1,1]
    s_set_gpr_idx_off
    s_sub_u32 s48, s48, 1
    s_cbranch_scc1 K2_D3
    s_waitcnt vmcnt(6) lgkmcnt(0)
    v_mfma_f32_4x4x4_16b_bf16 v[120:123], v[184:185], v[72:73], 0 cbsz:4 abid:12
    v_exp_f32 v168, v160
    v_mfma_f32_4x4x4_16b_bf16 v[124:127], v[184:185], v[74:75], 0 cbsz:4 abid:12
    v_exp_f32 v169, v161
    v_mfma_f32_4x4x4_16b_bf16 v[128:131], v[184:185], v[76:77], 0 cbsz:4 abid:13
    v_exp_f32 v170, v162
    v_mfma_f32_4x4x4_16b_bf16 v[132:135], v[184:185], v[78:79], 0 cbsz:4 abid:13
    buffer_load_dwordx4 v[72:75], v188, s[28:31], 0 offen
    buffer_load_dwordx4 v[76:79], v189, s[28:31], 0 offen
    v_exp_f32 v171, v163
    s_waitcnt vmcnt(6)
    v_mfma_f32_4x4x4_16b_bf16 v[136:139], v[184:185], v[80:81], 0 cbsz:4 abid:14
    v_exp_f32 v172, v164
    v_mfma_f32_4x4x4_16b_bf16 v[140:143], v[184:185], v[82:83], 0 cbsz:4 abid:14
    v_exp_f32 v173, v165
    v_exp_f32 v174, v166
    v_exp_f32 v175, v167
    v_pk_add_f32 v[168:169], v[168:169], 1.0 op_sel_hi:[1,0]
    v_pk_add_f32 v[170:171], v[170:171], 1.0 op_sel_hi:[1,0]
    v_pk_add_f32 v[172:173], v[172:173], 1.0 op_sel_hi:[1,0]
    v_pk_add_f32 v[174:175], v[174:175], 1.0 op_sel_hi:[1,0]
    v_mfma_f32_4x4x4_16b_bf16 v[144:147], v[184:185], v[84:85], 0 cbsz:4 abid:15
    v_rcp_f32 v168, v168
    v_mfma_f32_4x4x4_16b_bf16 v[148:151], v[184:185], v[86:87], 0 cbsz:4 abid:15
    buffer_load_dwordx4 v[80:83], v190, s[28:31], 0 offen
    buffer_load_dwordx4 v[84:87], v191, s[28:31], 0 offen
    v_rcp_f32 v169, v169
    ds_read_b128 v[188:191], v196 offset:96
    ds_read_b64 v[184:185], v198 offset:512
    ds_read_b32 v254, v253 offset:2048
    v_mfma_f32_4x4x4_16b_bf16 v[152:155], v[186:187], v[176:177], 0 cbsz:4 abid:0
    v_rcp_f32 v170, v170
    v_mfma_f32_4x4x4_16b_bf16 v[156:159], v[186:187], v[180:181], 0 cbsz:4 abid:0
    v_rcp_f32 v171, v171
    v_rcp_f32 v172, v172
    v_rcp_f32 v173, v173
    v_rcp_f32 v174, v174
    v_rcp_f32 v175, v175
    v_readfirstlane_b32 s49, v195
    ds_read_b128 v[192:195], v197 offset:16
    v_add_u32 v196, 64, v196
    v_add_u32 v197, 16, v197
    v_add_u32 v198, 512, v198
    v_add_u32 v199, 256, v199
    v_pk_mul_f32 v[168:169], v[168:169], v[160:161]
    v_pk_mul_f32 v[170:171], v[170:171], v[162:163]
    v_pk_mul_f32 v[172:173], v[172:173], v[164:165]
    v_pk_mul_f32 v[174:175], v[174:175], v[166:167]
    s_set_gpr_idx_on s49, gpr_idx(SRC2,DST)
    v_pk_fma_f32 v[16:17], v[168:169], v[120:121], v[16:17] op_sel:[0,0,0] op_sel_hi:[0,1,1]
    v_pk_fma_f32 v[18:19], v[168:169], v[122:123], v[18:19] op_sel:[0,0,0] op_sel_hi:[0,1,1]
    v_pk_fma_f32 v[20:21], v[172:173], v[124:125], v[20:21] op_sel:[0,0,0] op_sel_hi:[0,1,1]
    v_pk_fma_f32 v[22:23], v[172:173], v[126:127], v[22:23] op_sel:[0,0,0] op_sel_hi:[0,1,1]
    s_lshr_b32 s49, s49, 8
    s_set_gpr_idx_idx s49
    v_pk_fma_f32 v[16:17], v[168:169], v[128:129], v[16:17] op_sel:[1,0,0] op_sel_hi:[1,1,1]
    v_pk_fma_f32 v[18:19], v[168:169], v[130:131], v[18:19] op_sel:[1,0,0] op_sel_hi:[1,1,1]
    v_pk_fma_f32 v[20:21], v[172:173], v[132:133], v[20:21] op_sel:[1,0,0] op_sel_hi:[1,1,1]
    v_pk_fma_f32 v[22:23], v[172:173], v[134:135], v[22:23] op_sel:[1,0,0] op_sel_hi:[1,1,1]
    s_lshr_b32 s49, s49, 8
    s_set_gpr_idx_idx s49
    v_pk_fma_f32 v[16:17], v[170:171], v[136:137], v[16:17] op_sel:[0,0,0] op_sel_hi:[0,1,1]
    v_pk_fma_f32 v[18:19], v[170:171], v[138:139], v[18:19] op_sel:[0,0,0] op_sel_hi:[0,1,1]
    v_pk_fma_f32 v[20:21], v[174:175], v[140:141], v[20:21] op_sel:[0,0,0] op_sel_hi:[0,1,1]
    v_pk_fma_f32 v[22:23], v[174:175], v[142:143], v[22:23] op_sel:[0,0,0] op_sel_hi:[0,1,1]
    s_lshr_b32 s49, s49, 8
    s_set_gpr_idx_idx s49
    v_pk_fma_f32 v[16:17], v[170:171], v[144:145], v[16:17] op_sel:[1,0,0] op_sel_hi:[1,1,1]
    v_pk_fma_f32 v[18:19], v[170:171], v[146:147], v[18:19] op_sel:[1,0,0] op_sel_hi:[1,1,1]
    v_pk_fma_f32 v[20:21], v[174:175], v[148:149], v[20:21] op_sel:[1,0,0] op_sel_hi:[1,1,1]
    v_pk_fma_f32 v[22:23], v[174:175], v[150:151], v[22:23] op_sel:[1,0,0] op_sel_hi:[1,1,1]
    s_set_gpr_idx_off
    s_sub_u32 s48, s48, 1
    s_cbranch_scc0 K2_LOOP
K2_D0:
    s_cmp_eq_u32 s48, -1
    s_cbranch_scc1 K2_WA0
    s_waitcnt vmcnt(2)
K2_WA0:
    s_waitcnt vmcnt(6) lgkmcnt(0)
    v_mfma_f32_4x4x4_16b_bf16 v[120:123], v[184:185], v[56:57], 0 cbsz:4 abid:0
    v_exp_f32 v168, v152
    v_mfma_f32_4x4x4_16b_bf16 v[124:127], v[184:185], v[58:59], 0 cbsz:4 abid:0
    v_exp_f32 v169, v153
    v_mfma_f32_4x4x4_16b_bf16 v[128:131], v[184:185], v[60:61], 0 cbsz:4 abid:1
    v_exp_f32 v170, v154
    v_mfma_f32_4x4x4_16b_bf16 v[132:135], v[184:185], v[62:63], 0 cbsz:4 abid:1
    v_exp_f32 v171, v155
    s_cmp_eq_u32 s48, -1
    s_cbranch_scc1 K2_WB0
    s_waitcnt vmcnt(0)
K2_WB0:
    s_waitcnt vmcnt(4)
    v_mfma_f32_4x4x4_16b_bf16 v[136:139], v[184:185], v[64:65], 0 cbsz:4 abid:2
    v_exp_f32 v172, v156
    v_mfma_f32_4x4x4_16b_bf16 v[140:143], v[184:185], v[66:67], 0 cbsz:4 abid:2
    v_exp_f32 v173, v157
    v_exp_f32 v174, v158
    v_exp_f32 v175, v159
    v_pk_add_f32 v[168:169], v[168:169], 1.0 op_sel_hi:[1,0]
    v_pk_add_f32 v[170:171], v[170:171], 1.0 op_sel_hi:[1,0]
    v_pk_add_f32 v[172:173], v[172:173], 1.0 op_sel_hi:[1,0]
    v_pk_add_f32 v[174:175], v[174:175], 1.0 op_sel_hi:[1,0]
    v_mfma_f32_4x4x4_16b_bf16 v[144:147], v[184:185], v[68:69], 0 cbsz:4 abid:3
    v_rcp_f32 v168, v168
    v_mfma_f32_4x4x4_16b_bf16 v[148:151], v[184:185], v[70:71], 0 cbsz:4 abid:3
    v_rcp_f32 v169, v169
    v_mfma_f32_4x4x4_16b_bf16 v[160:163], v[186:187], v[176:177], 0 cbsz:4 abid:1
    v_rcp_f32 v170, v170
    v_mfma_f32_4x4x4_16b_bf16 v[164:167], v[186:187], v[180:181], 0 cbsz:4 abid:1
    v_rcp_f32 v171, v171
    v_rcp_f32 v172, v172
    v_rcp_f32 v173, v173
    v_rcp_f32 v174, v174
    v_rcp_f32 v175, v175
    v_readfirstlane_b32 s49, v192
    v_pk_mul_f32 v[168:169], v[168:169], v[152:153]
    v_pk_mul_f32 v[170:171], v[170:171], v[154:155]
    v_pk_mul_f32 v[172:173], v[172:173], v[156:157]
    v_pk_mul_f32 v[174:175], v[174:175], v[158:159]
    s_set_gpr_idx_on s49, gpr_idx(SRC2,DST)
    v_pk_fma_f32 v[16:17], v[168:169], v[120:121], v[16:17] op_sel:[0,0,0] op_sel_hi:[0,1,1]
    v_pk_fma_f32 v[18:19], v[168:169], v[122:123], v[18:19] op_sel:[0,0,0] op_sel_hi:[0,1,1]
    v_pk_fma_f32 v[20:21], v[172:173], v[124:125], v[20:21] op_sel:[0,0,0] op_sel_hi:[0,1,1]
    v_pk_fma_f32 v[22:23], v[172:173], v[126:127], v[22:23] op_sel:[0,0,0] op_sel_hi:[0,1,1]
    s_lshr_b32 s49, s49, 8
    s_set_gpr_idx_idx s49
    v_pk_fma_f32 v[16:17], v[168:169], v[128:129], v[16:17] op_sel:[1,0,0] op_sel_hi:[1,1,1]
    v_pk_fma_f32 v[18:19], v[168:169], v[130:131], v[18:19] op_sel:[1,0,0] op_sel_hi:[1,1,1]
    v_pk_fma_f32 v[20:21], v[172:173], v[132:133], v[20:21] op_sel:[1,0,0] op_sel_hi:[1,1,1]
    v_pk_fma_f32 v[22:23], v[172:173], v[134:135], v[22:23] op_sel:[1,0,0] op_sel_hi:[1,1,1]
    s_lshr_b32 s49, s49, 8
    s_set_gpr_idx_idx s49
    v_pk_fma_f32 v[16:17], v[170:171], v[136:137], v[16:17] op_sel:[0,0,0] op_sel_hi:[0,1,1]
    v_pk_fma_f32 v[18:19], v[170:171], v[138:139], v[18:19] op_sel:[0,0,0] op_sel_hi:[0,1,1]
    v_pk_fma_f32 v[20:21], v[174:175], v[140:141], v[20:21] op_sel:[0,0,0] op_sel_hi:[0,1,1]
    v_pk_fma_f32 v[22:23], v[174:175], v[142:143], v[22:23] op_sel:[0,0,0] op_sel_hi:[0,1,1]
    s_lshr_b32 s49, s49, 8
    s_set_gpr_idx_idx s49
    v_pk_fma_f32 v[16:17], v[170:171], v[144:145], v[16:17] op_sel:[1,0,0] op_sel_hi:[1,1,1]
    v_pk_fma_f32 v[18:19], v[170:171], v[146:147], v[18:19] op_sel:[1,0,0] op_sel_hi:[1,1,1]
    v_pk_fma_f32 v[20:21], v[174:175], v[148:149], v[20:21] op_sel:[1,0,0] op_sel_hi:[1,1,1]
    v_pk_fma_f32 v[22:23], v[174:175], v[150:151], v[22:23] op_sel:[1,0,0] op_sel_hi:[1,1,1]
    s_set_gpr_idx_off
    s_sub_u32 s48, s48, 1
    s_cmp_eq_u32 s48, -3
    s_cbranch_scc1 K2_LOOPDONE
K2_D1:
    s_cmp_eq_u32 s48, -1
    s_cbranch_scc1 K2_WA1
    s_waitcnt vmcnt(2)
K2_WA1:
    s_waitcnt vmcnt(6) lgkmcnt(0)
    v_mfma_f32_4x4x4_16b_bf16 v[120:123], v[184:185], v[72:73], 0 cbsz:4 abid:4
    v_exp_f32 v168, v160
    v_mfma_f32_4x4x4_16b_bf16 v[124:127], v[184:185], v[74:75], 0 cbsz:4 abid:4
    v_exp_f32 v169, v161
    v_mfma_f32_4x4x4_16b_bf16 v[128:131], v[184:185], v[76:77], 0 cbsz:4 abid:5
    v_exp_f32 v170, v162
    v_mfma_f32_4x4x4_16b_bf16 v[132:135], v[184:185], v[78:79], 0 cbsz:4 abid:5
    v_exp_f32 v171, v163
    s_cmp_eq_u32 s48, -1
    s_cbranch_scc1 K2_WB1
    s_waitcnt vmcnt(0)
K2_WB1:
    s_waitcnt vmcnt(4)
    v_mfma_f32_4x4x4_16b_bf16 v[136:139], v[184:185], v[80:81], 0 cbsz:4 abid:6
    v_exp_f32 v172, v164
    v_mfma_f32_4x4x4_16b_bf16 v[140:143], v[184:185], v[82:83], 0 cbsz:4 abid:6
    v_exp_f32 v173, v165
    v_exp_f32 v174, v166
    v_exp_f32 v175, v167
    v_pk_add_f32 v[168:169], v[168:169], 1.0 op_sel_hi:[1,0]
    v_pk_add_f32 v[170:171], v[170:171], 1.0 op_sel_hi:[1,0]
    v_pk_add_f32 v[172:173], v[172:173], 1.0 op_sel_hi:[1,0]
    v_pk_add_f32 v[174:175], v[174:175], 1.0 op_sel_hi:[1,0]
    v_mfma_f32_4x4x4_16b_bf16 v[144:147], v[184:185], v[84:85], 0 cbsz:4 abid:7
    v_rcp_f32 v168, v168
    v_mfma_f32_4x4x4_16b_bf16 v[148:151], v[184:185], v[86:87], 0 cbsz:4 abid:7
    v_rcp_f32 v169, v169
    v_mfma_f32_4x4x4_16b_bf16 v[152:155], v[186:187], v[176:177], 0 cbsz:4 abid:2
    v_rcp_f32 v170, v170
    v_mfma_f32_4x4x4_16b_bf16 v[156:159], v[186:187], v[180:181], 0 cbsz:4 abid:2
    v_rcp_f32 v171, v171
    v_rcp_f32 v172, v172
    v_rcp_f32 v173, v173
    v_rcp_f32 v174, v174
    v_rcp_f32 v175, v175
    v_readfirstlane_b32 s49, v193
    v_pk_mul_f32 v[168:169], v[168:169], v[160:161]
    v_pk_mul_f32 v[170:171], v[170:171], v[162:163]
    v_pk_mul_f32 v[172:173], v[172:173], v[164:165]
    v_pk_mul_f32 v[174:175], v[174:175], v[166:167]
    s_set_gpr_idx_on s49, gpr_idx(SRC2,DST)
    v_pk_fma_f32 v[16:17], v[168:169], v[120:121], v[16:17] op_sel:[0,0,0] op_sel_hi:[0,1,1]
    v_pk_fma_f32 v[18:19], v[168:169], v[122:123], v[18:19] op_sel:[0,0,0] op_sel_hi:[0,1,1]
    v_pk_fma_f32 v[20:21], v[172:173], v[124:125], v[20:21] op_sel:[0,0,0] op_sel_hi:[0,1,1]
    v_pk_fma_f32 v[22:23], v[172:173], v[126:127], v[22:23] op_sel:[0,0,0] op_sel_hi:[0,1,1]
    s_lshr_b32 s49, s49, 8
    s_set_gpr_idx_idx s49
    v_pk_fma_f32 v[16:17], v[168:169], v[128:129], v[16:17] op_sel:[1,0,0] op_sel_hi:[1,1,1]
    v_pk_fma_f32 v[18:19], v[168:169], v[130:131], v[18:19] op_sel:[1,0,0] op_sel_hi:[1,1,1]
    v_pk_fma_f32 v[20:21], v[172:173], v[132:133], v[20:21] op_sel:[1,0,0] op_sel_hi:[1,1,1]
    v_pk_fma_f32 v[22:23], v[172:173], v[134:135], v[22:23] op_sel:[1,0,0] op_sel_hi:[1,1,1]
    s_lshr_b32 s49, s49, 8
    s_set_gpr_idx_idx s49
    v_pk_fma_f32 v[16:17], v[170:171], v[136:137], v[16:17] op_sel:[0,0,0] op_sel_hi:[0,1,1]
    v_pk_fma_f32 v[18:19], v[170:171], v[138:139], v[18:19] op_sel:[0,0,0] op_sel_hi:[0,1,1]
    v_pk_fma_f32 v[20:21], v[174:175], v[140:141], v[20:21] op_sel:[0,0,0] op_sel_hi:[0,1,1]
    v_pk_fma_f32 v[22:23], v[174:175], v[142:143], v[22:23] op_sel:[0,0,0] op_sel_hi:[0,1,1]
    s_lshr_b32 s49, s49, 8
    s_set_gpr_idx_idx s49
    v_pk_fma_f32 v[16:17], v[170:171], v[144:145], v[16:17] op_sel:[1,0,0] op_sel_hi:[1,1,1]
    v_pk_fma_f32 v[18:19], v[170:171], v[146:147], v[18:19] op_sel:[1,0,0] op_sel_hi:[1,1,1]
    v_pk_fma_f32 v[20:21], v[174:175], v[148:149], v[20:21] op_sel:[1,0,0] op_sel_hi:[1,1,1]
    v_pk_fma_f32 v[22:23], v[174:175], v[150:151], v[22:23] op_sel:[1,0,0] op_sel_hi:[1,1,1]
    s_set_gpr_idx_off
    s_sub_u32 s48, s48, 1
    s_cmp_eq_u32 s48, -3
    s_cbranch_scc1 K2_LOOPDONE
K2_D2:
    s_cmp_eq_u32 s48, -1
    s_cbranch_scc1 K2_WA2
    s_waitcnt vmcnt(2)
K2_WA2:
    s_waitcnt vmcnt(6) lgkmcnt(0)
    v_mfma_f32_4x4x4_16b_bf16 v[120:123], v[184:185], v[56:57], 0 cbsz:4 abid:8
    v_exp_f32 v168, v152
    v_mfma_f32_4x4x4_16b_bf16 v[124:127], v[184:185], v[58:59], 0 cbsz:4 abid:8
    v_exp_f32 v169, v153
    v_mfma_f32_4x4x4_16b_bf16 v[128:131], v[184:185], v[60:61], 0 cbsz:4 abid:9
    v_exp_f32 v170, v154
    v_mfma_f32_4x4x4_16b_bf16 v[132:135], v[184:185], v[62:63], 0 cbsz:4 abid:9
    v_exp_f32 v171, v155
    s_cmp_eq_u32 s48, -1
    s_cbranch_scc1 K2_WB2
    s_waitcnt vmcnt(0)
K2_WB2:
    s_waitcnt vmcnt(4)
    v_mfma_f32_4x4x4_16b_bf16 v[136:139], v[184:185], v[64:65], 0 cbsz:4 abid:10
    v_exp_f32 v172, v156
    v_mfma_f32_4x4x4_16b_bf16 v[140:143], v[184:185], v[66:67], 0 cbsz:4 abid:10
    v_exp_f32 v173, v157
    v_exp_f32 v174, v158
    v_exp_f32 v175, v159
    v_pk_add_f32 v[168:169], v[168:169], 1.0 op_sel_hi:[1,0]
    v_pk_add_f32 v[170:171], v[170:171], 1.0 op_sel_hi:[1,0]
    v_pk_add_f32 v[172:173], v[172:173], 1.0 op_sel_hi:[1,0]
    v_pk_add_f32 v[174:175], v[174:175], 1.0 op_sel_hi:[1,0]
    v_mfma_f32_4x4x4_16b_bf16 v[144:147], v[184:185], v[68:69], 0 cbsz:4 abid:11
    v_rcp_f32 v168, v168
    v_mfma_f32_4x4x4_16b_bf16 v[148:151], v[184:185], v[70:71], 0 cbsz:4 abid:11
    v_rcp_f32 v169, v169
    v_mfma_f32_4x4x4_16b_bf16 v[160:163], v[186:187], v[176:177], 0 cbsz:4 abid:3
    v_rcp_f32 v170, v170
    v_mfma_f32_4x4x4_16b_bf16 v[164:167], v[186:187], v[180:181], 0 cbsz:4 abid:3
    v_rcp_f32 v171, v171
    v_rcp_f32 v172, v172
    ds_read_b64 v[186:187], v199 offset:264
    v_rcp_f32 v173, v173
    v_rcp_f32 v174, v174
    v_rcp_f32 v175, v175
    v_readfirstlane_b32 s49, v194
    v_pk_mul_f32 v[168:169], v[168:169], v[152:153]
    v_pk_mul_f32 v[170:171], v[170:171], v[154:155]
    v_pk_mul_f32 v[172:173], v[172:173], v[156:157]
    v_pk_mul_f32 v[174:175], v[174:175], v[158:159]
    s_set_gpr_idx_on s49, gpr_idx(SRC2,DST)
    v_pk_fma_f32 v[16:17], v[168:169], v[120:121], v[16:17] op_sel:[0,0,0] op_sel_hi:[0,1,1]
    v_pk_fma_f32 v[18:19], v[168:169], v[122:123], v[18:19] op_sel:[0,0,0] op_sel_hi:[0,1,1]
    v_pk_fma_f32 v[20:21], v[172:173], v[124:125], v[20:21] op_sel:[0,0,0] op_sel_hi:[0,1,1]
    v_pk_fma_f32 v[22:23], v[172:173], v[126:127], v[22:23] op_sel:[0,0,0] op_sel_hi:[0,1,1]
    s_lshr_b32 s49, s49, 8
    s_set_gpr_idx_idx s49
    v_pk_fma_f32 v[16:17], v[168:169], v[128:129], v[16:17] op_sel:[1,0,0] op_sel_hi:[1,1,1]
    v_pk_fma_f32 v[18:19], v[168:169], v[130:131], v[18:19] op_sel:[1,0,0] op_sel_hi:[1,1,1]
    v_pk_fma_f32 v[20:21], v[172:173], v[132:133], v[20:21] op_sel:[1,0,0] op_sel_hi:[1,1,1]
    v_pk_fma_f32 v[22:23], v[172:173], v[134:135], v[22:23] op_sel:[1,0,0] op_sel_hi:[1,1,1]
    s_lshr_b32 s49, s49, 8
    s_set_gpr_idx_idx s49
    v_pk_fma_f32 v[16:17], v[170:171], v[136:137], v[16:17] op_sel:[0,0,0] op_sel_hi:[0,1,1]
    v_pk_fma_f32 v[18:19], v[170:171], v[138:139], v[18:19] op_sel:[0,0,0] op_sel_hi:[0,1,1]
    v_pk_fma_f32 v[20:21], v[174:175], v[140:141], v[20:21] op_sel:[0,0,0] op_sel_hi:[0,1,1]
    v_pk_fma_f32 v[22:23], v[174:175], v[142:143], v[22:23] op_sel:[0,0,0] op_sel_hi:[0,1,1]
    s_lshr_b32 s49, s49, 8
    s_set_gpr_idx_idx s49
    v_pk_fma_f32 v[16:17], v[170:171], v[144:145], v[16:17] op_sel:[1,0,0] op_sel_hi:[1,1,1]
    v_pk_fma_f32 v[18:19], v[170:171], v[146:147], v[18:19] op_sel:[1,0,0] op_sel_hi:[1,1,1]
    v_pk_fma_f32 v[20:21], v[174:175], v[148:149], v[20:21] op_sel:[1,0,0] op_sel_hi:[1,1,1]
    v_pk_fma_f32 v[22:23], v[174:175], v[150:151], v[22:23] op_sel:[1,0,0] op_sel_hi:[1,1,1]
    s_set_gpr_idx_off
    s_sub_u32 s48, s48, 1
    s_cmp_eq_u32 s48, -3
    s_cbranch_scc1 K2_LOOPDONE
K2_D3:
    s_cmp_eq_u32 s48, -1
    s_cbranch_scc1 K2_WA3
    s_waitcnt vmcnt(2)
K2_WA3:
    s_waitcnt vmcnt(6) lgkmcnt(0)
    v_mfma_f32_4x4x4_16b_bf16 v[120:123], v[184:185], v[72:73], 0 cbsz:4 abid:12
    v_exp_f32 v168, v160
    v_mfma_f32_4x4x4_16b_bf16 v[124:127], v[184:185], v[74:75], 0 cbsz:4 abid:12
    v_exp_f32 v169, v161
    v_mfma_f32_4x4x4_16b_bf16 v[128:131], v[184:185], v[76:77], 0 cbsz:4 abid:13
    v_exp_f32 v170, v162
    v_mfma_f32_4x4x4_16b_bf16 v[132:135], v[184:185], v[78:79], 0 cbsz:4 abid:13
    v_exp_f32 v171, v163
    s_cmp_eq_u32 s48, -1
    s_cbranch_scc1 K2_WB3
    s_waitcnt vmcnt(0)
K2_WB3:
    s_waitcnt vmcnt(4)
    v_mfma_f32_4x4x4_16b_bf16 v[136:139], v[184:185], v[80:81], 0 cbsz:4 abid:14
    v_exp_f32 v172, v164
    v_mfma_f32_4x4x4_16b_bf16 v[140:143], v[184:185], v[82:83], 0 cbsz:4 abid:14
    v_exp_f32 v173, v165
    v_exp_f32 v174, v166
    v_exp_f32 v175, v167
    v_pk_add_f32 v[168:169], v[168:169], 1.0 op_sel_hi:[1,0]
    v_pk_add_f32 v[170:171], v[170:171], 1.0 op_sel_hi:[1,0]
    v_pk_add_f32 v[172:173], v[172:173], 1.0 op_sel_hi:[1,0]
    v_pk_add_f32 v[174:175], v[174:175], 1.0 op_sel_hi:[1,0]
    v_mfma_f32_4x4x4_16b_bf16 v[144:147], v[184:185], v[84:85], 0 cbsz:4 abid:15
    v_rcp_f32 v168, v168
    v_mfma_f32_4x4x4_16b_bf16 v[148:151], v[184:185], v[86:87], 0 cbsz:4 abid:15
    v_rcp_f32 v169, v169
    ds_read_b64 v[184:185], v198 offset:512
    v_mfma_f32_4x4x4_16b_bf16 v[152:155], v[186:187], v[176:177], 0 cbsz:4 abid:0
    v_rcp_f32 v170, v170
    v_mfma_f32_4x4x4_16b_bf16 v[156:159], v[186:187], v[180:181], 0 cbsz:4 abid:0
    v_rcp_f32 v171, v171
    v_rcp_f32 v172, v172
    v_rcp_f32 v173, v173
    v_rcp_f32 v174, v174
    v_rcp_f32 v175, v175
    v_readfirstlane_b32 s49, v195
    ds_read_b128 v[192:195], v197 offset:16
    v_add_u32 v196, 64, v196
    v_add_u32 v197, 16, v197
    v_add_u32 v198, 512, v198
    v_add_u32 v199, 256, v199
    v_pk_mul_f32 v[168:169], v[168:169], v[160:161]
    v_pk_mul_f32 v[170:171], v[170:171], v[162:163]
    v_pk_mul_f32 v[172:173], v[172:173], v[164:165]
    v_pk_mul_f32 v[174:175], v[174:175], v[166:167]
    s_set_gpr_idx_on s49, gpr_idx(SRC2,DST)
    v_pk_fma_f32 v[16:17], v[168:169], v[120:121], v[16:17] op_sel:[0,0,0] op_sel_hi:[0,1,1]
    v_pk_fma_f32 v[18:19], v[168:169], v[122:123], v[18:19] op_sel:[0,0,0] op_sel_hi:[0,1,1]
    v_pk_fma_f32 v[20:21], v[172:173], v[124:125], v[20:21] op_sel:[0,0,0] op_sel_hi:[0,1,1]
    v_pk_fma_f32 v[22:23], v[172:173], v[126:127], v[22:23] op_sel:[0,0,0] op_sel_hi:[0,1,1]
    s_lshr_b32 s49, s49, 8
    s_set_gpr_idx_idx s49
    v_pk_fma_f32 v[16:17], v[168:169], v[128:129], v[16:17] op_sel:[1,0,0] op_sel_hi:[1,1,1]
    v_pk_fma_f32 v[18:19], v[168:169], v[130:131], v[18:19] op_sel:[1,0,0] op_sel_hi:[1,1,1]
    v_pk_fma_f32 v[20:21], v[172:173], v[132:133], v[20:21] op_sel:[1,0,0] op_sel_hi:[1,1,1]
    v_pk_fma_f32 v[22:23], v[172:173], v[134:135], v[22:23] op_sel:[1,0,0] op_sel_hi:[1,1,1]
    s_lshr_b32 s49, s49, 8
    s_set_gpr_idx_idx s49
    v_pk_fma_f32 v[16:17], v[170:171], v[136:137], v[16:17] op_sel:[0,0,0] op_sel_hi:[0,1,1]
    v_pk_fma_f32 v[18:19], v[170:171], v[138:139], v[18:19] op_sel:[0,0,0] op_sel_hi:[0,1,1]
    v_pk_fma_f32 v[20:21], v[174:175], v[140:141], v[20:21] op_sel:[0,0,0] op_sel_hi:[0,1,1]
    v_pk_fma_f32 v[22:23], v[174:175], v[142:143], v[22:23] op_sel:[0,0,0] op_sel_hi:[0,1,1]
    s_lshr_b32 s49, s49, 8
    s_set_gpr_idx_idx s49
    v_pk_fma_f32 v[16:17], v[170:171], v[144:145], v[16:17] op_sel:[1,0,0] op_sel_hi:[1,1,1]
    v_pk_fma_f32 v[18:19], v[170:171], v[146:147], v[18:19] op_sel:[1,0,0] op_sel_hi:[1,1,1]
    v_pk_fma_f32 v[20:21], v[174:175], v[148:149], v[20:21] op_sel:[1,0,0] op_sel_hi:[1,1,1]
    v_pk_fma_f32 v[22:23], v[174:175], v[150:151], v[22:23] op_sel:[1,0,0] op_sel_hi:[1,1,1]
    s_set_gpr_idx_off
    s_sub_u32 s48, s48, 1
    s_cmp_eq_u32 s48, -3
    s_cbranch_scc0 K2_D0
K2_LOOPDONE:
    v_mov_b32 v254, -1
    ds_write_b32 v252, v254 offset:2048
    s_setprio 0
    s_add_u32 s47, s47, 1536
    s_cmp_ge_u32 s47, s46
    s_cbranch_scc1 K_EPI
    s_waitcnt vmcnt(0) lgkmcnt(0)
    s_barrier
    ds_write_b128 v8, v[4:7]
    ds_write_b32 v3, v4 offset:2048
    v_cmp_gt_u32 vcc, 128, v0
    s_and_saveexec_b64 s[56:57], vcc
    ds_write_b32 v3, v4 offset:0
    s_mov_b64 exec, s[56:57]
    s_waitcnt lgkmcnt(0)
    s_barrier
    s_cmp_eq_u32 s55, 0
    s_cbranch_scc1 K_ROUND
    s_branch K_FB
K_LATER:
    s_mov_b64 exec, s[40:41]
    buffer_load_dwordx4 v[88:91], v100, s[36:39], s61 offen sc1
    s_mov_b64 exec, s[42:43]
    buffer_load_dwordx4 v[92:95], v101, s[36:39], s61 offen sc1
    s_mov_b64 exec, s[44:45]
    buffer_load_dwordx4 v[96:99], v102, s[36:39], s61 offen sc1
    s_mov_b64 exec, -1
K_LATER2:
    v_lshrrev_b32 v81, 2, v72
    v_and_b32 v81, 0xfc, v81
    v_lshrrev_b32 v82, 2, v74
    v_and_b32 v82, 0xfc, v82
    v_lshrrev_b32 v83, 2, v76
    v_and_b32 v83, 0xfc, v83
    s_branch K_BAL
K_FB0:
    s_mov_b32 s46, 320000
    s_and_b32 s56, s3, 3
    s_lshl_b32 s56, s56, 6
    s_add_u32 s56, s56, 114944
    v_lshrrev_b32 v10, 4, v1
    v_lshlrev_b32 v10, 11, v10
    v_and_b32 v12, 15, v1
    v_lshl_or_b32 v10, v12, 2, v10
    v_add_u32 v10, s56, v10
    s_mov_b32 s56, 0x05040100
    s_mov_b32 s57, 0x07060302
    ds_read2st64_b32 v[120:121], v10 offset0:0 offset1:1
    ds_read2st64_b32 v[122:123], v10 offset0:2 offset1:3
    ds_read2st64_b32 v[124:125], v10 offset0:4 offset1:5
    ds_read2st64_b32 v[126:127], v10 offset0:6 offset1:7
    ds_read2st64_b32 v[128:129], v10 offset0:32 offset1:33
    ds_read2st64_b32 v[130:131], v10 offset0:34 offset1:35
    ds_read2st64_b32 v[132:133], v10 offset0:36 offset1:37
    ds_read2st64_b32 v[134:135], v10 offset0:38 offset1:39
    ds_read2st64_b32 v[136:137], v10 offset0:64 offset1:65
    ds_read2st64_b32 v[138:139], v10 offset0:66 offset1:67
    ds_read2st64_b32 v[140:141], v10 offset0:68 offset1:69
    ds_read2st64_b32 v[142:143], v10 offset0:70 offset1:71
    ds_read2st64_b32 v[144:145], v10 offset0:96 offset1:97
    ds_read2st64_b32 v[146:147], v10 offset0:98 offset1:99
    ds_read2st64_b32 v[148:149], v10 offset0:100 offset1:101
    ds_read2st64_b32 v[150:151], v10 offset0:102 offset1:103
    s_waitcnt lgkmcnt(15)
    v_perm_b32 v200, v121, v120, s56
    v_perm_b32 v216, v121, v120, s57
    s_waitcnt lgkmcnt(14)
    v_perm_b32 v201, v123, v122, s56
    v_perm_b32 v217, v123, v122, s57
    s_waitcnt lgkmcnt(13)
    v_perm_b32 v202, v125, v124, s56
    v_perm_b32 v218, v125, v124, s57
    s_waitcnt lgkmcnt(12)
    v_perm_b32 v203, v127, v126, s56
    v_perm_b32 v219, v127, v126, s57
    s_waitcnt lgkmcnt(11)
    v_perm_b32 v204, v129, v128, s56
    v_perm_b32 v220, v129, v128, s57
    s_waitcnt lgkmcnt(10)
    v_perm_b32 v205, v131, v130, s56
    v_perm_b32 v221, v131, v130, s57
    s_waitcnt lgkmcnt(9)
    v_perm_b32 v206, v133, v132, s56
    v_perm_b32 v222, v133, v132, s57
    s_waitcnt lgkmcnt(8)
    v_perm_b32 v207, v135, v134, s56
    v_perm_b32 v223, v135, v134, s57
    s_waitcnt lgkmcnt(7)
    v_perm_b32 v208, v137, v136, s56
    v_perm_b32 v224, v137, v136, s57
    s_waitcnt lgkmcnt(6)
    v_perm_b32 v209, v139, v138, s56
    v_perm_b32 v225, v139, v138, s57
    s_waitcnt lgkmcnt(5)
    v_perm_b32 v210, v141, v140, s56
    v_perm_b32 v226, v141, v140, s57
    s_waitcnt lgkmcnt(4)
    v_perm_b32 v211, v143, v142, s56
    v_perm_b32 v227, v143, v142, s57
    s_waitcnt lgkmcnt(3)
    v_perm_b32 v212, v145, v144, s56
    v_perm_b32 v228, v145, v144, s57
    s_waitcnt lgkmcnt(2)
    v_perm_b32 v213, v147, v146, s56
    v_perm_b32 v229, v147, v146, s57
    s_waitcnt lgkmcnt(1)
    v_perm_b32 v214, v149, v148, s56
    v_perm_b32 v230, v149, v148, s57
    s_waitcnt lgkmcnt(0)
    v_perm_b32 v215, v151, v150, s56
    v_perm_b32 v231, v151, v150, s57
K_FB:
    s_mul_i32 s56, s3, 192
    s_add_u32 s56, s56, s47
    v_add_u32 v68, s56, v1
    v_add_u32 v69, 64, v68
    v_add_u32 v70, 128, v68
    v_cmp_gt_u32 s[40:41], s46, v68
    v_min_u32 v68, 319999, v68
    v_lshlrev_b32 v81, 2, v68
    v_lshlrev_b32 v100, 3, v68
    global_load_dword v56, v81, s[8:9]
    global_load_dword v60, v81, s[6:7]
    global_load_dwordx2 v[88:89], v100, s[10:11]
    global_load_dwordx2 v[90:91], v100, s[12:13]
    v_cmp_gt_u32 s[42:43], s46, v69
    v_min_u32 v69, 319999, v69
    v_lshlrev_b32 v82, 2, v69
    v_lshlrev_b32 v101, 3, v69
    global_load_dword v57, v82, s[8:9]
    global_load_dword v61, v82, s[6:7]
    global_load_dwordx2 v[92:93], v101, s[10:11]
    global_load_dwordx2 v[94:95], v101, s[12:13]
    v_cmp_gt_u32 s[44:45], s46, v70
    v_min_u32 v70, 319999, v70
    v_lshlrev_b32 v83, 2, v70
    v_lshlrev_b32 v102, 3, v70
    global_load_dword v58, v83, s[8:9]
    global_load_dword v62, v83, s[6:7]
    global_load_dwordx2 v[96:97], v102, s[10:11]
    global_load_dwordx2 v[98:99], v102, s[12:13]
    v_mov_b32 v14, 64
    s_waitcnt vmcnt(0)
    v_mul_u32_u24 v68, 214749, v56
    v_lshrrev_b32 v68, 23, v68
    v_cmp_eq_u32 vcc, s53, v68
    s_and_b64 s[40:41], s[40:41], vcc
    v_subrev_u32 v72, s54, v56
    v_mul_u32_u24 v68, 1677, v60
    v_lshrrev_b32 v68, 20, v68
    v_lshl_or_b32 v72, v72, 4, v68
    v_lshl_or_b32 v72, v60, 10, v72
    v_mul_u32_u24 v69, 214749, v57
    v_lshrrev_b32 v69, 23, v69
    v_cmp_eq_u32 vcc, s53, v69
    s_and_b64 s[42:43], s[42:43], vcc
    v_subrev_u32 v74, s54, v57
    v_mul_u32_u24 v69, 1677, v61
    v_lshrrev_b32 v69, 20, v69
    v_lshl_or_b32 v74, v74, 4, v69
    v_lshl_or_b32 v74, v61, 10, v74
    v_mul_u32_u24 v70, 214749, v58
    v_lshrrev_b32 v70, 23, v70
    v_cmp_eq_u32 vcc, s53, v70
    s_and_b64 s[44:45], s[44:45], vcc
    v_subrev_u32 v76, s54, v58
    v_mul_u32_u24 v70, 1677, v62
    v_lshrrev_b32 v70, 20, v70
    v_lshl_or_b32 v76, v76, 4, v70
    v_lshl_or_b32 v76, v62, 10, v76
    s_cmp_lg_u32 s47, 0
    s_cbranch_scc1 K_LATER2
    s_branch K_GOT
K_EPI:
    s_mov_b32 s56, 0xbf317218
    s_mov_b32 s57, s56
    v_pk_mul_f32 v[16:17], v[16:17], s[56:57]
    v_pk_mul_f32 v[18:19], v[18:19], s[56:57]
    v_pk_mul_f32 v[20:21], v[20:21], s[56:57]
    v_pk_mul_f32 v[22:23], v[22:23], s[56:57]
    v_cvt_pk_bf16_f32 v16, v16, v20
    ds_write_b32 v106, v16 offset:0
    v_cvt_pk_bf16_f32 v17, v17, v21
    ds_write_b32 v106, v17 offset:288
    v_cvt_pk_bf16_f32 v18, v18, v22
    ds_write_b32 v106, v18 offset:576
    v_cvt_pk_bf16_f32 v19, v19, v23
    ds_write_b32 v106, v19 offset:864
    v_pk_mul_f32 v[24:25], v[24:25], s[56:57]
    v_pk_mul_f32 v[26:27], v[26:27], s[56:57]
    v_pk_mul_f32 v[28:29], v[28:29], s[56:57]
    v_pk_mul_f32 v[30:31], v[30:31], s[56:57]
    v_cvt_pk_bf16_f32 v24, v24, v28
    ds_write_b32 v107, v24 offset:0
    v_cvt_pk_bf16_f32 v25, v25, v29
    ds_write_b32 v107, v25 offset:288
    v_cvt_pk_bf16_f32 v26, v26, v30
    ds_write_b32 v107, v26 offset:576
    v_cvt_pk_bf16_f32 v27, v27, v31
    ds_write_b32 v107, v27 offset:864
    v_pk_mul_f32 v[32:33], v[32:33], s[56:57]
    v_pk_mul_f32 v[34:35], v[34:35], s[56:57]
    v_pk_mul_f32 v[36:37], v[36:37], s[56:57]
    v_pk_mul_f32 v[38:39], v[38:39], s[56:57]
    v_cvt_pk_bf16_f32 v32, v32, v36
    ds_write_b32 v116, v32 offset:0
    v_cvt_pk_bf16_f32 v33, v33, v37
    ds_write_b32 v116, v33 offset:288
    v_cvt_pk_bf16_f32 v34, v34, v38
    ds_write_b32 v116, v34 offset:576
    v_cvt_pk_bf16_f32 v35, v35, v39
    ds_write_b32 v116, v35 offset:864
    v_pk_mul_f32 v[40:41], v[40:41], s[56:57]
    v_pk_mul_f32 v[42:43], v[42:43], s[56:57]
    v_pk_mul_f32 v[44:45], v[44:45], s[56:57]
    v_pk_mul_f32 v[46:47], v[46:47], s[56:57]
    v_cvt_pk_bf16_f32 v40, v40, v44
    ds_write_b32 v117, v40 offset:0
    v_cvt_pk_bf16_f32 v41, v41, v45
    ds_write_b32 v117, v41 offset:288
    v_cvt_pk_bf16_f32 v42, v42, v46
    ds_write_b32 v117, v42 offset:576
    v_cvt_pk_bf16_f32 v43, v43, v47
    ds_write_b32 v117, v43 offset:864
    v_pk_mul_f32 v[48:49], v[48:49], s[56:57]
    v_pk_mul_f32 v[50:51], v[50:51], s[56:57]
    v_pk_mul_f32 v[52:53], v[52:53], s[56:57]
    v_pk_mul_f32 v[54:55], v[54:55], s[56:57]
    v_cvt_pk_bf16_f32 v48, v48, v52
    ds_write_b32 v118, v48 offset:0
    v_cvt_pk_bf16_f32 v49, v49, v53
    ds_write_b32 v118, v49 offset:288
    v_cvt_pk_bf16_f32 v50, v50, v54
    ds_write_b32 v118, v50 offset:576
    v_cvt_pk_bf16_f32 v51, v51, v55
    ds_write_b32 v118, v51 offset:864
    v_and_b32 v12, 15, v1
    v_lshrrev_b32 v13, 4, v1
    s_lshr_b32 s58, s3, 2
    s_mul_i32 s59, s58, 4608
    s_add_u32 s59, s59, 106752
    v_mul_u32_u24 v14, 288, v12
    v_lshl_add_u32 v14, v13, 4, v14
    v_add_u32 v14, s59, v14
    s_lshl_b32 s58, s58, 2
    s_add_u32 s58, s58, s54
    s_lshl_b32 s58, s58, 10
    s_and_b32 s59, s3, 3
    s_lshl_b32 s59, s59, 8
    s_add_u32 s58, s58, s59
    v_lshlrev_b32 v13, 10, v13
    v_lshl_add_u32 v13, v12, 4, v13
    s_waitcnt vmcnt(0) lgkmcnt(0)
    s_barrier
    ds_read_b128 v[56:59], v14 offset:0
    ds_read_b128 v[60:63], v14 offset:64
    ds_read_b128 v[64:67], v14 offset:128
    ds_read_b128 v[68:71], v14 offset:192
    ds_read_b128 v[72:75], v14 offset:9216
    ds_read_b128 v[76:79], v14 offset:9280
    ds_read_b128 v[80:83], v14 offset:9344
    ds_read_b128 v[84:87], v14 offset:9408
    ds_read_b128 v[88:91], v14 offset:18432
    ds_read_b128 v[92:95], v14 offset:18496
    ds_read_b128 v[96:99], v14 offset:18560
    ds_read_b128 v[100:103], v14 offset:18624
    ds_read_b128 v[104:107], v14 offset:27648
    ds_read_b128 v[108:111], v14 offset:27712
    ds_read_b128 v[112:115], v14 offset:27776
    ds_read_b128 v[116:119], v14 offset:27840
    s_waitcnt lgkmcnt(15)
    v_mfma_f32_16x16x32_bf16 v[120:123], v[56:59], v[200:203], 0
    v_mfma_f32_16x16x32_bf16 v[124:127], v[56:59], v[216:219], 0
    s_waitcnt lgkmcnt(14)
    v_mfma_f32_16x16x32_bf16 v[120:123], v[60:63], v[204:207], v[120:123]
    v_mfma_f32_16x16x32_bf16 v[124:127], v[60:63], v[220:223], v[124:127]
    s_waitcnt lgkmcnt(13)
    v_mfma_f32_16x16x32_bf16 v[120:123], v[64:67], v[208:211], v[120:123]
    v_mfma_f32_16x16x32_bf16 v[124:127], v[64:67], v[224:227], v[124:127]
    s_waitcnt lgkmcnt(12)
    v_mfma_f32_16x16x32_bf16 v[120:123], v[68:71], v[212:215], v[120:123]
    v_mfma_f32_16x16x32_bf16 v[124:127], v[68:71], v[228:231], v[124:127]
    ds_read_b128 v[56:59], v14 offset:36864
    ds_read_b128 v[60:63], v14 offset:36928
    ds_read_b128 v[64:67], v14 offset:36992
    ds_read_b128 v[68:71], v14 offset:37056
    s_waitcnt lgkmcnt(15)
    v_mfma_f32_16x16x32_bf16 v[128:131], v[72:75], v[200:203], 0
    v_mfma_f32_16x16x32_bf16 v[132:135], v[72:75], v[216:219], 0
    s_waitcnt lgkmcnt(14)
    v_mfma_f32_16x16x32_bf16 v[128:131], v[76:79], v[204:207], v[128:131]
    v_mfma_f32_16x16x32_bf16 v[132:135], v[76:79], v[220:223], v[132:135]
    s_waitcnt lgkmcnt(13)
    v_mfma_f32_16x16x32_bf16 v[128:131], v[80:83], v[208:211], v[128:131]
    v_mfma_f32_16x16x32_bf16 v[132:135], v[80:83], v[224:227], v[132:135]
    s_waitcnt lgkmcnt(12)
    v_mfma_f32_16x16x32_bf16 v[128:131], v[84:87], v[212:215], v[128:131]
    v_mfma_f32_16x16x32_bf16 v[132:135], v[84:87], v[228:231], v[132:135]
    v_cvt_pk_bf16_f32 v136, v120, v121
    v_cvt_pk_bf16_f32 v137, v122, v123
    v_cvt_pk_bf16_f32 v138, v124, v125
    v_cvt_pk_bf16_f32 v139, v126, v127
    buffer_store_dwordx4 v[136:139], v13, s[32:35], s58 offen sc1
    s_add_u32 s58, s58, 8192
    s_waitcnt lgkmcnt(11)
    v_mfma_f32_16x16x32_bf16 v[120:123], v[88:91], v[200:203], 0
    v_mfma_f32_16x16x32_bf16 v[124:127], v[88:91], v[216:219], 0
    s_waitcnt lgkmcnt(10)
    v_mfma_f32_16x16x32_bf16 v[120:123], v[92:95], v[204:207], v[120:123]
    v_mfma_f32_16x16x32_bf16 v[124:127], v[92:95], v[220:223], v[124:127]
    s_waitcnt lgkmcnt(9)
    v_mfma_f32_16x16x32_bf16 v[120:123], v[96:99], v[208:211], v[120:123]
    v_mfma_f32_16x16x32_bf16 v[124:127], v[96:99], v[224:227], v[124:127]
    s_waitcnt lgkmcnt(8)
    v_mfma_f32_16x16x32_bf16 v[120:123], v[100:103], v[212:215], v[120:123]
    v_mfma_f32_16x16x32_bf16 v[124:127], v[100:103], v[228:231], v[124:127]
    v_cvt_pk_bf16_f32 v140, v128, v129
    v_cvt_pk_bf16_f32 v141, v130, v131
    v_cvt_pk_bf16_f32 v142, v132, v133
    v_cvt_pk_bf16_f32 v143, v134, v135
    buffer_store_dwordx4 v[140:143], v13, s[32:35], s58 offen sc1
    s_add_u32 s58, s58, 8192
    s_waitcnt lgkmcnt(7)
    v_mfma_f32_16x16x32_bf16 v[128:131], v[104:107], v[200:203], 0
    v_mfma_f32_16x16x32_bf16 v[132:135], v[104:107], v[216:219], 0
    s_waitcnt lgkmcnt(6)
    v_mfma_f32_16x16x32_bf16 v[128:131], v[108:111], v[204:207], v[128:131]
    v_mfma_f32_16x16x32_bf16 v[132:135], v[108:111], v[220:223], v[132:135]
    s_waitcnt lgkmcnt(5)
    v_mfma_f32_16x16x32_bf16 v[128:131], v[112:115], v[208:211], v[128:131]
    v_mfma_f32_16x16x32_bf16 v[132:135], v[112:115], v[224:227], v[132:135]
    s_waitcnt lgkmcnt(4)
    v_mfma_f32_16x16x32_bf16 v[128:131], v[116:119], v[212:215], v[128:131]
    v_mfma_f32_16x16x32_bf16 v[132:135], v[116:119], v[228:231], v[132:135]
    v_cvt_pk_bf16_f32 v136, v120, v121
    v_cvt_pk_bf16_f32 v137, v122, v123
    v_cvt_pk_bf16_f32 v138, v124, v125
    v_cvt_pk_bf16_f32 v139, v126, v127
    buffer_store_dwordx4 v[136:139], v13, s[32:35], s58 offen sc1
    s_add_u32 s58, s58, 8192
    s_waitcnt lgkmcnt(3)
    v_mfma_f32_16x16x32_bf16 v[120:123], v[56:59], v[200:203], 0
    v_mfma_f32_16x16x32_bf16 v[124:127], v[56:59], v[216:219], 0
    s_waitcnt lgkmcnt(2)
    v_mfma_f32_16x16x32_bf16 v[120:123], v[60:63], v[204:207], v[120:123]
    v_mfma_f32_16x16x32_bf16 v[124:127], v[60:63], v[220:223], v[124:127]
    s_waitcnt lgkmcnt(1)
    v_mfma_f32_16x16x32_bf16 v[120:123], v[64:67], v[208:211], v[120:123]
    v_mfma_f32_16x16x32_bf16 v[124:127], v[64:67], v[224:227], v[124:127]
    s_waitcnt lgkmcnt(0)
    v_mfma_f32_16x16x32_bf16 v[120:123], v[68:71], v[212:215], v[120:123]
    v_mfma_f32_16x16x32_bf16 v[124:127], v[68:71], v[228:231], v[124:127]
    v_cvt_pk_bf16_f32 v140, v128, v129
    v_cvt_pk_bf16_f32 v141, v130, v131
    v_cvt_pk_bf16_f32 v142, v132, v133
    v_cvt_pk_bf16_f32 v143, v134, v135
    buffer_store_dwordx4 v[140:143], v13, s[32:35], s58 offen sc1
    s_add_u32 s58, s58, 8192
    s_nop 0
    v_cvt_pk_bf16_f32 v136, v120, v121
    v_cvt_pk_bf16_f32 v137, v122, v123
    v_cvt_pk_bf16_f32 v138, v124, v125
    v_cvt_pk_bf16_f32 v139, v126, v127
    buffer_store_dwordx4 v[136:139], v13, s[32:35], s58 offen sc1
    s_or_b32 s56, s55, s3
    s_cmp_lg_u32 s56, 0
    s_cbranch_scc1 K_NOEPO
    v_mov_b32 v10, s52
    s_mov_b64 exec, 1
    buffer_store_dword v10, v4, s[36:39], 0 offen offset:0
K_NOEPO:
K_END:
    s_endpgm
.p2align 6
.type K_TAB,@object
K_TAB:
.byte 6, 5, 14, 7, 4, 2, 0, 1, 3, 12, 22, 11, 10, 8, 30, 9, 19, 13, 15, 17, 16, 21, 23, 20, 18, 25, 29, 28, 31, 27, 26, 24, 34, 32, 39, 33, 35, 36, 37, 38, 255, 255, 255, 255, 255, 255, 255, 255, 255, 255, 255, 255, 255, 255, 255, 255, 255, 255, 255, 255, 255, 255, 255, 255
.byte 3, 2, 4, 7, 0, 1, 6, 8, 5, 9, 15, 13, 14, 11, 12, 22, 21, 16, 10, 23, 17, 20, 30, 19, 18, 25, 27, 24, 29, 28, 26, 31, 34, 37, 36, 39, 33, 38, 32, 35, 255, 255, 255, 255, 255, 255, 255, 255, 255, 255, 255, 255, 255, 255, 255, 255, 255, 255, 255, 255, 255, 255, 255, 255
.section .rodata,"a"
.p2align 6
.amdhsa_kernel gather_scatter__tensor_product_equiv_tfn__graph_kernel
  .amdhsa_next_free_vgpr 256
  .amdhsa_next_free_sgpr 72
  .amdhsa_accum_offset 256
  .amdhsa_group_segment_fixed_size 0
  .amdhsa_kernarg_size 88
  .amdhsa_user_sgpr_count 2
  .amdhsa_user_sgpr_kernarg_segment_ptr 1
  .amdhsa_system_sgpr_workgroup_id_x 1
  .amdhsa_float_denorm_mode_32 3
.end_amdhsa_kernel
```

```asm
; @launch grid=(256,1,1) block=(512,1,1) lds=152832
.amdgcn_target "amdgcn-amd-amdhsa--gfx950"
.text
.globl gather_scatter__tensor_product_equiv_tfn__graph_kernel
.p2align 8
.type gather_scatter__tensor_product_equiv_tfn__graph_kernel,@function
gather_scatter__tensor_product_equiv_tfn__graph_kernel:
    s_cmp_ge_u32 s2, 256
    s_cbranch_scc1 K_END
    s_load_dwordx16 s[4:19], s[0:1], 0
    s_load_dwordx2 s[20:21], s[0:1], 64
    s_load_dwordx2 s[24:25], s[0:1], 80
    v_lshrrev_b32 v2, 6, v0
    v_and_b32 v1, 63, v0
    v_readfirstlane_b32 s3, v2
    v_lshlrev_b32 v10, 4, v0
    s_mul_i32 s57, s2, 5120
    v_lshlrev_b32 v3, 2, v0
    s_cmp_lg_u32 s3, 5
    s_cbranch_scc1 K_PF0
    s_getpc_b64 s[26:27]
K_PC3:
    v_lshlrev_b32 v13, 7, v1
    global_load_dword v255, v13, s[26:27]
    v_add_u32 v13, 8192, v13
    v_min_u32 v13, K_TAB-K_PC3, v13
    global_load_dword v255, v13, s[26:27]
K_PF0:
    v_or_b32 v13, 0x4b000000, v1
    s_cmp_eq_u32 s3, 2
    s_cselect_b32 s56, -1, 0
    v_add_u32 v11, s57, v10
    v_and_b32 v13, s56, v13
    v_lshlrev_b32 v12, 1, v11
    ds_write_b32 v3, v13
    s_cmp_lt_u32 s2, 250
    s_cselect_b32 s56, 5, 0
    s_cmp_lt_u32 s3, s56
    s_waitcnt lgkmcnt(0)
    s_cbranch_scc0 K_BA
    global_load_dwordx4 v[120:123], v11, s[8:9]
    global_load_dwordx4 v[124:127], v11, s[6:7]
K_BA:
    s_barrier
    s_cbranch_scc0 K_HELP
    global_load_dwordx4 v[128:131], v12, s[10:11] offset:0
    global_load_dwordx4 v[132:135], v12, s[10:11] offset:16
    global_load_dwordx4 v[136:139], v12, s[12:13] offset:0
    global_load_dwordx4 v[140:143], v12, s[12:13] offset:16
    s_mov_b32 s40, 1
    s_load_dword s52, s[24:25], 0
    v_mov_b32 v4, 0
    v_mov_b32 v5, 0
    v_mov_b32 v6, 0
    v_mov_b32 v7, 0
    v_add_u32 v8, 106752, v10
    v_lshlrev_b32 v9, 4, v1
    v_lshlrev_b32 v15, 2, v1
    ds_write_b128 v8, v[4:7]
    ds_write_b32 v3, v4 offset:2048
    s_and_b32 s53, s2, 7
    s_lshr_b32 s56, s2, 3
    s_lshl_b32 s53, s53, 5
    s_or_b32 s53, s53, s56
    s_mul_i32 s54, s53, 625
    s_add_u32 s57, s54, 640
    s_add_u32 s54, s54, 15
    s_lshr_b32 s54, s54, 4
    s_lshr_b32 s57, s57, 4
    s_mov_b32 s28, s4
    s_and_b32 s29, s5, 0xffff
    s_or_b32 s29, s29, 0x100000
    s_mov_b32 s30, 10240000
    s_mov_b32 s31, 0x800000
    s_mov_b32 s32, s20
    s_mov_b32 s33, s21
    s_lshl_b32 s34, s57, 10
    s_mov_b32 s35, 0x20000
    s_mov_b32 s36, s24
    s_mov_b32 s37, s25
    s_mov_b32 s38, 8388608
    s_mov_b32 s39, 0x20000
    s_mov_b32 s47, 0
    s_mov_b32 s63, 0
    v_mov_b32 v14, 1
    s_lshr_b32 s27, s53, 5
    s_mul_i32 s27, s27, 20009
    s_add_u32 s27, s27, 14
    s_lshr_b32 s27, s27, 4
    s_lshl_b32 s27, s27, 10
    v_mov_b32 v16, 0
    v_mov_b32 v17, 0
    v_mov_b32 v18, 0
    v_mov_b32 v19, 0
    v_mov_b32 v20, 0
    v_mov_b32 v21, 0
    v_mov_b32 v22, 0
    v_mov_b32 v23, 0
    v_mov_b32 v24, 0
    v_mov_b32 v25, 0
    v_mov_b32 v26, 0
    v_mov_b32 v27, 0
    v_mov_b32 v28, 0
    v_mov_b32 v29, 0
    v_mov_b32 v30, 0
    v_mov_b32 v31, 0
    v_mov_b32 v32, 0
    v_mov_b32 v33, 0
    v_mov_b32 v34, 0
    v_mov_b32 v35, 0
    v_mov_b32 v36, 0
    v_mov_b32 v37, 0
    v_mov_b32 v38, 0
    v_mov_b32 v39, 0
    v_mov_b32 v40, 0
    v_mov_b32 v41, 0
    v_mov_b32 v42, 0
    v_mov_b32 v43, 0
    v_mov_b32 v44, 0
    v_mov_b32 v45, 0
    v_mov_b32 v46, 0
    v_mov_b32 v47, 0
    v_mov_b32 v48, 0
    v_mov_b32 v49, 0
    v_mov_b32 v50, 0
    v_mov_b32 v51, 0
    v_mov_b32 v52, 0
    v_mov_b32 v53, 0
    v_mov_b32 v54, 0
    v_mov_b32 v55, 0
    s_waitcnt vmcnt(5)
    v_mul_u32_u24 v60, 214749, v120
    v_lshrrev_b32 v60, 23, v60
    v_lshlrev_b32 v144, 2, v60
    ds_add_rtn_u32 v148, v144, v14 offset:768
    v_mul_u32_u24 v61, 214749, v121
    v_lshrrev_b32 v61, 23, v61
    v_lshlrev_b32 v145, 2, v61
    ds_add_rtn_u32 v149, v145, v14 offset:768
    v_mul_u32_u24 v62, 214749, v122
    v_lshrrev_b32 v62, 23, v62
    v_lshlrev_b32 v146, 2, v62
    ds_add_rtn_u32 v150, v146, v14 offset:768
    v_mul_u32_u24 v63, 214749, v123
    v_lshrrev_b32 v63, 23, v63
    v_lshlrev_b32 v147, 2, v63
    ds_add_rtn_u32 v151, v147, v14 offset:768
    v_mul_u32_u24 v64, 625, v60
    v_add_u32 v64, 15, v64
    v_lshrrev_b32 v64, 4, v64
    v_sub_u32 v56, v120, v64
    v_mul_u32_u24 v64, 625, v61
    v_add_u32 v64, 15, v64
    v_lshrrev_b32 v64, 4, v64
    v_sub_u32 v57, v121, v64
    v_mul_u32_u24 v64, 625, v62
    v_add_u32 v64, 15, v64
    v_lshrrev_b32 v64, 4, v64
    v_sub_u32 v58, v122, v64
    v_mul_u32_u24 v64, 625, v63
    v_add_u32 v64, 15, v64
    v_lshrrev_b32 v64, 4, v64
    v_sub_u32 v59, v123, v64
    s_branch K_BB
K_HELP:
    s_mov_b32 s40, 0
    s_load_dword s52, s[24:25], 0
    v_mov_b32 v4, 0
    v_mov_b32 v5, 0
    v_mov_b32 v6, 0
    v_mov_b32 v7, 0
    v_add_u32 v8, 106752, v10
    v_lshlrev_b32 v9, 4, v1
    v_lshlrev_b32 v15, 2, v1
    ds_write_b128 v8, v[4:7]
    ds_write_b32 v3, v4 offset:2048
    s_and_b32 s53, s2, 7
    s_lshr_b32 s56, s2, 3
    s_lshl_b32 s53, s53, 5
    s_or_b32 s53, s53, s56
    s_cmp_eq_u32 s3, 7
    s_cbranch_scc1 K_HELP7
    s_cmp_lg_u32 s3, 6
    s_cbranch_scc1 K_HELP2
    s_and_b32 s56, s53, 31
    s_lshl_b32 s56, s56, 10
    v_lshl_add_u32 v13, v1, 7, s56
    s_mov_b64 exec, 0xff
    global_load_dword v255, v13, s[18:19]
    s_mov_b64 exec, -1
    s_branch K_HELP2
K_HELP7:
    s_mov_b32 m0, 147712
    s_getpc_b64 s[26:27]
K_PC:
    global_load_lds_dwordx4 v9, s[14:15]
    s_add_u32 s26, s26, K_TAB-K_PC
    s_addc_u32 s27, s27, 0
    s_mov_b32 m0, 148736
    s_mov_b64 exec, 0xff
    global_load_lds_dwordx4 v9, s[16:17]
    s_mov_b32 m0, 148864
    s_nop 0
    global_load_lds_dwordx4 v9, s[26:27]
    s_mov_b64 exec, -1
K_HELP2:
    s_mul_i32 s54, s53, 625
    s_add_u32 s57, s54, 640
    s_add_u32 s54, s54, 15
    s_lshr_b32 s54, s54, 4
    s_lshr_b32 s57, s57, 4
    s_mov_b32 s28, s4
    s_and_b32 s29, s5, 0xffff
    s_or_b32 s29, s29, 0x100000
    s_mov_b32 s30, 10240000
    s_mov_b32 s31, 0x800000
    s_mov_b32 s32, s20
    s_mov_b32 s33, s21
    s_lshl_b32 s34, s57, 10
    s_mov_b32 s35, 0x20000
    s_mov_b32 s36, s24
    s_mov_b32 s37, s25
    s_mov_b32 s38, 8388608
    s_mov_b32 s39, 0x20000
    s_mov_b32 s47, 0
    s_mov_b32 s63, 0
    v_mov_b32 v14, 1
    s_lshr_b32 s27, s53, 5
    s_mul_i32 s27, s27, 20009
    s_add_u32 s27, s27, 14
    s_lshr_b32 s27, s27, 4
    s_lshl_b32 s27, s27, 10
    v_mov_b32 v16, 0
    v_mov_b32 v17, 0
    v_mov_b32 v18, 0
    v_mov_b32 v19, 0
    v_mov_b32 v20, 0
    v_mov_b32 v21, 0
    v_mov_b32 v22, 0
    v_mov_b32 v23, 0
    v_mov_b32 v24, 0
    v_mov_b32 v25, 0
    v_mov_b32 v26, 0
    v_mov_b32 v27, 0
    v_mov_b32 v28, 0
    v_mov_b32 v29, 0
    v_mov_b32 v30, 0
    v_mov_b32 v31, 0
    v_mov_b32 v32, 0
    v_mov_b32 v33, 0
    v_mov_b32 v34, 0
    v_mov_b32 v35, 0
    v_mov_b32 v36, 0
    v_mov_b32 v37, 0
    v_mov_b32 v38, 0
    v_mov_b32 v39, 0
    v_mov_b32 v40, 0
    v_mov_b32 v41, 0
    v_mov_b32 v42, 0
    v_mov_b32 v43, 0
    v_mov_b32 v44, 0
    v_mov_b32 v45, 0
    v_mov_b32 v46, 0
    v_mov_b32 v47, 0
    v_mov_b32 v48, 0
    v_mov_b32 v49, 0
    v_mov_b32 v50, 0
    v_mov_b32 v51, 0
    v_mov_b32 v52, 0
    v_mov_b32 v53, 0
    v_mov_b32 v54, 0
    v_mov_b32 v55, 0
K_BB:
    s_waitcnt lgkmcnt(0)
    s_barrier
    s_add_u32 s52, s52, 1
    s_and_b32 s56, s52, 0x3ff
    s_lshl_b32 s58, s56, 22
    s_lshl_b32 s26, s52, 24
    s_cmp_eq_u32 s3, 7
    s_cselect_b32 s56, 1, s40
    s_cmp_eq_u32 s56, 0
    s_cbranch_scc1 K_BC1
    ds_read_b128 v[152:155], v9 offset:768
    s_cmp_eq_u32 s3, 7
    s_cbranch_scc1 K_SC
    s_waitcnt vmcnt(4)
    v_mul_u32_u24 v60, 1677, v124
    v_lshrrev_b32 v60, 20, v60
    v_lshl_or_b32 v56, v56, 4, v60
    v_lshl_or_b32 v56, v124, 10, v56
    v_mul_u32_u24 v61, 1677, v125
    v_lshrrev_b32 v61, 20, v61
    v_lshl_or_b32 v57, v57, 4, v61
    v_lshl_or_b32 v57, v125, 10, v57
    v_mul_u32_u24 v62, 1677, v126
    v_lshrrev_b32 v62, 20, v62
    v_lshl_or_b32 v58, v58, 4, v62
    v_lshl_or_b32 v58, v126, 10, v58
    v_mul_u32_u24 v63, 1677, v127
    v_lshrrev_b32 v63, 20, v63
    v_lshl_or_b32 v59, v59, 4, v63
    v_lshl_or_b32 v59, v127, 10, v59
K_SC:
    s_waitcnt lgkmcnt(0)
    v_add_u32 v156, v152, v153
    v_add_u32 v157, v156, v154
    v_add_u32 v158, v157, v155
    v_mov_b32 v160, v158
    v_or_b32 v66, s26, v56
    v_mov_b32 v67, s52
    v_add_u32_dpp v160, v160, v160 row_shr:1 row_mask:0xf bank_mask:0xf
    v_or_b32 v68, s26, v57
    v_mov_b32 v69, s52
    v_add_u32_dpp v160, v160, v160 row_shr:2 row_mask:0xf bank_mask:0xf
    v_or_b32 v70, s26, v58
    v_mov_b32 v71, s52
    v_add_u32_dpp v160, v160, v160 row_shr:4 row_mask:0xf bank_mask:0xf
    v_or_b32 v72, s26, v59
    v_mov_b32 v73, s52
    v_add_u32_dpp v160, v160, v160 row_shr:8 row_mask:0xf bank_mask:0xf
    s_nop 1
    v_add_u32_dpp v160, v160, v160 row_bcast:15 row_mask:0xa bank_mask:0xf
    s_nop 1
    v_add_u32_dpp v160, v160, v160 row_bcast:31 row_mask:0xc bank_mask:0xf
    v_sub_u32 v160, v160, v158
    v_add_u32 v161, v160, v152
    v_add_u32 v162, v160, v156
    v_add_u32 v163, v160, v157
    s_cmp_lg_u32 s3, 7
    s_cbranch_scc1 K_NOROW
    v_lshl_or_b32 v168, v152, 11, v160
    v_or_b32 v168, s58, v168
    v_mov_b32 v169, s52
    v_lshl_or_b32 v170, v153, 11, v161
    v_or_b32 v170, s58, v170
    v_mov_b32 v171, s52
    v_lshl_or_b32 v172, v154, 11, v162
    v_or_b32 v172, s58, v172
    v_mov_b32 v173, s52
    v_lshl_or_b32 v174, v155, 11, v163
    v_or_b32 v174, s58, v174
    v_mov_b32 v175, s52
    s_lshl_b32 s57, s2, 11
    s_add_u32 s57, s57, 8192
    v_lshlrev_b32 v12, 5, v1
    buffer_store_dwordx4 v[168:171], v12, s[36:39], s57 offen sc1
    buffer_store_dwordx4 v[172:175], v12, s[36:39], s57 offen offset:16 sc1
    s_branch K_BC1
K_NOROW:
    ds_write_b128 v9, v[160:163] offset:4096
    ds_read_b32 v60, v144 offset:4096
    ds_read_b32 v61, v145 offset:4096
    ds_read_b32 v62, v146 offset:4096
    ds_read_b32 v63, v147 offset:4096
    s_waitcnt lgkmcnt(3)
    v_add_lshl_u32 v144, v60, v148, 3
    ds_write_b64 v144, v[66:67] offset:13824
    s_waitcnt lgkmcnt(3)
    v_add_lshl_u32 v145, v61, v149, 3
    ds_write_b64 v145, v[68:69] offset:13824
    s_waitcnt lgkmcnt(3)
    v_add_lshl_u32 v146, v62, v150, 3
    ds_write_b64 v146, v[70:71] offset:13824
    s_waitcnt lgkmcnt(3)
    v_add_lshl_u32 v147, v63, v151, 3
    ds_write_b64 v147, v[72:73] offset:13824
    s_mov_b32 s56, 44800
    v_lshl_add_u32 v144, v144, 1, s56
    v_lshl_add_u32 v145, v145, 1, s56
    v_lshl_add_u32 v146, v146, 1, s56
    v_lshl_add_u32 v147, v147, 1, s56
K_BC1:
    s_mul_i32 s60, s2, 10240
    s_add_u32 s60, s60, 532480
    s_sub_u32 s56, s3, 5
    s_lshl_b32 s57, s56, 14
    v_add_u32 v13, s57, v9
    s_add_u32 s57, s57, 114944
    s_waitcnt lgkmcnt(0)
    s_barrier
    s_cmp_ge_u32 s2, 250
    s_cbranch_scc1 K_KS2
    ds_read_b128 v[76:79], v10 offset:13824
    s_cmp_lt_u32 s56, 2
    s_cbranch_scc0 K_KS1
    ds_read_b128 v[80:83], v10 offset:16896
    s_add_u32 s59, s60, 3072
    s_waitcnt lgkmcnt(0)
    buffer_store_dwordx4 v[80:83], v10, s[36:39], s59 offen sc1
K_KS1:
    s_waitcnt lgkmcnt(0)
    buffer_store_dwordx4 v[76:79], v10, s[36:39], s60 offen sc1
K_KS2:
    s_cmp_lt_u32 s56, 2
    s_cbranch_scc1 K_DMA
    s_cmp_eq_u32 s40, 0
    s_cbranch_scc1 K_BC7
    s_waitcnt vmcnt(2)
    ds_write2_b64 v144, v[128:129], v[136:137] offset0:0 offset1:1
    ds_write2_b64 v145, v[130:131], v[138:139] offset0:0 offset1:1
    s_waitcnt vmcnt(1)
    ds_write2_b64 v146, v[132:133], v[140:141] offset0:0 offset1:1
    ds_write2_b64 v147, v[134:135], v[142:143] offset0:0 offset1:1
    s_branch K_BC
K_DMA:
    s_mov_b32 m0, s57
    s_add_u32 s57, s57, 4096
    global_load_lds_dwordx4 v13, s[18:19] offset:0
    global_load_lds_dwordx4 v13, s[18:19] offset:1024
    global_load_lds_dwordx4 v13, s[18:19] offset:2048
    global_load_lds_dwordx4 v13, s[18:19] offset:3072
    v_add_u32 v13, 4096, v13
    s_mov_b32 m0, s57
    s_add_u32 s57, s57, 4096
    global_load_lds_dwordx4 v13, s[18:19] offset:0
    global_load_lds_dwordx4 v13, s[18:19] offset:1024
    global_load_lds_dwordx4 v13, s[18:19] offset:2048
    global_load_lds_dwordx4 v13, s[18:19] offset:3072
    v_add_u32 v13, 4096, v13
    s_mov_b32 m0, s57
    s_add_u32 s57, s57, 4096
    global_load_lds_dwordx4 v13, s[18:19] offset:0
    global_load_lds_dwordx4 v13, s[18:19] offset:1024
    global_load_lds_dwordx4 v13, s[18:19] offset:2048
    global_load_lds_dwordx4 v13, s[18:19] offset:3072
    v_add_u32 v13, 4096, v13
    s_mov_b32 m0, s57
    s_add_u32 s57, s57, 4096
    global_load_lds_dwordx4 v13, s[18:19] offset:0
    global_load_lds_dwordx4 v13, s[18:19] offset:1024
    global_load_lds_dwordx4 v13, s[18:19] offset:2048
    global_load_lds_dwordx4 v13, s[18:19] offset:3072
    s_branch K_BC
K_BC7:
    s_cmp_ge_u32 s2, 250
    s_cbranch_scc0 K_BC8
    s_waitcnt vmcnt(2)
K_BC8:
    s_waitcnt vmcnt(3)
K_BC:
    s_mul_i32 s56, s2, 20480
    s_add_u32 s56, s56, 3145728
    s_add_u32 s57, s56, 8192
    s_add_u32 s59, s56, 16384
    v_lshlrev_b32 v11, 11, v0
    s_lshl_b32 s61, s53, 3
    s_add_u32 s61, s61, 8192
    s_waitcnt lgkmcnt(0)
    s_barrier
    s_cmp_ge_u32 s2, 250
    s_cbranch_scc1 K_NOST
    ds_read_b128 v[56:59], v10 offset:44800
    ds_read_b128 v[60:63], v10 offset:52992
    s_cmp_ge_u32 s3, 4
    s_cbranch_scc1 K_ST1
    ds_read_b128 v[64:67], v10 offset:61184
    s_waitcnt lgkmcnt(0)
    buffer_store_dwordx4 v[64:67], v10, s[36:39], s59 offen sc1
K_ST1:
    s_waitcnt lgkmcnt(1)
    buffer_store_dwordx4 v[56:59], v10, s[36:39], s56 offen sc1
    s_waitcnt lgkmcnt(0)
    buffer_store_dwordx4 v[60:63], v10, s[36:39], s57 offen sc1
K_NOST:
    s_cmp_ge_u32 s3, 4
    s_cbranch_scc1 K_NOA0
    buffer_load_dwordx2 v[152:153], v11, s[36:39], s61 offen sc1
K_NOA0:
    s_lshr_b32 s56, s34, 10
    s_sub_u32 s56, s56, s54
    s_sub_u32 s56, s56, 39
    s_lshl_b32 s56, s56, 6
    s_add_u32 s56, s56, 148864
    v_add_u32 v2, s56, v1
    v_add_u32 v13, 147712, v15
    ds_read_u8 v2, v2
    ds_read2st64_b32 v[188:189], v13 offset0:0 offset1:1
    ds_read2st64_b32 v[190:191], v13 offset0:2 offset1:3
    v_and_b32 v12, 3, v1
    v_lshlrev_b32 v12, 5, v12
    v_bfe_u32 v13, v1, 2, 2
    v_lshl_or_b32 v12, v13, 1, v12
    v_add_u32 v12, 148736, v12
    ds_read_u16 v192, v12 offset:0
    ds_read_u16 v193, v12 offset:8
    ds_read_u16 v194, v12 offset:16
    ds_read_u16 v195, v12 offset:24
    v_mov_b32 v252, v3
    v_xor_b32 v253, 1024, v3
    v_mul_u32_u24 v185, 128, v0
    s_mov_b32 s56, 0xbfb8aa3b
    s_waitcnt lgkmcnt(0)
    v_lshlrev_b32 v136, 16, v188
    v_mul_f32 v140, s56, v136
    v_lshlrev_b32 v137, 16, v189
    v_mul_f32 v141, s56, v137
    v_lshlrev_b32 v138, 16, v190
    v_mul_f32 v142, s56, v138
    v_lshlrev_b32 v139, 16, v191
    v_mul_f32 v143, s56, v139
    v_cvt_pk_bf16_f32 v176, v140, v141
    v_cvt_pk_bf16_f32 v177, v142, v143
    v_and_b32 v136, 0xffff0000, v188
    v_mul_f32 v140, s56, v136
    v_and_b32 v137, 0xffff0000, v189
    v_mul_f32 v141, s56, v137
    v_and_b32 v138, 0xffff0000, v190
    v_mul_f32 v142, s56, v138
    v_and_b32 v139, 0xffff0000, v191
    v_mul_f32 v143, s56, v139
    v_cvt_pk_bf16_f32 v180, v140, v141
    v_cvt_pk_bf16_f32 v181, v142, v143
    v_lshl_or_b32 v136, v193, 16, v192
    v_lshl_or_b32 v137, v195, 16, v194
    v_lshrrev_b32 v13, 4, v1
    v_cmp_eq_u32 vcc, 0, v13
    s_nop 1
    v_cndmask_b32 v232, 0, v136, vcc
    v_cndmask_b32 v233, 0, v137, vcc
    v_cmp_eq_u32 vcc, 1, v13
    s_nop 1
    v_cndmask_b32 v234, 0, v136, vcc
    v_cndmask_b32 v235, 0, v137, vcc
    v_cmp_eq_u32 vcc, 2, v13
    s_nop 1
    v_cndmask_b32 v236, 0, v136, vcc
    v_cndmask_b32 v237, 0, v137, vcc
    v_cmp_eq_u32 vcc, 3, v13
    s_nop 1
    v_cndmask_b32 v238, 0, v136, vcc
    v_cndmask_b32 v239, 0, v137, vcc
    v_mul_u32_u24 v13, 5120, v1
    s_cmp_ge_u32 s3, 4
    s_cbranch_scc1 K_TABOK
    s_mov_b32 s59, 40000
    s_lshr_b32 s58, s58, 22
    s_branch K_POLLA1
K_POLLA:
    buffer_load_dwordx2 v[152:153], v11, s[36:39], s61 offen sc1
K_POLLA1:
    s_waitcnt vmcnt(0)
    v_lshrrev_b32 v154, 22, v152
    v_cmp_ne_u32 vcc, s52, v153
    v_cmp_ne_u32 s[56:57], s58, v154
    s_or_b64 vcc, vcc, s[56:57]
    s_cbranch_vccz K_POLLAOK
    s_sub_u32 s59, s59, 1
    s_cbranch_scc0 K_POLLA
    ds_write_b32 v4, v14 offset:1792
K_POLLAOK:
    ds_write_b32 v3, v152 offset:5120
K_TABOK:
    s_waitcnt vmcnt(0) lgkmcnt(0)
    s_barrier
    s_cmp_lg_u32 s3, 4
    s_cbranch_scc1 K_NOFLAG
    s_mul_i32 s56, s2, 128
    s_add_u32 s56, s56, 8323072
    v_mov_b32 v10, s52
    s_mov_b64 exec, 1
    buffer_store_dword v10, v4, s[36:39], s56 offen sc1
    s_mov_b64 exec, -1
K_NOFLAG:
    ds_read_b128 v[120:123], v9 offset:5120
    ds_read_b32 v10, v4 offset:1792
    s_cmp_lt_u32 s3, 6
    s_cbranch_scc1 K_NOPFX
    s_mov_b32 s64, s4
    s_mov_b32 s65, s5
    s_mov_b32 s66, 10240000
    s_mov_b32 s67, 0x20000
    s_sub_u32 s68, 7, s3
    s_lshl_b32 s68, s68, 5
    s_and_b32 s69, s53, 31
    s_add_u32 s68, s68, s69
    s_lshl_b32 s68, s68, 13
    s_add_u32 s68, s68, s27
    v_lshlrev_b32 v12, 7, v1
    buffer_load_dword v255, v12, s[64:67], s68 offen
K_NOPFX:
    s_waitcnt lgkmcnt(0)
    v_readfirstlane_b32 s55, v10
    v_bfe_u32 v124, v120, 11, 11
    v_bfe_u32 v125, v121, 11, 11
    v_bfe_u32 v126, v122, 11, 11
    v_bfe_u32 v127, v123, 11, 11
    v_add_u32 v129, v124, v125
    v_add_u32 v130, v129, v126
    v_add_u32 v131, v130, v127
    v_mov_b32 v132, v131
    v_and_b32 v120, 0x7ff, v120
    v_add_u32 v248, v13, v120
    v_add_u32_dpp v132, v132, v132 row_shr:1 row_mask:0xf bank_mask:0xf
    v_and_b32 v121, 0x7ff, v121
    v_add_u32 v249, v13, v121
    v_add_u32_dpp v132, v132, v132 row_shr:2 row_mask:0xf bank_mask:0xf
    v_add_u32 v249, 1280, v249
    v_and_b32 v122, 0x7ff, v122
    v_add_u32_dpp v132, v132, v132 row_shr:4 row_mask:0xf bank_mask:0xf
    v_add_u32 v250, v13, v122
    v_add_u32 v250, 2560, v250
    v_add_u32_dpp v132, v132, v132 row_shr:8 row_mask:0xf bank_mask:0xf
    v_and_b32 v123, 0x7ff, v123
    v_add_u32 v251, v13, v123
    v_add_u32_dpp v132, v132, v132 row_bcast:15 row_mask:0xa bank_mask:0xf
    v_add_u32 v251, 3840, v251
    s_nop 0
    v_add_u32_dpp v132, v132, v132 row_bcast:31 row_mask:0xc bank_mask:0xf
    s_cmp_lg_u32 s55, 0
    s_cbranch_scc1 K_FB0
    v_readlane_b32 s46, v132, 63
    v_sub_u32 v240, v132, v131
    v_add_u32 v241, v240, v124
    v_add_u32 v242, v240, v129
    v_add_u32 v243, v240, v130
    v_sub_u32 v248, v248, v240
    v_add_u32 v244, v240, v124
    v_sub_u32 v249, v249, v241
    v_add_u32 v245, v241, v125
    v_sub_u32 v250, v250, v242
    v_add_u32 v246, v242, v126
    v_sub_u32 v251, v251, v243
    v_add_u32 v247, v243, v127
K_ROUND:
    s_mul_i32 s56, s3, 192
    s_add_u32 s56, s56, s47
    s_add_u32 s57, s56, 192
    s_lshl_b32 s58, s3, 10
    s_add_u32 s58, s58, 106752
    v_cmp_lt_u32 vcc, s56, v244
    v_cmp_gt_u32 s[60:61], s57, v240
    v_subrev_u32 v56, s56, v240
    v_max_i32 v56, 0, v56
    v_lshl_add_u32 v56, v56, 2, s58
    s_and_b64 exec, vcc, s[60:61]
    ds_max_u32 v56, v248
    s_mov_b64 exec, -1
    v_cmp_lt_u32 vcc, s56, v245
    v_cmp_gt_u32 s[60:61], s57, v241
    v_subrev_u32 v57, s56, v241
    v_max_i32 v57, 0, v57
    v_lshl_add_u32 v57, v57, 2, s58
    s_and_b64 exec, vcc, s[60:61]
    ds_max_u32 v57, v249
    s_mov_b64 exec, -1
    v_cmp_lt_u32 vcc, s56, v246
    v_cmp_gt_u32 s[60:61], s57, v242
    v_subrev_u32 v58, s56, v242
    v_max_i32 v58, 0, v58
    v_lshl_add_u32 v58, v58, 2, s58
    s_and_b64 exec, vcc, s[60:61]
    ds_max_u32 v58, v250
    s_mov_b64 exec, -1
    v_cmp_lt_u32 vcc, s56, v247
    v_cmp_gt_u32 s[60:61], s57, v243
    v_subrev_u32 v59, s56, v243
    v_max_i32 v59, 0, v59
    v_lshl_add_u32 v59, v59, 2, s58
    s_and_b64 exec, vcc, s[60:61]
    ds_max_u32 v59, v251
    s_mov_b64 exec, -1
    v_add_u32 v60, s58, v15
    ds_read_b32 v64, v60 offset:0
    ds_read_b32 v65, v60 offset:256
    ds_read_b32 v66, v60 offset:512
    v_add_u32 v68, s56, v1
    v_add_u32 v69, 64, v68
    v_add_u32 v70, 128, v68
    v_cmp_gt_u32 s[40:41], s46, v68
    v_cmp_gt_u32 s[42:43], s46, v69
    v_cmp_gt_u32 s[44:45], s46, v70
    s_mov_b32 s60, 532480
    s_mov_b32 s61, 3145728
    s_lshr_b32 s62, s26, 24
    s_waitcnt lgkmcnt(0)
    v_max_u32_dpp v64, v64, v64 row_shr:1 row_mask:0xf bank_mask:0xf
    v_max_u32_dpp v65, v65, v65 row_shr:1 row_mask:0xf bank_mask:0xf
    v_max_u32_dpp v66, v66, v66 row_shr:1 row_mask:0xf bank_mask:0xf
    v_max_u32_dpp v64, v64, v64 row_shr:2 row_mask:0xf bank_mask:0xf
    v_max_u32_dpp v65, v65, v65 row_shr:2 row_mask:0xf bank_mask:0xf
    v_max_u32_dpp v66, v66, v66 row_shr:2 row_mask:0xf bank_mask:0xf
    v_max_u32_dpp v64, v64, v64 row_shr:4 row_mask:0xf bank_mask:0xf
    v_max_u32_dpp v65, v65, v65 row_shr:4 row_mask:0xf bank_mask:0xf
    v_max_u32_dpp v66, v66, v66 row_shr:4 row_mask:0xf bank_mask:0xf
    v_max_u32_dpp v64, v64, v64 row_shr:8 row_mask:0xf bank_mask:0xf
    v_max_u32_dpp v65, v65, v65 row_shr:8 row_mask:0xf bank_mask:0xf
    v_max_u32_dpp v66, v66, v66 row_shr:8 row_mask:0xf bank_mask:0xf
    v_max_u32_dpp v64, v64, v64 row_bcast:15 row_mask:0xa bank_mask:0xf
    v_max_u32_dpp v65, v65, v65 row_bcast:15 row_mask:0xa bank_mask:0xf
    v_max_u32_dpp v66, v66, v66 row_bcast:15 row_mask:0xa bank_mask:0xf
    v_max_u32_dpp v64, v64, v64 row_bcast:31 row_mask:0xc bank_mask:0xf
    v_max_u32_dpp v65, v65, v65 row_bcast:31 row_mask:0xc bank_mask:0xf
    v_max_u32_dpp v66, v66, v66 row_bcast:31 row_mask:0xc bank_mask:0xf
    v_readlane_b32 s56, v64, 63
    v_readlane_b32 s57, v65, 63
    v_add_u32 v68, v68, v64
    s_max_u32 s57, s56, s57
    v_max_u32 v65, s56, v65
    v_max_u32 v66, s57, v66
    v_add_u32 v69, v69, v65
    v_add_u32 v70, v70, v66
    v_lshlrev_b32 v81, 3, v68
    v_lshlrev_b32 v82, 3, v69
    v_lshlrev_b32 v83, 3, v70
    s_mov_b64 exec, s[40:41]
    buffer_load_dwordx2 v[72:73], v81, s[36:39], s60 offen sc1
    s_mov_b64 exec, s[42:43]
    buffer_load_dwordx2 v[74:75], v82, s[36:39], s60 offen sc1
    s_mov_b64 exec, s[44:45]
    buffer_load_dwordx2 v[76:77], v83, s[36:39], s60 offen sc1
    s_mov_b64 exec, -1
    v_lshlrev_b32 v100, 4, v68
    v_lshlrev_b32 v101, 4, v69
    v_lshlrev_b32 v102, 4, v70
    s_cmp_lg_u32 s47, 0
    s_cbranch_scc1 K_KEYS1
    s_and_b32 s56, s3, 3
    s_lshl_b32 s56, s56, 6
    s_add_u32 s56, s56, 114944
    v_lshrrev_b32 v10, 4, v1
    v_lshlrev_b32 v10, 11, v10
    v_and_b32 v12, 15, v1
    v_lshl_or_b32 v10, v12, 2, v10
    v_add_u32 v10, s56, v10
    s_mov_b32 s56, 0x05040100
    s_mov_b32 s57, 0x07060302
    ds_read2st64_b32 v[120:121], v10 offset0:0 offset1:1
    ds_read2st64_b32 v[122:123], v10 offset0:2 offset1:3
    ds_read2st64_b32 v[124:125], v10 offset0:4 offset1:5
    ds_read2st64_b32 v[126:127], v10 offset0:6 offset1:7
    ds_read2st64_b32 v[128:129], v10 offset0:32 offset1:33
    ds_read2st64_b32 v[130:131], v10 offset0:34 offset1:35
    ds_read2st64_b32 v[132:133], v10 offset0:36 offset1:37
    ds_read2st64_b32 v[134:135], v10 offset0:38 offset1:39
    ds_read2st64_b32 v[136:137], v10 offset0:64 offset1:65
    ds_read2st64_b32 v[138:139], v10 offset0:66 offset1:67
    ds_read2st64_b32 v[140:141], v10 offset0:68 offset1:69
    ds_read2st64_b32 v[142:143], v10 offset0:70 offset1:71
    ds_read2st64_b32 v[144:145], v10 offset0:96 offset1:97
    ds_read2st64_b32 v[146:147], v10 offset0:98 offset1:99
    ds_read2st64_b32 v[148:149], v10 offset0:100 offset1:101
    ds_read2st64_b32 v[150:151], v10 offset0:102 offset1:103
    s_waitcnt lgkmcnt(15)
    v_perm_b32 v200, v121, v120, s56
    v_perm_b32 v216, v121, v120, s57
    s_waitcnt lgkmcnt(14)
    v_perm_b32 v201, v123, v122, s56
    v_perm_b32 v217, v123, v122, s57
    s_waitcnt lgkmcnt(13)
    v_perm_b32 v202, v125, v124, s56
    v_perm_b32 v218, v125, v124, s57
    s_waitcnt lgkmcnt(12)
    v_perm_b32 v203, v127, v126, s56
    v_perm_b32 v219, v127, v126, s57
    s_waitcnt lgkmcnt(11)
    v_perm_b32 v204, v129, v128, s56
    v_perm_b32 v220, v129, v128, s57
    s_waitcnt lgkmcnt(10)
    v_perm_b32 v205, v131, v130, s56
    v_perm_b32 v221, v131, v130, s57
    s_waitcnt lgkmcnt(9)
    v_perm_b32 v206, v133, v132, s56
    v_perm_b32 v222, v133, v132, s57
    s_waitcnt lgkmcnt(8)
    v_perm_b32 v207, v135, v134, s56
    v_perm_b32 v223, v135, v134, s57
    s_waitcnt lgkmcnt(7)
    v_perm_b32 v208, v137, v136, s56
    v_perm_b32 v224, v137, v136, s57
    s_waitcnt lgkmcnt(6)
    v_perm_b32 v209, v139, v138, s56
    v_perm_b32 v225, v139, v138, s57
    s_waitcnt lgkmcnt(5)
    v_perm_b32 v210, v141, v140, s56
    v_perm_b32 v226, v141, v140, s57
    s_waitcnt lgkmcnt(4)
    v_perm_b32 v211, v143, v142, s56
    v_perm_b32 v227, v143, v142, s57
    s_waitcnt lgkmcnt(3)
    v_perm_b32 v212, v145, v144, s56
    v_perm_b32 v228, v145, v144, s57
    s_waitcnt lgkmcnt(2)
    v_perm_b32 v213, v147, v146, s56
    v_perm_b32 v229, v147, v146, s57
    s_waitcnt lgkmcnt(1)
    v_perm_b32 v214, v149, v148, s56
    v_perm_b32 v230, v149, v148, s57
    s_waitcnt lgkmcnt(0)
    v_perm_b32 v215, v151, v150, s56
    v_perm_b32 v231, v151, v150, s57
    s_branch K_KEYS1
K_KEYS:
    s_mov_b64 exec, s[40:41]
    buffer_load_dwordx2 v[72:73], v81, s[36:39], s60 offen sc1
    s_mov_b64 exec, s[42:43]
    buffer_load_dwordx2 v[74:75], v82, s[36:39], s60 offen sc1
    s_mov_b64 exec, s[44:45]
    buffer_load_dwordx2 v[76:77], v83, s[36:39], s60 offen sc1
    s_mov_b64 exec, -1
K_KEYS1:
    v_mov_b32 v14, 64
    s_mov_b64 s[58:59], 0
    s_waitcnt vmcnt(2)
    v_lshrrev_b32 v78, 24, v72
    v_cmp_ne_u32 vcc, s52, v73
    v_cmp_ne_u32 s[56:57], s62, v78
    s_or_b64 vcc, vcc, s[56:57]
    s_and_b64 vcc, vcc, s[40:41]
    s_or_b64 s[58:59], s[58:59], vcc
    s_waitcnt vmcnt(1)
    v_lshrrev_b32 v79, 24, v74
    v_cmp_ne_u32 vcc, s52, v75
    v_cmp_ne_u32 s[56:57], s62, v79
    s_or_b64 vcc, vcc, s[56:57]
    s_and_b64 vcc, vcc, s[42:43]
    s_or_b64 s[58:59], s[58:59], vcc
    s_waitcnt vmcnt(0)
    v_lshrrev_b32 v80, 24, v76
    v_cmp_ne_u32 vcc, s52, v77
    v_cmp_ne_u32 s[56:57], s62, v80
    s_or_b64 vcc, vcc, s[56:57]
    s_and_b64 vcc, vcc, s[44:45]
    s_or_b64 s[58:59], s[58:59], vcc
    s_cbranch_scc1 K_KEYS
    s_cmp_lg_u32 s47, 0
    s_cbranch_scc1 K_LATER
    s_mov_b32 s62, 8323072
    s_cmp_lt_u32 s3, 4
    s_cbranch_scc0 K_GOT
    buffer_load_dword v184, v185, s[36:39], s62 offen sc1
K_GOT:
    v_lshrrev_b32 v81, 2, v72
    v_and_b32 v81, 0xfc, v81
    v_lshrrev_b32 v82, 2, v74
    v_and_b32 v82, 0xfc, v82
    v_lshrrev_b32 v83, 2, v76
    v_and_b32 v83, 0xfc, v83
    s_mov_b64 exec, s[40:41]
    ds_add_u32 v81, v14 offset:512
    s_mov_b64 exec, s[42:43]
    ds_add_u32 v82, v14 offset:512
    s_mov_b64 exec, s[44:45]
    ds_add_u32 v83, v14 offset:512
    s_mov_b64 exec, -1
    s_lshr_b32 s56, s3, 2
    s_or_b32 s56, s56, s55
    s_cbranch_scc1 K_POLLBOK
K_POLLB:
    s_waitcnt vmcnt(0)
    v_cmp_ne_u32 vcc, s52, v184
    s_cbranch_vccz K_POLLBOK
    buffer_load_dword v184, v185, s[36:39], s62 offen sc1
    s_branch K_POLLB
K_POLLBOK:
    s_waitcnt lgkmcnt(0)
    s_barrier
    s_cmp_lg_u32 s55, 0
    s_cbranch_scc1 K_NOPF
    s_mov_b64 exec, s[40:41]
    buffer_load_dwordx4 v[88:91], v100, s[36:39], s61 offen sc1
    s_mov_b64 exec, s[42:43]
    buffer_load_dwordx4 v[92:95], v101, s[36:39], s61 offen sc1
    s_mov_b64 exec, s[44:45]
    buffer_load_dwordx4 v[96:99], v102, s[36:39], s61 offen sc1
    s_mov_b64 exec, -1
    s_cmp_lt_u32 s3, 5
    s_cbranch_scc1 K_NOPF
    s_mov_b32 s64, s4
    s_mov_b32 s65, s5
    s_mov_b32 s66, 10240000
    s_mov_b32 s67, 0x20000
    s_sub_u32 s68, 9, s3
    s_lshl_b32 s68, s68, 5
    s_and_b32 s69, s53, 31
    s_add_u32 s68, s68, s69
    s_lshl_b32 s68, s68, 13
    s_add_u32 s68, s68, s27
    v_lshlrev_b32 v12, 7, v1
    buffer_load_dword v255, v12, s[64:67], s68 offen
K_NOPF:
    ds_read_b32 v168, v15 offset:512
    ds_read_b128 v[120:123], v4 offset:512
    ds_read_b128 v[124:127], v4 offset:528
    ds_read_b128 v[128:131], v4 offset:544
    ds_read_b128 v[132:135], v4 offset:560
    ds_read_b128 v[136:139], v4 offset:576
    ds_read_b128 v[140:143], v4 offset:592
    ds_read_b128 v[144:147], v4 offset:608
    ds_read_b128 v[148:151], v4 offset:624
    ds_read_b128 v[152:155], v4 offset:640
    ds_read_b128 v[156:159], v4 offset:656
    v_cmp_gt_u32 vcc, 40, v1
    s_waitcnt lgkmcnt(9)
    v_pk_add_f32 v[120:121], v[120:121], v[168:169] op_sel_hi:[1,0] neg_lo:[0,1] neg_hi:[0,1] clamp
    v_pk_add_f32 v[122:123], v[122:123], v[168:169] op_sel_hi:[1,0] neg_lo:[0,1] neg_hi:[0,1] clamp
    s_waitcnt lgkmcnt(8)
    v_pk_add_f32 v[124:125], v[124:125], v[168:169] op_sel_hi:[1,0] neg_lo:[0,1] neg_hi:[0,1] clamp
    v_pk_add_f32 v[124:125], v[124:125], v[120:121]
    v_pk_add_f32 v[126:127], v[126:127], v[168:169] op_sel_hi:[1,0] neg_lo:[0,1] neg_hi:[0,1] clamp
    v_pk_add_f32 v[126:127], v[126:127], v[122:123]
    s_waitcnt lgkmcnt(7)
    v_pk_add_f32 v[128:129], v[128:129], v[168:169] op_sel_hi:[1,0] neg_lo:[0,1] neg_hi:[0,1] clamp
    v_pk_add_f32 v[128:129], v[128:129], v[124:125]
    v_pk_add_f32 v[130:131], v[130:131], v[168:169] op_sel_hi:[1,0] neg_lo:[0,1] neg_hi:[0,1] clamp
    v_pk_add_f32 v[130:131], v[130:131], v[126:127]
    s_waitcnt lgkmcnt(6)
    v_pk_add_f32 v[132:133], v[132:133], v[168:169] op_sel_hi:[1,0] neg_lo:[0,1] neg_hi:[0,1] clamp
    v_pk_add_f32 v[132:133], v[132:133], v[128:129]
    v_pk_add_f32 v[134:135], v[134:135], v[168:169] op_sel_hi:[1,0] neg_lo:[0,1] neg_hi:[0,1] clamp
    v_pk_add_f32 v[134:135], v[134:135], v[130:131]
    s_waitcnt lgkmcnt(5)
    v_pk_add_f32 v[136:137], v[136:137], v[168:169] op_sel_hi:[1,0] neg_lo:[0,1] neg_hi:[0,1] clamp
    v_pk_add_f32 v[136:137], v[136:137], v[132:133]
    v_pk_add_f32 v[138:139], v[138:139], v[168:169] op_sel_hi:[1,0] neg_lo:[0,1] neg_hi:[0,1] clamp
    v_pk_add_f32 v[138:139], v[138:139], v[134:135]
    s_waitcnt lgkmcnt(4)
    v_pk_add_f32 v[140:141], v[140:141], v[168:169] op_sel_hi:[1,0] neg_lo:[0,1] neg_hi:[0,1] clamp
    v_pk_add_f32 v[140:141], v[140:141], v[136:137]
    v_pk_add_f32 v[142:143], v[142:143], v[168:169] op_sel_hi:[1,0] neg_lo:[0,1] neg_hi:[0,1] clamp
    v_pk_add_f32 v[142:143], v[142:143], v[138:139]
    s_waitcnt lgkmcnt(3)
    v_pk_add_f32 v[144:145], v[144:145], v[168:169] op_sel_hi:[1,0] neg_lo:[0,1] neg_hi:[0,1] clamp
    v_pk_add_f32 v[144:145], v[144:145], v[140:141]
    v_pk_add_f32 v[146:147], v[146:147], v[168:169] op_sel_hi:[1,0] neg_lo:[0,1] neg_hi:[0,1] clamp
    v_pk_add_f32 v[146:147], v[146:147], v[142:143]
    s_waitcnt lgkmcnt(2)
    v_pk_add_f32 v[148:149], v[148:149], v[168:169] op_sel_hi:[1,0] neg_lo:[0,1] neg_hi:[0,1] clamp
    v_pk_add_f32 v[148:149], v[148:149], v[144:145]
    v_pk_add_f32 v[150:151], v[150:151], v[168:169] op_sel_hi:[1,0] neg_lo:[0,1] neg_hi:[0,1] clamp
    v_pk_add_f32 v[150:151], v[150:151], v[146:147]
    s_waitcnt lgkmcnt(1)
    v_pk_add_f32 v[152:153], v[152:153], v[168:169] op_sel_hi:[1,0] neg_lo:[0,1] neg_hi:[0,1] clamp
    v_pk_add_f32 v[152:153], v[152:153], v[148:149]
    v_pk_add_f32 v[154:155], v[154:155], v[168:169] op_sel_hi:[1,0] neg_lo:[0,1] neg_hi:[0,1] clamp
    v_pk_add_f32 v[154:155], v[154:155], v[150:151]
    s_waitcnt lgkmcnt(0)
    v_pk_add_f32 v[156:157], v[156:157], v[168:169] op_sel_hi:[1,0] neg_lo:[0,1] neg_hi:[0,1] clamp
    v_pk_add_f32 v[156:157], v[156:157], v[152:153]
    v_pk_add_f32 v[158:159], v[158:159], v[168:169] op_sel_hi:[1,0] neg_lo:[0,1] neg_hi:[0,1] clamp
    v_pk_add_f32 v[158:159], v[158:159], v[154:155]
    v_pk_add_f32 v[158:159], v[158:159], v[156:157]
    v_add_f32 v158, v158, v159
    v_cvt_u32_f32 v158, v158
    v_lshlrev_b32 v158, 2, v158
    ds_bpermute_b32 v2, v158, v2
    s_waitcnt lgkmcnt(0)
    v_cndmask_b32 v2, -1, v2, vcc
K_BAL:
    ds_bpermute_b32 v84, v81, v2
    ds_bpermute_b32 v85, v82, v2
    ds_bpermute_b32 v86, v83, v2
    v_mov_b32 v14, 1
    v_lshlrev_b32 v10, 3, v1
    s_lshr_b32 s56, s53, 4
    s_and_b32 s56, s56, 14
    v_subrev_u32 v103, s56, v72
    v_and_b32 v103, 15, v103
    v_subrev_u32 v104, s56, v74
    v_and_b32 v104, 15, v104
    v_subrev_u32 v105, s56, v76
    v_and_b32 v105, 15, v105
    s_waitcnt lgkmcnt(2)
    s_mov_b64 exec, s[40:41]
    v_and_b32 v81, 7, v84
    v_lshl_or_b32 v103, v81, 4, v103
    v_lshlrev_b32 v81, 2, v103
    ds_add_rtn_u32 v78, v81, v14 offset:0
    s_waitcnt lgkmcnt(2)
    s_mov_b64 exec, s[42:43]
    v_and_b32 v82, 7, v85
    v_lshl_or_b32 v104, v82, 4, v104
    v_lshlrev_b32 v82, 2, v104
    ds_add_rtn_u32 v79, v82, v14 offset:0
    s_waitcnt lgkmcnt(2)
    s_mov_b64 exec, s[44:45]
    v_and_b32 v83, 7, v86
    v_lshl_or_b32 v105, v83, 4, v105
    v_lshlrev_b32 v83, 2, v105
    ds_add_rtn_u32 v80, v83, v14 offset:0
    s_mov_b64 exec, -1
    v_lshlrev_b32 v81, 1, v103
    v_lshlrev_b32 v103, 4, v103
    v_and_b32 v84, 0x38, v84
    v_and_b32 v72, 16776192, v72
    v_lshlrev_b32 v82, 1, v104
    v_lshlrev_b32 v104, 4, v104
    v_and_b32 v85, 0x38, v85
    v_and_b32 v74, 16776192, v74
    v_lshlrev_b32 v83, 1, v105
    v_lshlrev_b32 v105, 4, v105
    v_and_b32 v86, 0x38, v86
    v_and_b32 v76, 16776192, v76
    s_lshl_b32 s56, s3, 3
    s_add_u32 s57, s56, 7
    v_lshrrev_b32 v114, 3, v1
    v_mul_u32_u24 v114, 48, v114
    s_waitcnt lgkmcnt(0)
    s_barrier
    ds_read_b64 v[108:109], v10 offset:0
    s_sub_u32 s58, s27, 1024
    s_cselect_b32 s58, 10238976, s58
    s_waitcnt lgkmcnt(0)
    v_add_u32 v110, v108, v109
    v_mov_b32 v111, v110
    v_and_b32 v12, 15, v1
    v_lshrrev_b32 v11, 2, v1
    v_add_u32_dpp v111, v111, v111 row_shr:1 row_mask:0xf bank_mask:0xf
    v_and_b32 v11, 8, v11
    v_xor_b32 v11, v11, v1
    v_add_u32_dpp v111, v111, v111 row_shr:2 row_mask:0xf bank_mask:0xf
    v_mov_b32 v115, s58
    v_mov_b32 v254, 0
    v_add_u32_dpp v111, v111, v111 row_shr:4 row_mask:0xf bank_mask:0xf
    v_lshlrev_b32 v11, 3, v11
    v_lshrrev_b32 v13, 2, v1
    v_add_u32_dpp v111, v111, v111 row_shr:8 row_mask:0xf bank_mask:0xf
    v_and_b32 v10, 3, v1
    v_lshl_or_b32 v13, v10, 4, v13
    v_add_u32_dpp v111, v111, v111 row_bcast:15 row_mask:0xa bank_mask:0xf
    v_lshlrev_b32 v10, 2, v10
    v_and_b32 v10, 8, v10
    v_add_u32_dpp v111, v111, v111 row_bcast:31 row_mask:0xc bank_mask:0xf
    v_sub_u32 v110, v111, v110
    v_readlane_b32 s51, v111, s57
    v_xor_b32 v10, v10, v13
    v_lshlrev_b32 v10, 3, v10
    v_mov_b32_dpp v112, v110 row_newbcast:0 row_mask:0xf bank_mask:0x3
    v_readlane_b32 s58, v110, s56
    s_nop 0
    v_mov_b32_dpp v112, v110 row_newbcast:8 row_mask:0xf bank_mask:0xc
    v_add_u32 v113, 15, v112
    v_and_b32 v113, -16, v113
    v_add_u32 v113, v113, v114
    v_sub_u32 v112, v113, v112
    v_add_u32 v112, v112, v110
    v_add_u32 v108, v112, v108
    v_lshl_or_b32 v108, v108, 16, v112
    v_readlane_b32 s50, v113, s56
    ds_bpermute_b32 v81, v81, v108
    ds_bpermute_b32 v82, v82, v108
    ds_bpermute_b32 v83, v83, v108
    s_sub_u32 s51, s51, s58
    s_add_u32 s56, s50, s51
    v_add_u32 v109, s56, v1
    v_lshlrev_b32 v110, 2, v109
    v_lshlrev_b32 v111, 4, v109
    s_mov_b64 exec, 0xfffff
    ds_write_b32 v110, v115 offset:4096
    ds_write_b8 v109, v4 offset:11840
    ds_write_b128 v111, v[4:7] offset:13824
    s_mov_b64 exec, s[40:41]
    s_waitcnt lgkmcnt(5)
    v_bfe_u32 v81, v81, v103, 16
    v_add_u32 v81, v81, v78
    v_lshlrev_b32 v78, 2, v81
    v_lshlrev_b32 v103, 4, v81
    ds_write_b32 v78, v72 offset:4096
    ds_write_b8 v81, v84 offset:11840
    s_mov_b64 exec, s[42:43]
    s_waitcnt lgkmcnt(6)
    v_bfe_u32 v82, v82, v104, 16
    v_add_u32 v82, v82, v79
    v_lshlrev_b32 v79, 2, v82
    v_lshlrev_b32 v104, 4, v82
    ds_write_b32 v79, v74 offset:4096
    ds_write_b8 v82, v85 offset:11840
    s_mov_b64 exec, s[44:45]
    s_waitcnt lgkmcnt(7)
    v_bfe_u32 v83, v83, v105, 16
    v_add_u32 v83, v83, v80
    v_lshlrev_b32 v80, 2, v83
    v_lshlrev_b32 v105, 4, v83
    ds_write_b32 v80, v76 offset:4096
    ds_write_b8 v83, v86 offset:11840
    s_mov_b64 exec, -1
    s_add_u32 s58, s3, 0
    v_cmp_eq_u32 vcc, s58, v2
    s_ff1_i32_b64 s58, vcc
    s_mul_i32 s58, s58, 1152
    s_add_u32 s58, s58, 106752
    v_add_u32 v106, s58, v15
    s_add_u32 s58, s3, 8
    v_cmp_eq_u32 vcc, s58, v2
    s_ff1_i32_b64 s58, vcc
    s_mul_i32 s58, s58, 1152
    s_add_u32 s58, s58, 106752
    v_add_u32 v107, s58, v15
    s_add_u32 s58, s3, 16
    v_cmp_eq_u32 vcc, s58, v2
    s_ff1_i32_b64 s58, vcc
    s_mul_i32 s58, s58, 1152
    s_add_u32 s58, s58, 106752
    v_add_u32 v116, s58, v15
    s_add_u32 s58, s3, 24
    v_cmp_eq_u32 vcc, s58, v2
    s_ff1_i32_b64 s58, vcc
    s_mul_i32 s58, s58, 1152
    s_add_u32 s58, s58, 106752
    v_add_u32 v117, s58, v15
    s_add_u32 s58, s3, 32
    v_cmp_eq_u32 vcc, s58, v2
    s_ff1_i32_b64 s58, vcc
    s_mul_i32 s58, s58, 1152
    s_add_u32 s58, s58, 106752
    v_add_u32 v118, s58, v15
    s_cmp_lt_u32 s3, 5
    s_cselect_b32 s56, 1, s47
    s_or_b32 s56, s56, s55
    s_cbranch_scc0 K_PW1
    s_waitcnt vmcnt(0)
K_PW1:
    s_waitcnt vmcnt(1)
    s_mov_b64 exec, s[40:41]
    ds_write_b128 v103, v[88:91] offset:13824
    s_mov_b64 exec, s[42:43]
    ds_write_b128 v104, v[92:95] offset:13824
    s_mov_b64 exec, s[44:45]
    ds_write_b128 v105, v[96:99] offset:13824
    s_mov_b64 exec, -1
    s_lshl_b32 s56, s50, 2
    s_add_u32 s56, s56, 4096
    v_mov_b32 v196, s56
    s_add_u32 s56, s50, 11840
    v_mov_b32 v197, s56
    s_lshl_b32 s56, s50, 5
    s_add_u32 s56, s56, 44800
    v_add_u32 v198, s56, v10
    v_add_u32 v11, s56, v11
    s_lshl_b32 s57, s50, 4
    s_add_u32 s57, s57, 13824
    v_lshl_add_u32 v199, v12, 4, s57
    v_add_u32 v10, s57, v9
    s_add_u32 s48, s51, 3
    s_lshr_b32 s48, s48, 2
    s_waitcnt lgkmcnt(0)
    s_barrier
    s_cmp_eq_u32 s48, 0
    s_cbranch_scc1 K2_LOOPDONE
    ds_read_b128 v[120:123], v196 offset:0
    ds_read_b128 v[124:127], v196 offset:16
    ds_read_b64 v[152:153], v10
    ds_read2_b64 v[188:191], v196 offset0:4 offset1:5
    ds_read_b64 v[186:187], v199 offset:8
    ds_read_b128 v[192:195], v197
    s_lshl_b32 s56, s48, 2
    s_waitcnt lgkmcnt(5)
    buffer_load_dwordx4 v[56:59], v120, s[28:31], 0 offen
    buffer_load_dwordx4 v[60:63], v121, s[28:31], 0 offen
    buffer_load_dwordx4 v[64:67], v122, s[28:31], 0 offen
    buffer_load_dwordx4 v[68:71], v123, s[28:31], 0 offen
    s_waitcnt lgkmcnt(4)
    buffer_load_dwordx4 v[72:75], v124, s[28:31], 0 offen
    buffer_load_dwordx4 v[76:79], v125, s[28:31], 0 offen
    buffer_load_dwordx4 v[80:83], v126, s[28:31], 0 offen
    buffer_load_dwordx4 v[84:87], v127, s[28:31], 0 offen
K_APREP:
    v_cmp_gt_u32 vcc, s56, v1
    s_waitcnt lgkmcnt(0)
    s_nop 0
    v_cndmask_b32 v160, 0, v152, vcc
    v_cndmask_b32 v161, 0, v153, vcc
    ds_read_b64 v[152:153], v10 offset:1024
    v_add_u32 v10, 1024, v10
    v_mfma_f32_16x16x16_bf16 v[136:139], v[232:233], v[160:161], 0
    v_mfma_f32_16x16x16_bf16 v[140:143], v[234:235], v[160:161], 0
    v_mfma_f32_16x16x16_bf16 v[144:147], v[236:237], v[160:161], 0
    v_mfma_f32_16x16x16_bf16 v[148:151], v[238:239], v[160:161], 0
    s_nop 4
    v_cvt_pk_bf16_f32 v168, v136, v137
    v_cvt_pk_bf16_f32 v169, v138, v139
    ds_write_b64 v11, v[168:169] offset:0
    s_sub_u32 s56, s56, 16
    s_cmp_le_i32 s56, 0
    s_cbranch_scc1 K_APDONE
    v_cvt_pk_bf16_f32 v170, v140, v141
    v_cvt_pk_bf16_f32 v171, v142, v143
    ds_write_b64 v11, v[170:171] offset:512
    s_sub_u32 s56, s56, 16
    s_cmp_le_i32 s56, 0
    s_cbranch_scc1 K_APDONE
    v_cvt_pk_bf16_f32 v172, v144, v145
    v_cvt_pk_bf16_f32 v173, v146, v147
    ds_write_b64 v11, v[172:173] offset:1024
    s_sub_u32 s56, s56, 16
    s_cmp_le_i32 s56, 0
    s_cbranch_scc1 K_APDONE
    v_cvt_pk_bf16_f32 v174, v148, v149
    v_cvt_pk_bf16_f32 v175, v150, v151
    ds_write_b64 v11, v[174:175] offset:1536
    s_sub_u32 s56, s56, 16
    s_cmp_le_i32 s56, 0
    s_cbranch_scc1 K_APDONE
    v_add_u32 v11, 2048, v11
    s_branch K_APREP
K_APDONE:
    s_waitcnt lgkmcnt(0)
    ds_read_b64 v[184:185], v198
    v_mfma_f32_4x4x4_16b_bf16 v[152:155], v[186:187], v[176:177], 0 cbsz:4 abid:0
    v_mfma_f32_4x4x4_16b_bf16 v[156:159], v[186:187], v[180:181], 0 cbsz:4 abid:0
    s_sub_u32 s48, s48, 3
    s_nop 2
    s_cbranch_scc1 K2_D0
.p2align 4
K2_LOOP:
    s_waitcnt vmcnt(6) lgkmcnt(0)
    v_subrev_u32 v255, s27, v188
    v_cmp_gt_u32 vcc, v255, v254
    ds_write_b32 v252, v255 offset:2048
    s_setprio 0
    s_cbranch_vccnz K2_P0
    s_setprio 1
K2_P0:
    v_mfma_f32_4x4x4_16b_bf16 v[120:123], v[184:185], v[56:57], 0 cbsz:4 abid:0
    v_exp_f32 v168, v152
    v_mfma_f32_4x4x4_16b_bf16 v[124:127], v[184:185], v[58:59], 0 cbsz:4 abid:0
    v_exp_f32 v169, v153
    v_mfma_f32_4x4x4_16b_bf16 v[128:131], v[184:185], v[60:61], 0 cbsz:4 abid:1
    v_exp_f32 v170, v154
    v_mfma_f32_4x4x4_16b_bf16 v[132:135], v[184:185], v[62:63], 0 cbsz:4 abid:1
    buffer_load_dwordx4 v[56:59], v188, s[28:31], 0 offen
    buffer_load_dwordx4 v[60:63], v189, s[28:31], 0 offen
    v_exp_f32 v171, v155
    s_waitcnt vmcnt(6)
    v_mfma_f32_4x4x4_16b_bf16 v[136:139], v[184:185], v[64:65], 0 cbsz:4 abid:2
    v_exp_f32 v172, v156
    v_mfma_f32_4x4x4_16b_bf16 v[140:143], v[184:185], v[66:67], 0 cbsz:4 abid:2
    v_exp_f32 v173, v157
    v_exp_f32 v174, v158
    v_exp_f32 v175, v159
    v_pk_add_f32 v[168:169], v[168:169], 1.0 op_sel_hi:[1,0]
    v_pk_add_f32 v[170:171], v[170:171], 1.0 op_sel_hi:[1,0]
    v_pk_add_f32 v[172:173], v[172:173], 1.0 op_sel_hi:[1,0]
    v_pk_add_f32 v[174:175], v[174:175], 1.0 op_sel_hi:[1,0]
    v_mfma_f32_4x4x4_16b_bf16 v[144:147], v[184:185], v[68:69], 0 cbsz:4 abid:3
    v_rcp_f32 v168, v168
    v_mfma_f32_4x4x4_16b_bf16 v[148:151], v[184:185], v[70:71], 0 cbsz:4 abid:3
    buffer_load_dwordx4 v[64:67], v190, s[28:31], 0 offen
    buffer_load_dwordx4 v[68:71], v191, s[28:31], 0 offen
    v_rcp_f32 v169, v169
    ds_read_b128 v[188:191], v196 offset:48
    v_mfma_f32_4x4x4_16b_bf16 v[160:163], v[186:187], v[176:177], 0 cbsz:4 abid:1
    v_rcp_f32 v170, v170
    v_mfma_f32_4x4x4_16b_bf16 v[164:167], v[186:187], v[180:181], 0 cbsz:4 abid:1
    v_rcp_f32 v171, v171
    v_rcp_f32 v172, v172
    v_rcp_f32 v173, v173
    v_rcp_f32 v174, v174
    v_rcp_f32 v175, v175
    v_readfirstlane_b32 s49, v192
    v_pk_mul_f32 v[168:169], v[168:169], v[152:153]
    v_pk_mul_f32 v[170:171], v[170:171], v[154:155]
    v_pk_mul_f32 v[172:173], v[172:173], v[156:157]
    v_pk_mul_f32 v[174:175], v[174:175], v[158:159]
    s_set_gpr_idx_on s49, gpr_idx(SRC2,DST)
    v_pk_fma_f32 v[16:17], v[168:169], v[120:121], v[16:17] op_sel:[0,0,0] op_sel_hi:[0,1,1]
    v_pk_fma_f32 v[18:19], v[168:169], v[122:123], v[18:19] op_sel:[0,0,0] op_sel_hi:[0,1,1]
    v_pk_fma_f32 v[20:21], v[172:173], v[124:125], v[20:21] op_sel:[0,0,0] op_sel_hi:[0,1,1]
    v_pk_fma_f32 v[22:23], v[172:173], v[126:127], v[22:23] op_sel:[0,0,0] op_sel_hi:[0,1,1]
    s_lshr_b32 s49, s49, 8
    s_set_gpr_idx_idx s49
    v_pk_fma_f32 v[16:17], v[168:169], v[128:129], v[16:17] op_sel:[1,0,0] op_sel_hi:[1,1,1]
    v_pk_fma_f32 v[18:19], v[168:169], v[130:131], v[18:19] op_sel:[1,0,0] op_sel_hi:[1,1,1]
    v_pk_fma_f32 v[20:21], v[172:173], v[132:133], v[20:21] op_sel:[1,0,0] op_sel_hi:[1,1,1]
    v_pk_fma_f32 v[22:23], v[172:173], v[134:135], v[22:23] op_sel:[1,0,0] op_sel_hi:[1,1,1]
    s_lshr_b32 s49, s49, 8
    s_set_gpr_idx_idx s49
    v_pk_fma_f32 v[16:17], v[170:171], v[136:137], v[16:17] op_sel:[0,0,0] op_sel_hi:[0,1,1]
    v_pk_fma_f32 v[18:19], v[170:171], v[138:139], v[18:19] op_sel:[0,0,0] op_sel_hi:[0,1,1]
    v_pk_fma_f32 v[20:21], v[174:175], v[140:141], v[20:21] op_sel:[0,0,0] op_sel_hi:[0,1,1]
    v_pk_fma_f32 v[22:23], v[174:175], v[142:143], v[22:23] op_sel:[0,0,0] op_sel_hi:[0,1,1]
    s_lshr_b32 s49, s49, 8
    s_set_gpr_idx_idx s49
    v_pk_fma_f32 v[16:17], v[170:171], v[144:145], v[16:17] op_sel:[1,0,0] op_sel_hi:[1,1,1]
    v_pk_fma_f32 v[18:19], v[170:171], v[146:147], v[18:19] op_sel:[1,0,0] op_sel_hi:[1,1,1]
    v_pk_fma_f32 v[20:21], v[174:175], v[148:149], v[20:21] op_sel:[1,0,0] op_sel_hi:[1,1,1]
    v_pk_fma_f32 v[22:23], v[174:175], v[150:151], v[22:23] op_sel:[1,0,0] op_sel_hi:[1,1,1]
    s_set_gpr_idx_off
    s_sub_u32 s48, s48, 1
    s_cbranch_scc1 K2_D1
    s_waitcnt vmcnt(6) lgkmcnt(0)
    v_mfma_f32_4x4x4_16b_bf16 v[120:123], v[184:185], v[72:73], 0 cbsz:4 abid:4
    v_exp_f32 v168, v160
    v_mfma_f32_4x4x4_16b_bf16 v[124:127], v[184:185], v[74:75], 0 cbsz:4 abid:4
    v_exp_f32 v169, v161
    v_mfma_f32_4x4x4_16b_bf16 v[128:131], v[184:185], v[76:77], 0 cbsz:4 abid:5
    v_exp_f32 v170, v162
    v_mfma_f32_4x4x4_16b_bf16 v[132:135], v[184:185], v[78:79], 0 cbsz:4 abid:5
    buffer_load_dwordx4 v[72:75], v188, s[28:31], 0 offen
    buffer_load_dwordx4 v[76:79], v189, s[28:31], 0 offen
    v_exp_f32 v171, v163
    s_waitcnt vmcnt(6)
    v_mfma_f32_4x4x4_16b_bf16 v[136:139], v[184:185], v[80:81], 0 cbsz:4 abid:6
    v_exp_f32 v172, v164
    v_mfma_f32_4x4x4_16b_bf16 v[140:143], v[184:185], v[82:83], 0 cbsz:4 abid:6
    v_exp_f32 v173, v165
    v_exp_f32 v174, v166
    v_exp_f32 v175, v167
    v_pk_add_f32 v[168:169], v[168:169], 1.0 op_sel_hi:[1,0]
    v_pk_add_f32 v[170:171], v[170:171], 1.0 op_sel_hi:[1,0]
    v_pk_add_f32 v[172:173], v[172:173], 1.0 op_sel_hi:[1,0]
    v_pk_add_f32 v[174:175], v[174:175], 1.0 op_sel_hi:[1,0]
    v_mfma_f32_4x4x4_16b_bf16 v[144:147], v[184:185], v[84:85], 0 cbsz:4 abid:7
    v_rcp_f32 v168, v168
    v_mfma_f32_4x4x4_16b_bf16 v[148:151], v[184:185], v[86:87], 0 cbsz:4 abid:7
    buffer_load_dwordx4 v[80:83], v190, s[28:31], 0 offen
    buffer_load_dwordx4 v[84:87], v191, s[28:31], 0 offen
    v_rcp_f32 v169, v169
    ds_read_b128 v[188:191], v196 offset:64
    ds_read_b32 v254, v253 offset:2048
    v_mfma_f32_4x4x4_16b_bf16 v[152:155], v[186:187], v[176:177], 0 cbsz:4 abid:2
    v_rcp_f32 v170, v170
    v_mfma_f32_4x4x4_16b_bf16 v[156:159], v[186:187], v[180:181], 0 cbsz:4 abid:2
    v_rcp_f32 v171, v171
    v_rcp_f32 v172, v172
    v_rcp_f32 v173, v173
    v_rcp_f32 v174, v174
    v_rcp_f32 v175, v175
    v_readfirstlane_b32 s49, v193
    v_pk_mul_f32 v[168:169], v[168:169], v[160:161]
    v_pk_mul_f32 v[170:171], v[170:171], v[162:163]
    v_pk_mul_f32 v[172:173], v[172:173], v[164:165]
    v_pk_mul_f32 v[174:175], v[174:175], v[166:167]
    s_set_gpr_idx_on s49, gpr_idx(SRC2,DST)
    v_pk_fma_f32 v[16:17], v[168:169], v[120:121], v[16:17] op_sel:[0,0,0] op_sel_hi:[0,1,1]
    v_pk_fma_f32 v[18:19], v[168:169], v[122:123], v[18:19] op_sel:[0,0,0] op_sel_hi:[0,1,1]
    v_pk_fma_f32 v[20:21], v[172:173], v[124:125], v[20:21] op_sel:[0,0,0] op_sel_hi:[0,1,1]
    v_pk_fma_f32 v[22:23], v[172:173], v[126:127], v[22:23] op_sel:[0,0,0] op_sel_hi:[0,1,1]
    s_lshr_b32 s49, s49, 8
    s_set_gpr_idx_idx s49
    v_pk_fma_f32 v[16:17], v[168:169], v[128:129], v[16:17] op_sel:[1,0,0] op_sel_hi:[1,1,1]
    v_pk_fma_f32 v[18:19], v[168:169], v[130:131], v[18:19] op_sel:[1,0,0] op_sel_hi:[1,1,1]
    v_pk_fma_f32 v[20:21], v[172:173], v[132:133], v[20:21] op_sel:[1,0,0] op_sel_hi:[1,1,1]
    v_pk_fma_f32 v[22:23], v[172:173], v[134:135], v[22:23] op_sel:[1,0,0] op_sel_hi:[1,1,1]
    s_lshr_b32 s49, s49, 8
    s_set_gpr_idx_idx s49
    v_pk_fma_f32 v[16:17], v[170:171], v[136:137], v[16:17] op_sel:[0,0,0] op_sel_hi:[0,1,1]
    v_pk_fma_f32 v[18:19], v[170:171], v[138:139], v[18:19] op_sel:[0,0,0] op_sel_hi:[0,1,1]
    v_pk_fma_f32 v[20:21], v[174:175], v[140:141], v[20:21] op_sel:[0,0,0] op_sel_hi:[0,1,1]
    v_pk_fma_f32 v[22:23], v[174:175], v[142:143], v[22:23] op_sel:[0,0,0] op_sel_hi:[0,1,1]
    s_lshr_b32 s49, s49, 8
    s_set_gpr_idx_idx s49
    v_pk_fma_f32 v[16:17], v[170:171], v[144:145], v[16:17] op_sel:[1,0,0] op_sel_hi:[1,1,1]
    v_pk_fma_f32 v[18:19], v[170:171], v[146:147], v[18:19] op_sel:[1,0,0] op_sel_hi:[1,1,1]
    v_pk_fma_f32 v[20:21], v[174:175], v[148:149], v[20:21] op_sel:[1,0,0] op_sel_hi:[1,1,1]
    v_pk_fma_f32 v[22:23], v[174:175], v[150:151], v[22:23] op_sel:[1,0,0] op_sel_hi:[1,1,1]
    s_set_gpr_idx_off
    s_sub_u32 s48, s48, 1
    s_cbranch_scc1 K2_D2
    s_waitcnt vmcnt(6) lgkmcnt(0)
    v_subrev_u32 v255, s27, v188
    v_cmp_gt_u32 vcc, v255, v254
    ds_write_b32 v252, v255 offset:2048
    s_setprio 0
    s_cbranch_vccnz K2_P2
    s_setprio 1
K2_P2:
    v_mfma_f32_4x4x4_16b_bf16 v[120:123], v[184:185], v[56:57], 0 cbsz:4 abid:8
    v_exp_f32 v168, v152
    v_mfma_f32_4x4x4_16b_bf16 v[124:127], v[184:185], v[58:59], 0 cbsz:4 abid:8
    v_exp_f32 v169, v153
    v_mfma_f32_4x4x4_16b_bf16 v[128:131], v[184:185], v[60:61], 0 cbsz:4 abid:9
    v_exp_f32 v170, v154
    v_mfma_f32_4x4x4_16b_bf16 v[132:135], v[184:185], v[62:63], 0 cbsz:4 abid:9
    buffer_load_dwordx4 v[56:59], v188, s[28:31], 0 offen
    buffer_load_dwordx4 v[60:63], v189, s[28:31], 0 offen
    v_exp_f32 v171, v155
    s_waitcnt vmcnt(6)
    v_mfma_f32_4x4x4_16b_bf16 v[136:139], v[184:185], v[64:65], 0 cbsz:4 abid:10
    v_exp_f32 v172, v156
    v_mfma_f32_4x4x4_16b_bf16 v[140:143], v[184:185], v[66:67], 0 cbsz:4 abid:10
    v_exp_f32 v173, v157
    v_exp_f32 v174, v158
    v_exp_f32 v175, v159
    v_pk_add_f32 v[168:169], v[168:169], 1.0 op_sel_hi:[1,0]
    v_pk_add_f32 v[170:171], v[170:171], 1.0 op_sel_hi:[1,0]
    v_pk_add_f32 v[172:173], v[172:173], 1.0 op_sel_hi:[1,0]
    v_pk_add_f32 v[174:175], v[174:175], 1.0 op_sel_hi:[1,0]
    v_mfma_f32_4x4x4_16b_bf16 v[144:147], v[184:185], v[68:69], 0 cbsz:4 abid:11
    v_rcp_f32 v168, v168
    v_mfma_f32_4x4x4_16b_bf16 v[148:151], v[184:185], v[70:71], 0 cbsz:4 abid:11
    buffer_load_dwordx4 v[64:67], v190, s[28:31], 0 offen
    buffer_load_dwordx4 v[68:71], v191, s[28:31], 0 offen
    v_rcp_f32 v169, v169
    ds_read_b128 v[188:191], v196 offset:80
    v_mfma_f32_4x4x4_16b_bf16 v[160:163], v[186:187], v[176:177], 0 cbsz:4 abid:3
    v_rcp_f32 v170, v170
    v_mfma_f32_4x4x4_16b_bf16 v[164:167], v[186:187], v[180:181], 0 cbsz:4 abid:3
    v_rcp_f32 v171, v171
    v_rcp_f32 v172, v172
    ds_read_b64 v[186:187], v199 offset:264
    v_rcp_f32 v173, v173
    v_rcp_f32 v174, v174
    v_rcp_f32 v175, v175
    v_readfirstlane_b32 s49, v194
    v_pk_mul_f32 v[168:169], v[168:169], v[152:153]
    v_pk_mul_f32 v[170:171], v[170:171], v[154:155]
    v_pk_mul_f32 v[172:173], v[172:173], v[156:157]
    v_pk_mul_f32 v[174:175], v[174:175], v[158:159]
    s_set_gpr_idx_on s49, gpr_idx(SRC2,DST)
    v_pk_fma_f32 v[16:17], v[168:169], v[120:121], v[16:17] op_sel:[0,0,0] op_sel_hi:[0,1,1]
    v_pk_fma_f32 v[18:19], v[168:169], v[122:123], v[18:19] op_sel:[0,0,0] op_sel_hi:[0,1,1]
    v_pk_fma_f32 v[20:21], v[172:173], v[124:125], v[20:21] op_sel:[0,0,0] op_sel_hi:[0,1,1]
    v_pk_fma_f32 v[22:23], v[172:173], v[126:127], v[22:23] op_sel:[0,0,0] op_sel_hi:[0,1,1]
    s_lshr_b32 s49, s49, 8
    s_set_gpr_idx_idx s49
    v_pk_fma_f32 v[16:17], v[168:169], v[128:129], v[16:17] op_sel:[1,0,0] op_sel_hi:[1,1,1]
    v_pk_fma_f32 v[18:19], v[168:169], v[130:131], v[18:19] op_sel:[1,0,0] op_sel_hi:[1,1,1]
    v_pk_fma_f32 v[20:21], v[172:173], v[132:133], v[20:21] op_sel:[1,0,0] op_sel_hi:[1,1,1]
    v_pk_fma_f32 v[22:23], v[172:173], v[134:135], v[22:23] op_sel:[1,0,0] op_sel_hi:[1,1,1]
    s_lshr_b32 s49, s49, 8
    s_set_gpr_idx_idx s49
    v_pk_fma_f32 v[16:17], v[170:171], v[136:137], v[16:17] op_sel:[0,0,0] op_sel_hi:[0,1,1]
    v_pk_fma_f32 v[18:19], v[170:171], v[138:139], v[18:19] op_sel:[0,0,0] op_sel_hi:[0,1,1]
    v_pk_fma_f32 v[20:21], v[174:175], v[140:141], v[20:21] op_sel:[0,0,0] op_sel_hi:[0,1,1]
    v_pk_fma_f32 v[22:23], v[174:175], v[142:143], v[22:23] op_sel:[0,0,0] op_sel_hi:[0,1,1]
    s_lshr_b32 s49, s49, 8
    s_set_gpr_idx_idx s49
    v_pk_fma_f32 v[16:17], v[170:171], v[144:145], v[16:17] op_sel:[1,0,0] op_sel_hi:[1,1,1]
    v_pk_fma_f32 v[18:19], v[170:171], v[146:147], v[18:19] op_sel:[1,0,0] op_sel_hi:[1,1,1]
    v_pk_fma_f32 v[20:21], v[174:175], v[148:149], v[20:21] op_sel:[1,0,0] op_sel_hi:[1,1,1]
    v_pk_fma_f32 v[22:23], v[174:175], v[150:151], v[22:23] op_sel:[1,0,0] op_sel_hi:[1,1,1]
    s_set_gpr_idx_off
    s_sub_u32 s48, s48, 1
    s_cbranch_scc1 K2_D3
    s_waitcnt vmcnt(6) lgkmcnt(0)
    v_mfma_f32_4x4x4_16b_bf16 v[120:123], v[184:185], v[72:73], 0 cbsz:4 abid:12
    v_exp_f32 v168, v160
    v_mfma_f32_4x4x4_16b_bf16 v[124:127], v[184:185], v[74:75], 0 cbsz:4 abid:12
    v_exp_f32 v169, v161
    v_mfma_f32_4x4x4_16b_bf16 v[128:131], v[184:185], v[76:77], 0 cbsz:4 abid:13
    v_exp_f32 v170, v162
    v_mfma_f32_4x4x4_16b_bf16 v[132:135], v[184:185], v[78:79], 0 cbsz:4 abid:13
    buffer_load_dwordx4 v[72:75], v188, s[28:31], 0 offen
    buffer_load_dwordx4 v[76:79], v189, s[28:31], 0 offen
    v_exp_f32 v171, v163
    s_waitcnt vmcnt(6)
    v_mfma_f32_4x4x4_16b_bf16 v[136:139], v[184:185], v[80:81], 0 cbsz:4 abid:14
    v_exp_f32 v172, v164
    v_mfma_f32_4x4x4_16b_bf16 v[140:143], v[184:185], v[82:83], 0 cbsz:4 abid:14
    v_exp_f32 v173, v165
    v_exp_f32 v174, v166
    v_exp_f32 v175, v167
    v_pk_add_f32 v[168:169], v[168:169], 1.0 op_sel_hi:[1,0]
    v_pk_add_f32 v[170:171], v[170:171], 1.0 op_sel_hi:[1,0]
    v_pk_add_f32 v[172:173], v[172:173], 1.0 op_sel_hi:[1,0]
    v_pk_add_f32 v[174:175], v[174:175], 1.0 op_sel_hi:[1,0]
    v_mfma_f32_4x4x4_16b_bf16 v[144:147], v[184:185], v[84:85], 0 cbsz:4 abid:15
    v_rcp_f32 v168, v168
    v_mfma_f32_4x4x4_16b_bf16 v[148:151], v[184:185], v[86:87], 0 cbsz:4 abid:15
    buffer_load_dwordx4 v[80:83], v190, s[28:31], 0 offen
    buffer_load_dwordx4 v[84:87], v191, s[28:31], 0 offen
    v_rcp_f32 v169, v169
    ds_read_b128 v[188:191], v196 offset:96
    ds_read_b64 v[184:185], v198 offset:512
    ds_read_b32 v254, v253 offset:2048
    v_mfma_f32_4x4x4_16b_bf16 v[152:155], v[186:187], v[176:177], 0 cbsz:4 abid:0
    v_rcp_f32 v170, v170
    v_mfma_f32_4x4x4_16b_bf16 v[156:159], v[186:187], v[180:181], 0 cbsz:4 abid:0
    v_rcp_f32 v171, v171
    v_rcp_f32 v172, v172
    v_rcp_f32 v173, v173
    v_rcp_f32 v174, v174
    v_rcp_f32 v175, v175
    v_readfirstlane_b32 s49, v195
    ds_read_b128 v[192:195], v197 offset:16
    v_add_u32 v196, 64, v196
    v_add_u32 v197, 16, v197
    v_add_u32 v198, 512, v198
    v_add_u32 v199, 256, v199
    v_pk_mul_f32 v[168:169], v[168:169], v[160:161]
    v_pk_mul_f32 v[170:171], v[170:171], v[162:163]
    v_pk_mul_f32 v[172:173], v[172:173], v[164:165]
    v_pk_mul_f32 v[174:175], v[174:175], v[166:167]
    s_set_gpr_idx_on s49, gpr_idx(SRC2,DST)
    v_pk_fma_f32 v[16:17], v[168:169], v[120:121], v[16:17] op_sel:[0,0,0] op_sel_hi:[0,1,1]
    v_pk_fma_f32 v[18:19], v[168:169], v[122:123], v[18:19] op_sel:[0,0,0] op_sel_hi:[0,1,1]
    v_pk_fma_f32 v[20:21], v[172:173], v[124:125], v[20:21] op_sel:[0,0,0] op_sel_hi:[0,1,1]
    v_pk_fma_f32 v[22:23], v[172:173], v[126:127], v[22:23] op_sel:[0,0,0] op_sel_hi:[0,1,1]
    s_lshr_b32 s49, s49, 8
    s_set_gpr_idx_idx s49
    v_pk_fma_f32 v[16:17], v[168:169], v[128:129], v[16:17] op_sel:[1,0,0] op_sel_hi:[1,1,1]
    v_pk_fma_f32 v[18:19], v[168:169], v[130:131], v[18:19] op_sel:[1,0,0] op_sel_hi:[1,1,1]
    v_pk_fma_f32 v[20:21], v[172:173], v[132:133], v[20:21] op_sel:[1,0,0] op_sel_hi:[1,1,1]
    v_pk_fma_f32 v[22:23], v[172:173], v[134:135], v[22:23] op_sel:[1,0,0] op_sel_hi:[1,1,1]
    s_lshr_b32 s49, s49, 8
    s_set_gpr_idx_idx s49
    v_pk_fma_f32 v[16:17], v[170:171], v[136:137], v[16:17] op_sel:[0,0,0] op_sel_hi:[0,1,1]
    v_pk_fma_f32 v[18:19], v[170:171], v[138:139], v[18:19] op_sel:[0,0,0] op_sel_hi:[0,1,1]
    v_pk_fma_f32 v[20:21], v[174:175], v[140:141], v[20:21] op_sel:[0,0,0] op_sel_hi:[0,1,1]
    v_pk_fma_f32 v[22:23], v[174:175], v[142:143], v[22:23] op_sel:[0,0,0] op_sel_hi:[0,1,1]
    s_lshr_b32 s49, s49, 8
    s_set_gpr_idx_idx s49
    v_pk_fma_f32 v[16:17], v[170:171], v[144:145], v[16:17] op_sel:[1,0,0] op_sel_hi:[1,1,1]
    v_pk_fma_f32 v[18:19], v[170:171], v[146:147], v[18:19] op_sel:[1,0,0] op_sel_hi:[1,1,1]
    v_pk_fma_f32 v[20:21], v[174:175], v[148:149], v[20:21] op_sel:[1,0,0] op_sel_hi:[1,1,1]
    v_pk_fma_f32 v[22:23], v[174:175], v[150:151], v[22:23] op_sel:[1,0,0] op_sel_hi:[1,1,1]
    s_set_gpr_idx_off
    s_sub_u32 s48, s48, 1
    s_cbranch_scc0 K2_LOOP
K2_D0:
    s_cmp_eq_u32 s48, -1
    s_cbranch_scc1 K2_WA0
    s_waitcnt vmcnt(2)
K2_WA0:
    s_waitcnt vmcnt(6) lgkmcnt(0)
    v_mfma_f32_4x4x4_16b_bf16 v[120:123], v[184:185], v[56:57], 0 cbsz:4 abid:0
    v_exp_f32 v168, v152
    v_mfma_f32_4x4x4_16b_bf16 v[124:127], v[184:185], v[58:59], 0 cbsz:4 abid:0
    v_exp_f32 v169, v153
    v_mfma_f32_4x4x4_16b_bf16 v[128:131], v[184:185], v[60:61], 0 cbsz:4 abid:1
    v_exp_f32 v170, v154
    v_mfma_f32_4x4x4_16b_bf16 v[132:135], v[184:185], v[62:63], 0 cbsz:4 abid:1
    v_exp_f32 v171, v155
    s_cmp_eq_u32 s48, -1
    s_cbranch_scc1 K2_WB0
    s_waitcnt vmcnt(0)
K2_WB0:
    s_waitcnt vmcnt(4)
    v_mfma_f32_4x4x4_16b_bf16 v[136:139], v[184:185], v[64:65], 0 cbsz:4 abid:2
    v_exp_f32 v172, v156
    v_mfma_f32_4x4x4_16b_bf16 v[140:143], v[184:185], v[66:67], 0 cbsz:4 abid:2
    v_exp_f32 v173, v157
    v_exp_f32 v174, v158
    v_exp_f32 v175, v159
    v_pk_add_f32 v[168:169], v[168:169], 1.0 op_sel_hi:[1,0]
    v_pk_add_f32 v[170:171], v[170:171], 1.0 op_sel_hi:[1,0]
    v_pk_add_f32 v[172:173], v[172:173], 1.0 op_sel_hi:[1,0]
    v_pk_add_f32 v[174:175], v[174:175], 1.0 op_sel_hi:[1,0]
    v_mfma_f32_4x4x4_16b_bf16 v[144:147], v[184:185], v[68:69], 0 cbsz:4 abid:3
    v_rcp_f32 v168, v168
    v_mfma_f32_4x4x4_16b_bf16 v[148:151], v[184:185], v[70:71], 0 cbsz:4 abid:3
    v_rcp_f32 v169, v169
    v_mfma_f32_4x4x4_16b_bf16 v[160:163], v[186:187], v[176:177], 0 cbsz:4 abid:1
    v_rcp_f32 v170, v170
    v_mfma_f32_4x4x4_16b_bf16 v[164:167], v[186:187], v[180:181], 0 cbsz:4 abid:1
    v_rcp_f32 v171, v171
    v_rcp_f32 v172, v172
    v_rcp_f32 v173, v173
    v_rcp_f32 v174, v174
    v_rcp_f32 v175, v175
    v_readfirstlane_b32 s49, v192
    v_pk_mul_f32 v[168:169], v[168:169], v[152:153]
    v_pk_mul_f32 v[170:171], v[170:171], v[154:155]
    v_pk_mul_f32 v[172:173], v[172:173], v[156:157]
    v_pk_mul_f32 v[174:175], v[174:175], v[158:159]
    s_set_gpr_idx_on s49, gpr_idx(SRC2,DST)
    v_pk_fma_f32 v[16:17], v[168:169], v[120:121], v[16:17] op_sel:[0,0,0] op_sel_hi:[0,1,1]
    v_pk_fma_f32 v[18:19], v[168:169], v[122:123], v[18:19] op_sel:[0,0,0] op_sel_hi:[0,1,1]
    v_pk_fma_f32 v[20:21], v[172:173], v[124:125], v[20:21] op_sel:[0,0,0] op_sel_hi:[0,1,1]
    v_pk_fma_f32 v[22:23], v[172:173], v[126:127], v[22:23] op_sel:[0,0,0] op_sel_hi:[0,1,1]
    s_lshr_b32 s49, s49, 8
    s_set_gpr_idx_idx s49
    v_pk_fma_f32 v[16:17], v[168:169], v[128:129], v[16:17] op_sel:[1,0,0] op_sel_hi:[1,1,1]
    v_pk_fma_f32 v[18:19], v[168:169], v[130:131], v[18:19] op_sel:[1,0,0] op_sel_hi:[1,1,1]
    v_pk_fma_f32 v[20:21], v[172:173], v[132:133], v[20:21] op_sel:[1,0,0] op_sel_hi:[1,1,1]
    v_pk_fma_f32 v[22:23], v[172:173], v[134:135], v[22:23] op_sel:[1,0,0] op_sel_hi:[1,1,1]
    s_lshr_b32 s49, s49, 8
    s_set_gpr_idx_idx s49
    v_pk_fma_f32 v[16:17], v[170:171], v[136:137], v[16:17] op_sel:[0,0,0] op_sel_hi:[0,1,1]
    v_pk_fma_f32 v[18:19], v[170:171], v[138:139], v[18:19] op_sel:[0,0,0] op_sel_hi:[0,1,1]
    v_pk_fma_f32 v[20:21], v[174:175], v[140:141], v[20:21] op_sel:[0,0,0] op_sel_hi:[0,1,1]
    v_pk_fma_f32 v[22:23], v[174:175], v[142:143], v[22:23] op_sel:[0,0,0] op_sel_hi:[0,1,1]
    s_lshr_b32 s49, s49, 8
    s_set_gpr_idx_idx s49
    v_pk_fma_f32 v[16:17], v[170:171], v[144:145], v[16:17] op_sel:[1,0,0] op_sel_hi:[1,1,1]
    v_pk_fma_f32 v[18:19], v[170:171], v[146:147], v[18:19] op_sel:[1,0,0] op_sel_hi:[1,1,1]
    v_pk_fma_f32 v[20:21], v[174:175], v[148:149], v[20:21] op_sel:[1,0,0] op_sel_hi:[1,1,1]
    v_pk_fma_f32 v[22:23], v[174:175], v[150:151], v[22:23] op_sel:[1,0,0] op_sel_hi:[1,1,1]
    s_set_gpr_idx_off
    s_sub_u32 s48, s48, 1
    s_cmp_eq_u32 s48, -3
    s_cbranch_scc1 K2_LOOPDONE
K2_D1:
    s_cmp_eq_u32 s48, -1
    s_cbranch_scc1 K2_WA1
    s_waitcnt vmcnt(2)
K2_WA1:
    s_waitcnt vmcnt(6) lgkmcnt(0)
    v_mfma_f32_4x4x4_16b_bf16 v[120:123], v[184:185], v[72:73], 0 cbsz:4 abid:4
    v_exp_f32 v168, v160
    v_mfma_f32_4x4x4_16b_bf16 v[124:127], v[184:185], v[74:75], 0 cbsz:4 abid:4
    v_exp_f32 v169, v161
    v_mfma_f32_4x4x4_16b_bf16 v[128:131], v[184:185], v[76:77], 0 cbsz:4 abid:5
    v_exp_f32 v170, v162
    v_mfma_f32_4x4x4_16b_bf16 v[132:135], v[184:185], v[78:79], 0 cbsz:4 abid:5
    v_exp_f32 v171, v163
    s_cmp_eq_u32 s48, -1
    s_cbranch_scc1 K2_WB1
    s_waitcnt vmcnt(0)
K2_WB1:
    s_waitcnt vmcnt(4)
    v_mfma_f32_4x4x4_16b_bf16 v[136:139], v[184:185], v[80:81], 0 cbsz:4 abid:6
    v_exp_f32 v172, v164
    v_mfma_f32_4x4x4_16b_bf16 v[140:143], v[184:185], v[82:83], 0 cbsz:4 abid:6
    v_exp_f32 v173, v165
    v_exp_f32 v174, v166
    v_exp_f32 v175, v167
    v_pk_add_f32 v[168:169], v[168:169], 1.0 op_sel_hi:[1,0]
    v_pk_add_f32 v[170:171], v[170:171], 1.0 op_sel_hi:[1,0]
    v_pk_add_f32 v[172:173], v[172:173], 1.0 op_sel_hi:[1,0]
    v_pk_add_f32 v[174:175], v[174:175], 1.0 op_sel_hi:[1,0]
    v_mfma_f32_4x4x4_16b_bf16 v[144:147], v[184:185], v[84:85], 0 cbsz:4 abid:7
    v_rcp_f32 v168, v168
    v_mfma_f32_4x4x4_16b_bf16 v[148:151], v[184:185], v[86:87], 0 cbsz:4 abid:7
    v_rcp_f32 v169, v169
    v_mfma_f32_4x4x4_16b_bf16 v[152:155], v[186:187], v[176:177], 0 cbsz:4 abid:2
    v_rcp_f32 v170, v170
    v_mfma_f32_4x4x4_16b_bf16 v[156:159], v[186:187], v[180:181], 0 cbsz:4 abid:2
    v_rcp_f32 v171, v171
    v_rcp_f32 v172, v172
    v_rcp_f32 v173, v173
    v_rcp_f32 v174, v174
    v_rcp_f32 v175, v175
    v_readfirstlane_b32 s49, v193
    v_pk_mul_f32 v[168:169], v[168:169], v[160:161]
    v_pk_mul_f32 v[170:171], v[170:171], v[162:163]
    v_pk_mul_f32 v[172:173], v[172:173], v[164:165]
    v_pk_mul_f32 v[174:175], v[174:175], v[166:167]
    s_set_gpr_idx_on s49, gpr_idx(SRC2,DST)
    v_pk_fma_f32 v[16:17], v[168:169], v[120:121], v[16:17] op_sel:[0,0,0] op_sel_hi:[0,1,1]
    v_pk_fma_f32 v[18:19], v[168:169], v[122:123], v[18:19] op_sel:[0,0,0] op_sel_hi:[0,1,1]
    v_pk_fma_f32 v[20:21], v[172:173], v[124:125], v[20:21] op_sel:[0,0,0] op_sel_hi:[0,1,1]
    v_pk_fma_f32 v[22:23], v[172:173], v[126:127], v[22:23] op_sel:[0,0,0] op_sel_hi:[0,1,1]
    s_lshr_b32 s49, s49, 8
    s_set_gpr_idx_idx s49
    v_pk_fma_f32 v[16:17], v[168:169], v[128:129], v[16:17] op_sel:[1,0,0] op_sel_hi:[1,1,1]
    v_pk_fma_f32 v[18:19], v[168:169], v[130:131], v[18:19] op_sel:[1,0,0] op_sel_hi:[1,1,1]
    v_pk_fma_f32 v[20:21], v[172:173], v[132:133], v[20:21] op_sel:[1,0,0] op_sel_hi:[1,1,1]
    v_pk_fma_f32 v[22:23], v[172:173], v[134:135], v[22:23] op_sel:[1,0,0] op_sel_hi:[1,1,1]
    s_lshr_b32 s49, s49, 8
    s_set_gpr_idx_idx s49
    v_pk_fma_f32 v[16:17], v[170:171], v[136:137], v[16:17] op_sel:[0,0,0] op_sel_hi:[0,1,1]
    v_pk_fma_f32 v[18:19], v[170:171], v[138:139], v[18:19] op_sel:[0,0,0] op_sel_hi:[0,1,1]
    v_pk_fma_f32 v[20:21], v[174:175], v[140:141], v[20:21] op_sel:[0,0,0] op_sel_hi:[0,1,1]
    v_pk_fma_f32 v[22:23], v[174:175], v[142:143], v[22:23] op_sel:[0,0,0] op_sel_hi:[0,1,1]
    s_lshr_b32 s49, s49, 8
    s_set_gpr_idx_idx s49
    v_pk_fma_f32 v[16:17], v[170:171], v[144:145], v[16:17] op_sel:[1,0,0] op_sel_hi:[1,1,1]
    v_pk_fma_f32 v[18:19], v[170:171], v[146:147], v[18:19] op_sel:[1,0,0] op_sel_hi:[1,1,1]
    v_pk_fma_f32 v[20:21], v[174:175], v[148:149], v[20:21] op_sel:[1,0,0] op_sel_hi:[1,1,1]
    v_pk_fma_f32 v[22:23], v[174:175], v[150:151], v[22:23] op_sel:[1,0,0] op_sel_hi:[1,1,1]
    s_set_gpr_idx_off
    s_sub_u32 s48, s48, 1
    s_cmp_eq_u32 s48, -3
    s_cbranch_scc1 K2_LOOPDONE
K2_D2:
    s_cmp_eq_u32 s48, -1
    s_cbranch_scc1 K2_WA2
    s_waitcnt vmcnt(2)
K2_WA2:
    s_waitcnt vmcnt(6) lgkmcnt(0)
    v_mfma_f32_4x4x4_16b_bf16 v[120:123], v[184:185], v[56:57], 0 cbsz:4 abid:8
    v_exp_f32 v168, v152
    v_mfma_f32_4x4x4_16b_bf16 v[124:127], v[184:185], v[58:59], 0 cbsz:4 abid:8
    v_exp_f32 v169, v153
    v_mfma_f32_4x4x4_16b_bf16 v[128:131], v[184:185], v[60:61], 0 cbsz:4 abid:9
    v_exp_f32 v170, v154
    v_mfma_f32_4x4x4_16b_bf16 v[132:135], v[184:185], v[62:63], 0 cbsz:4 abid:9
    v_exp_f32 v171, v155
    s_cmp_eq_u32 s48, -1
    s_cbranch_scc1 K2_WB2
    s_waitcnt vmcnt(0)
K2_WB2:
    s_waitcnt vmcnt(4)
    v_mfma_f32_4x4x4_16b_bf16 v[136:139], v[184:185], v[64:65], 0 cbsz:4 abid:10
    v_exp_f32 v172, v156
    v_mfma_f32_4x4x4_16b_bf16 v[140:143], v[184:185], v[66:67], 0 cbsz:4 abid:10
    v_exp_f32 v173, v157
    v_exp_f32 v174, v158
    v_exp_f32 v175, v159
    v_pk_add_f32 v[168:169], v[168:169], 1.0 op_sel_hi:[1,0]
    v_pk_add_f32 v[170:171], v[170:171], 1.0 op_sel_hi:[1,0]
    v_pk_add_f32 v[172:173], v[172:173], 1.0 op_sel_hi:[1,0]
    v_pk_add_f32 v[174:175], v[174:175], 1.0 op_sel_hi:[1,0]
    v_mfma_f32_4x4x4_16b_bf16 v[144:147], v[184:185], v[68:69], 0 cbsz:4 abid:11
    v_rcp_f32 v168, v168
    v_mfma_f32_4x4x4_16b_bf16 v[148:151], v[184:185], v[70:71], 0 cbsz:4 abid:11
    v_rcp_f32 v169, v169
    v_mfma_f32_4x4x4_16b_bf16 v[160:163], v[186:187], v[176:177], 0 cbsz:4 abid:3
    v_rcp_f32 v170, v170
    v_mfma_f32_4x4x4_16b_bf16 v[164:167], v[186:187], v[180:181], 0 cbsz:4 abid:3
    v_rcp_f32 v171, v171
    v_rcp_f32 v172, v172
    ds_read_b64 v[186:187], v199 offset:264
    v_rcp_f32 v173, v173
    v_rcp_f32 v174, v174
    v_rcp_f32 v175, v175
    v_readfirstlane_b32 s49, v194
    v_pk_mul_f32 v[168:169], v[168:169], v[152:153]
    v_pk_mul_f32 v[170:171], v[170:171], v[154:155]
    v_pk_mul_f32 v[172:173], v[172:173], v[156:157]
    v_pk_mul_f32 v[174:175], v[174:175], v[158:159]
    s_set_gpr_idx_on s49, gpr_idx(SRC2,DST)
    v_pk_fma_f32 v[16:17], v[168:169], v[120:121], v[16:17] op_sel:[0,0,0] op_sel_hi:[0,1,1]
    v_pk_fma_f32 v[18:19], v[168:169], v[122:123], v[18:19] op_sel:[0,0,0] op_sel_hi:[0,1,1]
    v_pk_fma_f32 v[20:21], v[172:173], v[124:125], v[20:21] op_sel:[0,0,0] op_sel_hi:[0,1,1]
    v_pk_fma_f32 v[22:23], v[172:173], v[126:127], v[22:23] op_sel:[0,0,0] op_sel_hi:[0,1,1]
    s_lshr_b32 s49, s49, 8
    s_set_gpr_idx_idx s49
    v_pk_fma_f32 v[16:17], v[168:169], v[128:129], v[16:17] op_sel:[1,0,0] op_sel_hi:[1,1,1]
    v_pk_fma_f32 v[18:19], v[168:169], v[130:131], v[18:19] op_sel:[1,0,0] op_sel_hi:[1,1,1]
    v_pk_fma_f32 v[20:21], v[172:173], v[132:133], v[20:21] op_sel:[1,0,0] op_sel_hi:[1,1,1]
    v_pk_fma_f32 v[22:23], v[172:173], v[134:135], v[22:23] op_sel:[1,0,0] op_sel_hi:[1,1,1]
    s_lshr_b32 s49, s49, 8
    s_set_gpr_idx_idx s49
    v_pk_fma_f32 v[16:17], v[170:171], v[136:137], v[16:17] op_sel:[0,0,0] op_sel_hi:[0,1,1]
    v_pk_fma_f32 v[18:19], v[170:171], v[138:139], v[18:19] op_sel:[0,0,0] op_sel_hi:[0,1,1]
    v_pk_fma_f32 v[20:21], v[174:175], v[140:141], v[20:21] op_sel:[0,0,0] op_sel_hi:[0,1,1]
    v_pk_fma_f32 v[22:23], v[174:175], v[142:143], v[22:23] op_sel:[0,0,0] op_sel_hi:[0,1,1]
    s_lshr_b32 s49, s49, 8
    s_set_gpr_idx_idx s49
    v_pk_fma_f32 v[16:17], v[170:171], v[144:145], v[16:17] op_sel:[1,0,0] op_sel_hi:[1,1,1]
    v_pk_fma_f32 v[18:19], v[170:171], v[146:147], v[18:19] op_sel:[1,0,0] op_sel_hi:[1,1,1]
    v_pk_fma_f32 v[20:21], v[174:175], v[148:149], v[20:21] op_sel:[1,0,0] op_sel_hi:[1,1,1]
    v_pk_fma_f32 v[22:23], v[174:175], v[150:151], v[22:23] op_sel:[1,0,0] op_sel_hi:[1,1,1]
    s_set_gpr_idx_off
    s_sub_u32 s48, s48, 1
    s_cmp_eq_u32 s48, -3
    s_cbranch_scc1 K2_LOOPDONE
K2_D3:
    s_cmp_eq_u32 s48, -1
    s_cbranch_scc1 K2_WA3
    s_waitcnt vmcnt(2)
K2_WA3:
    s_waitcnt vmcnt(6) lgkmcnt(0)
    v_mfma_f32_4x4x4_16b_bf16 v[120:123], v[184:185], v[72:73], 0 cbsz:4 abid:12
    v_exp_f32 v168, v160
    v_mfma_f32_4x4x4_16b_bf16 v[124:127], v[184:185], v[74:75], 0 cbsz:4 abid:12
    v_exp_f32 v169, v161
    v_mfma_f32_4x4x4_16b_bf16 v[128:131], v[184:185], v[76:77], 0 cbsz:4 abid:13
    v_exp_f32 v170, v162
    v_mfma_f32_4x4x4_16b_bf16 v[132:135], v[184:185], v[78:79], 0 cbsz:4 abid:13
    v_exp_f32 v171, v163
    s_cmp_eq_u32 s48, -1
    s_cbranch_scc1 K2_WB3
    s_waitcnt vmcnt(0)
K2_WB3:
    s_waitcnt vmcnt(4)
    v_mfma_f32_4x4x4_16b_bf16 v[136:139], v[184:185], v[80:81], 0 cbsz:4 abid:14
    v_exp_f32 v172, v164
    v_mfma_f32_4x4x4_16b_bf16 v[140:143], v[184:185], v[82:83], 0 cbsz:4 abid:14
    v_exp_f32 v173, v165
    v_exp_f32 v174, v166
    v_exp_f32 v175, v167
    v_pk_add_f32 v[168:169], v[168:169], 1.0 op_sel_hi:[1,0]
    v_pk_add_f32 v[170:171], v[170:171], 1.0 op_sel_hi:[1,0]
    v_pk_add_f32 v[172:173], v[172:173], 1.0 op_sel_hi:[1,0]
    v_pk_add_f32 v[174:175], v[174:175], 1.0 op_sel_hi:[1,0]
    v_mfma_f32_4x4x4_16b_bf16 v[144:147], v[184:185], v[84:85], 0 cbsz:4 abid:15
    v_rcp_f32 v168, v168
    v_mfma_f32_4x4x4_16b_bf16 v[148:151], v[184:185], v[86:87], 0 cbsz:4 abid:15
    v_rcp_f32 v169, v169
    ds_read_b64 v[184:185], v198 offset:512
    v_mfma_f32_4x4x4_16b_bf16 v[152:155], v[186:187], v[176:177], 0 cbsz:4 abid:0
    v_rcp_f32 v170, v170
    v_mfma_f32_4x4x4_16b_bf16 v[156:159], v[186:187], v[180:181], 0 cbsz:4 abid:0
    v_rcp_f32 v171, v171
    v_rcp_f32 v172, v172
    v_rcp_f32 v173, v173
    v_rcp_f32 v174, v174
    v_rcp_f32 v175, v175
    v_readfirstlane_b32 s49, v195
    ds_read_b128 v[192:195], v197 offset:16
    v_add_u32 v196, 64, v196
    v_add_u32 v197, 16, v197
    v_add_u32 v198, 512, v198
    v_add_u32 v199, 256, v199
    v_pk_mul_f32 v[168:169], v[168:169], v[160:161]
    v_pk_mul_f32 v[170:171], v[170:171], v[162:163]
    v_pk_mul_f32 v[172:173], v[172:173], v[164:165]
    v_pk_mul_f32 v[174:175], v[174:175], v[166:167]
    s_set_gpr_idx_on s49, gpr_idx(SRC2,DST)
    v_pk_fma_f32 v[16:17], v[168:169], v[120:121], v[16:17] op_sel:[0,0,0] op_sel_hi:[0,1,1]
    v_pk_fma_f32 v[18:19], v[168:169], v[122:123], v[18:19] op_sel:[0,0,0] op_sel_hi:[0,1,1]
    v_pk_fma_f32 v[20:21], v[172:173], v[124:125], v[20:21] op_sel:[0,0,0] op_sel_hi:[0,1,1]
    v_pk_fma_f32 v[22:23], v[172:173], v[126:127], v[22:23] op_sel:[0,0,0] op_sel_hi:[0,1,1]
    s_lshr_b32 s49, s49, 8
    s_set_gpr_idx_idx s49
    v_pk_fma_f32 v[16:17], v[168:169], v[128:129], v[16:17] op_sel:[1,0,0] op_sel_hi:[1,1,1]
    v_pk_fma_f32 v[18:19], v[168:169], v[130:131], v[18:19] op_sel:[1,0,0] op_sel_hi:[1,1,1]
    v_pk_fma_f32 v[20:21], v[172:173], v[132:133], v[20:21] op_sel:[1,0,0] op_sel_hi:[1,1,1]
    v_pk_fma_f32 v[22:23], v[172:173], v[134:135], v[22:23] op_sel:[1,0,0] op_sel_hi:[1,1,1]
    s_lshr_b32 s49, s49, 8
    s_set_gpr_idx_idx s49
    v_pk_fma_f32 v[16:17], v[170:171], v[136:137], v[16:17] op_sel:[0,0,0] op_sel_hi:[0,1,1]
    v_pk_fma_f32 v[18:19], v[170:171], v[138:139], v[18:19] op_sel:[0,0,0] op_sel_hi:[0,1,1]
    v_pk_fma_f32 v[20:21], v[174:175], v[140:141], v[20:21] op_sel:[0,0,0] op_sel_hi:[0,1,1]
    v_pk_fma_f32 v[22:23], v[174:175], v[142:143], v[22:23] op_sel:[0,0,0] op_sel_hi:[0,1,1]
    s_lshr_b32 s49, s49, 8
    s_set_gpr_idx_idx s49
    v_pk_fma_f32 v[16:17], v[170:171], v[144:145], v[16:17] op_sel:[1,0,0] op_sel_hi:[1,1,1]
    v_pk_fma_f32 v[18:19], v[170:171], v[146:147], v[18:19] op_sel:[1,0,0] op_sel_hi:[1,1,1]
    v_pk_fma_f32 v[20:21], v[174:175], v[148:149], v[20:21] op_sel:[1,0,0] op_sel_hi:[1,1,1]
    v_pk_fma_f32 v[22:23], v[174:175], v[150:151], v[22:23] op_sel:[1,0,0] op_sel_hi:[1,1,1]
    s_set_gpr_idx_off
    s_sub_u32 s48, s48, 1
    s_cmp_eq_u32 s48, -3
    s_cbranch_scc0 K2_D0
K2_LOOPDONE:
    v_mov_b32 v254, -1
    ds_write_b32 v252, v254 offset:2048
    s_setprio 0
    s_add_u32 s47, s47, 1536
    s_cmp_ge_u32 s47, s46
    s_cbranch_scc1 K_EPI
    s_waitcnt vmcnt(0) lgkmcnt(0)
    s_barrier
    ds_write_b128 v8, v[4:7]
    ds_write_b32 v3, v4 offset:2048
    v_cmp_gt_u32 vcc, 128, v0
    s_and_saveexec_b64 s[56:57], vcc
    ds_write_b32 v3, v4 offset:0
    s_mov_b64 exec, s[56:57]
    s_waitcnt lgkmcnt(0)
    s_barrier
    s_cmp_eq_u32 s55, 0
    s_cbranch_scc1 K_ROUND
    s_branch K_FB
K_LATER:
    s_mov_b64 exec, s[40:41]
    buffer_load_dwordx4 v[88:91], v100, s[36:39], s61 offen sc1
    s_mov_b64 exec, s[42:43]
    buffer_load_dwordx4 v[92:95], v101, s[36:39], s61 offen sc1
    s_mov_b64 exec, s[44:45]
    buffer_load_dwordx4 v[96:99], v102, s[36:39], s61 offen sc1
    s_mov_b64 exec, -1
K_LATER2:
    v_lshrrev_b32 v81, 2, v72
    v_and_b32 v81, 0xfc, v81
    v_lshrrev_b32 v82, 2, v74
    v_and_b32 v82, 0xfc, v82
    v_lshrrev_b32 v83, 2, v76
    v_and_b32 v83, 0xfc, v83
    s_branch K_BAL
K_FB0:
    s_mov_b32 s46, 320000
    s_and_b32 s56, s3, 3
    s_lshl_b32 s56, s56, 6
    s_add_u32 s56, s56, 114944
    v_lshrrev_b32 v10, 4, v1
    v_lshlrev_b32 v10, 11, v10
    v_and_b32 v12, 15, v1
    v_lshl_or_b32 v10, v12, 2, v10
    v_add_u32 v10, s56, v10
    s_mov_b32 s56, 0x05040100
    s_mov_b32 s57, 0x07060302
    ds_read2st64_b32 v[120:121], v10 offset0:0 offset1:1
    ds_read2st64_b32 v[122:123], v10 offset0:2 offset1:3
    ds_read2st64_b32 v[124:125], v10 offset0:4 offset1:5
    ds_read2st64_b32 v[126:127], v10 offset0:6 offset1:7
    ds_read2st64_b32 v[128:129], v10 offset0:32 offset1:33
    ds_read2st64_b32 v[130:131], v10 offset0:34 offset1:35
    ds_read2st64_b32 v[132:133], v10 offset0:36 offset1:37
    ds_read2st64_b32 v[134:135], v10 offset0:38 offset1:39
    ds_read2st64_b32 v[136:137], v10 offset0:64 offset1:65
    ds_read2st64_b32 v[138:139], v10 offset0:66 offset1:67
    ds_read2st64_b32 v[140:141], v10 offset0:68 offset1:69
    ds_read2st64_b32 v[142:143], v10 offset0:70 offset1:71
    ds_read2st64_b32 v[144:145], v10 offset0:96 offset1:97
    ds_read2st64_b32 v[146:147], v10 offset0:98 offset1:99
    ds_read2st64_b32 v[148:149], v10 offset0:100 offset1:101
    ds_read2st64_b32 v[150:151], v10 offset0:102 offset1:103
    s_waitcnt lgkmcnt(15)
    v_perm_b32 v200, v121, v120, s56
    v_perm_b32 v216, v121, v120, s57
    s_waitcnt lgkmcnt(14)
    v_perm_b32 v201, v123, v122, s56
    v_perm_b32 v217, v123, v122, s57
    s_waitcnt lgkmcnt(13)
    v_perm_b32 v202, v125, v124, s56
    v_perm_b32 v218, v125, v124, s57
    s_waitcnt lgkmcnt(12)
    v_perm_b32 v203, v127, v126, s56
    v_perm_b32 v219, v127, v126, s57
    s_waitcnt lgkmcnt(11)
    v_perm_b32 v204, v129, v128, s56
    v_perm_b32 v220, v129, v128, s57
    s_waitcnt lgkmcnt(10)
    v_perm_b32 v205, v131, v130, s56
    v_perm_b32 v221, v131, v130, s57
    s_waitcnt lgkmcnt(9)
    v_perm_b32 v206, v133, v132, s56
    v_perm_b32 v222, v133, v132, s57
    s_waitcnt lgkmcnt(8)
    v_perm_b32 v207, v135, v134, s56
    v_perm_b32 v223, v135, v134, s57
    s_waitcnt lgkmcnt(7)
    v_perm_b32 v208, v137, v136, s56
    v_perm_b32 v224, v137, v136, s57
    s_waitcnt lgkmcnt(6)
    v_perm_b32 v209, v139, v138, s56
    v_perm_b32 v225, v139, v138, s57
    s_waitcnt lgkmcnt(5)
    v_perm_b32 v210, v141, v140, s56
    v_perm_b32 v226, v141, v140, s57
    s_waitcnt lgkmcnt(4)
    v_perm_b32 v211, v143, v142, s56
    v_perm_b32 v227, v143, v142, s57
    s_waitcnt lgkmcnt(3)
    v_perm_b32 v212, v145, v144, s56
    v_perm_b32 v228, v145, v144, s57
    s_waitcnt lgkmcnt(2)
    v_perm_b32 v213, v147, v146, s56
    v_perm_b32 v229, v147, v146, s57
    s_waitcnt lgkmcnt(1)
    v_perm_b32 v214, v149, v148, s56
    v_perm_b32 v230, v149, v148, s57
    s_waitcnt lgkmcnt(0)
    v_perm_b32 v215, v151, v150, s56
    v_perm_b32 v231, v151, v150, s57
K_FB:
    s_mul_i32 s56, s3, 192
    s_add_u32 s56, s56, s47
    v_add_u32 v68, s56, v1
    v_add_u32 v69, 64, v68
    v_add_u32 v70, 128, v68
    v_cmp_gt_u32 s[40:41], s46, v68
    v_min_u32 v68, 319999, v68
    v_lshlrev_b32 v81, 2, v68
    v_lshlrev_b32 v100, 3, v68
    global_load_dword v56, v81, s[8:9]
    global_load_dword v60, v81, s[6:7]
    global_load_dwordx2 v[88:89], v100, s[10:11]
    global_load_dwordx2 v[90:91], v100, s[12:13]
    v_cmp_gt_u32 s[42:43], s46, v69
    v_min_u32 v69, 319999, v69
    v_lshlrev_b32 v82, 2, v69
    v_lshlrev_b32 v101, 3, v69
    global_load_dword v57, v82, s[8:9]
    global_load_dword v61, v82, s[6:7]
    global_load_dwordx2 v[92:93], v101, s[10:11]
    global_load_dwordx2 v[94:95], v101, s[12:13]
    v_cmp_gt_u32 s[44:45], s46, v70
    v_min_u32 v70, 319999, v70
    v_lshlrev_b32 v83, 2, v70
    v_lshlrev_b32 v102, 3, v70
    global_load_dword v58, v83, s[8:9]
    global_load_dword v62, v83, s[6:7]
    global_load_dwordx2 v[96:97], v102, s[10:11]
    global_load_dwordx2 v[98:99], v102, s[12:13]
    v_mov_b32 v14, 64
    s_waitcnt vmcnt(0)
    v_mul_u32_u24 v68, 214749, v56
    v_lshrrev_b32 v68, 23, v68
    v_cmp_eq_u32 vcc, s53, v68
    s_and_b64 s[40:41], s[40:41], vcc
    v_subrev_u32 v72, s54, v56
    v_mul_u32_u24 v68, 1677, v60
    v_lshrrev_b32 v68, 20, v68
    v_lshl_or_b32 v72, v72, 4, v68
    v_lshl_or_b32 v72, v60, 10, v72
    v_mul_u32_u24 v69, 214749, v57
    v_lshrrev_b32 v69, 23, v69
    v_cmp_eq_u32 vcc, s53, v69
    s_and_b64 s[42:43], s[42:43], vcc
    v_subrev_u32 v74, s54, v57
    v_mul_u32_u24 v69, 1677, v61
    v_lshrrev_b32 v69, 20, v69
    v_lshl_or_b32 v74, v74, 4, v69
    v_lshl_or_b32 v74, v61, 10, v74
    v_mul_u32_u24 v70, 214749, v58
    v_lshrrev_b32 v70, 23, v70
    v_cmp_eq_u32 vcc, s53, v70
    s_and_b64 s[44:45], s[44:45], vcc
    v_subrev_u32 v76, s54, v58
    v_mul_u32_u24 v70, 1677, v62
    v_lshrrev_b32 v70, 20, v70
    v_lshl_or_b32 v76, v76, 4, v70
    v_lshl_or_b32 v76, v62, 10, v76
    s_cmp_lg_u32 s47, 0
    s_cbranch_scc1 K_LATER2
    s_branch K_GOT
K_EPI:
    s_mov_b32 s56, 0xbf317218
    s_mov_b32 s57, s56
    v_pk_mul_f32 v[16:17], v[16:17], s[56:57]
    v_pk_mul_f32 v[18:19], v[18:19], s[56:57]
    v_pk_mul_f32 v[20:21], v[20:21], s[56:57]
    v_pk_mul_f32 v[22:23], v[22:23], s[56:57]
    v_cvt_pk_bf16_f32 v16, v16, v20
    ds_write_b32 v106, v16 offset:0
    v_cvt_pk_bf16_f32 v17, v17, v21
    ds_write_b32 v106, v17 offset:288
    v_cvt_pk_bf16_f32 v18, v18, v22
    ds_write_b32 v106, v18 offset:576
    v_cvt_pk_bf16_f32 v19, v19, v23
    ds_write_b32 v106, v19 offset:864
    v_pk_mul_f32 v[24:25], v[24:25], s[56:57]
    v_pk_mul_f32 v[26:27], v[26:27], s[56:57]
    v_pk_mul_f32 v[28:29], v[28:29], s[56:57]
    v_pk_mul_f32 v[30:31], v[30:31], s[56:57]
    v_cvt_pk_bf16_f32 v24, v24, v28
    ds_write_b32 v107, v24 offset:0
    v_cvt_pk_bf16_f32 v25, v25, v29
    ds_write_b32 v107, v25 offset:288
    v_cvt_pk_bf16_f32 v26, v26, v30
    ds_write_b32 v107, v26 offset:576
    v_cvt_pk_bf16_f32 v27, v27, v31
    ds_write_b32 v107, v27 offset:864
    v_pk_mul_f32 v[32:33], v[32:33], s[56:57]
    v_pk_mul_f32 v[34:35], v[34:35], s[56:57]
    v_pk_mul_f32 v[36:37], v[36:37], s[56:57]
    v_pk_mul_f32 v[38:39], v[38:39], s[56:57]
    v_cvt_pk_bf16_f32 v32, v32, v36
    ds_write_b32 v116, v32 offset:0
    v_cvt_pk_bf16_f32 v33, v33, v37
    ds_write_b32 v116, v33 offset:288
    v_cvt_pk_bf16_f32 v34, v34, v38
    ds_write_b32 v116, v34 offset:576
    v_cvt_pk_bf16_f32 v35, v35, v39
    ds_write_b32 v116, v35 offset:864
    v_pk_mul_f32 v[40:41], v[40:41], s[56:57]
    v_pk_mul_f32 v[42:43], v[42:43], s[56:57]
    v_pk_mul_f32 v[44:45], v[44:45], s[56:57]
    v_pk_mul_f32 v[46:47], v[46:47], s[56:57]
    v_cvt_pk_bf16_f32 v40, v40, v44
    ds_write_b32 v117, v40 offset:0
    v_cvt_pk_bf16_f32 v41, v41, v45
    ds_write_b32 v117, v41 offset:288
    v_cvt_pk_bf16_f32 v42, v42, v46
    ds_write_b32 v117, v42 offset:576
    v_cvt_pk_bf16_f32 v43, v43, v47
    ds_write_b32 v117, v43 offset:864
    v_pk_mul_f32 v[48:49], v[48:49], s[56:57]
    v_pk_mul_f32 v[50:51], v[50:51], s[56:57]
    v_pk_mul_f32 v[52:53], v[52:53], s[56:57]
    v_pk_mul_f32 v[54:55], v[54:55], s[56:57]
    v_cvt_pk_bf16_f32 v48, v48, v52
    ds_write_b32 v118, v48 offset:0
    v_cvt_pk_bf16_f32 v49, v49, v53
    ds_write_b32 v118, v49 offset:288
    v_cvt_pk_bf16_f32 v50, v50, v54
    ds_write_b32 v118, v50 offset:576
    v_cvt_pk_bf16_f32 v51, v51, v55
    ds_write_b32 v118, v51 offset:864
    v_and_b32 v12, 15, v1
    v_lshrrev_b32 v13, 4, v1
    s_lshr_b32 s58, s3, 2
    s_mul_i32 s59, s58, 4608
    s_add_u32 s59, s59, 106752
    v_mul_u32_u24 v14, 288, v12
    v_lshl_add_u32 v14, v13, 4, v14
    v_add_u32 v14, s59, v14
    s_lshl_b32 s58, s58, 2
    s_add_u32 s58, s58, s54
    s_lshl_b32 s58, s58, 10
    s_and_b32 s59, s3, 3
    s_lshl_b32 s59, s59, 8
    s_add_u32 s58, s58, s59
    v_lshlrev_b32 v13, 10, v13
    v_lshl_add_u32 v13, v12, 4, v13
    s_waitcnt vmcnt(0) lgkmcnt(0)
    s_barrier
    ds_read_b128 v[56:59], v14 offset:0
    ds_read_b128 v[60:63], v14 offset:64
    ds_read_b128 v[64:67], v14 offset:128
    ds_read_b128 v[68:71], v14 offset:192
    ds_read_b128 v[72:75], v14 offset:9216
    ds_read_b128 v[76:79], v14 offset:9280
    ds_read_b128 v[80:83], v14 offset:9344
    ds_read_b128 v[84:87], v14 offset:9408
    ds_read_b128 v[88:91], v14 offset:18432
    ds_read_b128 v[92:95], v14 offset:18496
    ds_read_b128 v[96:99], v14 offset:18560
    ds_read_b128 v[100:103], v14 offset:18624
    ds_read_b128 v[104:107], v14 offset:27648
    ds_read_b128 v[108:111], v14 offset:27712
    ds_read_b128 v[112:115], v14 offset:27776
    ds_read_b128 v[116:119], v14 offset:27840
    s_waitcnt lgkmcnt(15)
    v_mfma_f32_16x16x32_bf16 v[120:123], v[56:59], v[200:203], 0
    v_mfma_f32_16x16x32_bf16 v[124:127], v[56:59], v[216:219], 0
    s_waitcnt lgkmcnt(14)
    v_mfma_f32_16x16x32_bf16 v[120:123], v[60:63], v[204:207], v[120:123]
    v_mfma_f32_16x16x32_bf16 v[124:127], v[60:63], v[220:223], v[124:127]
    s_waitcnt lgkmcnt(13)
    v_mfma_f32_16x16x32_bf16 v[120:123], v[64:67], v[208:211], v[120:123]
    v_mfma_f32_16x16x32_bf16 v[124:127], v[64:67], v[224:227], v[124:127]
    s_waitcnt lgkmcnt(12)
    v_mfma_f32_16x16x32_bf16 v[120:123], v[68:71], v[212:215], v[120:123]
    v_mfma_f32_16x16x32_bf16 v[124:127], v[68:71], v[228:231], v[124:127]
    ds_read_b128 v[56:59], v14 offset:36864
    ds_read_b128 v[60:63], v14 offset:36928
    ds_read_b128 v[64:67], v14 offset:36992
    ds_read_b128 v[68:71], v14 offset:37056
    s_waitcnt lgkmcnt(15)
    v_mfma_f32_16x16x32_bf16 v[128:131], v[72:75], v[200:203], 0
    v_mfma_f32_16x16x32_bf16 v[132:135], v[72:75], v[216:219], 0
    s_waitcnt lgkmcnt(14)
    v_mfma_f32_16x16x32_bf16 v[128:131], v[76:79], v[204:207], v[128:131]
    v_mfma_f32_16x16x32_bf16 v[132:135], v[76:79], v[220:223], v[132:135]
    s_waitcnt lgkmcnt(13)
    v_mfma_f32_16x16x32_bf16 v[128:131], v[80:83], v[208:211], v[128:131]
    v_mfma_f32_16x16x32_bf16 v[132:135], v[80:83], v[224:227], v[132:135]
    s_waitcnt lgkmcnt(12)
    v_mfma_f32_16x16x32_bf16 v[128:131], v[84:87], v[212:215], v[128:131]
    v_mfma_f32_16x16x32_bf16 v[132:135], v[84:87], v[228:231], v[132:135]
    v_cvt_pk_bf16_f32 v136, v120, v121
    v_cvt_pk_bf16_f32 v137, v122, v123
    v_cvt_pk_bf16_f32 v138, v124, v125
    v_cvt_pk_bf16_f32 v139, v126, v127
    buffer_store_dwordx4 v[136:139], v13, s[32:35], s58 offen sc1
    s_add_u32 s58, s58, 8192
    s_waitcnt lgkmcnt(11)
    v_mfma_f32_16x16x32_bf16 v[120:123], v[88:91], v[200:203], 0
    v_mfma_f32_16x16x32_bf16 v[124:127], v[88:91], v[216:219], 0
    s_waitcnt lgkmcnt(10)
    v_mfma_f32_16x16x32_bf16 v[120:123], v[92:95], v[204:207], v[120:123]
    v_mfma_f32_16x16x32_bf16 v[124:127], v[92:95], v[220:223], v[124:127]
    s_waitcnt lgkmcnt(9)
    v_mfma_f32_16x16x32_bf16 v[120:123], v[96:99], v[208:211], v[120:123]
    v_mfma_f32_16x16x32_bf16 v[124:127], v[96:99], v[224:227], v[124:127]
    s_waitcnt lgkmcnt(8)
    v_mfma_f32_16x16x32_bf16 v[120:123], v[100:103], v[212:215], v[120:123]
    v_mfma_f32_16x16x32_bf16 v[124:127], v[100:103], v[228:231], v[124:127]
    v_cvt_pk_bf16_f32 v140, v128, v129
    v_cvt_pk_bf16_f32 v141, v130, v131
    v_cvt_pk_bf16_f32 v142, v132, v133
    v_cvt_pk_bf16_f32 v143, v134, v135
    buffer_store_dwordx4 v[140:143], v13, s[32:35], s58 offen sc1
    s_add_u32 s58, s58, 8192
    s_waitcnt lgkmcnt(7)
    v_mfma_f32_16x16x32_bf16 v[128:131], v[104:107], v[200:203], 0
    v_mfma_f32_16x16x32_bf16 v[132:135], v[104:107], v[216:219], 0
    s_waitcnt lgkmcnt(6)
    v_mfma_f32_16x16x32_bf16 v[128:131], v[108:111], v[204:207], v[128:131]
    v_mfma_f32_16x16x32_bf16 v[132:135], v[108:111], v[220:223], v[132:135]
    s_waitcnt lgkmcnt(5)
    v_mfma_f32_16x16x32_bf16 v[128:131], v[112:115], v[208:211], v[128:131]
    v_mfma_f32_16x16x32_bf16 v[132:135], v[112:115], v[224:227], v[132:135]
    s_waitcnt lgkmcnt(4)
    v_mfma_f32_16x16x32_bf16 v[128:131], v[116:119], v[212:215], v[128:131]
    v_mfma_f32_16x16x32_bf16 v[132:135], v[116:119], v[228:231], v[132:135]
    v_cvt_pk_bf16_f32 v136, v120, v121
    v_cvt_pk_bf16_f32 v137, v122, v123
    v_cvt_pk_bf16_f32 v138, v124, v125
    v_cvt_pk_bf16_f32 v139, v126, v127
    buffer_store_dwordx4 v[136:139], v13, s[32:35], s58 offen sc1
    s_add_u32 s58, s58, 8192
    s_waitcnt lgkmcnt(3)
    v_mfma_f32_16x16x32_bf16 v[120:123], v[56:59], v[200:203], 0
    v_mfma_f32_16x16x32_bf16 v[124:127], v[56:59], v[216:219], 0
    s_waitcnt lgkmcnt(2)
    v_mfma_f32_16x16x32_bf16 v[120:123], v[60:63], v[204:207], v[120:123]
    v_mfma_f32_16x16x32_bf16 v[124:127], v[60:63], v[220:223], v[124:127]
    s_waitcnt lgkmcnt(1)
    v_mfma_f32_16x16x32_bf16 v[120:123], v[64:67], v[208:211], v[120:123]
    v_mfma_f32_16x16x32_bf16 v[124:127], v[64:67], v[224:227], v[124:127]
    s_waitcnt lgkmcnt(0)
    v_mfma_f32_16x16x32_bf16 v[120:123], v[68:71], v[212:215], v[120:123]
    v_mfma_f32_16x16x32_bf16 v[124:127], v[68:71], v[228:231], v[124:127]
    v_cvt_pk_bf16_f32 v140, v128, v129
    v_cvt_pk_bf16_f32 v141, v130, v131
    v_cvt_pk_bf16_f32 v142, v132, v133
    v_cvt_pk_bf16_f32 v143, v134, v135
    buffer_store_dwordx4 v[140:143], v13, s[32:35], s58 offen sc1
    s_add_u32 s58, s58, 8192
    s_nop 0
    v_cvt_pk_bf16_f32 v136, v120, v121
    v_cvt_pk_bf16_f32 v137, v122, v123
    v_cvt_pk_bf16_f32 v138, v124, v125
    v_cvt_pk_bf16_f32 v139, v126, v127
    buffer_store_dwordx4 v[136:139], v13, s[32:35], s58 offen sc1
    s_or_b32 s56, s55, s3
    s_cmp_lg_u32 s56, 0
    s_cbranch_scc1 K_NOEPO
    v_mov_b32 v10, s52
    s_mov_b64 exec, 1
    buffer_store_dword v10, v4, s[36:39], 0 offen offset:0
K_NOEPO:
K_END:
    s_endpgm
.p2align 6
.type K_TAB,@object
K_TAB:
.byte 6, 5, 14, 7, 4, 2, 0, 1, 3, 12, 22, 11, 10, 8, 30, 9, 19, 13, 15, 17, 16, 21, 23, 20, 18, 25, 29, 28, 31, 27, 26, 24, 34, 32, 39, 33, 35, 36, 37, 38, 255, 255, 255, 255, 255, 255, 255, 255, 255, 255, 255, 255, 255, 255, 255, 255, 255, 255, 255, 255, 255, 255, 255, 255
.byte 3, 2, 4, 7, 0, 1, 6, 8, 5, 9, 15, 13, 14, 11, 12, 22, 21, 16, 10, 23, 17, 20, 30, 19, 18, 25, 27, 24, 29, 28, 26, 31, 34, 37, 36, 39, 33, 38, 32, 35, 255, 255, 255, 255, 255, 255, 255, 255, 255, 255, 255, 255, 255, 255, 255, 255, 255, 255, 255, 255, 255, 255, 255, 255
.section .rodata,"a"
.p2align 6
.amdhsa_kernel gather_scatter__tensor_product_equiv_tfn__graph_kernel
  .amdhsa_next_free_vgpr 256
  .amdhsa_next_free_sgpr 72
  .amdhsa_accum_offset 256
  .amdhsa_group_segment_fixed_size 0
  .amdhsa_kernarg_size 88
  .amdhsa_user_sgpr_count 2
  .amdhsa_user_sgpr_kernarg_segment_ptr 1
  .amdhsa_system_sgpr_workgroup_id_x 1
  .amdhsa_float_denorm_mode_32 3
.end_amdhsa_kernel
```

```asm
; @launch grid=(256,1,1) block=(512,1,1) lds=152832
.amdgcn_target "amdgcn-amd-amdhsa--gfx950"
.text
.globl gather_scatter__tensor_product_equiv_tfn__graph_kernel
.p2align 8
.type gather_scatter__tensor_product_equiv_tfn__graph_kernel,@function
gather_scatter__tensor_product_equiv_tfn__graph_kernel:
    s_cmp_ge_u32 s2, 256
    s_cbranch_scc1 K_END
    s_load_dwordx16 s[4:19], s[0:1], 0
    s_load_dwordx2 s[20:21], s[0:1], 64
    s_load_dwordx2 s[24:25], s[0:1], 80
    v_lshrrev_b32 v2, 6, v0
    v_and_b32 v1, 63, v0
    v_readfirstlane_b32 s3, v2
    v_lshlrev_b32 v10, 4, v0
    s_mul_i32 s57, s2, 5120
    v_lshlrev_b32 v3, 2, v0
    s_cmp_lg_u32 s3, 5
    s_cbranch_scc1 K_PF0
    s_getpc_b64 s[26:27]
K_PC3:
    v_lshlrev_b32 v13, 7, v1
    global_load_dword v255, v13, s[26:27]
    v_add_u32 v13, 8192, v13
    v_min_u32 v13, K_TAB-K_PC3, v13
    global_load_dword v255, v13, s[26:27]
K_PF0:
    v_or_b32 v13, 0x4b000000, v1
    s_cmp_eq_u32 s3, 2
    s_cselect_b32 s56, -1, 0
    v_add_u32 v11, s57, v10
    v_and_b32 v13, s56, v13
    v_lshlrev_b32 v12, 1, v11
    ds_write_b32 v3, v13
    s_cmp_lt_u32 s2, 250
    s_cselect_b32 s56, 5, 0
    s_cmp_lt_u32 s3, s56
    s_waitcnt lgkmcnt(0)
    s_cbranch_scc0 K_BA
    global_load_dwordx4 v[120:123], v11, s[8:9]
    global_load_dwordx4 v[124:127], v11, s[6:7]
K_BA:
    s_barrier
    s_cbranch_scc0 K_HELP
    global_load_dwordx4 v[128:131], v12, s[10:11] offset:0
    global_load_dwordx4 v[132:135], v12, s[10:11] offset:16
    global_load_dwordx4 v[136:139], v12, s[12:13] offset:0
    global_load_dwordx4 v[140:143], v12, s[12:13] offset:16
    s_mov_b32 s40, 1
    s_load_dword s52, s[24:25], 0
    v_mov_b32 v4, 0
    v_mov_b32 v5, 0
    v_mov_b32 v6, 0
    v_mov_b32 v7, 0
    v_add_u32 v8, 106752, v10
    v_lshlrev_b32 v9, 4, v1
    v_lshlrev_b32 v15, 2, v1
    ds_write_b128 v8, v[4:7]
    ds_write_b32 v3, v4 offset:2048
    s_and_b32 s53, s2, 7
    s_lshr_b32 s56, s2, 3
    s_lshl_b32 s53, s53, 5
    s_or_b32 s53, s53, s56
    s_mul_i32 s54, s53, 625
    s_add_u32 s57, s54, 640
    s_add_u32 s54, s54, 15
    s_lshr_b32 s54, s54, 4
    s_lshr_b32 s57, s57, 4
    s_mov_b32 s28, s4
    s_and_b32 s29, s5, 0xffff
    s_or_b32 s29, s29, 0x100000
    s_mov_b32 s30, 10240000
    s_mov_b32 s31, 0x800000
    s_mov_b32 s32, s20
    s_mov_b32 s33, s21
    s_lshl_b32 s34, s57, 10
    s_mov_b32 s35, 0x20000
    s_mov_b32 s36, s24
    s_mov_b32 s37, s25
    s_mov_b32 s38, 8388608
    s_mov_b32 s39, 0x20000
    s_mov_b32 s47, 0
    s_mov_b32 s63, 0
    v_mov_b32 v14, 1
    s_lshr_b32 s27, s53, 5
    s_mul_i32 s27, s27, 20009
    s_add_u32 s27, s27, 14
    s_lshr_b32 s27, s27, 4
    s_lshl_b32 s27, s27, 10
    v_mov_b32 v16, 0
    v_mov_b32 v17, 0
    v_mov_b32 v18, 0
    v_mov_b32 v19, 0
    v_mov_b32 v20, 0
    v_mov_b32 v21, 0
    v_mov_b32 v22, 0
    v_mov_b32 v23, 0
    v_mov_b32 v24, 0
    v_mov_b32 v25, 0
    v_mov_b32 v26, 0
    v_mov_b32 v27, 0
    v_mov_b32 v28, 0
    v_mov_b32 v29, 0
    v_mov_b32 v30, 0
    v_mov_b32 v31, 0
    v_mov_b32 v32, 0
    v_mov_b32 v33, 0
    v_mov_b32 v34, 0
    v_mov_b32 v35, 0
    v_mov_b32 v36, 0
    v_mov_b32 v37, 0
    v_mov_b32 v38, 0
    v_mov_b32 v39, 0
    v_mov_b32 v40, 0
    v_mov_b32 v41, 0
    v_mov_b32 v42, 0
    v_mov_b32 v43, 0
    v_mov_b32 v44, 0
    v_mov_b32 v45, 0
    v_mov_b32 v46, 0
    v_mov_b32 v47, 0
    v_mov_b32 v48, 0
    v_mov_b32 v49, 0
    v_mov_b32 v50, 0
    v_mov_b32 v51, 0
    v_mov_b32 v52, 0
    v_mov_b32 v53, 0
    v_mov_b32 v54, 0
    v_mov_b32 v55, 0
    s_waitcnt vmcnt(5)
    v_mul_u32_u24 v60, 214749, v120
    v_lshrrev_b32 v60, 23, v60
    v_lshlrev_b32 v144, 2, v60
    ds_add_rtn_u32 v148, v144, v14 offset:768
    v_mul_u32_u24 v61, 214749, v121
    v_lshrrev_b32 v61, 23, v61
    v_lshlrev_b32 v145, 2, v61
    ds_add_rtn_u32 v149, v145, v14 offset:768
    v_mul_u32_u24 v62, 214749, v122
    v_lshrrev_b32 v62, 23, v62
    v_lshlrev_b32 v146, 2, v62
    ds_add_rtn_u32 v150, v146, v14 offset:768
    v_mul_u32_u24 v63, 214749, v123
    v_lshrrev_b32 v63, 23, v63
    v_lshlrev_b32 v147, 2, v63
    ds_add_rtn_u32 v151, v147, v14 offset:768
    v_mul_u32_u24 v64, 625, v60
    v_add_u32 v64, 15, v64
    v_lshrrev_b32 v64, 4, v64
    v_sub_u32 v56, v120, v64
    v_mul_u32_u24 v64, 625, v61
    v_add_u32 v64, 15, v64
    v_lshrrev_b32 v64, 4, v64
    v_sub_u32 v57, v121, v64
    v_mul_u32_u24 v64, 625, v62
    v_add_u32 v64, 15, v64
    v_lshrrev_b32 v64, 4, v64
    v_sub_u32 v58, v122, v64
    v_mul_u32_u24 v64, 625, v63
    v_add_u32 v64, 15, v64
    v_lshrrev_b32 v64, 4, v64
    v_sub_u32 v59, v123, v64
    s_branch K_BB
K_HELP:
    s_mov_b32 s40, 0
    s_load_dword s52, s[24:25], 0
    v_mov_b32 v4, 0
    v_mov_b32 v5, 0
    v_mov_b32 v6, 0
    v_mov_b32 v7, 0
    v_add_u32 v8, 106752, v10
    v_lshlrev_b32 v9, 4, v1
    v_lshlrev_b32 v15, 2, v1
    ds_write_b128 v8, v[4:7]
    ds_write_b32 v3, v4 offset:2048
    s_and_b32 s53, s2, 7
    s_lshr_b32 s56, s2, 3
    s_lshl_b32 s53, s53, 5
    s_or_b32 s53, s53, s56
    s_cmp_eq_u32 s3, 7
    s_cbranch_scc1 K_HELP7
    s_cmp_lg_u32 s3, 6
    s_cbranch_scc1 K_HELP2
    s_and_b32 s56, s53, 31
    s_lshl_b32 s56, s56, 10
    v_lshl_add_u32 v13, v1, 7, s56
    s_mov_b64 exec, 0xff
    global_load_dword v255, v13, s[18:19]
    s_mov_b64 exec, -1
    s_branch K_HELP2
K_HELP7:
    s_mov_b32 m0, 147712
    s_getpc_b64 s[26:27]
K_PC:
    global_load_lds_dwordx4 v9, s[14:15]
    s_add_u32 s26, s26, K_TAB-K_PC
    s_addc_u32 s27, s27, 0
    s_mov_b32 m0, 148736
    s_mov_b64 exec, 0xff
    global_load_lds_dwordx4 v9, s[16:17]
    s_mov_b32 m0, 148864
    s_nop 0
    global_load_lds_dwordx4 v9, s[26:27]
    s_mov_b64 exec, -1
K_HELP2:
    s_mul_i32 s54, s53, 625
    s_add_u32 s57, s54, 640
    s_add_u32 s54, s54, 15
    s_lshr_b32 s54, s54, 4
    s_lshr_b32 s57, s57, 4
    s_mov_b32 s28, s4
    s_and_b32 s29, s5, 0xffff
    s_or_b32 s29, s29, 0x100000
    s_mov_b32 s30, 10240000
    s_mov_b32 s31, 0x800000
    s_mov_b32 s32, s20
    s_mov_b32 s33, s21
    s_lshl_b32 s34, s57, 10
    s_mov_b32 s35, 0x20000
    s_mov_b32 s36, s24
    s_mov_b32 s37, s25
    s_mov_b32 s38, 8388608
    s_mov_b32 s39, 0x20000
    s_mov_b32 s47, 0
    s_mov_b32 s63, 0
    v_mov_b32 v14, 1
    s_lshr_b32 s27, s53, 5
    s_mul_i32 s27, s27, 20009
    s_add_u32 s27, s27, 14
    s_lshr_b32 s27, s27, 4
    s_lshl_b32 s27, s27, 10
    v_mov_b32 v16, 0
    v_mov_b32 v17, 0
    v_mov_b32 v18, 0
    v_mov_b32 v19, 0
    v_mov_b32 v20, 0
    v_mov_b32 v21, 0
    v_mov_b32 v22, 0
    v_mov_b32 v23, 0
    v_mov_b32 v24, 0
    v_mov_b32 v25, 0
    v_mov_b32 v26, 0
    v_mov_b32 v27, 0
    v_mov_b32 v28, 0
    v_mov_b32 v29, 0
    v_mov_b32 v30, 0
    v_mov_b32 v31, 0
    v_mov_b32 v32, 0
    v_mov_b32 v33, 0
    v_mov_b32 v34, 0
    v_mov_b32 v35, 0
    v_mov_b32 v36, 0
    v_mov_b32 v37, 0
    v_mov_b32 v38, 0
    v_mov_b32 v39, 0
    v_mov_b32 v40, 0
    v_mov_b32 v41, 0
    v_mov_b32 v42, 0
    v_mov_b32 v43, 0
    v_mov_b32 v44, 0
    v_mov_b32 v45, 0
    v_mov_b32 v46, 0
    v_mov_b32 v47, 0
    v_mov_b32 v48, 0
    v_mov_b32 v49, 0
    v_mov_b32 v50, 0
    v_mov_b32 v51, 0
    v_mov_b32 v52, 0
    v_mov_b32 v53, 0
    v_mov_b32 v54, 0
    v_mov_b32 v55, 0
K_BB:
    s_waitcnt lgkmcnt(0)
    s_barrier
    s_add_u32 s52, s52, 1
    s_and_b32 s56, s52, 0x3ff
    s_lshl_b32 s58, s56, 22
    s_lshl_b32 s26, s52, 24
    s_cmp_eq_u32 s3, 7
    s_cselect_b32 s56, 1, s40
    s_cmp_eq_u32 s56, 0
    s_cbranch_scc1 K_BC1
    ds_read_b128 v[152:155], v9 offset:768
    s_cmp_eq_u32 s3, 7
    s_cbranch_scc1 K_SC
    s_waitcnt vmcnt(4)
    v_mul_u32_u24 v60, 1677, v124
    v_lshrrev_b32 v60, 20, v60
    v_lshl_or_b32 v56, v56, 4, v60
    v_lshl_or_b32 v56, v124, 10, v56
    v_mul_u32_u24 v61, 1677, v125
    v_lshrrev_b32 v61, 20, v61
    v_lshl_or_b32 v57, v57, 4, v61
    v_lshl_or_b32 v57, v125, 10, v57
    v_mul_u32_u24 v62, 1677, v126
    v_lshrrev_b32 v62, 20, v62
    v_lshl_or_b32 v58, v58, 4, v62
    v_lshl_or_b32 v58, v126, 10, v58
    v_mul_u32_u24 v63, 1677, v127
    v_lshrrev_b32 v63, 20, v63
    v_lshl_or_b32 v59, v59, 4, v63
    v_lshl_or_b32 v59, v127, 10, v59
K_SC:
    s_waitcnt lgkmcnt(0)
    v_add_u32 v156, v152, v153
    v_add_u32 v157, v156, v154
    v_add_u32 v158, v157, v155
    v_mov_b32 v160, v158
    v_or_b32 v66, s26, v56
    v_mov_b32 v67, s52
    v_add_u32_dpp v160, v160, v160 row_shr:1 row_mask:0xf bank_mask:0xf
    v_or_b32 v68, s26, v57
    v_mov_b32 v69, s52
    v_add_u32_dpp v160, v160, v160 row_shr:2 row_mask:0xf bank_mask:0xf
    v_or_b32 v70, s26, v58
    v_mov_b32 v71, s52
    v_add_u32_dpp v160, v160, v160 row_shr:4 row_mask:0xf bank_mask:0xf
    v_or_b32 v72, s26, v59
    v_mov_b32 v73, s52
    v_add_u32_dpp v160, v160, v160 row_shr:8 row_mask:0xf bank_mask:0xf
    s_nop 1
    v_add_u32_dpp v160, v160, v160 row_bcast:15 row_mask:0xa bank_mask:0xf
    s_nop 1
    v_add_u32_dpp v160, v160, v160 row_bcast:31 row_mask:0xc bank_mask:0xf
    v_sub_u32 v160, v160, v158
    v_add_u32 v161, v160, v152
    v_add_u32 v162, v160, v156
    v_add_u32 v163, v160, v157
    s_cmp_lg_u32 s3, 7
    s_cbranch_scc1 K_NOROW
    v_lshl_or_b32 v168, v152, 11, v160
    v_or_b32 v168, s58, v168
    v_mov_b32 v169, s52
    v_lshl_or_b32 v170, v153, 11, v161
    v_or_b32 v170, s58, v170
    v_mov_b32 v171, s52
    v_lshl_or_b32 v172, v154, 11, v162
    v_or_b32 v172, s58, v172
    v_mov_b32 v173, s52
    v_lshl_or_b32 v174, v155, 11, v163
    v_or_b32 v174, s58, v174
    v_mov_b32 v175, s52
    s_lshl_b32 s57, s2, 11
    s_add_u32 s57, s57, 8192
    v_lshlrev_b32 v12, 5, v1
    buffer_store_dwordx4 v[168:171], v12, s[36:39], s57 offen sc1
    buffer_store_dwordx4 v[172:175], v12, s[36:39], s57 offen offset:16 sc1
    s_branch K_BC1
K_NOROW:
    ds_write_b128 v9, v[160:163] offset:4096
    ds_read_b32 v60, v144 offset:4096
    ds_read_b32 v61, v145 offset:4096
    ds_read_b32 v62, v146 offset:4096
    ds_read_b32 v63, v147 offset:4096
    s_waitcnt lgkmcnt(3)
    v_add_lshl_u32 v144, v60, v148, 3
    ds_write_b64 v144, v[66:67] offset:13824
    s_waitcnt lgkmcnt(3)
    v_add_lshl_u32 v145, v61, v149, 3
    ds_write_b64 v145, v[68:69] offset:13824
    s_waitcnt lgkmcnt(3)
    v_add_lshl_u32 v146, v62, v150, 3
    ds_write_b64 v146, v[70:71] offset:13824
    s_waitcnt lgkmcnt(3)
    v_add_lshl_u32 v147, v63, v151, 3
    ds_write_b64 v147, v[72:73] offset:13824
    s_mov_b32 s56, 44800
    v_lshl_add_u32 v144, v144, 1, s56
    v_lshl_add_u32 v145, v145, 1, s56
    v_lshl_add_u32 v146, v146, 1, s56
    v_lshl_add_u32 v147, v147, 1, s56
K_BC1:
    s_mul_i32 s60, s2, 10240
    s_add_u32 s60, s60, 532480
    s_sub_u32 s56, s3, 5
    s_lshl_b32 s57, s56, 14
    v_add_u32 v13, s57, v9
    s_add_u32 s57, s57, 114944
    s_waitcnt lgkmcnt(0)
    s_barrier
    s_cmp_ge_u32 s2, 250
    s_cbranch_scc1 K_KS2
    ds_read_b128 v[76:79], v10 offset:13824
    s_cmp_lt_u32 s56, 2
    s_cbranch_scc0 K_KS1
    ds_read_b128 v[80:83], v10 offset:16896
    s_add_u32 s59, s60, 3072
    s_waitcnt lgkmcnt(0)
    buffer_store_dwordx4 v[80:83], v10, s[36:39], s59 offen sc1
K_KS1:
    s_waitcnt lgkmcnt(0)
    buffer_store_dwordx4 v[76:79], v10, s[36:39], s60 offen sc1
K_KS2:
    s_cmp_lt_u32 s56, 2
    s_cbranch_scc1 K_DMA
    s_cmp_eq_u32 s40, 0
    s_cbranch_scc1 K_BC7
    s_waitcnt vmcnt(2)
    ds_write2_b64 v144, v[128:129], v[136:137] offset0:0 offset1:1
    ds_write2_b64 v145, v[130:131], v[138:139] offset0:0 offset1:1
    s_waitcnt vmcnt(1)
    ds_write2_b64 v146, v[132:133], v[140:141] offset0:0 offset1:1
    ds_write2_b64 v147, v[134:135], v[142:143] offset0:0 offset1:1
    s_branch K_BC
K_DMA:
    s_mov_b32 m0, s57
    s_add_u32 s57, s57, 4096
    global_load_lds_dwordx4 v13, s[18:19] offset:0
    global_load_lds_dwordx4 v13, s[18:19] offset:1024
    global_load_lds_dwordx4 v13, s[18:19] offset:2048
    global_load_lds_dwordx4 v13, s[18:19] offset:3072
    v_add_u32 v13, 4096, v13
    s_mov_b32 m0, s57
    s_add_u32 s57, s57, 4096
    global_load_lds_dwordx4 v13, s[18:19] offset:0
    global_load_lds_dwordx4 v13, s[18:19] offset:1024
    global_load_lds_dwordx4 v13, s[18:19] offset:2048
    global_load_lds_dwordx4 v13, s[18:19] offset:3072
    v_add_u32 v13, 4096, v13
    s_mov_b32 m0, s57
    s_add_u32 s57, s57, 4096
    global_load_lds_dwordx4 v13, s[18:19] offset:0
    global_load_lds_dwordx4 v13, s[18:19] offset:1024
    global_load_lds_dwordx4 v13, s[18:19] offset:2048
    global_load_lds_dwordx4 v13, s[18:19] offset:3072
    v_add_u32 v13, 4096, v13
    s_mov_b32 m0, s57
    s_add_u32 s57, s57, 4096
    global_load_lds_dwordx4 v13, s[18:19] offset:0
    global_load_lds_dwordx4 v13, s[18:19] offset:1024
    global_load_lds_dwordx4 v13, s[18:19] offset:2048
    global_load_lds_dwordx4 v13, s[18:19] offset:3072
    s_branch K_BC
K_BC7:
    s_cmp_ge_u32 s2, 250
    s_cbranch_scc0 K_BC8
    s_waitcnt vmcnt(2)
K_BC8:
    s_waitcnt vmcnt(3)
K_BC:
    s_mul_i32 s56, s2, 20480
    s_add_u32 s56, s56, 3145728
    s_add_u32 s57, s56, 8192
    s_add_u32 s59, s56, 16384
    v_lshlrev_b32 v11, 11, v0
    s_lshl_b32 s61, s53, 3
    s_add_u32 s61, s61, 8192
    s_waitcnt lgkmcnt(0)
    s_barrier
    s_cmp_ge_u32 s2, 250
    s_cbranch_scc1 K_NOST
    ds_read_b128 v[56:59], v10 offset:44800
    ds_read_b128 v[60:63], v10 offset:52992
    ds_read_b128 v[64:67], v10 offset:61184
    s_waitcnt lgkmcnt(2)
    buffer_store_dwordx4 v[56:59], v10, s[36:39], s56 offen sc1
    s_waitcnt lgkmcnt(1)
    buffer_store_dwordx4 v[60:63], v10, s[36:39], s57 offen sc1
    s_cmp_ge_u32 s3, 4
    s_cbranch_scc1 K_NOST
    s_waitcnt lgkmcnt(0)
    buffer_store_dwordx4 v[64:67], v10, s[36:39], s59 offen sc1
K_NOST:
    s_cmp_ge_u32 s3, 4
    s_cbranch_scc1 K_NOA0
    buffer_load_dwordx2 v[152:153], v11, s[36:39], s61 offen sc1
K_NOA0:
    s_lshr_b32 s56, s34, 10
    s_sub_u32 s56, s56, s54
    s_sub_u32 s56, s56, 39
    s_lshl_b32 s56, s56, 6
    s_add_u32 s56, s56, 148864
    v_add_u32 v2, s56, v1
    v_add_u32 v13, 147712, v15
    ds_read_u8 v2, v2
    ds_read2st64_b32 v[188:189], v13 offset0:0 offset1:1
    ds_read2st64_b32 v[190:191], v13 offset0:2 offset1:3
    v_and_b32 v12, 3, v1
    v_lshlrev_b32 v12, 5, v12
    v_bfe_u32 v13, v1, 2, 2
    v_lshl_or_b32 v12, v13, 1, v12
    v_add_u32 v12, 148736, v12
    ds_read_u16 v192, v12 offset:0
    ds_read_u16 v193, v12 offset:8
    ds_read_u16 v194, v12 offset:16
    ds_read_u16 v195, v12 offset:24
    v_mov_b32 v252, v3
    v_xor_b32 v253, 1024, v3
    v_mul_u32_u24 v185, 128, v0
    s_mov_b32 s56, 0xbfb8aa3b
    s_waitcnt lgkmcnt(0)
    v_lshlrev_b32 v136, 16, v188
    v_mul_f32 v140, s56, v136
    v_lshlrev_b32 v137, 16, v189
    v_mul_f32 v141, s56, v137
    v_lshlrev_b32 v138, 16, v190
    v_mul_f32 v142, s56, v138
    v_lshlrev_b32 v139, 16, v191
    v_mul_f32 v143, s56, v139
    v_cvt_pk_bf16_f32 v176, v140, v141
    v_cvt_pk_bf16_f32 v177, v142, v143
    v_and_b32 v136, 0xffff0000, v188
    v_mul_f32 v140, s56, v136
    v_and_b32 v137, 0xffff0000, v189
    v_mul_f32 v141, s56, v137
    v_and_b32 v138, 0xffff0000, v190
    v_mul_f32 v142, s56, v138
    v_and_b32 v139, 0xffff0000, v191
    v_mul_f32 v143, s56, v139
    v_cvt_pk_bf16_f32 v180, v140, v141
    v_cvt_pk_bf16_f32 v181, v142, v143
    v_lshl_or_b32 v136, v193, 16, v192
    v_lshl_or_b32 v137, v195, 16, v194
    v_lshrrev_b32 v13, 4, v1
    v_cmp_eq_u32 vcc, 0, v13
    s_nop 1
    v_cndmask_b32 v232, 0, v136, vcc
    v_cndmask_b32 v233, 0, v137, vcc
    v_cmp_eq_u32 vcc, 1, v13
    s_nop 1
    v_cndmask_b32 v234, 0, v136, vcc
    v_cndmask_b32 v235, 0, v137, vcc
    v_cmp_eq_u32 vcc, 2, v13
    s_nop 1
    v_cndmask_b32 v236, 0, v136, vcc
    v_cndmask_b32 v237, 0, v137, vcc
    v_cmp_eq_u32 vcc, 3, v13
    s_nop 1
    v_cndmask_b32 v238, 0, v136, vcc
    v_cndmask_b32 v239, 0, v137, vcc
    v_mul_u32_u24 v13, 5120, v1
    s_cmp_ge_u32 s3, 4
    s_cbranch_scc1 K_TABOK
    s_mov_b32 s59, 40000
    s_lshr_b32 s58, s58, 22
    s_branch K_POLLA1
K_POLLA:
    buffer_load_dwordx2 v[152:153], v11, s[36:39], s61 offen sc1
K_POLLA1:
    s_waitcnt vmcnt(0)
    v_lshrrev_b32 v154, 22, v152
    v_cmp_ne_u32 vcc, s52, v153
    v_cmp_ne_u32 s[56:57], s58, v154
    s_or_b64 vcc, vcc, s[56:57]
    s_cbranch_vccz K_POLLAOK
    s_sub_u32 s59, s59, 1
    s_cbranch_scc0 K_POLLA
    ds_write_b32 v4, v14 offset:1792
K_POLLAOK:
    ds_write_b32 v3, v152 offset:5120
K_TABOK:
    s_waitcnt vmcnt(0) lgkmcnt(0)
    s_barrier
    s_cmp_lg_u32 s3, 0
    s_cbranch_scc1 K_NOFLAG
    s_mul_i32 s56, s2, 128
    s_add_u32 s56, s56, 8323072
    v_mov_b32 v10, s52
    s_mov_b64 exec, 1
    buffer_store_dword v10, v4, s[36:39], s56 offen sc1
    s_mov_b64 exec, -1
K_NOFLAG:
    ds_read_b128 v[120:123], v9 offset:5120
    ds_read_b32 v10, v4 offset:1792
    s_cmp_lt_u32 s3, 6
    s_cbranch_scc1 K_NOPFX
    s_mov_b32 s64, s4
    s_mov_b32 s65, s5
    s_mov_b32 s66, 10240000
    s_mov_b32 s67, 0x20000
    s_sub_u32 s68, 7, s3
    s_lshl_b32 s68, s68, 5
    s_and_b32 s69, s53, 31
    s_add_u32 s68, s68, s69
    s_lshl_b32 s68, s68, 13
    s_add_u32 s68, s68, s27
    v_lshlrev_b32 v12, 7, v1
    buffer_load_dword v255, v12, s[64:67], s68 offen
K_NOPFX:
    s_waitcnt lgkmcnt(0)
    v_readfirstlane_b32 s55, v10
    v_bfe_u32 v124, v120, 11, 11
    v_bfe_u32 v125, v121, 11, 11
    v_bfe_u32 v126, v122, 11, 11
    v_bfe_u32 v127, v123, 11, 11
    v_add_u32 v129, v124, v125
    v_add_u32 v130, v129, v126
    v_add_u32 v131, v130, v127
    v_mov_b32 v132, v131
    v_and_b32 v120, 0x7ff, v120
    v_add_u32 v248, v13, v120
    v_add_u32_dpp v132, v132, v132 row_shr:1 row_mask:0xf bank_mask:0xf
    v_and_b32 v121, 0x7ff, v121
    v_add_u32 v249, v13, v121
    v_add_u32_dpp v132, v132, v132 row_shr:2 row_mask:0xf bank_mask:0xf
    v_add_u32 v249, 1280, v249
    v_and_b32 v122, 0x7ff, v122
    v_add_u32_dpp v132, v132, v132 row_shr:4 row_mask:0xf bank_mask:0xf
    v_add_u32 v250, v13, v122
    v_add_u32 v250, 2560, v250
    v_add_u32_dpp v132, v132, v132 row_shr:8 row_mask:0xf bank_mask:0xf
    v_and_b32 v123, 0x7ff, v123
    v_add_u32 v251, v13, v123
    v_add_u32_dpp v132, v132, v132 row_bcast:15 row_mask:0xa bank_mask:0xf
    v_add_u32 v251, 3840, v251
    s_nop 0
    v_add_u32_dpp v132, v132, v132 row_bcast:31 row_mask:0xc bank_mask:0xf
    s_cmp_lg_u32 s55, 0
    s_cbranch_scc1 K_FB0
    v_readlane_b32 s46, v132, 63
    v_sub_u32 v240, v132, v131
    v_add_u32 v241, v240, v124
    v_add_u32 v242, v240, v129
    v_add_u32 v243, v240, v130
    v_sub_u32 v248, v248, v240
    v_add_u32 v244, v240, v124
    v_sub_u32 v249, v249, v241
    v_add_u32 v245, v241, v125
    v_sub_u32 v250, v250, v242
    v_add_u32 v246, v242, v126
    v_sub_u32 v251, v251, v243
    v_add_u32 v247, v243, v127
K_ROUND:
    s_mul_i32 s56, s3, 192
    s_add_u32 s56, s56, s47
    s_add_u32 s57, s56, 192
    s_lshl_b32 s58, s3, 10
    s_add_u32 s58, s58, 106752
    v_cmp_lt_u32 vcc, s56, v244
    v_cmp_gt_u32 s[60:61], s57, v240
    v_subrev_u32 v56, s56, v240
    v_max_i32 v56, 0, v56
    v_lshl_add_u32 v56, v56, 2, s58
    s_and_b64 exec, vcc, s[60:61]
    ds_max_u32 v56, v248
    s_mov_b64 exec, -1
    v_cmp_lt_u32 vcc, s56, v245
    v_cmp_gt_u32 s[60:61], s57, v241
    v_subrev_u32 v57, s56, v241
    v_max_i32 v57, 0, v57
    v_lshl_add_u32 v57, v57, 2, s58
    s_and_b64 exec, vcc, s[60:61]
    ds_max_u32 v57, v249
    s_mov_b64 exec, -1
    v_cmp_lt_u32 vcc, s56, v246
    v_cmp_gt_u32 s[60:61], s57, v242
    v_subrev_u32 v58, s56, v242
    v_max_i32 v58, 0, v58
    v_lshl_add_u32 v58, v58, 2, s58
    s_and_b64 exec, vcc, s[60:61]
    ds_max_u32 v58, v250
    s_mov_b64 exec, -1
    v_cmp_lt_u32 vcc, s56, v247
    v_cmp_gt_u32 s[60:61], s57, v243
    v_subrev_u32 v59, s56, v243
    v_max_i32 v59, 0, v59
    v_lshl_add_u32 v59, v59, 2, s58
    s_and_b64 exec, vcc, s[60:61]
    ds_max_u32 v59, v251
    s_mov_b64 exec, -1
    v_add_u32 v60, s58, v15
    ds_read_b32 v64, v60 offset:0
    ds_read_b32 v65, v60 offset:256
    ds_read_b32 v66, v60 offset:512
    v_add_u32 v68, s56, v1
    v_add_u32 v69, 64, v68
    v_add_u32 v70, 128, v68
    v_cmp_gt_u32 s[40:41], s46, v68
    v_cmp_gt_u32 s[42:43], s46, v69
    v_cmp_gt_u32 s[44:45], s46, v70
    s_mov_b32 s60, 532480
    s_mov_b32 s61, 3145728
    s_lshr_b32 s62, s26, 24
    s_waitcnt lgkmcnt(0)
    v_max_u32_dpp v64, v64, v64 row_shr:1 row_mask:0xf bank_mask:0xf
    v_max_u32_dpp v65, v65, v65 row_shr:1 row_mask:0xf bank_mask:0xf
    v_max_u32_dpp v66, v66, v66 row_shr:1 row_mask:0xf bank_mask:0xf
    v_max_u32_dpp v64, v64, v64 row_shr:2 row_mask:0xf bank_mask:0xf
    v_max_u32_dpp v65, v65, v65 row_shr:2 row_mask:0xf bank_mask:0xf
    v_max_u32_dpp v66, v66, v66 row_shr:2 row_mask:0xf bank_mask:0xf
    v_max_u32_dpp v64, v64, v64 row_shr:4 row_mask:0xf bank_mask:0xf
    v_max_u32_dpp v65, v65, v65 row_shr:4 row_mask:0xf bank_mask:0xf
    v_max_u32_dpp v66, v66, v66 row_shr:4 row_mask:0xf bank_mask:0xf
    v_max_u32_dpp v64, v64, v64 row_shr:8 row_mask:0xf bank_mask:0xf
    v_max_u32_dpp v65, v65, v65 row_shr:8 row_mask:0xf bank_mask:0xf
    v_max_u32_dpp v66, v66, v66 row_shr:8 row_mask:0xf bank_mask:0xf
    v_max_u32_dpp v64, v64, v64 row_bcast:15 row_mask:0xa bank_mask:0xf
    v_max_u32_dpp v65, v65, v65 row_bcast:15 row_mask:0xa bank_mask:0xf
    v_max_u32_dpp v66, v66, v66 row_bcast:15 row_mask:0xa bank_mask:0xf
    v_max_u32_dpp v64, v64, v64 row_bcast:31 row_mask:0xc bank_mask:0xf
    v_max_u32_dpp v65, v65, v65 row_bcast:31 row_mask:0xc bank_mask:0xf
    v_max_u32_dpp v66, v66, v66 row_bcast:31 row_mask:0xc bank_mask:0xf
    v_readlane_b32 s56, v64, 63
    v_readlane_b32 s57, v65, 63
    v_add_u32 v68, v68, v64
    s_max_u32 s57, s56, s57
    v_max_u32 v65, s56, v65
    v_max_u32 v66, s57, v66
    v_add_u32 v69, v69, v65
    v_add_u32 v70, v70, v66
    v_lshlrev_b32 v81, 3, v68
    v_lshlrev_b32 v82, 3, v69
    v_lshlrev_b32 v83, 3, v70
    s_mov_b64 exec, s[40:41]
    buffer_load_dwordx2 v[72:73], v81, s[36:39], s60 offen sc1
    s_mov_b64 exec, s[42:43]
    buffer_load_dwordx2 v[74:75], v82, s[36:39], s60 offen sc1
    s_mov_b64 exec, s[44:45]
    buffer_load_dwordx2 v[76:77], v83, s[36:39], s60 offen sc1
    s_mov_b64 exec, -1
    v_lshlrev_b32 v100, 4, v68
    v_lshlrev_b32 v101, 4, v69
    v_lshlrev_b32 v102, 4, v70
    s_cmp_lg_u32 s47, 0
    s_cbranch_scc1 K_KEYS1
    s_and_b32 s56, s3, 3
    s_lshl_b32 s56, s56, 6
    s_add_u32 s56, s56, 114944
    v_lshrrev_b32 v10, 4, v1
    v_lshlrev_b32 v10, 11, v10
    v_and_b32 v12, 15, v1
    v_lshl_or_b32 v10, v12, 2, v10
    v_add_u32 v10, s56, v10
    s_mov_b32 s56, 0x05040100
    s_mov_b32 s57, 0x07060302
    ds_read2st64_b32 v[120:121], v10 offset0:0 offset1:1
    ds_read2st64_b32 v[122:123], v10 offset0:2 offset1:3
    ds_read2st64_b32 v[124:125], v10 offset0:4 offset1:5
    ds_read2st64_b32 v[126:127], v10 offset0:6 offset1:7
    ds_read2st64_b32 v[128:129], v10 offset0:32 offset1:33
    ds_read2st64_b32 v[130:131], v10 offset0:34 offset1:35
    ds_read2st64_b32 v[132:133], v10 offset0:36 offset1:37
    ds_read2st64_b32 v[134:135], v10 offset0:38 offset1:39
    ds_read2st64_b32 v[136:137], v10 offset0:64 offset1:65
    ds_read2st64_b32 v[138:139], v10 offset0:66 offset1:67
    ds_read2st64_b32 v[140:141], v10 offset0:68 offset1:69
    ds_read2st64_b32 v[142:143], v10 offset0:70 offset1:71
    ds_read2st64_b32 v[144:145], v10 offset0:96 offset1:97
    ds_read2st64_b32 v[146:147], v10 offset0:98 offset1:99
    ds_read2st64_b32 v[148:149], v10 offset0:100 offset1:101
    ds_read2st64_b32 v[150:151], v10 offset0:102 offset1:103
    s_waitcnt lgkmcnt(15)
    v_perm_b32 v200, v121, v120, s56
    v_perm_b32 v216, v121, v120, s57
    s_waitcnt lgkmcnt(14)
    v_perm_b32 v201, v123, v122, s56
    v_perm_b32 v217, v123, v122, s57
    s_waitcnt lgkmcnt(13)
    v_perm_b32 v202, v125, v124, s56
    v_perm_b32 v218, v125, v124, s57
    s_waitcnt lgkmcnt(12)
    v_perm_b32 v203, v127, v126, s56
    v_perm_b32 v219, v127, v126, s57
    s_waitcnt lgkmcnt(11)
    v_perm_b32 v204, v129, v128, s56
    v_perm_b32 v220, v129, v128, s57
    s_waitcnt lgkmcnt(10)
    v_perm_b32 v205, v131, v130, s56
    v_perm_b32 v221, v131, v130, s57
    s_waitcnt lgkmcnt(9)
    v_perm_b32 v206, v133, v132, s56
    v_perm_b32 v222, v133, v132, s57
    s_waitcnt lgkmcnt(8)
    v_perm_b32 v207, v135, v134, s56
    v_perm_b32 v223, v135, v134, s57
    s_waitcnt lgkmcnt(7)
    v_perm_b32 v208, v137, v136, s56
    v_perm_b32 v224, v137, v136, s57
    s_waitcnt lgkmcnt(6)
    v_perm_b32 v209, v139, v138, s56
    v_perm_b32 v225, v139, v138, s57
    s_waitcnt lgkmcnt(5)
    v_perm_b32 v210, v141, v140, s56
    v_perm_b32 v226, v141, v140, s57
    s_waitcnt lgkmcnt(4)
    v_perm_b32 v211, v143, v142, s56
    v_perm_b32 v227, v143, v142, s57
    s_waitcnt lgkmcnt(3)
    v_perm_b32 v212, v145, v144, s56
    v_perm_b32 v228, v145, v144, s57
    s_waitcnt lgkmcnt(2)
    v_perm_b32 v213, v147, v146, s56
    v_perm_b32 v229, v147, v146, s57
    s_waitcnt lgkmcnt(1)
    v_perm_b32 v214, v149, v148, s56
    v_perm_b32 v230, v149, v148, s57
    s_waitcnt lgkmcnt(0)
    v_perm_b32 v215, v151, v150, s56
    v_perm_b32 v231, v151, v150, s57
    s_branch K_KEYS1
K_KEYS:
    s_mov_b64 exec, s[40:41]
    buffer_load_dwordx2 v[72:73], v81, s[36:39], s60 offen sc1
    s_mov_b64 exec, s[42:43]
    buffer_load_dwordx2 v[74:75], v82, s[36:39], s60 offen sc1
    s_mov_b64 exec, s[44:45]
    buffer_load_dwordx2 v[76:77], v83, s[36:39], s60 offen sc1
    s_mov_b64 exec, -1
K_KEYS1:
    v_mov_b32 v14, 64
    s_mov_b64 s[58:59], 0
    s_waitcnt vmcnt(2)
    v_lshrrev_b32 v78, 24, v72
    v_cmp_ne_u32 vcc, s52, v73
    v_cmp_ne_u32 s[56:57], s62, v78
    s_or_b64 vcc, vcc, s[56:57]
    s_and_b64 vcc, vcc, s[40:41]
    s_or_b64 s[58:59], s[58:59], vcc
    s_waitcnt vmcnt(1)
    v_lshrrev_b32 v79, 24, v74
    v_cmp_ne_u32 vcc, s52, v75
    v_cmp_ne_u32 s[56:57], s62, v79
    s_or_b64 vcc, vcc, s[56:57]
    s_and_b64 vcc, vcc, s[42:43]
    s_or_b64 s[58:59], s[58:59], vcc
    s_waitcnt vmcnt(0)
    v_lshrrev_b32 v80, 24, v76
    v_cmp_ne_u32 vcc, s52, v77
    v_cmp_ne_u32 s[56:57], s62, v80
    s_or_b64 vcc, vcc, s[56:57]
    s_and_b64 vcc, vcc, s[44:45]
    s_or_b64 s[58:59], s[58:59], vcc
    s_cbranch_scc1 K_KEYS
    s_cmp_lg_u32 s47, 0
    s_cbranch_scc1 K_LATER
    s_mov_b32 s62, 8323072
    s_cmp_lt_u32 s3, 4
    s_cbranch_scc0 K_GOT
    buffer_load_dword v184, v185, s[36:39], s62 offen sc1
K_GOT:
    v_lshrrev_b32 v81, 2, v72
    v_and_b32 v81, 0xfc, v81
    v_lshrrev_b32 v82, 2, v74
    v_and_b32 v82, 0xfc, v82
    v_lshrrev_b32 v83, 2, v76
    v_and_b32 v83, 0xfc, v83
    s_mov_b64 exec, s[40:41]
    ds_add_u32 v81, v14 offset:512
    s_mov_b64 exec, s[42:43]
    ds_add_u32 v82, v14 offset:512
    s_mov_b64 exec, s[44:45]
    ds_add_u32 v83, v14 offset:512
    s_mov_b64 exec, -1
    s_lshr_b32 s56, s3, 2
    s_or_b32 s56, s56, s55
    s_cbranch_scc1 K_POLLBOK
K_POLLB:
    s_waitcnt vmcnt(0)
    v_cmp_ne_u32 vcc, s52, v184
    s_cbranch_vccz K_POLLBOK
    buffer_load_dword v184, v185, s[36:39], s62 offen sc1
    s_branch K_POLLB
K_POLLBOK:
    s_waitcnt lgkmcnt(0)
    s_barrier
    s_cmp_lg_u32 s55, 0
    s_cbranch_scc1 K_NOPF
    s_mov_b64 exec, s[40:41]
    buffer_load_dwordx4 v[88:91], v100, s[36:39], s61 offen sc1
    s_mov_b64 exec, s[42:43]
    buffer_load_dwordx4 v[92:95], v101, s[36:39], s61 offen sc1
    s_mov_b64 exec, s[44:45]
    buffer_load_dwordx4 v[96:99], v102, s[36:39], s61 offen sc1
    s_mov_b64 exec, -1
    s_cmp_lt_u32 s3, 5
    s_cbranch_scc1 K_NOPF
    s_mov_b32 s64, s4
    s_mov_b32 s65, s5
    s_mov_b32 s66, 10240000
    s_mov_b32 s67, 0x20000
    s_sub_u32 s68, 9, s3
    s_lshl_b32 s68, s68, 5
    s_and_b32 s69, s53, 31
    s_add_u32 s68, s68, s69
    s_lshl_b32 s68, s68, 13
    s_add_u32 s68, s68, s27
    v_lshlrev_b32 v12, 7, v1
    buffer_load_dword v255, v12, s[64:67], s68 offen
K_NOPF:
    ds_read_b32 v168, v15 offset:512
    ds_read_b128 v[120:123], v4 offset:512
    ds_read_b128 v[124:127], v4 offset:528
    ds_read_b128 v[128:131], v4 offset:544
    ds_read_b128 v[132:135], v4 offset:560
    ds_read_b128 v[136:139], v4 offset:576
    ds_read_b128 v[140:143], v4 offset:592
    ds_read_b128 v[144:147], v4 offset:608
    ds_read_b128 v[148:151], v4 offset:624
    ds_read_b128 v[152:155], v4 offset:640
    ds_read_b128 v[156:159], v4 offset:656
    v_cmp_gt_u32 vcc, 40, v1
    s_waitcnt lgkmcnt(9)
    v_pk_add_f32 v[120:121], v[120:121], v[168:169] op_sel_hi:[1,0] neg_lo:[0,1] neg_hi:[0,1] clamp
    v_pk_add_f32 v[122:123], v[122:123], v[168:169] op_sel_hi:[1,0] neg_lo:[0,1] neg_hi:[0,1] clamp
    s_waitcnt lgkmcnt(8)
    v_pk_add_f32 v[124:125], v[124:125], v[168:169] op_sel_hi:[1,0] neg_lo:[0,1] neg_hi:[0,1] clamp
    v_pk_add_f32 v[124:125], v[124:125], v[120:121]
    v_pk_add_f32 v[126:127], v[126:127], v[168:169] op_sel_hi:[1,0] neg_lo:[0,1] neg_hi:[0,1] clamp
    v_pk_add_f32 v[126:127], v[126:127], v[122:123]
    s_waitcnt lgkmcnt(7)
    v_pk_add_f32 v[128:129], v[128:129], v[168:169] op_sel_hi:[1,0] neg_lo:[0,1] neg_hi:[0,1] clamp
    v_pk_add_f32 v[128:129], v[128:129], v[124:125]
    v_pk_add_f32 v[130:131], v[130:131], v[168:169] op_sel_hi:[1,0] neg_lo:[0,1] neg_hi:[0,1] clamp
    v_pk_add_f32 v[130:131], v[130:131], v[126:127]
    s_waitcnt lgkmcnt(6)
    v_pk_add_f32 v[132:133], v[132:133], v[168:169] op_sel_hi:[1,0] neg_lo:[0,1] neg_hi:[0,1] clamp
    v_pk_add_f32 v[132:133], v[132:133], v[128:129]
    v_pk_add_f32 v[134:135], v[134:135], v[168:169] op_sel_hi:[1,0] neg_lo:[0,1] neg_hi:[0,1] clamp
    v_pk_add_f32 v[134:135], v[134:135], v[130:131]
    s_waitcnt lgkmcnt(5)
    v_pk_add_f32 v[136:137], v[136:137], v[168:169] op_sel_hi:[1,0] neg_lo:[0,1] neg_hi:[0,1] clamp
    v_pk_add_f32 v[136:137], v[136:137], v[132:133]
    v_pk_add_f32 v[138:139], v[138:139], v[168:169] op_sel_hi:[1,0] neg_lo:[0,1] neg_hi:[0,1] clamp
    v_pk_add_f32 v[138:139], v[138:139], v[134:135]
    s_waitcnt lgkmcnt(4)
    v_pk_add_f32 v[140:141], v[140:141], v[168:169] op_sel_hi:[1,0] neg_lo:[0,1] neg_hi:[0,1] clamp
    v_pk_add_f32 v[140:141], v[140:141], v[136:137]
    v_pk_add_f32 v[142:143], v[142:143], v[168:169] op_sel_hi:[1,0] neg_lo:[0,1] neg_hi:[0,1] clamp
    v_pk_add_f32 v[142:143], v[142:143], v[138:139]
    s_waitcnt lgkmcnt(3)
    v_pk_add_f32 v[144:145], v[144:145], v[168:169] op_sel_hi:[1,0] neg_lo:[0,1] neg_hi:[0,1] clamp
    v_pk_add_f32 v[144:145], v[144:145], v[140:141]
    v_pk_add_f32 v[146:147], v[146:147], v[168:169] op_sel_hi:[1,0] neg_lo:[0,1] neg_hi:[0,1] clamp
    v_pk_add_f32 v[146:147], v[146:147], v[142:143]
    s_waitcnt lgkmcnt(2)
    v_pk_add_f32 v[148:149], v[148:149], v[168:169] op_sel_hi:[1,0] neg_lo:[0,1] neg_hi:[0,1] clamp
    v_pk_add_f32 v[148:149], v[148:149], v[144:145]
    v_pk_add_f32 v[150:151], v[150:151], v[168:169] op_sel_hi:[1,0] neg_lo:[0,1] neg_hi:[0,1] clamp
    v_pk_add_f32 v[150:151], v[150:151], v[146:147]
    s_waitcnt lgkmcnt(1)
    v_pk_add_f32 v[152:153], v[152:153], v[168:169] op_sel_hi:[1,0] neg_lo:[0,1] neg_hi:[0,1] clamp
    v_pk_add_f32 v[152:153], v[152:153], v[148:149]
    v_pk_add_f32 v[154:155], v[154:155], v[168:169] op_sel_hi:[1,0] neg_lo:[0,1] neg_hi:[0,1] clamp
    v_pk_add_f32 v[154:155], v[154:155], v[150:151]
    s_waitcnt lgkmcnt(0)
    v_pk_add_f32 v[156:157], v[156:157], v[168:169] op_sel_hi:[1,0] neg_lo:[0,1] neg_hi:[0,1] clamp
    v_pk_add_f32 v[156:157], v[156:157], v[152:153]
    v_pk_add_f32 v[158:159], v[158:159], v[168:169] op_sel_hi:[1,0] neg_lo:[0,1] neg_hi:[0,1] clamp
    v_pk_add_f32 v[158:159], v[158:159], v[154:155]
    v_pk_add_f32 v[158:159], v[158:159], v[156:157]
    v_add_f32 v158, v158, v159
    v_cvt_u32_f32 v158, v158
    v_lshlrev_b32 v158, 2, v158
    ds_bpermute_b32 v2, v158, v2
    s_waitcnt lgkmcnt(0)
    v_cndmask_b32 v2, -1, v2, vcc
K_BAL:
    ds_bpermute_b32 v84, v81, v2
    ds_bpermute_b32 v85, v82, v2
    ds_bpermute_b32 v86, v83, v2
    v_mov_b32 v14, 1
    v_lshlrev_b32 v10, 3, v1
    s_lshr_b32 s56, s53, 4
    s_and_b32 s56, s56, 14
    v_subrev_u32 v103, s56, v72
    v_and_b32 v103, 15, v103
    v_subrev_u32 v104, s56, v74
    v_and_b32 v104, 15, v104
    v_subrev_u32 v105, s56, v76
    v_and_b32 v105, 15, v105
    s_waitcnt lgkmcnt(2)
    s_mov_b64 exec, s[40:41]
    v_and_b32 v81, 7, v84
    v_lshl_or_b32 v103, v81, 4, v103
    v_lshlrev_b32 v81, 2, v103
    ds_add_rtn_u32 v78, v81, v14 offset:0
    s_waitcnt lgkmcnt(2)
    s_mov_b64 exec, s[42:43]
    v_and_b32 v82, 7, v85
    v_lshl_or_b32 v104, v82, 4, v104
    v_lshlrev_b32 v82, 2, v104
    ds_add_rtn_u32 v79, v82, v14 offset:0
    s_waitcnt lgkmcnt(2)
    s_mov_b64 exec, s[44:45]
    v_and_b32 v83, 7, v86
    v_lshl_or_b32 v105, v83, 4, v105
    v_lshlrev_b32 v83, 2, v105
    ds_add_rtn_u32 v80, v83, v14 offset:0
    s_mov_b64 exec, -1
    v_lshlrev_b32 v81, 1, v103
    v_lshlrev_b32 v103, 4, v103
    v_and_b32 v84, 0x38, v84
    v_and_b32 v72, 16776192, v72
    v_lshlrev_b32 v82, 1, v104
    v_lshlrev_b32 v104, 4, v104
    v_and_b32 v85, 0x38, v85
    v_and_b32 v74, 16776192, v74
    v_lshlrev_b32 v83, 1, v105
    v_lshlrev_b32 v105, 4, v105
    v_and_b32 v86, 0x38, v86
    v_and_b32 v76, 16776192, v76
    s_lshl_b32 s56, s3, 3
    s_add_u32 s57, s56, 7
    v_lshrrev_b32 v114, 3, v1
    v_mul_u32_u24 v114, 48, v114
    s_waitcnt lgkmcnt(0)
    s_barrier
    ds_read_b64 v[108:109], v10 offset:0
    s_sub_u32 s58, s27, 1024
    s_cselect_b32 s58, 10238976, s58
    s_waitcnt lgkmcnt(0)
    v_add_u32 v110, v108, v109
    v_mov_b32 v111, v110
    v_and_b32 v12, 15, v1
    v_lshrrev_b32 v11, 2, v1
    v_add_u32_dpp v111, v111, v111 row_shr:1 row_mask:0xf bank_mask:0xf
    v_and_b32 v11, 8, v11
    v_xor_b32 v11, v11, v1
    v_add_u32_dpp v111, v111, v111 row_shr:2 row_mask:0xf bank_mask:0xf
    v_mov_b32 v115, s58
    v_mov_b32 v254, 0
    v_add_u32_dpp v111, v111, v111 row_shr:4 row_mask:0xf bank_mask:0xf
    v_lshlrev_b32 v11, 3, v11
    v_lshrrev_b32 v13, 2, v1
    v_add_u32_dpp v111, v111, v111 row_shr:8 row_mask:0xf bank_mask:0xf
    v_and_b32 v10, 3, v1
    v_lshl_or_b32 v13, v10, 4, v13
    v_add_u32_dpp v111, v111, v111 row_bcast:15 row_mask:0xa bank_mask:0xf
    v_lshlrev_b32 v10, 2, v10
    v_and_b32 v10, 8, v10
    v_add_u32_dpp v111, v111, v111 row_bcast:31 row_mask:0xc bank_mask:0xf
    v_sub_u32 v110, v111, v110
    v_readlane_b32 s51, v111, s57
    v_xor_b32 v10, v10, v13
    v_lshlrev_b32 v10, 3, v10
    v_mov_b32_dpp v112, v110 row_newbcast:0 row_mask:0xf bank_mask:0x3
    v_readlane_b32 s58, v110, s56
    s_nop 0
    v_mov_b32_dpp v112, v110 row_newbcast:8 row_mask:0xf bank_mask:0xc
    v_add_u32 v113, 15, v112
    v_and_b32 v113, -16, v113
    v_add_u32 v113, v113, v114
    v_sub_u32 v112, v113, v112
    v_add_u32 v112, v112, v110
    v_add_u32 v108, v112, v108
    v_lshl_or_b32 v108, v108, 16, v112
    v_readlane_b32 s50, v113, s56
    ds_bpermute_b32 v81, v81, v108
    ds_bpermute_b32 v82, v82, v108
    ds_bpermute_b32 v83, v83, v108
    s_sub_u32 s51, s51, s58
    s_add_u32 s56, s50, s51
    v_add_u32 v109, s56, v1
    v_lshlrev_b32 v110, 2, v109
    v_lshlrev_b32 v111, 4, v109
    s_mov_b64 exec, 0xfffff
    ds_write_b32 v110, v115 offset:4096
    ds_write_b8 v109, v4 offset:11840
    ds_write_b128 v111, v[4:7] offset:13824
    s_mov_b64 exec, s[40:41]
    s_waitcnt lgkmcnt(5)
    v_bfe_u32 v81, v81, v103, 16
    v_add_u32 v81, v81, v78
    v_lshlrev_b32 v78, 2, v81
    v_lshlrev_b32 v103, 4, v81
    ds_write_b32 v78, v72 offset:4096
    ds_write_b8 v81, v84 offset:11840
    s_mov_b64 exec, s[42:43]
    s_waitcnt lgkmcnt(6)
    v_bfe_u32 v82, v82, v104, 16
    v_add_u32 v82, v82, v79
    v_lshlrev_b32 v79, 2, v82
    v_lshlrev_b32 v104, 4, v82
    ds_write_b32 v79, v74 offset:4096
    ds_write_b8 v82, v85 offset:11840
    s_mov_b64 exec, s[44:45]
    s_waitcnt lgkmcnt(7)
    v_bfe_u32 v83, v83, v105, 16
    v_add_u32 v83, v83, v80
    v_lshlrev_b32 v80, 2, v83
    v_lshlrev_b32 v105, 4, v83
    ds_write_b32 v80, v76 offset:4096
    ds_write_b8 v83, v86 offset:11840
    s_mov_b64 exec, -1
    s_add_u32 s58, s3, 0
    v_cmp_eq_u32 vcc, s58, v2
    s_ff1_i32_b64 s58, vcc
    s_mul_i32 s58, s58, 1152
    s_add_u32 s58, s58, 106752
    v_add_u32 v106, s58, v15
    s_add_u32 s58, s3, 8
    v_cmp_eq_u32 vcc, s58, v2
    s_ff1_i32_b64 s58, vcc
    s_mul_i32 s58, s58, 1152
    s_add_u32 s58, s58, 106752
    v_add_u32 v107, s58, v15
    s_add_u32 s58, s3, 16
    v_cmp_eq_u32 vcc, s58, v2
    s_ff1_i32_b64 s58, vcc
    s_mul_i32 s58, s58, 1152
    s_add_u32 s58, s58, 106752
    v_add_u32 v116, s58, v15
    s_add_u32 s58, s3, 24
    v_cmp_eq_u32 vcc, s58, v2
    s_ff1_i32_b64 s58, vcc
    s_mul_i32 s58, s58, 1152
    s_add_u32 s58, s58, 106752
    v_add_u32 v117, s58, v15
    s_add_u32 s58, s3, 32
    v_cmp_eq_u32 vcc, s58, v2
    s_ff1_i32_b64 s58, vcc
    s_mul_i32 s58, s58, 1152
    s_add_u32 s58, s58, 106752
    v_add_u32 v118, s58, v15
    s_cmp_lt_u32 s3, 5
    s_cselect_b32 s56, 1, s47
    s_or_b32 s56, s56, s55
    s_cbranch_scc0 K_PW1
    s_waitcnt vmcnt(0)
K_PW1:
    s_waitcnt vmcnt(1)
    s_mov_b64 exec, s[40:41]
    ds_write_b128 v103, v[88:91] offset:13824
    s_mov_b64 exec, s[42:43]
    ds_write_b128 v104, v[92:95] offset:13824
    s_mov_b64 exec, s[44:45]
    ds_write_b128 v105, v[96:99] offset:13824
    s_mov_b64 exec, -1
    s_lshl_b32 s56, s50, 2
    s_add_u32 s56, s56, 4096
    v_mov_b32 v196, s56
    s_add_u32 s56, s50, 11840
    v_mov_b32 v197, s56
    s_lshl_b32 s56, s50, 5
    s_add_u32 s56, s56, 44800
    v_add_u32 v198, s56, v10
    v_add_u32 v11, s56, v11
    s_lshl_b32 s57, s50, 4
    s_add_u32 s57, s57, 13824
    v_lshl_add_u32 v199, v12, 4, s57
    v_add_u32 v10, s57, v9
    s_add_u32 s48, s51, 3
    s_lshr_b32 s48, s48, 2
    s_waitcnt lgkmcnt(0)
    s_barrier
    s_cmp_eq_u32 s48, 0
    s_cbranch_scc1 K2_LOOPDONE
    ds_read_b128 v[120:123], v196 offset:0
    ds_read_b128 v[124:127], v196 offset:16
    ds_read_b64 v[152:153], v10
    ds_read2_b64 v[188:191], v196 offset0:4 offset1:5
    ds_read_b64 v[186:187], v199 offset:8
    ds_read_b128 v[192:195], v197
    s_lshl_b32 s56, s48, 2
    s_waitcnt lgkmcnt(5)
    buffer_load_dwordx4 v[56:59], v120, s[28:31], 0 offen
    buffer_load_dwordx4 v[60:63], v121, s[28:31], 0 offen
    buffer_load_dwordx4 v[64:67], v122, s[28:31], 0 offen
    buffer_load_dwordx4 v[68:71], v123, s[28:31], 0 offen
    s_waitcnt lgkmcnt(4)
    buffer_load_dwordx4 v[72:75], v124, s[28:31], 0 offen
    buffer_load_dwordx4 v[76:79], v125, s[28:31], 0 offen
    buffer_load_dwordx4 v[80:83], v126, s[28:31], 0 offen
    buffer_load_dwordx4 v[84:87], v127, s[28:31], 0 offen
K_APREP:
    v_cmp_gt_u32 vcc, s56, v1
    s_waitcnt lgkmcnt(0)
    s_nop 0
    v_cndmask_b32 v160, 0, v152, vcc
    v_cndmask_b32 v161, 0, v153, vcc
    ds_read_b64 v[152:153], v10 offset:1024
    v_add_u32 v10, 1024, v10
    v_mfma_f32_16x16x16_bf16 v[136:139], v[232:233], v[160:161], 0
    v_mfma_f32_16x16x16_bf16 v[140:143], v[234:235], v[160:161], 0
    v_mfma_f32_16x16x16_bf16 v[144:147], v[236:237], v[160:161], 0
    v_mfma_f32_16x16x16_bf16 v[148:151], v[238:239], v[160:161], 0
    s_nop 4
    v_cvt_pk_bf16_f32 v168, v136, v137
    v_cvt_pk_bf16_f32 v169, v138, v139
    ds_write_b64 v11, v[168:169] offset:0
    s_sub_u32 s56, s56, 16
    s_cmp_le_i32 s56, 0
    s_cbranch_scc1 K_APDONE
    v_cvt_pk_bf16_f32 v170, v140, v141
    v_cvt_pk_bf16_f32 v171, v142, v143
    ds_write_b64 v11, v[170:171] offset:512
    s_sub_u32 s56, s56, 16
    s_cmp_le_i32 s56, 0
    s_cbranch_scc1 K_APDONE
    v_cvt_pk_bf16_f32 v172, v144, v145
    v_cvt_pk_bf16_f32 v173, v146, v147
    ds_write_b64 v11, v[172:173] offset:1024
    s_sub_u32 s56, s56, 16
    s_cmp_le_i32 s56, 0
    s_cbranch_scc1 K_APDONE
    v_cvt_pk_bf16_f32 v174, v148, v149
    v_cvt_pk_bf16_f32 v175, v150, v151
    ds_write_b64 v11, v[174:175] offset:1536
    s_sub_u32 s56, s56, 16
    s_cmp_le_i32 s56, 0
    s_cbranch_scc1 K_APDONE
    v_add_u32 v11, 2048, v11
    s_branch K_APREP
K_APDONE:
    s_waitcnt lgkmcnt(0)
    ds_read_b64 v[184:185], v198
    v_mfma_f32_4x4x4_16b_bf16 v[152:155], v[186:187], v[176:177], 0 cbsz:4 abid:0
    v_mfma_f32_4x4x4_16b_bf16 v[156:159], v[186:187], v[180:181], 0 cbsz:4 abid:0
    s_sub_u32 s48, s48, 3
    s_nop 2
    s_cbranch_scc1 K2_D0
.p2align 4
K2_LOOP:
    s_waitcnt vmcnt(6) lgkmcnt(0)
    v_subrev_u32 v255, s27, v188
    v_cmp_gt_u32 vcc, v255, v254
    ds_write_b32 v252, v255 offset:2048
    s_setprio 0
    s_cbranch_vccnz K2_P0
    s_setprio 1
K2_P0:
    v_mfma_f32_4x4x4_16b_bf16 v[120:123], v[184:185], v[56:57], 0 cbsz:4 abid:0
    v_exp_f32 v168, v152
    v_mfma_f32_4x4x4_16b_bf16 v[124:127], v[184:185], v[58:59], 0 cbsz:4 abid:0
    v_exp_f32 v169, v153
    v_mfma_f32_4x4x4_16b_bf16 v[128:131], v[184:185], v[60:61], 0 cbsz:4 abid:1
    v_exp_f32 v170, v154
    v_mfma_f32_4x4x4_16b_bf16 v[132:135], v[184:185], v[62:63], 0 cbsz:4 abid:1
    buffer_load_dwordx4 v[56:59], v188, s[28:31], 0 offen
    buffer_load_dwordx4 v[60:63], v189, s[28:31], 0 offen
    v_exp_f32 v171, v155
    s_waitcnt vmcnt(6)
    v_mfma_f32_4x4x4_16b_bf16 v[136:139], v[184:185], v[64:65], 0 cbsz:4 abid:2
    v_exp_f32 v172, v156
    v_mfma_f32_4x4x4_16b_bf16 v[140:143], v[184:185], v[66:67], 0 cbsz:4 abid:2
    v_exp_f32 v173, v157
    v_exp_f32 v174, v158
    v_exp_f32 v175, v159
    v_pk_add_f32 v[168:169], v[168:169], 1.0 op_sel_hi:[1,0]
    v_pk_add_f32 v[170:171], v[170:171], 1.0 op_sel_hi:[1,0]
    v_pk_add_f32 v[172:173], v[172:173], 1.0 op_sel_hi:[1,0]
    v_pk_add_f32 v[174:175], v[174:175], 1.0 op_sel_hi:[1,0]
    v_mfma_f32_4x4x4_16b_bf16 v[144:147], v[184:185], v[68:69], 0 cbsz:4 abid:3
    v_rcp_f32 v168, v168
    v_mfma_f32_4x4x4_16b_bf16 v[148:151], v[184:185], v[70:71], 0 cbsz:4 abid:3
    buffer_load_dwordx4 v[64:67], v190, s[28:31], 0 offen
    buffer_load_dwordx4 v[68:71], v191, s[28:31], 0 offen
    v_rcp_f32 v169, v169
    ds_read_b128 v[188:191], v196 offset:48
    v_mfma_f32_4x4x4_16b_bf16 v[160:163], v[186:187], v[176:177], 0 cbsz:4 abid:1
    v_rcp_f32 v170, v170
    v_mfma_f32_4x4x4_16b_bf16 v[164:167], v[186:187], v[180:181], 0 cbsz:4 abid:1
    v_rcp_f32 v171, v171
    v_rcp_f32 v172, v172
    v_rcp_f32 v173, v173
    v_rcp_f32 v174, v174
    v_rcp_f32 v175, v175
    v_readfirstlane_b32 s49, v192
    v_pk_mul_f32 v[168:169], v[168:169], v[152:153]
    v_pk_mul_f32 v[170:171], v[170:171], v[154:155]
    v_pk_mul_f32 v[172:173], v[172:173], v[156:157]
    v_pk_mul_f32 v[174:175], v[174:175], v[158:159]
    s_set_gpr_idx_on s49, gpr_idx(SRC2,DST)
    v_pk_fma_f32 v[16:17], v[168:169], v[120:121], v[16:17] op_sel:[0,0,0] op_sel_hi:[0,1,1]
    v_pk_fma_f32 v[18:19], v[168:169], v[122:123], v[18:19] op_sel:[0,0,0] op_sel_hi:[0,1,1]
    v_pk_fma_f32 v[20:21], v[172:173], v[124:125], v[20:21] op_sel:[0,0,0] op_sel_hi:[0,1,1]
    v_pk_fma_f32 v[22:23], v[172:173], v[126:127], v[22:23] op_sel:[0,0,0] op_sel_hi:[0,1,1]
    s_lshr_b32 s49, s49, 8
    s_set_gpr_idx_idx s49
    v_pk_fma_f32 v[16:17], v[168:169], v[128:129], v[16:17] op_sel:[1,0,0] op_sel_hi:[1,1,1]
    v_pk_fma_f32 v[18:19], v[168:169], v[130:131], v[18:19] op_sel:[1,0,0] op_sel_hi:[1,1,1]
    v_pk_fma_f32 v[20:21], v[172:173], v[132:133], v[20:21] op_sel:[1,0,0] op_sel_hi:[1,1,1]
    v_pk_fma_f32 v[22:23], v[172:173], v[134:135], v[22:23] op_sel:[1,0,0] op_sel_hi:[1,1,1]
    s_lshr_b32 s49, s49, 8
    s_set_gpr_idx_idx s49
    v_pk_fma_f32 v[16:17], v[170:171], v[136:137], v[16:17] op_sel:[0,0,0] op_sel_hi:[0,1,1]
    v_pk_fma_f32 v[18:19], v[170:171], v[138:139], v[18:19] op_sel:[0,0,0] op_sel_hi:[0,1,1]
    v_pk_fma_f32 v[20:21], v[174:175], v[140:141], v[20:21] op_sel:[0,0,0] op_sel_hi:[0,1,1]
    v_pk_fma_f32 v[22:23], v[174:175], v[142:143], v[22:23] op_sel:[0,0,0] op_sel_hi:[0,1,1]
    s_lshr_b32 s49, s49, 8
    s_set_gpr_idx_idx s49
    v_pk_fma_f32 v[16:17], v[170:171], v[144:145], v[16:17] op_sel:[1,0,0] op_sel_hi:[1,1,1]
    v_pk_fma_f32 v[18:19], v[170:171], v[146:147], v[18:19] op_sel:[1,0,0] op_sel_hi:[1,1,1]
    v_pk_fma_f32 v[20:21], v[174:175], v[148:149], v[20:21] op_sel:[1,0,0] op_sel_hi:[1,1,1]
    v_pk_fma_f32 v[22:23], v[174:175], v[150:151], v[22:23] op_sel:[1,0,0] op_sel_hi:[1,1,1]
    s_set_gpr_idx_off
    s_sub_u32 s48, s48, 1
    s_cbranch_scc1 K2_D1
    s_waitcnt vmcnt(6) lgkmcnt(0)
    v_mfma_f32_4x4x4_16b_bf16 v[120:123], v[184:185], v[72:73], 0 cbsz:4 abid:4
    v_exp_f32 v168, v160
    v_mfma_f32_4x4x4_16b_bf16 v[124:127], v[184:185], v[74:75], 0 cbsz:4 abid:4
    v_exp_f32 v169, v161
    v_mfma_f32_4x4x4_16b_bf16 v[128:131], v[184:185], v[76:77], 0 cbsz:4 abid:5
    v_exp_f32 v170, v162
    v_mfma_f32_4x4x4_16b_bf16 v[132:135], v[184:185], v[78:79], 0 cbsz:4 abid:5
    buffer_load_dwordx4 v[72:75], v188, s[28:31], 0 offen
    buffer_load_dwordx4 v[76:79], v189, s[28:31], 0 offen
    v_exp_f32 v171, v163
    s_waitcnt vmcnt(6)
    v_mfma_f32_4x4x4_16b_bf16 v[136:139], v[184:185], v[80:81], 0 cbsz:4 abid:6
    v_exp_f32 v172, v164
    v_mfma_f32_4x4x4_16b_bf16 v[140:143], v[184:185], v[82:83], 0 cbsz:4 abid:6
    v_exp_f32 v173, v165
    v_exp_f32 v174, v166
    v_exp_f32 v175, v167
    v_pk_add_f32 v[168:169], v[168:169], 1.0 op_sel_hi:[1,0]
    v_pk_add_f32 v[170:171], v[170:171], 1.0 op_sel_hi:[1,0]
    v_pk_add_f32 v[172:173], v[172:173], 1.0 op_sel_hi:[1,0]
    v_pk_add_f32 v[174:175], v[174:175], 1.0 op_sel_hi:[1,0]
    v_mfma_f32_4x4x4_16b_bf16 v[144:147], v[184:185], v[84:85], 0 cbsz:4 abid:7
    v_rcp_f32 v168, v168
    v_mfma_f32_4x4x4_16b_bf16 v[148:151], v[184:185], v[86:87], 0 cbsz:4 abid:7
    buffer_load_dwordx4 v[80:83], v190, s[28:31], 0 offen
    buffer_load_dwordx4 v[84:87], v191, s[28:31], 0 offen
    v_rcp_f32 v169, v169
    ds_read_b128 v[188:191], v196 offset:64
    ds_read_b32 v254, v253 offset:2048
    v_mfma_f32_4x4x4_16b_bf16 v[152:155], v[186:187], v[176:177], 0 cbsz:4 abid:2
    v_rcp_f32 v170, v170
    v_mfma_f32_4x4x4_16b_bf16 v[156:159], v[186:187], v[180:181], 0 cbsz:4 abid:2
    v_rcp_f32 v171, v171
    v_rcp_f32 v172, v172
    v_rcp_f32 v173, v173
    v_rcp_f32 v174, v174
    v_rcp_f32 v175, v175
    v_readfirstlane_b32 s49, v193
    v_pk_mul_f32 v[168:169], v[168:169], v[160:161]
    v_pk_mul_f32 v[170:171], v[170:171], v[162:163]
    v_pk_mul_f32 v[172:173], v[172:173], v[164:165]
    v_pk_mul_f32 v[174:175], v[174:175], v[166:167]
    s_set_gpr_idx_on s49, gpr_idx(SRC2,DST)
    v_pk_fma_f32 v[16:17], v[168:169], v[120:121], v[16:17] op_sel:[0,0,0] op_sel_hi:[0,1,1]
    v_pk_fma_f32 v[18:19], v[168:169], v[122:123], v[18:19] op_sel:[0,0,0] op_sel_hi:[0,1,1]
    v_pk_fma_f32 v[20:21], v[172:173], v[124:125], v[20:21] op_sel:[0,0,0] op_sel_hi:[0,1,1]
    v_pk_fma_f32 v[22:23], v[172:173], v[126:127], v[22:23] op_sel:[0,0,0] op_sel_hi:[0,1,1]
    s_lshr_b32 s49, s49, 8
    s_set_gpr_idx_idx s49
    v_pk_fma_f32 v[16:17], v[168:169], v[128:129], v[16:17] op_sel:[1,0,0] op_sel_hi:[1,1,1]
    v_pk_fma_f32 v[18:19], v[168:169], v[130:131], v[18:19] op_sel:[1,0,0] op_sel_hi:[1,1,1]
    v_pk_fma_f32 v[20:21], v[172:173], v[132:133], v[20:21] op_sel:[1,0,0] op_sel_hi:[1,1,1]
    v_pk_fma_f32 v[22:23], v[172:173], v[134:135], v[22:23] op_sel:[1,0,0] op_sel_hi:[1,1,1]
    s_lshr_b32 s49, s49, 8
    s_set_gpr_idx_idx s49
    v_pk_fma_f32 v[16:17], v[170:171], v[136:137], v[16:17] op_sel:[0,0,0] op_sel_hi:[0,1,1]
    v_pk_fma_f32 v[18:19], v[170:171], v[138:139], v[18:19] op_sel:[0,0,0] op_sel_hi:[0,1,1]
    v_pk_fma_f32 v[20:21], v[174:175], v[140:141], v[20:21] op_sel:[0,0,0] op_sel_hi:[0,1,1]
    v_pk_fma_f32 v[22:23], v[174:175], v[142:143], v[22:23] op_sel:[0,0,0] op_sel_hi:[0,1,1]
    s_lshr_b32 s49, s49, 8
    s_set_gpr_idx_idx s49
    v_pk_fma_f32 v[16:17], v[170:171], v[144:145], v[16:17] op_sel:[1,0,0] op_sel_hi:[1,1,1]
    v_pk_fma_f32 v[18:19], v[170:171], v[146:147], v[18:19] op_sel:[1,0,0] op_sel_hi:[1,1,1]
    v_pk_fma_f32 v[20:21], v[174:175], v[148:149], v[20:21] op_sel:[1,0,0] op_sel_hi:[1,1,1]
    v_pk_fma_f32 v[22:23], v[174:175], v[150:151], v[22:23] op_sel:[1,0,0] op_sel_hi:[1,1,1]
    s_set_gpr_idx_off
    s_sub_u32 s48, s48, 1
    s_cbranch_scc1 K2_D2
    s_waitcnt vmcnt(6) lgkmcnt(0)
    v_subrev_u32 v255, s27, v188
    v_cmp_gt_u32 vcc, v255, v254
    ds_write_b32 v252, v255 offset:2048
    s_setprio 0
    s_cbranch_vccnz K2_P2
    s_setprio 1
K2_P2:
    v_mfma_f32_4x4x4_16b_bf16 v[120:123], v[184:185], v[56:57], 0 cbsz:4 abid:8
    v_exp_f32 v168, v152
    v_mfma_f32_4x4x4_16b_bf16 v[124:127], v[184:185], v[58:59], 0 cbsz:4 abid:8
    v_exp_f32 v169, v153
    v_mfma_f32_4x4x4_16b_bf16 v[128:131], v[184:185], v[60:61], 0 cbsz:4 abid:9
    v_exp_f32 v170, v154
    v_mfma_f32_4x4x4_16b_bf16 v[132:135], v[184:185], v[62:63], 0 cbsz:4 abid:9
    buffer_load_dwordx4 v[56:59], v188, s[28:31], 0 offen
    buffer_load_dwordx4 v[60:63], v189, s[28:31], 0 offen
    v_exp_f32 v171, v155
    s_waitcnt vmcnt(6)
    v_mfma_f32_4x4x4_16b_bf16 v[136:139], v[184:185], v[64:65], 0 cbsz:4 abid:10
    v_exp_f32 v172, v156
    v_mfma_f32_4x4x4_16b_bf16 v[140:143], v[184:185], v[66:67], 0 cbsz:4 abid:10
    v_exp_f32 v173, v157
    v_exp_f32 v174, v158
    v_exp_f32 v175, v159
    v_pk_add_f32 v[168:169], v[168:169], 1.0 op_sel_hi:[1,0]
    v_pk_add_f32 v[170:171], v[170:171], 1.0 op_sel_hi:[1,0]
    v_pk_add_f32 v[172:173], v[172:173], 1.0 op_sel_hi:[1,0]
    v_pk_add_f32 v[174:175], v[174:175], 1.0 op_sel_hi:[1,0]
    v_mfma_f32_4x4x4_16b_bf16 v[144:147], v[184:185], v[68:69], 0 cbsz:4 abid:11
    v_rcp_f32 v168, v168
    v_mfma_f32_4x4x4_16b_bf16 v[148:151], v[184:185], v[70:71], 0 cbsz:4 abid:11
    buffer_load_dwordx4 v[64:67], v190, s[28:31], 0 offen
    buffer_load_dwordx4 v[68:71], v191, s[28:31], 0 offen
    v_rcp_f32 v169, v169
    ds_read_b128 v[188:191], v196 offset:80
    v_mfma_f32_4x4x4_16b_bf16 v[160:163], v[186:187], v[176:177], 0 cbsz:4 abid:3
    v_rcp_f32 v170, v170
    v_mfma_f32_4x4x4_16b_bf16 v[164:167], v[186:187], v[180:181], 0 cbsz:4 abid:3
    v_rcp_f32 v171, v171
    v_rcp_f32 v172, v172
    ds_read_b64 v[186:187], v199 offset:264
    v_rcp_f32 v173, v173
    v_rcp_f32 v174, v174
    v_rcp_f32 v175, v175
    v_readfirstlane_b32 s49, v194
    v_pk_mul_f32 v[168:169], v[168:169], v[152:153]
    v_pk_mul_f32 v[170:171], v[170:171], v[154:155]
    v_pk_mul_f32 v[172:173], v[172:173], v[156:157]
    v_pk_mul_f32 v[174:175], v[174:175], v[158:159]
    s_set_gpr_idx_on s49, gpr_idx(SRC2,DST)
    v_pk_fma_f32 v[16:17], v[168:169], v[120:121], v[16:17] op_sel:[0,0,0] op_sel_hi:[0,1,1]
    v_pk_fma_f32 v[18:19], v[168:169], v[122:123], v[18:19] op_sel:[0,0,0] op_sel_hi:[0,1,1]
    v_pk_fma_f32 v[20:21], v[172:173], v[124:125], v[20:21] op_sel:[0,0,0] op_sel_hi:[0,1,1]
    v_pk_fma_f32 v[22:23], v[172:173], v[126:127], v[22:23] op_sel:[0,0,0] op_sel_hi:[0,1,1]
    s_lshr_b32 s49, s49, 8
    s_set_gpr_idx_idx s49
    v_pk_fma_f32 v[16:17], v[168:169], v[128:129], v[16:17] op_sel:[1,0,0] op_sel_hi:[1,1,1]
    v_pk_fma_f32 v[18:19], v[168:169], v[130:131], v[18:19] op_sel:[1,0,0] op_sel_hi:[1,1,1]
    v_pk_fma_f32 v[20:21], v[172:173], v[132:133], v[20:21] op_sel:[1,0,0] op_sel_hi:[1,1,1]
    v_pk_fma_f32 v[22:23], v[172:173], v[134:135], v[22:23] op_sel:[1,0,0] op_sel_hi:[1,1,1]
    s_lshr_b32 s49, s49, 8
    s_set_gpr_idx_idx s49
    v_pk_fma_f32 v[16:17], v[170:171], v[136:137], v[16:17] op_sel:[0,0,0] op_sel_hi:[0,1,1]
    v_pk_fma_f32 v[18:19], v[170:171], v[138:139], v[18:19] op_sel:[0,0,0] op_sel_hi:[0,1,1]
    v_pk_fma_f32 v[20:21], v[174:175], v[140:141], v[20:21] op_sel:[0,0,0] op_sel_hi:[0,1,1]
    v_pk_fma_f32 v[22:23], v[174:175], v[142:143], v[22:23] op_sel:[0,0,0] op_sel_hi:[0,1,1]
    s_lshr_b32 s49, s49, 8
    s_set_gpr_idx_idx s49
    v_pk_fma_f32 v[16:17], v[170:171], v[144:145], v[16:17] op_sel:[1,0,0] op_sel_hi:[1,1,1]
    v_pk_fma_f32 v[18:19], v[170:171], v[146:147], v[18:19] op_sel:[1,0,0] op_sel_hi:[1,1,1]
    v_pk_fma_f32 v[20:21], v[174:175], v[148:149], v[20:21] op_sel:[1,0,0] op_sel_hi:[1,1,1]
    v_pk_fma_f32 v[22:23], v[174:175], v[150:151], v[22:23] op_sel:[1,0,0] op_sel_hi:[1,1,1]
    s_set_gpr_idx_off
    s_sub_u32 s48, s48, 1
    s_cbranch_scc1 K2_D3
    s_waitcnt vmcnt(6) lgkmcnt(0)
    v_mfma_f32_4x4x4_16b_bf16 v[120:123], v[184:185], v[72:73], 0 cbsz:4 abid:12
    v_exp_f32 v168, v160
    v_mfma_f32_4x4x4_16b_bf16 v[124:127], v[184:185], v[74:75], 0 cbsz:4 abid:12
    v_exp_f32 v169, v161
    v_mfma_f32_4x4x4_16b_bf16 v[128:131], v[184:185], v[76:77], 0 cbsz:4 abid:13
    v_exp_f32 v170, v162
    v_mfma_f32_4x4x4_16b_bf16 v[132:135], v[184:185], v[78:79], 0 cbsz:4 abid:13
    buffer_load_dwordx4 v[72:75], v188, s[28:31], 0 offen
    buffer_load_dwordx4 v[76:79], v189, s[28:31], 0 offen
    v_exp_f32 v171, v163
    s_waitcnt vmcnt(6)
    v_mfma_f32_4x4x4_16b_bf16 v[136:139], v[184:185], v[80:81], 0 cbsz:4 abid:14
    v_exp_f32 v172, v164
    v_mfma_f32_4x4x4_16b_bf16 v[140:143], v[184:185], v[82:83], 0 cbsz:4 abid:14
    v_exp_f32 v173, v165
    v_exp_f32 v174, v166
    v_exp_f32 v175, v167
    v_pk_add_f32 v[168:169], v[168:169], 1.0 op_sel_hi:[1,0]
    v_pk_add_f32 v[170:171], v[170:171], 1.0 op_sel_hi:[1,0]
    v_pk_add_f32 v[172:173], v[172:173], 1.0 op_sel_hi:[1,0]
    v_pk_add_f32 v[174:175], v[174:175], 1.0 op_sel_hi:[1,0]
    v_mfma_f32_4x4x4_16b_bf16 v[144:147], v[184:185], v[84:85], 0 cbsz:4 abid:15
    v_rcp_f32 v168, v168
    v_mfma_f32_4x4x4_16b_bf16 v[148:151], v[184:185], v[86:87], 0 cbsz:4 abid:15
    buffer_load_dwordx4 v[80:83], v190, s[28:31], 0 offen
    buffer_load_dwordx4 v[84:87], v191, s[28:31], 0 offen
    v_rcp_f32 v169, v169
    ds_read_b128 v[188:191], v196 offset:96
    ds_read_b64 v[184:185], v198 offset:512
    ds_read_b32 v254, v253 offset:2048
    v_mfma_f32_4x4x4_16b_bf16 v[152:155], v[186:187], v[176:177], 0 cbsz:4 abid:0
    v_rcp_f32 v170, v170
    v_mfma_f32_4x4x4_16b_bf16 v[156:159], v[186:187], v[180:181], 0 cbsz:4 abid:0
    v_rcp_f32 v171, v171
    v_rcp_f32 v172, v172
    v_rcp_f32 v173, v173
    v_rcp_f32 v174, v174
    v_rcp_f32 v175, v175
    v_readfirstlane_b32 s49, v195
    ds_read_b128 v[192:195], v197 offset:16
    v_add_u32 v196, 64, v196
    v_add_u32 v197, 16, v197
    v_add_u32 v198, 512, v198
    v_add_u32 v199, 256, v199
    v_pk_mul_f32 v[168:169], v[168:169], v[160:161]
    v_pk_mul_f32 v[170:171], v[170:171], v[162:163]
    v_pk_mul_f32 v[172:173], v[172:173], v[164:165]
    v_pk_mul_f32 v[174:175], v[174:175], v[166:167]
    s_set_gpr_idx_on s49, gpr_idx(SRC2,DST)
    v_pk_fma_f32 v[16:17], v[168:169], v[120:121], v[16:17] op_sel:[0,0,0] op_sel_hi:[0,1,1]
    v_pk_fma_f32 v[18:19], v[168:169], v[122:123], v[18:19] op_sel:[0,0,0] op_sel_hi:[0,1,1]
    v_pk_fma_f32 v[20:21], v[172:173], v[124:125], v[20:21] op_sel:[0,0,0] op_sel_hi:[0,1,1]
    v_pk_fma_f32 v[22:23], v[172:173], v[126:127], v[22:23] op_sel:[0,0,0] op_sel_hi:[0,1,1]
    s_lshr_b32 s49, s49, 8
    s_set_gpr_idx_idx s49
    v_pk_fma_f32 v[16:17], v[168:169], v[128:129], v[16:17] op_sel:[1,0,0] op_sel_hi:[1,1,1]
    v_pk_fma_f32 v[18:19], v[168:169], v[130:131], v[18:19] op_sel:[1,0,0] op_sel_hi:[1,1,1]
    v_pk_fma_f32 v[20:21], v[172:173], v[132:133], v[20:21] op_sel:[1,0,0] op_sel_hi:[1,1,1]
    v_pk_fma_f32 v[22:23], v[172:173], v[134:135], v[22:23] op_sel:[1,0,0] op_sel_hi:[1,1,1]
    s_lshr_b32 s49, s49, 8
    s_set_gpr_idx_idx s49
    v_pk_fma_f32 v[16:17], v[170:171], v[136:137], v[16:17] op_sel:[0,0,0] op_sel_hi:[0,1,1]
    v_pk_fma_f32 v[18:19], v[170:171], v[138:139], v[18:19] op_sel:[0,0,0] op_sel_hi:[0,1,1]
    v_pk_fma_f32 v[20:21], v[174:175], v[140:141], v[20:21] op_sel:[0,0,0] op_sel_hi:[0,1,1]
    v_pk_fma_f32 v[22:23], v[174:175], v[142:143], v[22:23] op_sel:[0,0,0] op_sel_hi:[0,1,1]
    s_lshr_b32 s49, s49, 8
    s_set_gpr_idx_idx s49
    v_pk_fma_f32 v[16:17], v[170:171], v[144:145], v[16:17] op_sel:[1,0,0] op_sel_hi:[1,1,1]
    v_pk_fma_f32 v[18:19], v[170:171], v[146:147], v[18:19] op_sel:[1,0,0] op_sel_hi:[1,1,1]
    v_pk_fma_f32 v[20:21], v[174:175], v[148:149], v[20:21] op_sel:[1,0,0] op_sel_hi:[1,1,1]
    v_pk_fma_f32 v[22:23], v[174:175], v[150:151], v[22:23] op_sel:[1,0,0] op_sel_hi:[1,1,1]
    s_set_gpr_idx_off
    s_sub_u32 s48, s48, 1
    s_cbranch_scc0 K2_LOOP
K2_D0:
    s_cmp_eq_u32 s48, -1
    s_cbranch_scc1 K2_WA0
    s_waitcnt vmcnt(2)
K2_WA0:
    s_waitcnt vmcnt(6) lgkmcnt(0)
    v_mfma_f32_4x4x4_16b_bf16 v[120:123], v[184:185], v[56:57], 0 cbsz:4 abid:0
    v_exp_f32 v168, v152
    v_mfma_f32_4x4x4_16b_bf16 v[124:127], v[184:185], v[58:59], 0 cbsz:4 abid:0
    v_exp_f32 v169, v153
    v_mfma_f32_4x4x4_16b_bf16 v[128:131], v[184:185], v[60:61], 0 cbsz:4 abid:1
    v_exp_f32 v170, v154
    v_mfma_f32_4x4x4_16b_bf16 v[132:135], v[184:185], v[62:63], 0 cbsz:4 abid:1
    v_exp_f32 v171, v155
    s_cmp_eq_u32 s48, -1
    s_cbranch_scc1 K2_WB0
    s_waitcnt vmcnt(0)
K2_WB0:
    s_waitcnt vmcnt(4)
    v_mfma_f32_4x4x4_16b_bf16 v[136:139], v[184:185], v[64:65], 0 cbsz:4 abid:2
    v_exp_f32 v172, v156
    v_mfma_f32_4x4x4_16b_bf16 v[140:143], v[184:185], v[66:67], 0 cbsz:4 abid:2
    v_exp_f32 v173, v157
    v_exp_f32 v174, v158
    v_exp_f32 v175, v159
    v_pk_add_f32 v[168:169], v[168:169], 1.0 op_sel_hi:[1,0]
    v_pk_add_f32 v[170:171], v[170:171], 1.0 op_sel_hi:[1,0]
    v_pk_add_f32 v[172:173], v[172:173], 1.0 op_sel_hi:[1,0]
    v_pk_add_f32 v[174:175], v[174:175], 1.0 op_sel_hi:[1,0]
    v_mfma_f32_4x4x4_16b_bf16 v[144:147], v[184:185], v[68:69], 0 cbsz:4 abid:3
    v_rcp_f32 v168, v168
    v_mfma_f32_4x4x4_16b_bf16 v[148:151], v[184:185], v[70:71], 0 cbsz:4 abid:3
    v_rcp_f32 v169, v169
    v_mfma_f32_4x4x4_16b_bf16 v[160:163], v[186:187], v[176:177], 0 cbsz:4 abid:1
    v_rcp_f32 v170, v170
    v_mfma_f32_4x4x4_16b_bf16 v[164:167], v[186:187], v[180:181], 0 cbsz:4 abid:1
    v_rcp_f32 v171, v171
    v_rcp_f32 v172, v172
    v_rcp_f32 v173, v173
    v_rcp_f32 v174, v174
    v_rcp_f32 v175, v175
    v_readfirstlane_b32 s49, v192
    v_pk_mul_f32 v[168:169], v[168:169], v[152:153]
    v_pk_mul_f32 v[170:171], v[170:171], v[154:155]
    v_pk_mul_f32 v[172:173], v[172:173], v[156:157]
    v_pk_mul_f32 v[174:175], v[174:175], v[158:159]
    s_set_gpr_idx_on s49, gpr_idx(SRC2,DST)
    v_pk_fma_f32 v[16:17], v[168:169], v[120:121], v[16:17] op_sel:[0,0,0] op_sel_hi:[0,1,1]
    v_pk_fma_f32 v[18:19], v[168:169], v[122:123], v[18:19] op_sel:[0,0,0] op_sel_hi:[0,1,1]
    v_pk_fma_f32 v[20:21], v[172:173], v[124:125], v[20:21] op_sel:[0,0,0] op_sel_hi:[0,1,1]
    v_pk_fma_f32 v[22:23], v[172:173], v[126:127], v[22:23] op_sel:[0,0,0] op_sel_hi:[0,1,1]
    s_lshr_b32 s49, s49, 8
    s_set_gpr_idx_idx s49
    v_pk_fma_f32 v[16:17], v[168:169], v[128:129], v[16:17] op_sel:[1,0,0] op_sel_hi:[1,1,1]
    v_pk_fma_f32 v[18:19], v[168:169], v[130:131], v[18:19] op_sel:[1,0,0] op_sel_hi:[1,1,1]
    v_pk_fma_f32 v[20:21], v[172:173], v[132:133], v[20:21] op_sel:[1,0,0] op_sel_hi:[1,1,1]
    v_pk_fma_f32 v[22:23], v[172:173], v[134:135], v[22:23] op_sel:[1,0,0] op_sel_hi:[1,1,1]
    s_lshr_b32 s49, s49, 8
    s_set_gpr_idx_idx s49
    v_pk_fma_f32 v[16:17], v[170:171], v[136:137], v[16:17] op_sel:[0,0,0] op_sel_hi:[0,1,1]
    v_pk_fma_f32 v[18:19], v[170:171], v[138:139], v[18:19] op_sel:[0,0,0] op_sel_hi:[0,1,1]
    v_pk_fma_f32 v[20:21], v[174:175], v[140:141], v[20:21] op_sel:[0,0,0] op_sel_hi:[0,1,1]
    v_pk_fma_f32 v[22:23], v[174:175], v[142:143], v[22:23] op_sel:[0,0,0] op_sel_hi:[0,1,1]
    s_lshr_b32 s49, s49, 8
    s_set_gpr_idx_idx s49
    v_pk_fma_f32 v[16:17], v[170:171], v[144:145], v[16:17] op_sel:[1,0,0] op_sel_hi:[1,1,1]
    v_pk_fma_f32 v[18:19], v[170:171], v[146:147], v[18:19] op_sel:[1,0,0] op_sel_hi:[1,1,1]
    v_pk_fma_f32 v[20:21], v[174:175], v[148:149], v[20:21] op_sel:[1,0,0] op_sel_hi:[1,1,1]
    v_pk_fma_f32 v[22:23], v[174:175], v[150:151], v[22:23] op_sel:[1,0,0] op_sel_hi:[1,1,1]
    s_set_gpr_idx_off
    s_sub_u32 s48, s48, 1
    s_cmp_eq_u32 s48, -3
    s_cbranch_scc1 K2_LOOPDONE
K2_D1:
    s_cmp_eq_u32 s48, -1
    s_cbranch_scc1 K2_WA1
    s_waitcnt vmcnt(2)
K2_WA1:
    s_waitcnt vmcnt(6) lgkmcnt(0)
    v_mfma_f32_4x4x4_16b_bf16 v[120:123], v[184:185], v[72:73], 0 cbsz:4 abid:4
    v_exp_f32 v168, v160
    v_mfma_f32_4x4x4_16b_bf16 v[124:127], v[184:185], v[74:75], 0 cbsz:4 abid:4
    v_exp_f32 v169, v161
    v_mfma_f32_4x4x4_16b_bf16 v[128:131], v[184:185], v[76:77], 0 cbsz:4 abid:5
    v_exp_f32 v170, v162
    v_mfma_f32_4x4x4_16b_bf16 v[132:135], v[184:185], v[78:79], 0 cbsz:4 abid:5
    v_exp_f32 v171, v163
    s_cmp_eq_u32 s48, -1
    s_cbranch_scc1 K2_WB1
    s_waitcnt vmcnt(0)
K2_WB1:
    s_waitcnt vmcnt(4)
    v_mfma_f32_4x4x4_16b_bf16 v[136:139], v[184:185], v[80:81], 0 cbsz:4 abid:6
    v_exp_f32 v172, v164
    v_mfma_f32_4x4x4_16b_bf16 v[140:143], v[184:185], v[82:83], 0 cbsz:4 abid:6
    v_exp_f32 v173, v165
    v_exp_f32 v174, v166
    v_exp_f32 v175, v167
    v_pk_add_f32 v[168:169], v[168:169], 1.0 op_sel_hi:[1,0]
    v_pk_add_f32 v[170:171], v[170:171], 1.0 op_sel_hi:[1,0]
    v_pk_add_f32 v[172:173], v[172:173], 1.0 op_sel_hi:[1,0]
    v_pk_add_f32 v[174:175], v[174:175], 1.0 op_sel_hi:[1,0]
    v_mfma_f32_4x4x4_16b_bf16 v[144:147], v[184:185], v[84:85], 0 cbsz:4 abid:7
    v_rcp_f32 v168, v168
    v_mfma_f32_4x4x4_16b_bf16 v[148:151], v[184:185], v[86:87], 0 cbsz:4 abid:7
    v_rcp_f32 v169, v169
    v_mfma_f32_4x4x4_16b_bf16 v[152:155], v[186:187], v[176:177], 0 cbsz:4 abid:2
    v_rcp_f32 v170, v170
    v_mfma_f32_4x4x4_16b_bf16 v[156:159], v[186:187], v[180:181], 0 cbsz:4 abid:2
    v_rcp_f32 v171, v171
    v_rcp_f32 v172, v172
    v_rcp_f32 v173, v173
    v_rcp_f32 v174, v174
    v_rcp_f32 v175, v175
    v_readfirstlane_b32 s49, v193
    v_pk_mul_f32 v[168:169], v[168:169], v[160:161]
    v_pk_mul_f32 v[170:171], v[170:171], v[162:163]
    v_pk_mul_f32 v[172:173], v[172:173], v[164:165]
    v_pk_mul_f32 v[174:175], v[174:175], v[166:167]
    s_set_gpr_idx_on s49, gpr_idx(SRC2,DST)
    v_pk_fma_f32 v[16:17], v[168:169], v[120:121], v[16:17] op_sel:[0,0,0] op_sel_hi:[0,1,1]
    v_pk_fma_f32 v[18:19], v[168:169], v[122:123], v[18:19] op_sel:[0,0,0] op_sel_hi:[0,1,1]
    v_pk_fma_f32 v[20:21], v[172:173], v[124:125], v[20:21] op_sel:[0,0,0] op_sel_hi:[0,1,1]
    v_pk_fma_f32 v[22:23], v[172:173], v[126:127], v[22:23] op_sel:[0,0,0] op_sel_hi:[0,1,1]
    s_lshr_b32 s49, s49, 8
    s_set_gpr_idx_idx s49
    v_pk_fma_f32 v[16:17], v[168:169], v[128:129], v[16:17] op_sel:[1,0,0] op_sel_hi:[1,1,1]
    v_pk_fma_f32 v[18:19], v[168:169], v[130:131], v[18:19] op_sel:[1,0,0] op_sel_hi:[1,1,1]
    v_pk_fma_f32 v[20:21], v[172:173], v[132:133], v[20:21] op_sel:[1,0,0] op_sel_hi:[1,1,1]
    v_pk_fma_f32 v[22:23], v[172:173], v[134:135], v[22:23] op_sel:[1,0,0] op_sel_hi:[1,1,1]
    s_lshr_b32 s49, s49, 8
    s_set_gpr_idx_idx s49
    v_pk_fma_f32 v[16:17], v[170:171], v[136:137], v[16:17] op_sel:[0,0,0] op_sel_hi:[0,1,1]
    v_pk_fma_f32 v[18:19], v[170:171], v[138:139], v[18:19] op_sel:[0,0,0] op_sel_hi:[0,1,1]
    v_pk_fma_f32 v[20:21], v[174:175], v[140:141], v[20:21] op_sel:[0,0,0] op_sel_hi:[0,1,1]
    v_pk_fma_f32 v[22:23], v[174:175], v[142:143], v[22:23] op_sel:[0,0,0] op_sel_hi:[0,1,1]
    s_lshr_b32 s49, s49, 8
    s_set_gpr_idx_idx s49
    v_pk_fma_f32 v[16:17], v[170:171], v[144:145], v[16:17] op_sel:[1,0,0] op_sel_hi:[1,1,1]
    v_pk_fma_f32 v[18:19], v[170:171], v[146:147], v[18:19] op_sel:[1,0,0] op_sel_hi:[1,1,1]
    v_pk_fma_f32 v[20:21], v[174:175], v[148:149], v[20:21] op_sel:[1,0,0] op_sel_hi:[1,1,1]
    v_pk_fma_f32 v[22:23], v[174:175], v[150:151], v[22:23] op_sel:[1,0,0] op_sel_hi:[1,1,1]
    s_set_gpr_idx_off
    s_sub_u32 s48, s48, 1
    s_cmp_eq_u32 s48, -3
    s_cbranch_scc1 K2_LOOPDONE
K2_D2:
    s_cmp_eq_u32 s48, -1
    s_cbranch_scc1 K2_WA2
    s_waitcnt vmcnt(2)
K2_WA2:
    s_waitcnt vmcnt(6) lgkmcnt(0)
    v_mfma_f32_4x4x4_16b_bf16 v[120:123], v[184:185], v[56:57], 0 cbsz:4 abid:8
    v_exp_f32 v168, v152
    v_mfma_f32_4x4x4_16b_bf16 v[124:127], v[184:185], v[58:59], 0 cbsz:4 abid:8
    v_exp_f32 v169, v153
    v_mfma_f32_4x4x4_16b_bf16 v[128:131], v[184:185], v[60:61], 0 cbsz:4 abid:9
    v_exp_f32 v170, v154
    v_mfma_f32_4x4x4_16b_bf16 v[132:135], v[184:185], v[62:63], 0 cbsz:4 abid:9
    v_exp_f32 v171, v155
    s_cmp_eq_u32 s48, -1
    s_cbranch_scc1 K2_WB2
    s_waitcnt vmcnt(0)
K2_WB2:
    s_waitcnt vmcnt(4)
    v_mfma_f32_4x4x4_16b_bf16 v[136:139], v[184:185], v[64:65], 0 cbsz:4 abid:10
    v_exp_f32 v172, v156
    v_mfma_f32_4x4x4_16b_bf16 v[140:143], v[184:185], v[66:67], 0 cbsz:4 abid:10
    v_exp_f32 v173, v157
    v_exp_f32 v174, v158
    v_exp_f32 v175, v159
    v_pk_add_f32 v[168:169], v[168:169], 1.0 op_sel_hi:[1,0]
    v_pk_add_f32 v[170:171], v[170:171], 1.0 op_sel_hi:[1,0]
    v_pk_add_f32 v[172:173], v[172:173], 1.0 op_sel_hi:[1,0]
    v_pk_add_f32 v[174:175], v[174:175], 1.0 op_sel_hi:[1,0]
    v_mfma_f32_4x4x4_16b_bf16 v[144:147], v[184:185], v[68:69], 0 cbsz:4 abid:11
    v_rcp_f32 v168, v168
    v_mfma_f32_4x4x4_16b_bf16 v[148:151], v[184:185], v[70:71], 0 cbsz:4 abid:11
    v_rcp_f32 v169, v169
    v_mfma_f32_4x4x4_16b_bf16 v[160:163], v[186:187], v[176:177], 0 cbsz:4 abid:3
    v_rcp_f32 v170, v170
    v_mfma_f32_4x4x4_16b_bf16 v[164:167], v[186:187], v[180:181], 0 cbsz:4 abid:3
    v_rcp_f32 v171, v171
    v_rcp_f32 v172, v172
    ds_read_b64 v[186:187], v199 offset:264
    v_rcp_f32 v173, v173
    v_rcp_f32 v174, v174
    v_rcp_f32 v175, v175
    v_readfirstlane_b32 s49, v194
    v_pk_mul_f32 v[168:169], v[168:169], v[152:153]
    v_pk_mul_f32 v[170:171], v[170:171], v[154:155]
    v_pk_mul_f32 v[172:173], v[172:173], v[156:157]
    v_pk_mul_f32 v[174:175], v[174:175], v[158:159]
    s_set_gpr_idx_on s49, gpr_idx(SRC2,DST)
    v_pk_fma_f32 v[16:17], v[168:169], v[120:121], v[16:17] op_sel:[0,0,0] op_sel_hi:[0,1,1]
    v_pk_fma_f32 v[18:19], v[168:169], v[122:123], v[18:19] op_sel:[0,0,0] op_sel_hi:[0,1,1]
    v_pk_fma_f32 v[20:21], v[172:173], v[124:125], v[20:21] op_sel:[0,0,0] op_sel_hi:[0,1,1]
    v_pk_fma_f32 v[22:23], v[172:173], v[126:127], v[22:23] op_sel:[0,0,0] op_sel_hi:[0,1,1]
    s_lshr_b32 s49, s49, 8
    s_set_gpr_idx_idx s49
    v_pk_fma_f32 v[16:17], v[168:169], v[128:129], v[16:17] op_sel:[1,0,0] op_sel_hi:[1,1,1]
    v_pk_fma_f32 v[18:19], v[168:169], v[130:131], v[18:19] op_sel:[1,0,0] op_sel_hi:[1,1,1]
    v_pk_fma_f32 v[20:21], v[172:173], v[132:133], v[20:21] op_sel:[1,0,0] op_sel_hi:[1,1,1]
    v_pk_fma_f32 v[22:23], v[172:173], v[134:135], v[22:23] op_sel:[1,0,0] op_sel_hi:[1,1,1]
    s_lshr_b32 s49, s49, 8
    s_set_gpr_idx_idx s49
    v_pk_fma_f32 v[16:17], v[170:171], v[136:137], v[16:17] op_sel:[0,0,0] op_sel_hi:[0,1,1]
    v_pk_fma_f32 v[18:19], v[170:171], v[138:139], v[18:19] op_sel:[0,0,0] op_sel_hi:[0,1,1]
    v_pk_fma_f32 v[20:21], v[174:175], v[140:141], v[20:21] op_sel:[0,0,0] op_sel_hi:[0,1,1]
    v_pk_fma_f32 v[22:23], v[174:175], v[142:143], v[22:23] op_sel:[0,0,0] op_sel_hi:[0,1,1]
    s_lshr_b32 s49, s49, 8
    s_set_gpr_idx_idx s49
    v_pk_fma_f32 v[16:17], v[170:171], v[144:145], v[16:17] op_sel:[1,0,0] op_sel_hi:[1,1,1]
    v_pk_fma_f32 v[18:19], v[170:171], v[146:147], v[18:19] op_sel:[1,0,0] op_sel_hi:[1,1,1]
    v_pk_fma_f32 v[20:21], v[174:175], v[148:149], v[20:21] op_sel:[1,0,0] op_sel_hi:[1,1,1]
    v_pk_fma_f32 v[22:23], v[174:175], v[150:151], v[22:23] op_sel:[1,0,0] op_sel_hi:[1,1,1]
    s_set_gpr_idx_off
    s_sub_u32 s48, s48, 1
    s_cmp_eq_u32 s48, -3
    s_cbranch_scc1 K2_LOOPDONE
K2_D3:
    s_cmp_eq_u32 s48, -1
    s_cbranch_scc1 K2_WA3
    s_waitcnt vmcnt(2)
K2_WA3:
    s_waitcnt vmcnt(6) lgkmcnt(0)
    v_mfma_f32_4x4x4_16b_bf16 v[120:123], v[184:185], v[72:73], 0 cbsz:4 abid:12
    v_exp_f32 v168, v160
    v_mfma_f32_4x4x4_16b_bf16 v[124:127], v[184:185], v[74:75], 0 cbsz:4 abid:12
    v_exp_f32 v169, v161
    v_mfma_f32_4x4x4_16b_bf16 v[128:131], v[184:185], v[76:77], 0 cbsz:4 abid:13
    v_exp_f32 v170, v162
    v_mfma_f32_4x4x4_16b_bf16 v[132:135], v[184:185], v[78:79], 0 cbsz:4 abid:13
    v_exp_f32 v171, v163
    s_cmp_eq_u32 s48, -1
    s_cbranch_scc1 K2_WB3
    s_waitcnt vmcnt(0)
K2_WB3:
    s_waitcnt vmcnt(4)
    v_mfma_f32_4x4x4_16b_bf16 v[136:139], v[184:185], v[80:81], 0 cbsz:4 abid:14
    v_exp_f32 v172, v164
    v_mfma_f32_4x4x4_16b_bf16 v[140:143], v[184:185], v[82:83], 0 cbsz:4 abid:14
    v_exp_f32 v173, v165
    v_exp_f32 v174, v166
    v_exp_f32 v175, v167
    v_pk_add_f32 v[168:169], v[168:169], 1.0 op_sel_hi:[1,0]
    v_pk_add_f32 v[170:171], v[170:171], 1.0 op_sel_hi:[1,0]
    v_pk_add_f32 v[172:173], v[172:173], 1.0 op_sel_hi:[1,0]
    v_pk_add_f32 v[174:175], v[174:175], 1.0 op_sel_hi:[1,0]
    v_mfma_f32_4x4x4_16b_bf16 v[144:147], v[184:185], v[84:85], 0 cbsz:4 abid:15
    v_rcp_f32 v168, v168
    v_mfma_f32_4x4x4_16b_bf16 v[148:151], v[184:185], v[86:87], 0 cbsz:4 abid:15
    v_rcp_f32 v169, v169
    ds_read_b64 v[184:185], v198 offset:512
    v_mfma_f32_4x4x4_16b_bf16 v[152:155], v[186:187], v[176:177], 0 cbsz:4 abid:0
    v_rcp_f32 v170, v170
    v_mfma_f32_4x4x4_16b_bf16 v[156:159], v[186:187], v[180:181], 0 cbsz:4 abid:0
    v_rcp_f32 v171, v171
    v_rcp_f32 v172, v172
    v_rcp_f32 v173, v173
    v_rcp_f32 v174, v174
    v_rcp_f32 v175, v175
    v_readfirstlane_b32 s49, v195
    ds_read_b128 v[192:195], v197 offset:16
    v_add_u32 v196, 64, v196
    v_add_u32 v197, 16, v197
    v_add_u32 v198, 512, v198
    v_add_u32 v199, 256, v199
    v_pk_mul_f32 v[168:169], v[168:169], v[160:161]
    v_pk_mul_f32 v[170:171], v[170:171], v[162:163]
    v_pk_mul_f32 v[172:173], v[172:173], v[164:165]
    v_pk_mul_f32 v[174:175], v[174:175], v[166:167]
    s_set_gpr_idx_on s49, gpr_idx(SRC2,DST)
    v_pk_fma_f32 v[16:17], v[168:169], v[120:121], v[16:17] op_sel:[0,0,0] op_sel_hi:[0,1,1]
    v_pk_fma_f32 v[18:19], v[168:169], v[122:123], v[18:19] op_sel:[0,0,0] op_sel_hi:[0,1,1]
    v_pk_fma_f32 v[20:21], v[172:173], v[124:125], v[20:21] op_sel:[0,0,0] op_sel_hi:[0,1,1]
    v_pk_fma_f32 v[22:23], v[172:173], v[126:127], v[22:23] op_sel:[0,0,0] op_sel_hi:[0,1,1]
    s_lshr_b32 s49, s49, 8
    s_set_gpr_idx_idx s49
    v_pk_fma_f32 v[16:17], v[168:169], v[128:129], v[16:17] op_sel:[1,0,0] op_sel_hi:[1,1,1]
    v_pk_fma_f32 v[18:19], v[168:169], v[130:131], v[18:19] op_sel:[1,0,0] op_sel_hi:[1,1,1]
    v_pk_fma_f32 v[20:21], v[172:173], v[132:133], v[20:21] op_sel:[1,0,0] op_sel_hi:[1,1,1]
    v_pk_fma_f32 v[22:23], v[172:173], v[134:135], v[22:23] op_sel:[1,0,0] op_sel_hi:[1,1,1]
    s_lshr_b32 s49, s49, 8
    s_set_gpr_idx_idx s49
    v_pk_fma_f32 v[16:17], v[170:171], v[136:137], v[16:17] op_sel:[0,0,0] op_sel_hi:[0,1,1]
    v_pk_fma_f32 v[18:19], v[170:171], v[138:139], v[18:19] op_sel:[0,0,0] op_sel_hi:[0,1,1]
    v_pk_fma_f32 v[20:21], v[174:175], v[140:141], v[20:21] op_sel:[0,0,0] op_sel_hi:[0,1,1]
    v_pk_fma_f32 v[22:23], v[174:175], v[142:143], v[22:23] op_sel:[0,0,0] op_sel_hi:[0,1,1]
    s_lshr_b32 s49, s49, 8
    s_set_gpr_idx_idx s49
    v_pk_fma_f32 v[16:17], v[170:171], v[144:145], v[16:17] op_sel:[1,0,0] op_sel_hi:[1,1,1]
    v_pk_fma_f32 v[18:19], v[170:171], v[146:147], v[18:19] op_sel:[1,0,0] op_sel_hi:[1,1,1]
    v_pk_fma_f32 v[20:21], v[174:175], v[148:149], v[20:21] op_sel:[1,0,0] op_sel_hi:[1,1,1]
    v_pk_fma_f32 v[22:23], v[174:175], v[150:151], v[22:23] op_sel:[1,0,0] op_sel_hi:[1,1,1]
    s_set_gpr_idx_off
    s_sub_u32 s48, s48, 1
    s_cmp_eq_u32 s48, -3
    s_cbranch_scc0 K2_D0
K2_LOOPDONE:
    v_mov_b32 v254, -1
    ds_write_b32 v252, v254 offset:2048
    s_setprio 0
    s_add_u32 s47, s47, 1536
    s_cmp_ge_u32 s47, s46
    s_cbranch_scc1 K_EPI
    s_waitcnt vmcnt(0) lgkmcnt(0)
    s_barrier
    ds_write_b128 v8, v[4:7]
    ds_write_b32 v3, v4 offset:2048
    v_cmp_gt_u32 vcc, 128, v0
    s_and_saveexec_b64 s[56:57], vcc
    ds_write_b32 v3, v4 offset:0
    s_mov_b64 exec, s[56:57]
    s_waitcnt lgkmcnt(0)
    s_barrier
    s_cmp_eq_u32 s55, 0
    s_cbranch_scc1 K_ROUND
    s_branch K_FB
K_LATER:
    s_mov_b64 exec, s[40:41]
    buffer_load_dwordx4 v[88:91], v100, s[36:39], s61 offen sc1
    s_mov_b64 exec, s[42:43]
    buffer_load_dwordx4 v[92:95], v101, s[36:39], s61 offen sc1
    s_mov_b64 exec, s[44:45]
    buffer_load_dwordx4 v[96:99], v102, s[36:39], s61 offen sc1
    s_mov_b64 exec, -1
K_LATER2:
    v_lshrrev_b32 v81, 2, v72
    v_and_b32 v81, 0xfc, v81
    v_lshrrev_b32 v82, 2, v74
    v_and_b32 v82, 0xfc, v82
    v_lshrrev_b32 v83, 2, v76
    v_and_b32 v83, 0xfc, v83
    s_branch K_BAL
K_FB0:
    s_mov_b32 s46, 320000
    s_and_b32 s56, s3, 3
    s_lshl_b32 s56, s56, 6
    s_add_u32 s56, s56, 114944
    v_lshrrev_b32 v10, 4, v1
    v_lshlrev_b32 v10, 11, v10
    v_and_b32 v12, 15, v1
    v_lshl_or_b32 v10, v12, 2, v10
    v_add_u32 v10, s56, v10
    s_mov_b32 s56, 0x05040100
    s_mov_b32 s57, 0x07060302
    ds_read2st64_b32 v[120:121], v10 offset0:0 offset1:1
    ds_read2st64_b32 v[122:123], v10 offset0:2 offset1:3
    ds_read2st64_b32 v[124:125], v10 offset0:4 offset1:5
    ds_read2st64_b32 v[126:127], v10 offset0:6 offset1:7
    ds_read2st64_b32 v[128:129], v10 offset0:32 offset1:33
    ds_read2st64_b32 v[130:131], v10 offset0:34 offset1:35
    ds_read2st64_b32 v[132:133], v10 offset0:36 offset1:37
    ds_read2st64_b32 v[134:135], v10 offset0:38 offset1:39
    ds_read2st64_b32 v[136:137], v10 offset0:64 offset1:65
    ds_read2st64_b32 v[138:139], v10 offset0:66 offset1:67
    ds_read2st64_b32 v[140:141], v10 offset0:68 offset1:69
    ds_read2st64_b32 v[142:143], v10 offset0:70 offset1:71
    ds_read2st64_b32 v[144:145], v10 offset0:96 offset1:97
    ds_read2st64_b32 v[146:147], v10 offset0:98 offset1:99
    ds_read2st64_b32 v[148:149], v10 offset0:100 offset1:101
    ds_read2st64_b32 v[150:151], v10 offset0:102 offset1:103
    s_waitcnt lgkmcnt(15)
    v_perm_b32 v200, v121, v120, s56
    v_perm_b32 v216, v121, v120, s57
    s_waitcnt lgkmcnt(14)
    v_perm_b32 v201, v123, v122, s56
    v_perm_b32 v217, v123, v122, s57
    s_waitcnt lgkmcnt(13)
    v_perm_b32 v202, v125, v124, s56
    v_perm_b32 v218, v125, v124, s57
    s_waitcnt lgkmcnt(12)
    v_perm_b32 v203, v127, v126, s56
    v_perm_b32 v219, v127, v126, s57
    s_waitcnt lgkmcnt(11)
    v_perm_b32 v204, v129, v128, s56
    v_perm_b32 v220, v129, v128, s57
    s_waitcnt lgkmcnt(10)
    v_perm_b32 v205, v131, v130, s56
    v_perm_b32 v221, v131, v130, s57
    s_waitcnt lgkmcnt(9)
    v_perm_b32 v206, v133, v132, s56
    v_perm_b32 v222, v133, v132, s57
    s_waitcnt lgkmcnt(8)
    v_perm_b32 v207, v135, v134, s56
    v_perm_b32 v223, v135, v134, s57
    s_waitcnt lgkmcnt(7)
    v_perm_b32 v208, v137, v136, s56
    v_perm_b32 v224, v137, v136, s57
    s_waitcnt lgkmcnt(6)
    v_perm_b32 v209, v139, v138, s56
    v_perm_b32 v225, v139, v138, s57
    s_waitcnt lgkmcnt(5)
    v_perm_b32 v210, v141, v140, s56
    v_perm_b32 v226, v141, v140, s57
    s_waitcnt lgkmcnt(4)
    v_perm_b32 v211, v143, v142, s56
    v_perm_b32 v227, v143, v142, s57
    s_waitcnt lgkmcnt(3)
    v_perm_b32 v212, v145, v144, s56
    v_perm_b32 v228, v145, v144, s57
    s_waitcnt lgkmcnt(2)
    v_perm_b32 v213, v147, v146, s56
    v_perm_b32 v229, v147, v146, s57
    s_waitcnt lgkmcnt(1)
    v_perm_b32 v214, v149, v148, s56
    v_perm_b32 v230, v149, v148, s57
    s_waitcnt lgkmcnt(0)
    v_perm_b32 v215, v151, v150, s56
    v_perm_b32 v231, v151, v150, s57
K_FB:
    s_mul_i32 s56, s3, 192
    s_add_u32 s56, s56, s47
    v_add_u32 v68, s56, v1
    v_add_u32 v69, 64, v68
    v_add_u32 v70, 128, v68
    v_cmp_gt_u32 s[40:41], s46, v68
    v_min_u32 v68, 319999, v68
    v_lshlrev_b32 v81, 2, v68
    v_lshlrev_b32 v100, 3, v68
    global_load_dword v56, v81, s[8:9]
    global_load_dword v60, v81, s[6:7]
    global_load_dwordx2 v[88:89], v100, s[10:11]
    global_load_dwordx2 v[90:91], v100, s[12:13]
    v_cmp_gt_u32 s[42:43], s46, v69
    v_min_u32 v69, 319999, v69
    v_lshlrev_b32 v82, 2, v69
    v_lshlrev_b32 v101, 3, v69
    global_load_dword v57, v82, s[8:9]
    global_load_dword v61, v82, s[6:7]
    global_load_dwordx2 v[92:93], v101, s[10:11]
    global_load_dwordx2 v[94:95], v101, s[12:13]
    v_cmp_gt_u32 s[44:45], s46, v70
    v_min_u32 v70, 319999, v70
    v_lshlrev_b32 v83, 2, v70
    v_lshlrev_b32 v102, 3, v70
    global_load_dword v58, v83, s[8:9]
    global_load_dword v62, v83, s[6:7]
    global_load_dwordx2 v[96:97], v102, s[10:11]
    global_load_dwordx2 v[98:99], v102, s[12:13]
    v_mov_b32 v14, 64
    s_waitcnt vmcnt(0)
    v_mul_u32_u24 v68, 214749, v56
    v_lshrrev_b32 v68, 23, v68
    v_cmp_eq_u32 vcc, s53, v68
    s_and_b64 s[40:41], s[40:41], vcc
    v_subrev_u32 v72, s54, v56
    v_mul_u32_u24 v68, 1677, v60
    v_lshrrev_b32 v68, 20, v68
    v_lshl_or_b32 v72, v72, 4, v68
    v_lshl_or_b32 v72, v60, 10, v72
    v_mul_u32_u24 v69, 214749, v57
    v_lshrrev_b32 v69, 23, v69
    v_cmp_eq_u32 vcc, s53, v69
    s_and_b64 s[42:43], s[42:43], vcc
    v_subrev_u32 v74, s54, v57
    v_mul_u32_u24 v69, 1677, v61
    v_lshrrev_b32 v69, 20, v69
    v_lshl_or_b32 v74, v74, 4, v69
    v_lshl_or_b32 v74, v61, 10, v74
    v_mul_u32_u24 v70, 214749, v58
    v_lshrrev_b32 v70, 23, v70
    v_cmp_eq_u32 vcc, s53, v70
    s_and_b64 s[44:45], s[44:45], vcc
    v_subrev_u32 v76, s54, v58
    v_mul_u32_u24 v70, 1677, v62
    v_lshrrev_b32 v70, 20, v70
    v_lshl_or_b32 v76, v76, 4, v70
    v_lshl_or_b32 v76, v62, 10, v76
    s_cmp_lg_u32 s47, 0
    s_cbranch_scc1 K_LATER2
    s_branch K_GOT
K_EPI:
    s_mov_b32 s56, 0xbf317218
    s_mov_b32 s57, s56
    v_pk_mul_f32 v[16:17], v[16:17], s[56:57]
    v_pk_mul_f32 v[18:19], v[18:19], s[56:57]
    v_pk_mul_f32 v[20:21], v[20:21], s[56:57]
    v_pk_mul_f32 v[22:23], v[22:23], s[56:57]
    v_cvt_pk_bf16_f32 v16, v16, v20
    ds_write_b32 v106, v16 offset:0
    v_cvt_pk_bf16_f32 v17, v17, v21
    ds_write_b32 v106, v17 offset:288
    v_cvt_pk_bf16_f32 v18, v18, v22
    ds_write_b32 v106, v18 offset:576
    v_cvt_pk_bf16_f32 v19, v19, v23
    ds_write_b32 v106, v19 offset:864
    v_pk_mul_f32 v[24:25], v[24:25], s[56:57]
    v_pk_mul_f32 v[26:27], v[26:27], s[56:57]
    v_pk_mul_f32 v[28:29], v[28:29], s[56:57]
    v_pk_mul_f32 v[30:31], v[30:31], s[56:57]
    v_cvt_pk_bf16_f32 v24, v24, v28
    ds_write_b32 v107, v24 offset:0
    v_cvt_pk_bf16_f32 v25, v25, v29
    ds_write_b32 v107, v25 offset:288
    v_cvt_pk_bf16_f32 v26, v26, v30
    ds_write_b32 v107, v26 offset:576
    v_cvt_pk_bf16_f32 v27, v27, v31
    ds_write_b32 v107, v27 offset:864
    v_pk_mul_f32 v[32:33], v[32:33], s[56:57]
    v_pk_mul_f32 v[34:35], v[34:35], s[56:57]
    v_pk_mul_f32 v[36:37], v[36:37], s[56:57]
    v_pk_mul_f32 v[38:39], v[38:39], s[56:57]
    v_cvt_pk_bf16_f32 v32, v32, v36
    ds_write_b32 v116, v32 offset:0
    v_cvt_pk_bf16_f32 v33, v33, v37
    ds_write_b32 v116, v33 offset:288
    v_cvt_pk_bf16_f32 v34, v34, v38
    ds_write_b32 v116, v34 offset:576
    v_cvt_pk_bf16_f32 v35, v35, v39
    ds_write_b32 v116, v35 offset:864
    v_pk_mul_f32 v[40:41], v[40:41], s[56:57]
    v_pk_mul_f32 v[42:43], v[42:43], s[56:57]
    v_pk_mul_f32 v[44:45], v[44:45], s[56:57]
    v_pk_mul_f32 v[46:47], v[46:47], s[56:57]
    v_cvt_pk_bf16_f32 v40, v40, v44
    ds_write_b32 v117, v40 offset:0
    v_cvt_pk_bf16_f32 v41, v41, v45
    ds_write_b32 v117, v41 offset:288
    v_cvt_pk_bf16_f32 v42, v42, v46
    ds_write_b32 v117, v42 offset:576
    v_cvt_pk_bf16_f32 v43, v43, v47
    ds_write_b32 v117, v43 offset:864
    v_pk_mul_f32 v[48:49], v[48:49], s[56:57]
    v_pk_mul_f32 v[50:51], v[50:51], s[56:57]
    v_pk_mul_f32 v[52:53], v[52:53], s[56:57]
    v_pk_mul_f32 v[54:55], v[54:55], s[56:57]
    v_cvt_pk_bf16_f32 v48, v48, v52
    ds_write_b32 v118, v48 offset:0
    v_cvt_pk_bf16_f32 v49, v49, v53
    ds_write_b32 v118, v49 offset:288
    v_cvt_pk_bf16_f32 v50, v50, v54
    ds_write_b32 v118, v50 offset:576
    v_cvt_pk_bf16_f32 v51, v51, v55
    ds_write_b32 v118, v51 offset:864
    v_and_b32 v12, 15, v1
    v_lshrrev_b32 v13, 4, v1
    s_lshr_b32 s58, s3, 2
    s_mul_i32 s59, s58, 4608
    s_add_u32 s59, s59, 106752
    v_mul_u32_u24 v14, 288, v12
    v_lshl_add_u32 v14, v13, 4, v14
    v_add_u32 v14, s59, v14
    s_lshl_b32 s58, s58, 2
    s_add_u32 s58, s58, s54
    s_lshl_b32 s58, s58, 10
    s_and_b32 s59, s3, 3
    s_lshl_b32 s59, s59, 8
    s_add_u32 s58, s58, s59
    v_lshlrev_b32 v13, 10, v13
    v_lshl_add_u32 v13, v12, 4, v13
    s_waitcnt vmcnt(0) lgkmcnt(0)
    s_barrier
    ds_read_b128 v[56:59], v14 offset:0
    ds_read_b128 v[60:63], v14 offset:64
    ds_read_b128 v[64:67], v14 offset:128
    ds_read_b128 v[68:71], v14 offset:192
    ds_read_b128 v[72:75], v14 offset:9216
    ds_read_b128 v[76:79], v14 offset:9280
    ds_read_b128 v[80:83], v14 offset:9344
    ds_read_b128 v[84:87], v14 offset:9408
    ds_read_b128 v[88:91], v14 offset:18432
    ds_read_b128 v[92:95], v14 offset:18496
    ds_read_b128 v[96:99], v14 offset:18560
    ds_read_b128 v[100:103], v14 offset:18624
    ds_read_b128 v[104:107], v14 offset:27648
    ds_read_b128 v[108:111], v14 offset:27712
    ds_read_b128 v[112:115], v14 offset:27776
    ds_read_b128 v[116:119], v14 offset:27840
    s_waitcnt lgkmcnt(15)
    v_mfma_f32_16x16x32_bf16 v[120:123], v[56:59], v[200:203], 0
    v_mfma_f32_16x16x32_bf16 v[124:127], v[56:59], v[216:219], 0
    s_waitcnt lgkmcnt(14)
    v_mfma_f32_16x16x32_bf16 v[120:123], v[60:63], v[204:207], v[120:123]
    v_mfma_f32_16x16x32_bf16 v[124:127], v[60:63], v[220:223], v[124:127]
    s_waitcnt lgkmcnt(13)
    v_mfma_f32_16x16x32_bf16 v[120:123], v[64:67], v[208:211], v[120:123]
    v_mfma_f32_16x16x32_bf16 v[124:127], v[64:67], v[224:227], v[124:127]
    s_waitcnt lgkmcnt(12)
    v_mfma_f32_16x16x32_bf16 v[120:123], v[68:71], v[212:215], v[120:123]
    v_mfma_f32_16x16x32_bf16 v[124:127], v[68:71], v[228:231], v[124:127]
    ds_read_b128 v[56:59], v14 offset:36864
    ds_read_b128 v[60:63], v14 offset:36928
    ds_read_b128 v[64:67], v14 offset:36992
    ds_read_b128 v[68:71], v14 offset:37056
    s_waitcnt lgkmcnt(15)
    v_mfma_f32_16x16x32_bf16 v[128:131], v[72:75], v[200:203], 0
    v_mfma_f32_16x16x32_bf16 v[132:135], v[72:75], v[216:219], 0
    s_waitcnt lgkmcnt(14)
    v_mfma_f32_16x16x32_bf16 v[128:131], v[76:79], v[204:207], v[128:131]
    v_mfma_f32_16x16x32_bf16 v[132:135], v[76:79], v[220:223], v[132:135]
    s_waitcnt lgkmcnt(13)
    v_mfma_f32_16x16x32_bf16 v[128:131], v[80:83], v[208:211], v[128:131]
    v_mfma_f32_16x16x32_bf16 v[132:135], v[80:83], v[224:227], v[132:135]
    s_waitcnt lgkmcnt(12)
    v_mfma_f32_16x16x32_bf16 v[128:131], v[84:87], v[212:215], v[128:131]
    v_mfma_f32_16x16x32_bf16 v[132:135], v[84:87], v[228:231], v[132:135]
    v_cvt_pk_bf16_f32 v136, v120, v121
    v_cvt_pk_bf16_f32 v137, v122, v123
    v_cvt_pk_bf16_f32 v138, v124, v125
    v_cvt_pk_bf16_f32 v139, v126, v127
    buffer_store_dwordx4 v[136:139], v13, s[32:35], s58 offen sc1
    s_add_u32 s58, s58, 8192
    s_waitcnt lgkmcnt(11)
    v_mfma_f32_16x16x32_bf16 v[120:123], v[88:91], v[200:203], 0
    v_mfma_f32_16x16x32_bf16 v[124:127], v[88:91], v[216:219], 0
    s_waitcnt lgkmcnt(10)
    v_mfma_f32_16x16x32_bf16 v[120:123], v[92:95], v[204:207], v[120:123]
    v_mfma_f32_16x16x32_bf16 v[124:127], v[92:95], v[220:223], v[124:127]
    s_waitcnt lgkmcnt(9)
    v_mfma_f32_16x16x32_bf16 v[120:123], v[96:99], v[208:211], v[120:123]
    v_mfma_f32_16x16x32_bf16 v[124:127], v[96:99], v[224:227], v[124:127]
    s_waitcnt lgkmcnt(8)
    v_mfma_f32_16x16x32_bf16 v[120:123], v[100:103], v[212:215], v[120:123]
    v_mfma_f32_16x16x32_bf16 v[124:127], v[100:103], v[228:231], v[124:127]
    v_cvt_pk_bf16_f32 v140, v128, v129
    v_cvt_pk_bf16_f32 v141, v130, v131
    v_cvt_pk_bf16_f32 v142, v132, v133
    v_cvt_pk_bf16_f32 v143, v134, v135
    buffer_store_dwordx4 v[140:143], v13, s[32:35], s58 offen sc1
    s_add_u32 s58, s58, 8192
    s_waitcnt lgkmcnt(7)
    v_mfma_f32_16x16x32_bf16 v[128:131], v[104:107], v[200:203], 0
    v_mfma_f32_16x16x32_bf16 v[132:135], v[104:107], v[216:219], 0
    s_waitcnt lgkmcnt(6)
    v_mfma_f32_16x16x32_bf16 v[128:131], v[108:111], v[204:207], v[128:131]
    v_mfma_f32_16x16x32_bf16 v[132:135], v[108:111], v[220:223], v[132:135]
    s_waitcnt lgkmcnt(5)
    v_mfma_f32_16x16x32_bf16 v[128:131], v[112:115], v[208:211], v[128:131]
    v_mfma_f32_16x16x32_bf16 v[132:135], v[112:115], v[224:227], v[132:135]
    s_waitcnt lgkmcnt(4)
    v_mfma_f32_16x16x32_bf16 v[128:131], v[116:119], v[212:215], v[128:131]
    v_mfma_f32_16x16x32_bf16 v[132:135], v[116:119], v[228:231], v[132:135]
    v_cvt_pk_bf16_f32 v136, v120, v121
    v_cvt_pk_bf16_f32 v137, v122, v123
    v_cvt_pk_bf16_f32 v138, v124, v125
    v_cvt_pk_bf16_f32 v139, v126, v127
    buffer_store_dwordx4 v[136:139], v13, s[32:35], s58 offen sc1
    s_add_u32 s58, s58, 8192
    s_waitcnt lgkmcnt(3)
    v_mfma_f32_16x16x32_bf16 v[120:123], v[56:59], v[200:203], 0
    v_mfma_f32_16x16x32_bf16 v[124:127], v[56:59], v[216:219], 0
    s_waitcnt lgkmcnt(2)
    v_mfma_f32_16x16x32_bf16 v[120:123], v[60:63], v[204:207], v[120:123]
    v_mfma_f32_16x16x32_bf16 v[124:127], v[60:63], v[220:223], v[124:127]
    s_waitcnt lgkmcnt(1)
    v_mfma_f32_16x16x32_bf16 v[120:123], v[64:67], v[208:211], v[120:123]
    v_mfma_f32_16x16x32_bf16 v[124:127], v[64:67], v[224:227], v[124:127]
    s_waitcnt lgkmcnt(0)
    v_mfma_f32_16x16x32_bf16 v[120:123], v[68:71], v[212:215], v[120:123]
    v_mfma_f32_16x16x32_bf16 v[124:127], v[68:71], v[228:231], v[124:127]
    v_cvt_pk_bf16_f32 v140, v128, v129
    v_cvt_pk_bf16_f32 v141, v130, v131
    v_cvt_pk_bf16_f32 v142, v132, v133
    v_cvt_pk_bf16_f32 v143, v134, v135
    buffer_store_dwordx4 v[140:143], v13, s[32:35], s58 offen sc1
    s_add_u32 s58, s58, 8192
    s_nop 0
    v_cvt_pk_bf16_f32 v136, v120, v121
    v_cvt_pk_bf16_f32 v137, v122, v123
    v_cvt_pk_bf16_f32 v138, v124, v125
    v_cvt_pk_bf16_f32 v139, v126, v127
    buffer_store_dwordx4 v[136:139], v13, s[32:35], s58 offen sc1
    s_or_b32 s56, s55, s3
    s_cmp_lg_u32 s56, 0
    s_cbranch_scc1 K_NOEPO
    v_mov_b32 v10, s52
    s_mov_b64 exec, 1
    buffer_store_dword v10, v4, s[36:39], 0 offen offset:0
K_NOEPO:
K_END:
    s_endpgm
.p2align 6
.type K_TAB,@object
K_TAB:
.byte 6, 5, 14, 7, 4, 2, 0, 1, 3, 12, 22, 11, 10, 8, 30, 9, 19, 13, 15, 17, 16, 21, 23, 20, 18, 25, 29, 28, 31, 27, 26, 24, 34, 32, 39, 33, 35, 36, 37, 38, 255, 255, 255, 255, 255, 255, 255, 255, 255, 255, 255, 255, 255, 255, 255, 255, 255, 255, 255, 255, 255, 255, 255, 255
.byte 3, 2, 4, 7, 0, 1, 6, 8, 5, 9, 15, 13, 14, 11, 12, 22, 21, 16, 10, 23, 17, 20, 30, 19, 18, 25, 27, 24, 29, 28, 26, 31, 34, 37, 36, 39, 33, 38, 32, 35, 255, 255, 255, 255, 255, 255, 255, 255, 255, 255, 255, 255, 255, 255, 255, 255, 255, 255, 255, 255, 255, 255, 255, 255
.section .rodata,"a"
.p2align 6
.amdhsa_kernel gather_scatter__tensor_product_equiv_tfn__graph_kernel
  .amdhsa_next_free_vgpr 256
  .amdhsa_next_free_sgpr 72
  .amdhsa_accum_offset 256
  .amdhsa_group_segment_fixed_size 0
  .amdhsa_kernarg_size 88
  .amdhsa_user_sgpr_count 2
  .amdhsa_user_sgpr_kernarg_segment_ptr 1
  .amdhsa_system_sgpr_workgroup_id_x 1
  .amdhsa_float_denorm_mode_32 3
.end_amdhsa_kernel
```
